```python
import torch

def _softmax(x, axis=-1):
    return torch.softmax(x, dim=axis)
def _gelu(x):
    return torch.nn.functional.gelu(x, approximate="tanh")
def _silu(x):
    return torch.nn.functional.silu(x)
def _sigmoid(x):
    return torch.sigmoid(x)
def _layernorm(x, axis=-1, eps=1e-5):
    m = x.mean(dim=axis, keepdim=True)
    v = x.var(dim=axis, keepdim=True, unbiased=False)
    return (x - m) / torch.sqrt(v + eps)
def _scatter_add(tgt, idx, src, axis=0):
    return tgt.clone().index_add_(axis, idx, src)
def _segment_sum(src, seg, n):
    out = torch.zeros((n,) + src.shape[1:], dtype=src.dtype)
    return out.index_add_(0, seg, src)
def _pad(x, pw):
    flat = tuple(v for pair in reversed(pw) for v in pair)
    return torch.nn.functional.pad(x, flat)

kernel_name = 'recurrent_scan__compressed_kv_cla__mixer_s_mlp__prompt'

def setup_inputs():

    _w = (lambda a: (lambda t: t.to(torch.bfloat16) if t.is_floating_point() else t)(torch.as_tensor(a)))
    def _A_setup():
        B, H, Sq, Sk, D, M = 1, 32, 2048, 2048, 128, 512
        Dc = 4 * D
        return {
            "x": _w((lambda *s: torch.randn(*s, dtype=torch.bfloat16) * 0.05)(B, Sq, M)),
            "c_kv": _w((lambda *s: torch.randn(*s, dtype=torch.bfloat16) * 0.2)(B, Sk, Dc)),
            "w_q": _w((lambda *s: torch.randn(*s, dtype=torch.bfloat16) * 3.2)(M, H, D) * (M ** -0.5)),
            "w_uk": _w((lambda *s: torch.randn(*s, dtype=torch.bfloat16) * 3.2)(Dc, H, D) * (Dc ** -0.5)),
            "w_uv": _w((lambda *s: torch.randn(*s, dtype=torch.bfloat16) * 0.2)(Dc, H, D) * (Dc ** -0.5)),
            "w_o": _w((lambda *s: torch.randn(*s, dtype=torch.bfloat16) * 0.2)(H, D, M) * ((H * D) ** -0.5)),
        }
    _A_in = _A_setup()

    def _B_setup():
        B, S, D, F = 1, 2048, 512, 1376
        return {
            "x":  _w((lambda *s: torch.randn(*s, dtype=torch.bfloat16) * 0.05)(B, S, D)),
            "w1": _w((lambda *s: torch.randn(*s, dtype=torch.bfloat16) * 3.2)(D, D) * (D ** -0.5)),
            "w2": _w((lambda *s: torch.randn(*s, dtype=torch.bfloat16) * 3.2)(D, D) * (D ** -0.5)),
            "w3": _w((lambda *s: torch.randn(*s, dtype=torch.bfloat16) * 3.2)(D, F) * (D ** -0.5)),
            "w4": _w((lambda *s: torch.randn(*s, dtype=torch.bfloat16) * 1.6)(F, D) * (F ** -0.5)),
        }
    _B_in = _B_setup()

    return {
        "A_x": _A_in["x"],
        "A_c_kv": _A_in["c_kv"],
        "A_w_q": _A_in["w_q"],
        "A_w_uk": _A_in["w_uk"],
        "A_w_uv": _A_in["w_uv"],
        "A_w_o": _A_in["w_o"],
        "B_x": _B_in["x"],
        "B_w1": _B_in["w1"],
        "B_w2": _B_in["w2"],
        "B_w3": _B_in["w3"],
        "B_w4": _B_in["w4"],
    }

def reference(A_x, A_c_kv, A_w_q, A_w_uk, A_w_uv, A_w_o, B_x, B_w1, B_w2, B_w3, B_w4):
    def _A_ref(x, c_kv, w_q, w_uk, w_uv, w_o):
        B, Sq, M = x.shape[0], x.shape[1], x.shape[2]
        Sk = c_kv.shape[1]
        H, D = w_q.shape[1], w_q.shape[2]
        q = torch.einsum("bqm,mhd->bhqd", x, w_q)
        k = torch.einsum("bkc,chd->bhkd", c_kv, w_uk)
        v = torch.einsum("bkc,chd->bhkd", c_kv, w_uv)
        scores = torch.einsum("bhqd,bhkd->bhqk", q, k) * (D ** -0.5)
        off = Sk - Sq
        qi = torch.arange(Sq)[:, None]
        kj = torch.arange(Sk)[None, :]
        cmask = kj <= (qi + off)
        scores = torch.where(cmask[None, None], scores, -1e9)
        p = _softmax(scores, axis=-1)
        ctx = torch.einsum("bhqk,bhkd->bhqd", p, v)
        return torch.einsum("bhqd,hdm->bqm", ctx, w_o)

    def _B_ref(x, w1, w2, w3, w4):
        B, S, D = x.shape
        h = _gelu(_layernorm(x, axis=-1) @ w1)
        c = D // 4
        g0 = _pad(h[:, :, 0*c:1*c], ((0, 0), (1, 0), (0, 0)))[:, :S, :]
        g1 = _pad(h[:, :, 1*c:2*c], ((0, 0), (0, 1), (0, 0)))[:, 1:, :]
        g2 = _pad(h[:, :, 2*c:3*c], ((0, 0), (2, 0), (0, 0)))[:, :S, :]
        g3 = _pad(h[:, :, 3*c:   ], ((0, 0), (0, 2), (0, 0)))[:, 2:, :]
        hs = torch.concatenate([g0, g1, g2, g3], axis=-1) @ w2
        x1 = x + hs
        h2 = _gelu(_layernorm(x1, axis=-1) @ w3) @ w4
        return x1 + h2

    x = A_x
    xn = _layernorm(x, axis=-1)
    s = _A_ref(xn, A_c_kv, A_w_q, A_w_uk, A_w_uv, A_w_o)
    g = _silu(_B_ref(xn, B_w1, B_w2, B_w3, B_w4))
    return x + s * g
```

```asm
; @launch kernel=kvattn_kernel grid=(256,1,1) block=(512,1,1) lds=163840
.amdgcn_target "amdgcn-amd-amdhsa--gfx950"
.text
.globl kvattn_kernel
.p2align 8
.type kvattn_kernel,@function
kvattn_kernel:
    s_cmp_ge_u32 s2, 256
    s_cbranch_scc1 F_EXIT
    s_load_dwordx2 s[4:5], s[0:1], 0
    s_load_dwordx2 s[6:7], s[0:1], 8
    s_load_dwordx2 s[8:9], s[0:1], 24
    s_load_dwordx2 s[10:11], s[0:1], 32
    s_load_dwordx2 s[12:13], s[0:1], 104
    s_load_dwordx2 s[52:53], s[0:1], 16
    s_load_dwordx2 s[54:55], s[0:1], 40
    s_load_dwordx2 s[56:57], s[0:1], 56
    s_load_dwordx2 s[58:59], s[0:1], 64
    s_load_dwordx2 s[60:61], s[0:1], 72
    s_load_dwordx2 s[62:63], s[0:1], 80
    v_and_b32 v1, 63, v0
    v_lshrrev_b32 v2, 6, v0
    s_nop 0
    v_readfirstlane_b32 s3, v2
    v_lshrrev_b32 v2, 1, v1
    v_lshlrev_b32 v2, 5, v2
    v_and_b32 v3, 1, v1
    v_lshlrev_b32 v3, 3, v3
    v_or_b32 v7, v2, v3
    s_lshl_b32 s46, s2, 3
    s_add_u32 s46, s46, s3
    s_lshl_b32 s46, s46, 10
    s_and_b32 s14, s2, 7
    s_lshr_b32 s15, s2, 3
    s_and_b32 s16, s15, 3
    s_lshl_b32 s36, s14, 2
    s_add_u32 s16, s16, s36
    s_lshr_b32 s17, s15, 2
    s_and_b32 s43, s3, 3
    s_lshl_b32 s38, s17, 18
    s_lshl_b32 s36, s3, 12
    s_add_u32 s38, s38, s36
    s_lshl_b32 s39, s16, 8
    s_lshl_b32 s36, s43, 17
    s_add_u32 s39, s39, s36
    s_lshl_b32 s40, s3, 10
    s_lshl_b32 s41, s3, 12
    v_lshrrev_b32 v3, 4, v1
    v_and_b32 v4, 15, v1
    s_lshl_b32 s36, s43, 2
    v_add_u32 v5, s36, v3
    v_xor_b32 v5, v5, v4
    v_lshlrev_b32 v5, 4, v5
    v_lshlrev_b32 v2, 10, v3
    v_or_b32 v36, v2, v5
    v_lshlrev_b32 v2, 13, v3
    v_lshlrev_b32 v3, 2, v3
    v_xor_b32 v4, v4, v3
    v_lshlrev_b32 v4, 4, v4
    v_or_b32 v37, v2, v4
    s_waitcnt lgkmcnt(0)
    s_mov_b32 s20, s4
    s_mov_b32 s21, s5
    s_mov_b32 s22, 0x200000
    s_mov_b32 s23, 0x00020000
    buffer_load_dwordx2 v[48:49], v7, s[20:23], s46 offen
    buffer_load_dwordx2 v[50:51], v7, s[20:23], s46 offen offset:16
    s_mov_b32 s28, s8
    s_mov_b32 s29, s9
    s_mov_b32 s30, 0x400000
    s_mov_b32 s31, 0x00020000
    s_cmp_ge_u32 s3, 4
    s_cselect_b32 s28, s10, s28
    s_cselect_b32 s29, s11, s29
    s_mov_b32 s24, s6
    s_mov_b32 s25, s7
    s_mov_b32 s26, 0x200000
    s_mov_b32 s27, 0x00020000
    s_add_u32 s100, s12, 0xe90000
    s_addc_u32 s101, s13, 0
    s_cmp_lg_u32 s2, 0
    s_cbranch_scc1 L1_NOZ
    v_mov_b32 v28, 0
    v_mov_b32 v29, 0
    v_mov_b32 v30, 0
    v_mov_b32 v31, 0
    v_lshlrev_b32 v24, 4, v1
    v_add_u32 v24, s40, v24
    global_store_dwordx4 v24, v[28:31], s[100:101] sc1
    v_add_u32 v25, 8192, v24
    global_store_dwordx4 v25, v[28:31], s[100:101] sc1
L1_NOZ:
    s_add_u32 m0, s41, 65536
    s_add_u32 s36, s39, 0
    buffer_load_dwordx4 v37, s[28:31], s36 offen offset:0 lds
    s_add_u32 s36, s39, 31744
    buffer_load_dwordx4 v37, s[28:31], s36 offen offset:1024 lds
    s_add_u32 s36, s39, 63488
    buffer_load_dwordx4 v37, s[28:31], s36 offen offset:2048 lds
    s_add_u32 s36, s39, 95232
    buffer_load_dwordx4 v37, s[28:31], s36 offen offset:3072 lds
    s_add_u32 m0, s40, 0
    s_add_u32 s36, s38, 0
    buffer_load_dwordx4 v36, s[24:27], s36 offen lds
    s_add_u32 m0, s40, 32768
    s_add_u32 s36, s38, 32768
    buffer_load_dwordx4 v36, s[24:27], s36 offen lds
    s_add_u32 m0, s41, 98304
    s_add_u32 s36, s39, 524288
    buffer_load_dwordx4 v37, s[28:31], s36 offen offset:0 lds
    s_add_u32 s36, s39, 556032
    buffer_load_dwordx4 v37, s[28:31], s36 offen offset:1024 lds
    s_add_u32 s36, s39, 587776
    buffer_load_dwordx4 v37, s[28:31], s36 offen offset:2048 lds
    s_add_u32 s36, s39, 619520
    buffer_load_dwordx4 v37, s[28:31], s36 offen offset:3072 lds
    v_lshrrev_b32 v2, 1, v1
    v_lshlrev_b32 v2, 13, v2
    v_and_b32 v3, 1, v1
    v_lshlrev_b32 v3, 7, v3
    v_or_b32 v2, v2, v3
    s_lshl_b32 s36, s17, 19
    s_and_b32 s37, s3, 1
    s_lshl_b32 s37, s37, 18
    s_add_u32 s36, s36, s37
    s_lshl_b32 s37, s16, 8
    s_add_u32 s36, s36, s37
    s_and_b32 s37, s3, 2
    s_lshl_b32 s37, s37, 29
    s_add_u32 s36, s36, s37
    buffer_load_dword v112, v2, s[28:31], s36 offen
    s_add_u32 m0, s41, 131072
    s_add_u32 s36, s39, 1048576
    buffer_load_dwordx4 v37, s[28:31], s36 offen offset:0 lds
    s_add_u32 s36, s39, 1080320
    buffer_load_dwordx4 v37, s[28:31], s36 offen offset:1024 lds
    s_add_u32 s36, s39, 1112064
    buffer_load_dwordx4 v37, s[28:31], s36 offen offset:2048 lds
    s_add_u32 s36, s39, 1143808
    buffer_load_dwordx4 v37, s[28:31], s36 offen offset:3072 lds
    s_add_u32 m0, s40, 8192
    s_add_u32 s36, s38, 256
    buffer_load_dwordx4 v36, s[24:27], s36 offen lds
    s_add_u32 m0, s40, 40960
    s_add_u32 s36, s38, 33024
    buffer_load_dwordx4 v36, s[24:27], s36 offen lds
    s_load_dwordx2 s[6:7], s[0:1], 96
    s_mov_b32 s77, 8
    s_mov_b32 s18, 0x3727c5ac
    s_mov_b32 s19, 0x3b000000
    s_lshl_b32 s42, s16, 5
    s_lshl_b32 s36, s17, 2
    s_add_u32 s42, s42, s36
    s_lshl_b32 s42, s42, 15
    s_add_u32 s42, s42, 16777216
    s_lshl_b32 s36, s43, 11
    s_lshl_b32 s37, s43, 12
    s_add_u32 s37, s37, 16384
    s_cmp_ge_u32 s3, 4
    s_cselect_b32 s36, s37, s36
    s_add_u32 s42, s42, s36
    v_and_b32 v2, 31, v1
    v_lshrrev_b32 v3, 5, v1
    v_and_b32 v4, 15, v2
    v_xor_b32 v4, v4, v3
    v_lshlrev_b32 v4, 4, v4
    v_lshlrev_b32 v2, 8, v2
    v_or_b32 v40, v2, v4
    v_lshrrev_b32 v2, 2, v1
    v_and_b32 v2, 3, v2
    v_lshlrev_b32 v4, 3, v3
    v_add_u32 v4, v4, v2
    v_lshlrev_b32 v4, 8, v4
    v_lshrrev_b32 v5, 4, v1
    v_and_b32 v5, 1, v5
    v_lshlrev_b32 v5, 5, v5
    v_and_b32 v6, 3, v1
    v_lshlrev_b32 v6, 3, v6
    v_or_b32 v4, v4, v5
    v_or_b32 v4, v4, v6
    s_lshr_b32 s36, s3, 2
    s_lshl_b32 s36, s36, 14
    s_add_u32 s36, s36, 65536
    v_add_u32 v4, s36, v4
    v_xor_b32 v5, s43, v2
    v_lshlrev_b32 v5, 6, v5
    v_or_b32 v38, v4, v5
    v_add_u32 v39, 0x10000, v38
    v_lshlrev_b32 v41, 4, v1
    s_lshr_b32 s45, s2, 2
    s_lshl_b32 s45, s45, 15
    s_and_b32 s37, s2, 3
    s_lshl_b32 s37, s37, 7
    s_add_u32 s45, s45, s37
    s_lshl_b32 s37, s3, 12
    s_add_u32 s45, s45, s37
    s_add_u32 s45, s45, 0
    s_mov_b32 s32, s12
    s_mov_b32 s33, s13
    s_mov_b32 s34, 0x10000000
    s_mov_b32 s35, 0x00020000
    s_mov_b32 s48, s52
    s_mov_b32 s49, s53
    s_mov_b32 s50, 0x400000
    s_mov_b32 s51, 0x00020000
    s_lshl_b32 s47, s17, 19
    s_and_b32 s36, s3, 1
    s_lshl_b32 s36, s36, 18
    s_add_u32 s47, s47, s36
    s_lshl_b32 s36, s16, 8
    s_add_u32 s47, s47, s36
    s_cmp_ge_u32 s3, 2
    s_cselect_b32 s36, 0x40000000, 0
    s_add_u32 s47, s47, s36
    v_lshrrev_b32 v2, 1, v1
    v_lshlrev_b32 v2, 13, v2
    v_and_b32 v4, 1, v1
    v_lshlrev_b32 v4, 7, v4
    v_or_b32 v0, v2, v4
    s_lshl_b32 s36, s2, 3
    s_add_u32 s36, s36, s3
    s_mov_b32 s64, s56
    s_mov_b32 s65, s57
    s_mov_b32 s66, 0x80000
    s_mov_b32 s67, 0x00020000
    s_mov_b32 s68, s60
    s_mov_b32 s69, s61
    s_mov_b32 s70, 0x158000
    s_mov_b32 s71, 0x00020000
    s_mov_b32 s76, 1024
    s_mov_b32 s37, s36
    s_cmp_ge_u32 s36, 512
    s_cselect_b32 s64, s58, s64
    s_cselect_b32 s65, s59, s65
    s_cselect_b32 s72, 512, 0
    s_cmp_ge_u32 s36, 1024
    s_cselect_b32 s64, s60, s64
    s_cselect_b32 s65, s61, s65
    s_cselect_b32 s66, 0x158000, s66
    s_cselect_b32 s72, 1024, s72
    s_cselect_b32 s76, 2752, s76
    s_sub_u32 s37, s37, s72
    s_and_b32 s72, s37, 31
    s_mul_i32 s72, s72, s76
    s_lshl_b32 s72, s72, 4
    s_lshr_b32 s37, s37, 5
    s_lshl_b32 s37, s37, 6
    s_add_u32 s72, s72, s37
    s_and_b32 s73, s36, 31
    s_mul_i32 s73, s73, 44032
    s_lshr_b32 s37, s36, 5
    s_lshl_b32 s37, s37, 6
    s_add_u32 s73, s73, s37
    s_add_u32 s73, s73, 2048
    s_lshl_b32 s74, s36, 10
    s_add_u32 s74, s74, 12582912
    s_add_u32 s75, s74, 2097152
    v_lshrrev_b32 v2, 2, v1
    v_and_b32 v3, 3, v1
    v_lshlrev_b32 v3, 4, v3
    v_mad_u32_u24 v26, v2, s76, v3
    v_mul_u32_u24 v27, 2752, v2
    v_add_u32 v27, v27, v3
    s_cmp_ge_u32 s36, 352
    s_cselect_b32 s36, 0x40000000, 0
    v_or_b32 v27, s36, v27
    s_lshl_b32 s76, s16, 5
    s_add_u32 s76, s76, s17
    s_lshl_b32 s76, s76, 2
    s_add_u32 s76, s76, 2048
    s_mov_b32 s56, s12
    s_mov_b32 s57, s13
    s_mov_b32 s58, 0x10000000
    s_mov_b32 s59, 0x00020000
    s_mov_b32 s60, s12
    s_mov_b32 s61, s13
    s_mov_b32 s62, 0x10000000
    s_mov_b32 s63, 0x00020000
    s_waitcnt vmcnt(17)
    v_lshlrev_b32 v8, 16, v48
    v_and_b32 v9, 0xffff0000, v48
    v_lshlrev_b32 v10, 16, v49
    v_and_b32 v11, 0xffff0000, v49
    v_lshlrev_b32 v12, 16, v50
    v_and_b32 v13, 0xffff0000, v50
    v_lshlrev_b32 v14, 16, v51
    v_and_b32 v15, 0xffff0000, v51
    v_add_f32 v16, v8, v9
    v_add_f32 v17, v10, v11
    v_add_f32 v18, v12, v13
    v_add_f32 v19, v14, v15
    v_add_f32 v16, v16, v17
    v_add_f32 v18, v18, v19
    v_add_f32 v16, v16, v18
    s_nop 1
    v_add_f32_dpp v16, v16, v16 row_shr:1 row_mask:0xf bank_mask:0xf bound_ctrl:0
    s_nop 1
    v_add_f32_dpp v16, v16, v16 row_shr:2 row_mask:0xf bank_mask:0xf bound_ctrl:0
    s_nop 1
    v_add_f32_dpp v16, v16, v16 row_shr:4 row_mask:0xf bank_mask:0xf bound_ctrl:0
    s_nop 1
    v_add_f32_dpp v16, v16, v16 row_shr:8 row_mask:0xf bank_mask:0xf bound_ctrl:0
    s_nop 1
    v_add_f32_dpp v16, v16, v16 row_bcast:15 row_mask:0xa bank_mask:0xf
    s_nop 1
    v_add_f32_dpp v16, v16, v16 row_bcast:31 row_mask:0xc bank_mask:0xf
    s_nop 0
    v_readlane_b32 s44, v16, 63
    v_mov_b32 v24, s19
    s_nop 0
    v_mul_f32 v24, s44, v24
    v_sub_f32 v16, v8, v24
    v_sub_f32 v17, v9, v24
    v_sub_f32 v18, v10, v24
    v_sub_f32 v19, v11, v24
    v_sub_f32 v20, v12, v24
    v_sub_f32 v21, v13, v24
    v_sub_f32 v22, v14, v24
    v_sub_f32 v23, v15, v24
    v_mul_f32 v25, v16, v16
    v_fmac_f32 v25, v17, v17
    v_fmac_f32 v25, v18, v18
    v_fmac_f32 v25, v19, v19
    v_fmac_f32 v25, v20, v20
    v_fmac_f32 v25, v21, v21
    v_fmac_f32 v25, v22, v22
    v_fmac_f32 v25, v23, v23
    s_nop 1
    v_add_f32_dpp v25, v25, v25 row_shr:1 row_mask:0xf bank_mask:0xf bound_ctrl:0
    s_nop 1
    v_add_f32_dpp v25, v25, v25 row_shr:2 row_mask:0xf bank_mask:0xf bound_ctrl:0
    s_nop 1
    v_add_f32_dpp v25, v25, v25 row_shr:4 row_mask:0xf bank_mask:0xf bound_ctrl:0
    s_nop 1
    v_add_f32_dpp v25, v25, v25 row_shr:8 row_mask:0xf bank_mask:0xf bound_ctrl:0
    s_nop 1
    v_add_f32_dpp v25, v25, v25 row_bcast:15 row_mask:0xa bank_mask:0xf
    s_nop 1
    v_add_f32_dpp v25, v25, v25 row_bcast:31 row_mask:0xc bank_mask:0xf
    s_nop 0
    v_readlane_b32 s44, v25, 63
    v_mov_b32 v25, s19
    s_nop 0
    v_mul_f32 v25, s44, v25
    v_cvt_pk_bf16_f32 v24, v24, v24
    v_and_b32 v24, 0xffff0000, v24
    v_cvt_pk_bf16_f32 v25, v25, v25
    v_and_b32 v25, 0xffff0000, v25
    v_add_f32 v25, s18, v25
    v_cvt_pk_bf16_f32 v25, v25, v25
    v_and_b32 v25, 0xffff0000, v25
    v_sqrt_f32 v25, v25
    s_nop 0
    v_cvt_pk_bf16_f32 v25, v25, v25
    v_and_b32 v25, 0xffff0000, v25
    v_rcp_f32 v25, v25
    v_sub_f32 v16, v8, v24
    v_sub_f32 v17, v9, v24
    v_sub_f32 v18, v10, v24
    v_sub_f32 v19, v11, v24
    v_sub_f32 v20, v12, v24
    v_sub_f32 v21, v13, v24
    v_sub_f32 v22, v14, v24
    v_sub_f32 v23, v15, v24
    v_cvt_pk_bf16_f32 v28, v16, v17
    v_cvt_pk_bf16_f32 v29, v18, v19
    v_cvt_pk_bf16_f32 v30, v20, v21
    v_cvt_pk_bf16_f32 v31, v22, v23
    v_lshlrev_b32 v16, 16, v28
    v_and_b32 v17, 0xffff0000, v28
    v_lshlrev_b32 v18, 16, v29
    v_and_b32 v19, 0xffff0000, v29
    v_lshlrev_b32 v20, 16, v30
    v_and_b32 v21, 0xffff0000, v30
    v_lshlrev_b32 v22, 16, v31
    v_and_b32 v23, 0xffff0000, v31
    v_mul_f32 v16, v16, v25
    v_mul_f32 v17, v17, v25
    v_mul_f32 v18, v18, v25
    v_mul_f32 v19, v19, v25
    v_mul_f32 v20, v20, v25
    v_mul_f32 v21, v21, v25
    v_mul_f32 v22, v22, v25
    v_mul_f32 v23, v23, v25
    v_cvt_pk_bf16_f32 v28, v16, v17
    v_cvt_pk_bf16_f32 v29, v18, v19
    v_cvt_pk_bf16_f32 v30, v20, v21
    v_cvt_pk_bf16_f32 v31, v22, v23
    v_lshlrev_b32 v8, 16, v28
    v_and_b32 v9, 0xffff0000, v28
    v_lshlrev_b32 v10, 16, v29
    v_and_b32 v11, 0xffff0000, v29
    v_lshlrev_b32 v12, 16, v30
    v_and_b32 v13, 0xffff0000, v30
    v_lshlrev_b32 v14, 16, v31
    v_and_b32 v15, 0xffff0000, v31
    v_add_f32 v16, v8, v9
    v_add_f32 v17, v10, v11
    v_add_f32 v18, v12, v13
    v_add_f32 v19, v14, v15
    v_add_f32 v16, v16, v17
    v_add_f32 v18, v18, v19
    v_add_f32 v16, v16, v18
    s_nop 1
    v_add_f32_dpp v16, v16, v16 row_shr:1 row_mask:0xf bank_mask:0xf bound_ctrl:0
    s_nop 1
    v_add_f32_dpp v16, v16, v16 row_shr:2 row_mask:0xf bank_mask:0xf bound_ctrl:0
    s_nop 1
    v_add_f32_dpp v16, v16, v16 row_shr:4 row_mask:0xf bank_mask:0xf bound_ctrl:0
    s_nop 1
    v_add_f32_dpp v16, v16, v16 row_shr:8 row_mask:0xf bank_mask:0xf bound_ctrl:0
    s_nop 1
    v_add_f32_dpp v16, v16, v16 row_bcast:15 row_mask:0xa bank_mask:0xf
    s_nop 1
    v_add_f32_dpp v16, v16, v16 row_bcast:31 row_mask:0xc bank_mask:0xf
    s_nop 0
    v_readlane_b32 s44, v16, 63
    v_mov_b32 v24, s19
    s_nop 0
    v_mul_f32 v24, s44, v24
    v_sub_f32 v16, v8, v24
    v_sub_f32 v17, v9, v24
    v_sub_f32 v18, v10, v24
    v_sub_f32 v19, v11, v24
    v_sub_f32 v20, v12, v24
    v_sub_f32 v21, v13, v24
    v_sub_f32 v22, v14, v24
    v_sub_f32 v23, v15, v24
    v_mul_f32 v25, v16, v16
    v_fmac_f32 v25, v17, v17
    v_fmac_f32 v25, v18, v18
    v_fmac_f32 v25, v19, v19
    v_fmac_f32 v25, v20, v20
    v_fmac_f32 v25, v21, v21
    v_fmac_f32 v25, v22, v22
    v_fmac_f32 v25, v23, v23
    s_nop 1
    v_add_f32_dpp v25, v25, v25 row_shr:1 row_mask:0xf bank_mask:0xf bound_ctrl:0
    s_nop 1
    v_add_f32_dpp v25, v25, v25 row_shr:2 row_mask:0xf bank_mask:0xf bound_ctrl:0
    s_nop 1
    v_add_f32_dpp v25, v25, v25 row_shr:4 row_mask:0xf bank_mask:0xf bound_ctrl:0
    s_nop 1
    v_add_f32_dpp v25, v25, v25 row_shr:8 row_mask:0xf bank_mask:0xf bound_ctrl:0
    s_nop 1
    v_add_f32_dpp v25, v25, v25 row_bcast:15 row_mask:0xa bank_mask:0xf
    s_nop 1
    v_add_f32_dpp v25, v25, v25 row_bcast:31 row_mask:0xc bank_mask:0xf
    s_nop 0
    v_readlane_b32 s44, v25, 63
    v_mov_b32 v25, s19
    s_nop 0
    v_mul_f32 v25, s44, v25
    v_cvt_pk_bf16_f32 v24, v24, v24
    v_and_b32 v24, 0xffff0000, v24
    v_cvt_pk_bf16_f32 v25, v25, v25
    v_and_b32 v25, 0xffff0000, v25
    v_add_f32 v25, s18, v25
    v_cvt_pk_bf16_f32 v25, v25, v25
    v_and_b32 v25, 0xffff0000, v25
    v_sqrt_f32 v25, v25
    s_nop 0
    v_cvt_pk_bf16_f32 v25, v25, v25
    v_and_b32 v25, 0xffff0000, v25
    v_rcp_f32 v25, v25
    v_sub_f32 v16, v8, v24
    v_sub_f32 v17, v9, v24
    v_sub_f32 v18, v10, v24
    v_sub_f32 v19, v11, v24
    v_sub_f32 v20, v12, v24
    v_sub_f32 v21, v13, v24
    v_sub_f32 v22, v14, v24
    v_sub_f32 v23, v15, v24
    v_cvt_pk_bf16_f32 v32, v16, v17
    v_cvt_pk_bf16_f32 v33, v18, v19
    v_cvt_pk_bf16_f32 v34, v20, v21
    v_cvt_pk_bf16_f32 v35, v22, v23
    v_lshlrev_b32 v16, 16, v32
    v_and_b32 v17, 0xffff0000, v32
    v_lshlrev_b32 v18, 16, v33
    v_and_b32 v19, 0xffff0000, v33
    v_lshlrev_b32 v20, 16, v34
    v_and_b32 v21, 0xffff0000, v34
    v_lshlrev_b32 v22, 16, v35
    v_and_b32 v23, 0xffff0000, v35
    v_mul_f32 v16, v16, v25
    v_mul_f32 v17, v17, v25
    v_mul_f32 v18, v18, v25
    v_mul_f32 v19, v19, v25
    v_mul_f32 v20, v20, v25
    v_mul_f32 v21, v21, v25
    v_mul_f32 v22, v22, v25
    v_mul_f32 v23, v23, v25
    v_cvt_pk_bf16_f32 v32, v16, v17
    v_cvt_pk_bf16_f32 v33, v18, v19
    v_cvt_pk_bf16_f32 v34, v20, v21
    v_cvt_pk_bf16_f32 v35, v22, v23
    v_add_u32 v7, s3, v1
    v_and_b32 v7, 7, v7
    v_lshlrev_b32 v7, 4, v7
    v_lshlrev_b32 v6, 7, v1
    s_mov_b32 s36, 24576
    v_add3_u32 v6, v6, v7, s36
    ds_write_b128 v6, v[28:31]
    ds_write_b128 v6, v[32:35] offset:32768
    s_cmp_ge_u32 s3, 4
    s_cbranch_scc1 L1_V
    v_add_u32 v42, 0, v40
    v_add_u32 v43, 32768, v40
    s_waitcnt lgkmcnt(0)
    s_waitcnt vmcnt(11)
    s_barrier
    s_mov_b32 s5, 32768
    s_cmp_lg_u32 s2, 0
    s_cbranch_scc1 L1_NOCLR
    s_cmp_lg_u32 s3, 0
    s_cbranch_scc1 L1_NOCLR
    v_mov_b32 v4, 0
    v_mov_b32 v5, 1
    s_mov_b64 exec, 1
    global_store_dword v4, v5, s[6:7] sc1
    s_mov_b64 exec, -1
L1_NOCLR:
    ds_read_b64_tr_b16 v[128:129], v38 offset:0
    ds_read_b64_tr_b16 v[130:131], v38 offset:1024
    ds_read_b64_tr_b16 v[132:133], v38 offset:4096
    ds_read_b64_tr_b16 v[134:135], v38 offset:5120
    ds_read_b64_tr_b16 v[136:137], v38 offset:8192
    ds_read_b64_tr_b16 v[138:139], v38 offset:9216
    ds_read_b64_tr_b16 v[140:141], v38 offset:12288
    ds_read_b64_tr_b16 v[142:143], v38 offset:13312
    ds_read_b128 v[56:59], v42 offset:0
    ds_read_b128 v[60:63], v43 offset:0
    v_xor_b32 v47, 32, v42
    ds_read_b128 v[64:67], v47 offset:0
    v_xor_b32 v45, 32, v43
    ds_read_b128 v[68:71], v45 offset:0
    v_lshrrev_b32 v6, 3, v1
    v_add_u32 v7, v6, v1
    v_and_b32 v7, 7, v7
    v_lshlrev_b32 v7, 4, v7
    v_lshlrev_b32 v6, 7, v6
    s_lshl_b32 s36, s3, 10
    s_add_u32 s36, s36, 24576
    v_add3_u32 v6, v6, v7, s36
    ds_read_b128 v[28:31], v6
    ds_read_b128 v[32:35], v6 offset:32768
    v_lshrrev_b32 v6, 4, v1
    v_lshlrev_b32 v6, 10, v6
    v_bfe_u32 v7, v1, 3, 1
    v_lshlrev_b32 v7, 9, v7
    v_or_b32 v6, v6, v7
    v_and_b32 v7, 7, v1
    v_lshlrev_b32 v7, 4, v7
    v_or_b32 v6, v6, v7
    s_waitcnt lgkmcnt(6)
    s_waitcnt lgkmcnt(5)
    v_mfma_f32_32x32x16_bf16 v[80:95], v[128:131], v[56:59], 0
    v_xor_b32 v46, 64, v42
    ds_read_b128 v[72:75], v46 offset:0
    s_waitcnt lgkmcnt(5)
    v_mfma_f32_32x32x16_bf16 v[96:111], v[128:131], v[60:63], 0
    v_xor_b32 v47, 64, v43
    ds_read_b128 v[76:79], v47 offset:0
    s_waitcnt lgkmcnt(2)
    buffer_store_dwordx4 v[28:31], v6, s[32:35], s45 offen sc1
    s_add_u32 s45, s45, 2097152
    buffer_store_dwordx4 v[32:35], v6, s[32:35], s45 offen sc1
    s_waitcnt lgkmcnt(5)
    v_mfma_f32_32x32x16_bf16 v[80:95], v[132:135], v[64:67], v[80:95]
    v_xor_b32 v45, 96, v42
    ds_read_b128 v[56:59], v45 offset:0
    s_waitcnt lgkmcnt(5)
    v_mfma_f32_32x32x16_bf16 v[96:111], v[132:135], v[68:71], v[96:111]
    v_xor_b32 v46, 96, v43
    ds_read_b128 v[60:63], v46 offset:0
    s_waitcnt vmcnt(9)
    s_barrier
    s_add_u32 m0, s41, 65536
    s_add_u32 s36, s39, 1572864
    buffer_load_dwordx4 v37, s[28:31], s36 offen offset:0 lds
    s_add_u32 s36, s39, 1604608
    buffer_load_dwordx4 v37, s[28:31], s36 offen offset:1024 lds
    s_add_u32 s36, s39, 1636352
    buffer_load_dwordx4 v37, s[28:31], s36 offen offset:2048 lds
    s_add_u32 s36, s39, 1668096
    buffer_load_dwordx4 v37, s[28:31], s36 offen offset:3072 lds
    ds_read_b64_tr_b16 v[144:145], v38 offset:32768
    ds_read_b64_tr_b16 v[146:147], v38 offset:33792
    ds_read_b64_tr_b16 v[148:149], v38 offset:36864
    ds_read_b64_tr_b16 v[150:151], v38 offset:37888
    ds_read_b64_tr_b16 v[152:153], v38 offset:40960
    ds_read_b64_tr_b16 v[154:155], v38 offset:41984
    ds_read_b64_tr_b16 v[156:157], v38 offset:45056
    ds_read_b64_tr_b16 v[158:159], v38 offset:46080
    s_waitcnt lgkmcnt(11)
    v_mfma_f32_32x32x16_bf16 v[80:95], v[136:139], v[72:75], v[80:95]
    v_xor_b32 v47, 128, v42
    ds_read_b128 v[64:67], v47 offset:0
    s_waitcnt lgkmcnt(11)
    v_mfma_f32_32x32x16_bf16 v[96:111], v[136:139], v[76:79], v[96:111]
    v_xor_b32 v45, 128, v43
    ds_read_b128 v[68:71], v45 offset:0
    s_waitcnt vmcnt(23)
    s_waitcnt lgkmcnt(11)
    v_mfma_f32_32x32x16_bf16 v[80:95], v[140:143], v[56:59], v[80:95]
    v_xor_b32 v46, 160, v42
    ds_read_b128 v[72:75], v46 offset:0
    s_waitcnt lgkmcnt(11)
    v_mfma_f32_32x32x16_bf16 v[96:111], v[140:143], v[60:63], v[96:111]
    v_xor_b32 v47, 160, v43
    ds_read_b128 v[76:79], v47 offset:0
    s_waitcnt lgkmcnt(4)
    s_waitcnt lgkmcnt(3)
    v_mfma_f32_32x32x16_bf16 v[80:95], v[144:147], v[64:67], v[80:95]
    v_xor_b32 v45, 192, v42
    ds_read_b128 v[56:59], v45 offset:0
    s_waitcnt lgkmcnt(3)
    v_mfma_f32_32x32x16_bf16 v[96:111], v[144:147], v[68:71], v[96:111]
    v_xor_b32 v46, 192, v43
    ds_read_b128 v[60:63], v46 offset:0
    s_waitcnt lgkmcnt(3)
    v_mfma_f32_32x32x16_bf16 v[80:95], v[148:151], v[72:75], v[80:95]
    v_xor_b32 v47, 224, v42
    ds_read_b128 v[64:67], v47 offset:0
    s_waitcnt lgkmcnt(3)
    v_mfma_f32_32x32x16_bf16 v[96:111], v[148:151], v[76:79], v[96:111]
    v_xor_b32 v45, 224, v43
    ds_read_b128 v[68:71], v45 offset:0
    s_waitcnt vmcnt(6)
    s_barrier
    s_cmp_lg_u32 s3, 0
    s_cbranch_scc1 L1_NOCP
    v_mov_b32 v4, 0
    global_load_dword v5, v4, s[6:7] sc1
L1_NOCP:
    s_add_u32 m0, s41, 98304
    s_add_u32 s36, s39, 2097152
    buffer_load_dwordx4 v37, s[28:31], s36 offen offset:0 lds
    s_add_u32 s36, s39, 2128896
    buffer_load_dwordx4 v37, s[28:31], s36 offen offset:1024 lds
    s_add_u32 s36, s39, 2160640
    buffer_load_dwordx4 v37, s[28:31], s36 offen offset:2048 lds
    s_add_u32 s36, s39, 2192384
    buffer_load_dwordx4 v37, s[28:31], s36 offen offset:3072 lds
    ds_read_b64_tr_b16 v[160:161], v39 offset:0
    ds_read_b64_tr_b16 v[162:163], v39 offset:1024
    ds_read_b64_tr_b16 v[164:165], v39 offset:4096
    ds_read_b64_tr_b16 v[166:167], v39 offset:5120
    ds_read_b64_tr_b16 v[168:169], v39 offset:8192
    ds_read_b64_tr_b16 v[170:171], v39 offset:9216
    ds_read_b64_tr_b16 v[172:173], v39 offset:12288
    ds_read_b64_tr_b16 v[174:175], v39 offset:13312
    s_waitcnt lgkmcnt(11)
    v_mfma_f32_32x32x16_bf16 v[80:95], v[152:155], v[56:59], v[80:95]
    ds_read_b128 v[72:75], v42 offset:8192
    s_add_u32 m0, s40, 16384
    s_add_u32 s36, s38, 512
    buffer_load_dwordx4 v36, s[24:27], s36 offen lds
    s_waitcnt lgkmcnt(11)
    v_mfma_f32_32x32x16_bf16 v[96:111], v[152:155], v[60:63], v[96:111]
    ds_read_b128 v[76:79], v43 offset:8192
    s_add_u32 m0, s40, 49152
    s_add_u32 s36, s38, 33280
    buffer_load_dwordx4 v36, s[24:27], s36 offen lds
    s_waitcnt lgkmcnt(11)
    v_mfma_f32_32x32x16_bf16 v[80:95], v[156:159], v[64:67], v[80:95]
    v_xor_b32 v45, 32, v42
    ds_read_b128 v[56:59], v45 offset:8192
    s_waitcnt lgkmcnt(11)
    v_mfma_f32_32x32x16_bf16 v[96:111], v[156:159], v[68:71], v[96:111]
    v_xor_b32 v46, 32, v43
    ds_read_b128 v[60:63], v46 offset:8192
    s_waitcnt lgkmcnt(4)
    s_waitcnt lgkmcnt(3)
    v_mfma_f32_32x32x16_bf16 v[80:95], v[160:163], v[72:75], v[80:95]
    v_xor_b32 v47, 64, v42
    ds_read_b128 v[64:67], v47 offset:8192
    s_waitcnt lgkmcnt(3)
    v_mfma_f32_32x32x16_bf16 v[96:111], v[160:163], v[76:79], v[96:111]
    v_xor_b32 v45, 64, v43
    ds_read_b128 v[68:71], v45 offset:8192
    s_waitcnt lgkmcnt(3)
    v_mfma_f32_32x32x16_bf16 v[80:95], v[164:167], v[56:59], v[80:95]
    v_xor_b32 v46, 96, v42
    ds_read_b128 v[72:75], v46 offset:8192
    s_waitcnt lgkmcnt(3)
    v_mfma_f32_32x32x16_bf16 v[96:111], v[164:167], v[60:63], v[96:111]
    v_xor_b32 v47, 96, v43
    ds_read_b128 v[76:79], v47 offset:8192
    s_cmp_lg_u32 s3, 0
    s_cbranch_scc1 L1_NOREG
    s_waitcnt vmcnt(6)
    v_cmp_eq_u32 vcc, 0, v5
    s_cbranch_vccnz L1_CSLOW
L1_COK:
L1_NOREG:
    s_waitcnt vmcnt(6)
    s_barrier
    s_lshr_b32 s36, s2, 4
    s_lshl_b32 s36, s36, 5
    s_and_b32 s37, s2, 15
    s_add_u32 s36, s36, s37
    s_lshl_b32 s36, s36, 2
    s_add_u32 s36, s36, 0
    s_cmp_lg_u32 s3, 0
    s_cbranch_scc1 L1_XEV0
    v_mov_b32 v2, s36
    v_mov_b32 v3, s77
    s_mov_b64 exec, 1
    global_store_dword v2, v3, s[100:101] sc1
    s_mov_b64 exec, -1
L1_XEV0:
    s_add_u32 m0, s41, 131072
    s_add_u32 s36, s39, 2621440
    buffer_load_dwordx4 v37, s[28:31], s36 offen offset:0 lds
    s_add_u32 s36, s39, 2653184
    buffer_load_dwordx4 v37, s[28:31], s36 offen offset:1024 lds
    s_add_u32 s36, s39, 2684928
    buffer_load_dwordx4 v37, s[28:31], s36 offen offset:2048 lds
    s_add_u32 s36, s39, 2716672
    buffer_load_dwordx4 v37, s[28:31], s36 offen offset:3072 lds
    ds_read_b64_tr_b16 v[176:177], v38 offset:0
    ds_read_b64_tr_b16 v[178:179], v38 offset:1024
    ds_read_b64_tr_b16 v[180:181], v38 offset:4096
    ds_read_b64_tr_b16 v[182:183], v38 offset:5120
    ds_read_b64_tr_b16 v[184:185], v38 offset:8192
    ds_read_b64_tr_b16 v[186:187], v38 offset:9216
    ds_read_b64_tr_b16 v[188:189], v38 offset:12288
    ds_read_b64_tr_b16 v[190:191], v38 offset:13312
    s_waitcnt lgkmcnt(11)
    v_mfma_f32_32x32x16_bf16 v[80:95], v[168:171], v[64:67], v[80:95]
    v_xor_b32 v45, 128, v42
    ds_read_b128 v[56:59], v45 offset:8192
    s_waitcnt lgkmcnt(11)
    v_mfma_f32_32x32x16_bf16 v[96:111], v[168:171], v[68:71], v[96:111]
    v_xor_b32 v46, 128, v43
    ds_read_b128 v[60:63], v46 offset:8192
    s_waitcnt lgkmcnt(11)
    v_mfma_f32_32x32x16_bf16 v[80:95], v[172:175], v[72:75], v[80:95]
    v_xor_b32 v47, 160, v42
    ds_read_b128 v[64:67], v47 offset:8192
    s_waitcnt lgkmcnt(11)
    v_mfma_f32_32x32x16_bf16 v[96:111], v[172:175], v[76:79], v[96:111]
    v_xor_b32 v45, 160, v43
    ds_read_b128 v[68:71], v45 offset:8192
    s_waitcnt lgkmcnt(4)
    s_waitcnt lgkmcnt(3)
    v_mfma_f32_32x32x16_bf16 v[80:95], v[176:179], v[56:59], v[80:95]
    v_xor_b32 v46, 192, v42
    ds_read_b128 v[72:75], v46 offset:8192
    s_waitcnt lgkmcnt(3)
    v_mfma_f32_32x32x16_bf16 v[96:111], v[176:179], v[60:63], v[96:111]
    v_xor_b32 v47, 192, v43
    ds_read_b128 v[76:79], v47 offset:8192
    s_waitcnt lgkmcnt(3)
    v_mfma_f32_32x32x16_bf16 v[80:95], v[180:183], v[64:67], v[80:95]
    v_xor_b32 v45, 224, v42
    ds_read_b128 v[56:59], v45 offset:8192
    s_waitcnt lgkmcnt(3)
    v_mfma_f32_32x32x16_bf16 v[96:111], v[180:183], v[68:71], v[96:111]
    v_xor_b32 v46, 224, v43
    ds_read_b128 v[60:63], v46 offset:8192
    s_waitcnt vmcnt(4)
    s_barrier
    s_add_u32 m0, s41, 65536
    s_add_u32 s36, s39, 3145728
    buffer_load_dwordx4 v37, s[28:31], s36 offen offset:0 lds
    s_add_u32 s36, s39, 3177472
    buffer_load_dwordx4 v37, s[28:31], s36 offen offset:1024 lds
    s_add_u32 s36, s39, 3209216
    buffer_load_dwordx4 v37, s[28:31], s36 offen offset:2048 lds
    s_add_u32 s36, s39, 3240960
    buffer_load_dwordx4 v37, s[28:31], s36 offen offset:3072 lds
    ds_read_b64_tr_b16 v[192:193], v38 offset:32768
    ds_read_b64_tr_b16 v[194:195], v38 offset:33792
    ds_read_b64_tr_b16 v[196:197], v38 offset:36864
    ds_read_b64_tr_b16 v[198:199], v38 offset:37888
    ds_read_b64_tr_b16 v[200:201], v38 offset:40960
    ds_read_b64_tr_b16 v[202:203], v38 offset:41984
    ds_read_b64_tr_b16 v[204:205], v38 offset:45056
    ds_read_b64_tr_b16 v[206:207], v38 offset:46080
    s_waitcnt lgkmcnt(11)
    v_mfma_f32_32x32x16_bf16 v[80:95], v[184:187], v[72:75], v[80:95]
    ds_read_b128 v[64:67], v42 offset:16384
    s_add_u32 m0, s40, 24576
    s_add_u32 s36, s38, 768
    buffer_load_dwordx4 v36, s[24:27], s36 offen lds
    s_waitcnt lgkmcnt(11)
    v_mfma_f32_32x32x16_bf16 v[96:111], v[184:187], v[76:79], v[96:111]
    ds_read_b128 v[68:71], v43 offset:16384
    s_add_u32 m0, s40, 57344
    s_add_u32 s36, s38, 33536
    buffer_load_dwordx4 v36, s[24:27], s36 offen lds
    s_waitcnt lgkmcnt(11)
    v_mfma_f32_32x32x16_bf16 v[80:95], v[188:191], v[56:59], v[80:95]
    v_xor_b32 v46, 32, v42
    ds_read_b128 v[72:75], v46 offset:16384
    s_waitcnt lgkmcnt(11)
    v_mfma_f32_32x32x16_bf16 v[96:111], v[188:191], v[60:63], v[96:111]
    v_xor_b32 v47, 32, v43
    ds_read_b128 v[76:79], v47 offset:16384
    s_waitcnt lgkmcnt(4)
    s_waitcnt lgkmcnt(3)
    v_mfma_f32_32x32x16_bf16 v[80:95], v[192:195], v[64:67], v[80:95]
    v_xor_b32 v45, 64, v42
    ds_read_b128 v[56:59], v45 offset:16384
    s_waitcnt lgkmcnt(3)
    v_mfma_f32_32x32x16_bf16 v[96:111], v[192:195], v[68:71], v[96:111]
    v_xor_b32 v46, 64, v43
    ds_read_b128 v[60:63], v46 offset:16384
    s_waitcnt lgkmcnt(3)
    v_mfma_f32_32x32x16_bf16 v[80:95], v[196:199], v[72:75], v[80:95]
    v_xor_b32 v47, 96, v42
    ds_read_b128 v[64:67], v47 offset:16384
    s_waitcnt lgkmcnt(3)
    v_mfma_f32_32x32x16_bf16 v[96:111], v[196:199], v[76:79], v[96:111]
    v_xor_b32 v45, 96, v43
    ds_read_b128 v[68:71], v45 offset:16384
    s_waitcnt vmcnt(6)
    s_barrier
    s_add_u32 m0, s41, 98304
    s_add_u32 s36, s39, 3670016
    buffer_load_dwordx4 v37, s[28:31], s36 offen offset:0 lds
    s_add_u32 s36, s39, 3701760
    buffer_load_dwordx4 v37, s[28:31], s36 offen offset:1024 lds
    s_add_u32 s36, s39, 3733504
    buffer_load_dwordx4 v37, s[28:31], s36 offen offset:2048 lds
    s_add_u32 s36, s39, 3765248
    buffer_load_dwordx4 v37, s[28:31], s36 offen offset:3072 lds
    ds_read_b64_tr_b16 v[208:209], v39 offset:0
    ds_read_b64_tr_b16 v[210:211], v39 offset:1024
    ds_read_b64_tr_b16 v[212:213], v39 offset:4096
    ds_read_b64_tr_b16 v[214:215], v39 offset:5120
    ds_read_b64_tr_b16 v[216:217], v39 offset:8192
    ds_read_b64_tr_b16 v[218:219], v39 offset:9216
    ds_read_b64_tr_b16 v[220:221], v39 offset:12288
    ds_read_b64_tr_b16 v[222:223], v39 offset:13312
    s_waitcnt lgkmcnt(11)
    v_mfma_f32_32x32x16_bf16 v[80:95], v[200:203], v[56:59], v[80:95]
    v_xor_b32 v46, 128, v42
    ds_read_b128 v[72:75], v46 offset:16384
    s_waitcnt lgkmcnt(11)
    v_mfma_f32_32x32x16_bf16 v[96:111], v[200:203], v[60:63], v[96:111]
    v_xor_b32 v47, 128, v43
    ds_read_b128 v[76:79], v47 offset:16384
    s_waitcnt lgkmcnt(11)
    v_mfma_f32_32x32x16_bf16 v[80:95], v[204:207], v[64:67], v[80:95]
    v_xor_b32 v45, 160, v42
    ds_read_b128 v[56:59], v45 offset:16384
    s_waitcnt lgkmcnt(11)
    v_mfma_f32_32x32x16_bf16 v[96:111], v[204:207], v[68:71], v[96:111]
    v_xor_b32 v46, 160, v43
    ds_read_b128 v[60:63], v46 offset:16384
    s_waitcnt lgkmcnt(4)
    s_waitcnt lgkmcnt(3)
    v_mfma_f32_32x32x16_bf16 v[80:95], v[208:211], v[72:75], v[80:95]
    v_xor_b32 v47, 192, v42
    ds_read_b128 v[64:67], v47 offset:16384
    s_waitcnt lgkmcnt(3)
    v_mfma_f32_32x32x16_bf16 v[96:111], v[208:211], v[76:79], v[96:111]
    v_xor_b32 v45, 192, v43
    ds_read_b128 v[68:71], v45 offset:16384
    s_waitcnt lgkmcnt(3)
    v_mfma_f32_32x32x16_bf16 v[80:95], v[212:215], v[56:59], v[80:95]
    v_xor_b32 v46, 224, v42
    ds_read_b128 v[72:75], v46 offset:16384
    s_waitcnt lgkmcnt(3)
    v_mfma_f32_32x32x16_bf16 v[96:111], v[212:215], v[60:63], v[96:111]
    v_xor_b32 v47, 224, v43
    ds_read_b128 v[76:79], v47 offset:16384
    s_waitcnt vmcnt(4)
    s_barrier
    s_add_u32 m0, s40, 131072
    s_add_u32 s36, s38, 65536
    buffer_load_dwordx4 v36, s[24:27], s36 offen lds
    s_add_u32 m0, s40, 139264
    s_add_u32 s36, s38, 65792
    buffer_load_dwordx4 v36, s[24:27], s36 offen lds
    s_add_u32 m0, s40, 147456
    s_add_u32 s36, s38, 66048
    buffer_load_dwordx4 v36, s[24:27], s36 offen lds
    s_add_u32 m0, s40, 155648
    s_add_u32 s36, s38, 66304
    buffer_load_dwordx4 v36, s[24:27], s36 offen lds
    ds_read_b64_tr_b16 v[224:225], v38 offset:0
    ds_read_b64_tr_b16 v[226:227], v38 offset:1024
    ds_read_b64_tr_b16 v[228:229], v38 offset:4096
    ds_read_b64_tr_b16 v[230:231], v38 offset:5120
    ds_read_b64_tr_b16 v[232:233], v38 offset:8192
    ds_read_b64_tr_b16 v[234:235], v38 offset:9216
    ds_read_b64_tr_b16 v[236:237], v38 offset:12288
    ds_read_b64_tr_b16 v[238:239], v38 offset:13312
    s_waitcnt lgkmcnt(11)
    v_mfma_f32_32x32x16_bf16 v[80:95], v[216:219], v[64:67], v[80:95]
    ds_read_b128 v[56:59], v42 offset:24576
    s_waitcnt lgkmcnt(11)
    v_mfma_f32_32x32x16_bf16 v[96:111], v[216:219], v[68:71], v[96:111]
    ds_read_b128 v[60:63], v43 offset:24576
    s_waitcnt lgkmcnt(11)
    v_mfma_f32_32x32x16_bf16 v[80:95], v[220:223], v[72:75], v[80:95]
    v_xor_b32 v47, 32, v42
    ds_read_b128 v[64:67], v47 offset:24576
    s_waitcnt lgkmcnt(11)
    v_mfma_f32_32x32x16_bf16 v[96:111], v[220:223], v[76:79], v[96:111]
    v_xor_b32 v45, 32, v43
    ds_read_b128 v[68:71], v45 offset:24576
    s_waitcnt lgkmcnt(4)
    s_waitcnt lgkmcnt(3)
    v_mfma_f32_32x32x16_bf16 v[80:95], v[224:227], v[56:59], v[80:95]
    v_xor_b32 v46, 64, v42
    ds_read_b128 v[72:75], v46 offset:24576
    s_waitcnt lgkmcnt(3)
    v_mfma_f32_32x32x16_bf16 v[96:111], v[224:227], v[60:63], v[96:111]
    v_xor_b32 v47, 64, v43
    ds_read_b128 v[76:79], v47 offset:24576
    s_waitcnt lgkmcnt(3)
    v_mfma_f32_32x32x16_bf16 v[80:95], v[228:231], v[64:67], v[80:95]
    v_xor_b32 v45, 96, v42
    ds_read_b128 v[56:59], v45 offset:24576
    s_waitcnt lgkmcnt(3)
    v_mfma_f32_32x32x16_bf16 v[96:111], v[228:231], v[68:71], v[96:111]
    v_xor_b32 v46, 96, v43
    ds_read_b128 v[60:63], v46 offset:24576
    s_waitcnt vmcnt(4)
    s_barrier
    s_add_u32 m0, s40, 65536
    s_add_u32 s36, s38, 98304
    buffer_load_dwordx4 v36, s[24:27], s36 offen lds
    s_add_u32 m0, s40, 73728
    s_add_u32 s36, s38, 98560
    buffer_load_dwordx4 v36, s[24:27], s36 offen lds
    s_add_u32 m0, s40, 81920
    s_add_u32 s36, s38, 98816
    buffer_load_dwordx4 v36, s[24:27], s36 offen lds
    s_add_u32 m0, s40, 90112
    s_add_u32 s36, s38, 99072
    buffer_load_dwordx4 v36, s[24:27], s36 offen lds
    ds_read_b64_tr_b16 v[240:241], v38 offset:32768
    ds_read_b64_tr_b16 v[242:243], v38 offset:33792
    ds_read_b64_tr_b16 v[244:245], v38 offset:36864
    ds_read_b64_tr_b16 v[246:247], v38 offset:37888
    ds_read_b64_tr_b16 v[248:249], v38 offset:40960
    ds_read_b64_tr_b16 v[250:251], v38 offset:41984
    ds_read_b64_tr_b16 v[252:253], v38 offset:45056
    ds_read_b64_tr_b16 v[254:255], v38 offset:46080
    s_waitcnt lgkmcnt(11)
    v_mfma_f32_32x32x16_bf16 v[80:95], v[232:235], v[72:75], v[80:95]
    v_xor_b32 v47, 128, v42
    ds_read_b128 v[64:67], v47 offset:24576
    s_waitcnt lgkmcnt(11)
    v_mfma_f32_32x32x16_bf16 v[96:111], v[232:235], v[76:79], v[96:111]
    v_xor_b32 v45, 128, v43
    ds_read_b128 v[68:71], v45 offset:24576
    s_waitcnt lgkmcnt(11)
    v_mfma_f32_32x32x16_bf16 v[80:95], v[236:239], v[56:59], v[80:95]
    v_xor_b32 v46, 160, v42
    ds_read_b128 v[72:75], v46 offset:24576
    s_waitcnt lgkmcnt(11)
    v_mfma_f32_32x32x16_bf16 v[96:111], v[236:239], v[60:63], v[96:111]
    v_xor_b32 v47, 160, v43
    ds_read_b128 v[76:79], v47 offset:24576
    s_waitcnt lgkmcnt(4)
    s_waitcnt lgkmcnt(3)
    v_mfma_f32_32x32x16_bf16 v[80:95], v[240:243], v[64:67], v[80:95]
    v_xor_b32 v45, 192, v42
    ds_read_b128 v[56:59], v45 offset:24576
    s_waitcnt lgkmcnt(3)
    v_mfma_f32_32x32x16_bf16 v[96:111], v[240:243], v[68:71], v[96:111]
    v_xor_b32 v46, 192, v43
    ds_read_b128 v[60:63], v46 offset:24576
    s_waitcnt lgkmcnt(3)
    v_mfma_f32_32x32x16_bf16 v[80:95], v[244:247], v[72:75], v[80:95]
    v_xor_b32 v47, 224, v42
    ds_read_b128 v[64:67], v47 offset:24576
    s_waitcnt lgkmcnt(3)
    v_mfma_f32_32x32x16_bf16 v[96:111], v[244:247], v[76:79], v[96:111]
    v_xor_b32 v45, 224, v43
    ds_read_b128 v[68:71], v45 offset:24576
    s_waitcnt vmcnt(4)
    s_barrier
    s_add_u32 m0, s40, 98304
    s_add_u32 s36, s38, 131072
    buffer_load_dwordx4 v36, s[24:27], s36 offen lds
    s_add_u32 m0, s40, 106496
    s_add_u32 s36, s38, 131328
    buffer_load_dwordx4 v36, s[24:27], s36 offen lds
    s_add_u32 m0, s40, 114688
    s_add_u32 s36, s38, 131584
    buffer_load_dwordx4 v36, s[24:27], s36 offen lds
    s_add_u32 m0, s40, 122880
    s_add_u32 s36, s38, 131840
    buffer_load_dwordx4 v36, s[24:27], s36 offen lds
    v_add_u32 v44, 131072, v40
    s_waitcnt lgkmcnt(3)
    v_mfma_f32_32x32x16_bf16 v[80:95], v[248:251], v[56:59], v[80:95]
    ds_read_b128 v[72:75], v44 offset:0
    s_waitcnt lgkmcnt(3)
    v_mfma_f32_32x32x16_bf16 v[96:111], v[248:251], v[60:63], v[96:111]
    v_xor_b32 v47, 32, v44
    ds_read_b128 v[76:79], v47 offset:0
    s_waitcnt lgkmcnt(3)
    v_mfma_f32_32x32x16_bf16 v[80:95], v[252:255], v[64:67], v[80:95]
    v_xor_b32 v45, 64, v44
    ds_read_b128 v[56:59], v45 offset:0
    s_waitcnt lgkmcnt(3)
    v_mfma_f32_32x32x16_bf16 v[96:111], v[252:255], v[68:71], v[96:111]
    v_xor_b32 v46, 96, v44
    ds_read_b128 v[60:63], v46 offset:0
    s_waitcnt lgkmcnt(3)
    v_mfma_f32_32x32x16_bf16 v[112:127], v[128:131], v[72:75], 0
    v_xor_b32 v47, 128, v44
    ds_read_b128 v[64:67], v47 offset:0
    s_lshl_b32 s36, s3, 11
    s_add_u32 m0, s36, 32768
    s_nop 0
    buffer_load_dwordx4 v26, s[64:67], s72 offen lds
    s_add_u32 m0, s36, 33792
    s_nop 0
    buffer_load_dwordx4 v27, s[68:71], s73 offen lds
    s_waitcnt lgkmcnt(3)
    v_mfma_f32_32x32x16_bf16 v[112:127], v[132:135], v[76:79], v[112:127]
    v_xor_b32 v45, 160, v44
    ds_read_b128 v[68:71], v45 offset:0
    s_waitcnt lgkmcnt(3)
    v_mfma_f32_32x32x16_bf16 v[112:127], v[136:139], v[56:59], v[112:127]
    v_xor_b32 v46, 192, v44
    ds_read_b128 v[72:75], v46 offset:0
    s_waitcnt lgkmcnt(3)
    v_mfma_f32_32x32x16_bf16 v[112:127], v[140:143], v[60:63], v[112:127]
    v_xor_b32 v47, 224, v44
    ds_read_b128 v[76:79], v47 offset:0
    v_cvt_pk_bf16_f32 v48, v80, v81
    v_cvt_pk_bf16_f32 v49, v82, v83
    s_waitcnt lgkmcnt(3)
    v_mfma_f32_32x32x16_bf16 v[112:127], v[144:147], v[64:67], v[112:127]
    ds_read_b128 v[56:59], v44 offset:8192
    v_cvt_pk_bf16_f32 v50, v84, v85
    v_cvt_pk_bf16_f32 v51, v86, v87
    s_waitcnt lgkmcnt(3)
    v_mfma_f32_32x32x16_bf16 v[112:127], v[148:151], v[68:71], v[112:127]
    v_xor_b32 v46, 32, v44
    ds_read_b128 v[60:63], v46 offset:8192
    s_add_u32 s43, s42, 0
    buffer_store_dwordx4 v[48:51], v41, s[60:63], s43 offen sc1
    s_waitcnt lgkmcnt(3)
    v_mfma_f32_32x32x16_bf16 v[112:127], v[152:155], v[72:75], v[112:127]
    v_xor_b32 v47, 64, v44
    ds_read_b128 v[64:67], v47 offset:8192
    s_waitcnt lgkmcnt(3)
    v_mfma_f32_32x32x16_bf16 v[112:127], v[156:159], v[76:79], v[112:127]
    v_xor_b32 v45, 96, v44
    ds_read_b128 v[68:71], v45 offset:8192
    s_waitcnt lgkmcnt(3)
    v_mfma_f32_32x32x16_bf16 v[112:127], v[160:163], v[56:59], v[112:127]
    v_xor_b32 v46, 128, v44
    ds_read_b128 v[72:75], v46 offset:8192
    s_waitcnt lgkmcnt(3)
    v_mfma_f32_32x32x16_bf16 v[112:127], v[164:167], v[60:63], v[112:127]
    v_xor_b32 v47, 160, v44
    ds_read_b128 v[76:79], v47 offset:8192
    s_waitcnt lgkmcnt(3)
    v_mfma_f32_32x32x16_bf16 v[112:127], v[168:171], v[64:67], v[112:127]
    v_xor_b32 v45, 192, v44
    ds_read_b128 v[56:59], v45 offset:8192
    s_waitcnt lgkmcnt(3)
    v_mfma_f32_32x32x16_bf16 v[112:127], v[172:175], v[68:71], v[112:127]
    v_xor_b32 v46, 224, v44
    ds_read_b128 v[60:63], v46 offset:8192
    v_cvt_pk_bf16_f32 v52, v88, v89
    v_cvt_pk_bf16_f32 v53, v90, v91
    s_waitcnt lgkmcnt(3)
    v_mfma_f32_32x32x16_bf16 v[112:127], v[176:179], v[72:75], v[112:127]
    ds_read_b128 v[64:67], v44 offset:16384
    v_cvt_pk_bf16_f32 v54, v92, v93
    v_cvt_pk_bf16_f32 v55, v94, v95
    s_waitcnt lgkmcnt(3)
    v_mfma_f32_32x32x16_bf16 v[112:127], v[180:183], v[76:79], v[112:127]
    v_xor_b32 v45, 32, v44
    ds_read_b128 v[68:71], v45 offset:16384
    s_add_u32 s43, s42, 1024
    buffer_store_dwordx4 v[52:55], v41, s[60:63], s43 offen sc1
    s_waitcnt lgkmcnt(3)
    v_mfma_f32_32x32x16_bf16 v[112:127], v[184:187], v[56:59], v[112:127]
    v_xor_b32 v46, 64, v44
    ds_read_b128 v[72:75], v46 offset:16384
    s_waitcnt lgkmcnt(3)
    v_mfma_f32_32x32x16_bf16 v[112:127], v[188:191], v[60:63], v[112:127]
    v_xor_b32 v47, 96, v44
    ds_read_b128 v[76:79], v47 offset:16384
    s_waitcnt lgkmcnt(3)
    v_mfma_f32_32x32x16_bf16 v[112:127], v[192:195], v[64:67], v[112:127]
    v_xor_b32 v45, 128, v44
    ds_read_b128 v[56:59], v45 offset:16384
    s_waitcnt lgkmcnt(3)
    v_mfma_f32_32x32x16_bf16 v[112:127], v[196:199], v[68:71], v[112:127]
    v_xor_b32 v46, 160, v44
    ds_read_b128 v[60:63], v46 offset:16384
    s_waitcnt lgkmcnt(3)
    v_mfma_f32_32x32x16_bf16 v[112:127], v[200:203], v[72:75], v[112:127]
    v_xor_b32 v47, 192, v44
    ds_read_b128 v[64:67], v47 offset:16384
    s_waitcnt lgkmcnt(3)
    v_mfma_f32_32x32x16_bf16 v[112:127], v[204:207], v[76:79], v[112:127]
    v_xor_b32 v45, 224, v44
    ds_read_b128 v[68:71], v45 offset:16384
    v_cvt_pk_bf16_f32 v48, v96, v97
    v_cvt_pk_bf16_f32 v49, v98, v99
    s_waitcnt vmcnt(8)
    s_barrier
    s_add_u32 m0, s40, 0
    s_add_u32 s36, s38, 163840
    buffer_load_dwordx4 v36, s[24:27], s36 offen lds
    s_add_u32 m0, s40, 8192
    s_add_u32 s36, s38, 164096
    buffer_load_dwordx4 v36, s[24:27], s36 offen lds
    s_add_u32 m0, s40, 16384
    s_add_u32 s36, s38, 164352
    buffer_load_dwordx4 v36, s[24:27], s36 offen lds
    s_add_u32 m0, s40, 24576
    s_add_u32 s36, s38, 164608
    buffer_load_dwordx4 v36, s[24:27], s36 offen lds
    v_add_u32 v42, 65536, v40
    s_waitcnt lgkmcnt(3)
    v_mfma_f32_32x32x16_bf16 v[112:127], v[208:211], v[56:59], v[112:127]
    ds_read_b128 v[72:75], v44 offset:24576
    v_cvt_pk_bf16_f32 v50, v100, v101
    v_cvt_pk_bf16_f32 v51, v102, v103
    s_waitcnt lgkmcnt(3)
    v_mfma_f32_32x32x16_bf16 v[112:127], v[212:215], v[60:63], v[112:127]
    v_xor_b32 v47, 32, v44
    ds_read_b128 v[76:79], v47 offset:24576
    s_add_u32 s43, s42, 8192
    buffer_store_dwordx4 v[48:51], v41, s[60:63], s43 offen sc1
    s_waitcnt lgkmcnt(3)
    v_mfma_f32_32x32x16_bf16 v[112:127], v[216:219], v[64:67], v[112:127]
    v_xor_b32 v45, 64, v44
    ds_read_b128 v[56:59], v45 offset:24576
    s_waitcnt lgkmcnt(3)
    v_mfma_f32_32x32x16_bf16 v[112:127], v[220:223], v[68:71], v[112:127]
    v_xor_b32 v46, 96, v44
    ds_read_b128 v[60:63], v46 offset:24576
    s_waitcnt lgkmcnt(3)
    v_mfma_f32_32x32x16_bf16 v[112:127], v[224:227], v[72:75], v[112:127]
    v_xor_b32 v47, 128, v44
    ds_read_b128 v[64:67], v47 offset:24576
    s_waitcnt lgkmcnt(3)
    v_mfma_f32_32x32x16_bf16 v[112:127], v[228:231], v[76:79], v[112:127]
    v_xor_b32 v45, 160, v44
    ds_read_b128 v[68:71], v45 offset:24576
    s_waitcnt lgkmcnt(3)
    v_mfma_f32_32x32x16_bf16 v[112:127], v[232:235], v[56:59], v[112:127]
    v_xor_b32 v46, 192, v44
    ds_read_b128 v[72:75], v46 offset:24576
    s_waitcnt lgkmcnt(3)
    v_mfma_f32_32x32x16_bf16 v[112:127], v[236:239], v[60:63], v[112:127]
    v_xor_b32 v47, 224, v44
    ds_read_b128 v[76:79], v47 offset:24576
    v_cvt_pk_bf16_f32 v52, v104, v105
    v_cvt_pk_bf16_f32 v53, v106, v107
    s_waitcnt lgkmcnt(3)
    v_mfma_f32_32x32x16_bf16 v[112:127], v[240:243], v[64:67], v[112:127]
    ds_read_b128 v[56:59], v42 offset:0
    v_cvt_pk_bf16_f32 v54, v108, v109
    v_cvt_pk_bf16_f32 v55, v110, v111
    s_waitcnt lgkmcnt(3)
    v_mfma_f32_32x32x16_bf16 v[112:127], v[244:247], v[68:71], v[112:127]
    v_xor_b32 v46, 32, v42
    ds_read_b128 v[60:63], v46 offset:0
    s_add_u32 s43, s42, 9216
    buffer_store_dwordx4 v[52:55], v41, s[60:63], s43 offen sc1
    s_waitcnt lgkmcnt(3)
    v_mfma_f32_32x32x16_bf16 v[112:127], v[248:251], v[72:75], v[112:127]
    v_xor_b32 v47, 64, v42
    ds_read_b128 v[64:67], v47 offset:0
    s_waitcnt lgkmcnt(3)
    v_mfma_f32_32x32x16_bf16 v[112:127], v[252:255], v[76:79], v[112:127]
    v_xor_b32 v45, 96, v42
    ds_read_b128 v[68:71], v45 offset:0
    v_lshrrev_b32 v16, 5, v1
    v_lshlrev_b32 v16, 8, v16
    v_bfe_u32 v17, v1, 2, 2
    v_lshlrev_b32 v17, 6, v17
    v_or_b32 v16, v16, v17
    v_bfe_u32 v17, v1, 4, 1
    v_lshlrev_b32 v17, 5, v17
    v_or_b32 v16, v16, v17
    v_and_b32 v17, 3, v1
    v_lshlrev_b32 v17, 3, v17
    v_or_b32 v16, v16, v17
    s_lshl_b32 s36, s3, 11
    s_add_u32 s36, s36, 32768
    v_add_u32 v16, s36, v16
    v_and_b32 v18, 0x40000000, v27
    v_or_b32 v18, v18, v41
    s_waitcnt lgkmcnt(3)
    v_mfma_f32_32x32x16_bf16 v[80:95], v[128:131], v[56:59], 0
    v_xor_b32 v46, 128, v42
    ds_read_b128 v[72:75], v46 offset:0
    s_waitcnt lgkmcnt(3)
    v_mfma_f32_32x32x16_bf16 v[80:95], v[132:135], v[60:63], v[80:95]
    v_xor_b32 v47, 160, v42
    ds_read_b128 v[76:79], v47 offset:0
    s_waitcnt lgkmcnt(3)
    v_mfma_f32_32x32x16_bf16 v[80:95], v[136:139], v[64:67], v[80:95]
    v_xor_b32 v45, 192, v42
    ds_read_b128 v[56:59], v45 offset:0
    s_waitcnt lgkmcnt(3)
    v_mfma_f32_32x32x16_bf16 v[80:95], v[140:143], v[68:71], v[80:95]
    v_xor_b32 v46, 224, v42
    ds_read_b128 v[60:63], v46 offset:0
    v_cvt_pk_bf16_f32 v48, v112, v113
    v_cvt_pk_bf16_f32 v49, v114, v115
    s_waitcnt lgkmcnt(3)
    v_mfma_f32_32x32x16_bf16 v[80:95], v[144:147], v[72:75], v[80:95]
    ds_read_b128 v[64:67], v42 offset:8192
    v_cvt_pk_bf16_f32 v50, v116, v117
    v_cvt_pk_bf16_f32 v51, v118, v119
    buffer_load_dword v24, v0, s[48:51], s47 offen
    s_waitcnt lgkmcnt(3)
    v_mfma_f32_32x32x16_bf16 v[80:95], v[148:151], v[76:79], v[80:95]
    v_xor_b32 v45, 32, v42
    ds_read_b128 v[68:71], v45 offset:8192
    s_add_u32 s43, s42, 32768
    buffer_store_dwordx4 v[48:51], v41, s[60:63], s43 offen sc1
    s_waitcnt lgkmcnt(3)
    v_mfma_f32_32x32x16_bf16 v[80:95], v[152:155], v[56:59], v[80:95]
    v_xor_b32 v46, 64, v42
    ds_read_b128 v[72:75], v46 offset:8192
    s_waitcnt lgkmcnt(3)
    v_mfma_f32_32x32x16_bf16 v[80:95], v[156:159], v[60:63], v[80:95]
    v_xor_b32 v47, 96, v42
    ds_read_b128 v[76:79], v47 offset:8192
    s_waitcnt lgkmcnt(3)
    v_mfma_f32_32x32x16_bf16 v[80:95], v[160:163], v[64:67], v[80:95]
    v_xor_b32 v45, 128, v42
    ds_read_b128 v[56:59], v45 offset:8192
    s_waitcnt lgkmcnt(3)
    v_mfma_f32_32x32x16_bf16 v[80:95], v[164:167], v[68:71], v[80:95]
    v_xor_b32 v46, 160, v42
    ds_read_b128 v[60:63], v46 offset:8192
    s_waitcnt lgkmcnt(3)
    v_mfma_f32_32x32x16_bf16 v[80:95], v[168:171], v[72:75], v[80:95]
    v_xor_b32 v47, 192, v42
    ds_read_b128 v[64:67], v47 offset:8192
    s_waitcnt lgkmcnt(3)
    v_mfma_f32_32x32x16_bf16 v[80:95], v[172:175], v[76:79], v[80:95]
    v_xor_b32 v45, 224, v42
    ds_read_b128 v[68:71], v45 offset:8192
    s_waitcnt vmcnt(10)
    ds_read_b64_tr_b16 v[8:9], v16 offset:0
    ds_read_b64_tr_b16 v[10:11], v16 offset:512
    ds_read_b64_tr_b16 v[12:13], v16 offset:1024
    ds_read_b64_tr_b16 v[14:15], v16 offset:1536
    s_waitcnt lgkmcnt(7)
    v_mfma_f32_32x32x16_bf16 v[80:95], v[176:179], v[56:59], v[80:95]
    ds_read_b128 v[72:75], v42 offset:16384
    s_waitcnt lgkmcnt(7)
    v_mfma_f32_32x32x16_bf16 v[80:95], v[180:183], v[60:63], v[80:95]
    v_xor_b32 v47, 32, v42
    ds_read_b128 v[76:79], v47 offset:16384
    s_waitcnt lgkmcnt(7)
    v_mfma_f32_32x32x16_bf16 v[80:95], v[184:187], v[64:67], v[80:95]
    v_xor_b32 v45, 64, v42
    ds_read_b128 v[56:59], v45 offset:16384
    s_waitcnt lgkmcnt(7)
    v_mfma_f32_32x32x16_bf16 v[80:95], v[188:191], v[68:71], v[80:95]
    v_xor_b32 v46, 96, v42
    ds_read_b128 v[60:63], v46 offset:16384
    s_waitcnt lgkmcnt(3)
    v_mfma_f32_32x32x16_bf16 v[80:95], v[192:195], v[72:75], v[80:95]
    v_xor_b32 v47, 128, v42
    ds_read_b128 v[64:67], v47 offset:16384
    s_waitcnt lgkmcnt(5)
    buffer_store_dwordx4 v[8:11], v41, s[32:35], s74 offen sc1
    buffer_store_dwordx4 v[12:15], v18, s[32:35], s75 offen sc1
    s_waitcnt lgkmcnt(3)
    v_mfma_f32_32x32x16_bf16 v[80:95], v[196:199], v[76:79], v[80:95]
    v_xor_b32 v45, 160, v42
    ds_read_b128 v[68:71], v45 offset:16384
    s_waitcnt lgkmcnt(3)
    v_mfma_f32_32x32x16_bf16 v[80:95], v[200:203], v[56:59], v[80:95]
    v_xor_b32 v46, 192, v42
    ds_read_b128 v[72:75], v46 offset:16384
    s_waitcnt lgkmcnt(3)
    v_mfma_f32_32x32x16_bf16 v[80:95], v[204:207], v[60:63], v[80:95]
    v_xor_b32 v47, 224, v42
    ds_read_b128 v[76:79], v47 offset:16384
    v_cvt_pk_bf16_f32 v52, v120, v121
    v_cvt_pk_bf16_f32 v53, v122, v123
    s_waitcnt vmcnt(14)
    s_barrier
    s_add_u32 m0, s40, 32768
    s_add_u32 s36, s38, 196608
    buffer_load_dwordx4 v36, s[24:27], s36 offen lds
    s_add_u32 m0, s40, 40960
    s_add_u32 s36, s38, 196864
    buffer_load_dwordx4 v36, s[24:27], s36 offen lds
    s_add_u32 m0, s40, 49152
    s_add_u32 s36, s38, 197120
    buffer_load_dwordx4 v36, s[24:27], s36 offen lds
    s_add_u32 m0, s40, 57344
    s_add_u32 s36, s38, 197376
    buffer_load_dwordx4 v36, s[24:27], s36 offen lds
    v_add_u32 v43, 98304, v40
    s_waitcnt lgkmcnt(3)
    v_mfma_f32_32x32x16_bf16 v[80:95], v[208:211], v[64:67], v[80:95]
    ds_read_b128 v[56:59], v42 offset:24576
    v_cvt_pk_bf16_f32 v54, v124, v125
    v_cvt_pk_bf16_f32 v55, v126, v127
    s_waitcnt lgkmcnt(3)
    v_mfma_f32_32x32x16_bf16 v[80:95], v[212:215], v[68:71], v[80:95]
    v_xor_b32 v46, 32, v42
    ds_read_b128 v[60:63], v46 offset:24576
    s_add_u32 s43, s42, 33792
    buffer_store_dwordx4 v[52:55], v41, s[60:63], s43 offen sc1
    s_waitcnt lgkmcnt(3)
    v_mfma_f32_32x32x16_bf16 v[80:95], v[216:219], v[72:75], v[80:95]
    v_xor_b32 v47, 64, v42
    ds_read_b128 v[64:67], v47 offset:24576
    s_waitcnt lgkmcnt(3)
    v_mfma_f32_32x32x16_bf16 v[80:95], v[220:223], v[76:79], v[80:95]
    v_xor_b32 v45, 96, v42
    ds_read_b128 v[68:71], v45 offset:24576
    s_waitcnt lgkmcnt(3)
    v_mfma_f32_32x32x16_bf16 v[80:95], v[224:227], v[56:59], v[80:95]
    v_xor_b32 v46, 128, v42
    ds_read_b128 v[72:75], v46 offset:24576
    s_waitcnt lgkmcnt(3)
    v_mfma_f32_32x32x16_bf16 v[80:95], v[228:231], v[60:63], v[80:95]
    v_xor_b32 v47, 160, v42
    ds_read_b128 v[76:79], v47 offset:24576
    s_waitcnt lgkmcnt(3)
    v_mfma_f32_32x32x16_bf16 v[80:95], v[232:235], v[64:67], v[80:95]
    v_xor_b32 v45, 192, v42
    ds_read_b128 v[56:59], v45 offset:24576
    s_waitcnt lgkmcnt(3)
    v_mfma_f32_32x32x16_bf16 v[80:95], v[236:239], v[68:71], v[80:95]
    v_xor_b32 v46, 224, v42
    ds_read_b128 v[60:63], v46 offset:24576
    s_waitcnt lgkmcnt(3)
    v_mfma_f32_32x32x16_bf16 v[80:95], v[240:243], v[72:75], v[80:95]
    ds_read_b128 v[64:67], v43 offset:0
    s_waitcnt lgkmcnt(3)
    v_mfma_f32_32x32x16_bf16 v[80:95], v[244:247], v[76:79], v[80:95]
    v_xor_b32 v45, 32, v43
    ds_read_b128 v[68:71], v45 offset:0
    s_waitcnt lgkmcnt(3)
    v_mfma_f32_32x32x16_bf16 v[80:95], v[248:251], v[56:59], v[80:95]
    v_xor_b32 v46, 64, v43
    ds_read_b128 v[72:75], v46 offset:0
    s_waitcnt lgkmcnt(3)
    v_mfma_f32_32x32x16_bf16 v[80:95], v[252:255], v[60:63], v[80:95]
    v_xor_b32 v47, 96, v43
    ds_read_b128 v[76:79], v47 offset:0
    s_waitcnt lgkmcnt(3)
    v_mfma_f32_32x32x16_bf16 v[96:111], v[128:131], v[64:67], 0
    v_xor_b32 v45, 128, v43
    ds_read_b128 v[56:59], v45 offset:0
    s_waitcnt lgkmcnt(3)
    v_mfma_f32_32x32x16_bf16 v[96:111], v[132:135], v[68:71], v[96:111]
    v_xor_b32 v46, 160, v43
    ds_read_b128 v[60:63], v46 offset:0
    s_waitcnt lgkmcnt(3)
    v_mfma_f32_32x32x16_bf16 v[96:111], v[136:139], v[72:75], v[96:111]
    v_xor_b32 v47, 192, v43
    ds_read_b128 v[64:67], v47 offset:0
    s_waitcnt lgkmcnt(3)
    v_mfma_f32_32x32x16_bf16 v[96:111], v[140:143], v[76:79], v[96:111]
    v_xor_b32 v45, 224, v43
    ds_read_b128 v[68:71], v45 offset:0
    v_cvt_pk_bf16_f32 v48, v80, v81
    v_cvt_pk_bf16_f32 v49, v82, v83
    s_waitcnt lgkmcnt(3)
    v_mfma_f32_32x32x16_bf16 v[96:111], v[144:147], v[56:59], v[96:111]
    ds_read_b128 v[72:75], v43 offset:8192
    v_cvt_pk_bf16_f32 v50, v84, v85
    v_cvt_pk_bf16_f32 v51, v86, v87
    s_waitcnt lgkmcnt(3)
    v_mfma_f32_32x32x16_bf16 v[96:111], v[148:151], v[60:63], v[96:111]
    v_xor_b32 v47, 32, v43
    ds_read_b128 v[76:79], v47 offset:8192
    s_add_u32 s43, s42, 40960
    buffer_store_dwordx4 v[48:51], v41, s[60:63], s43 offen sc1
    s_waitcnt lgkmcnt(3)
    v_mfma_f32_32x32x16_bf16 v[96:111], v[152:155], v[64:67], v[96:111]
    v_xor_b32 v45, 64, v43
    ds_read_b128 v[56:59], v45 offset:8192
    s_waitcnt lgkmcnt(3)
    v_mfma_f32_32x32x16_bf16 v[96:111], v[156:159], v[68:71], v[96:111]
    v_xor_b32 v46, 96, v43
    ds_read_b128 v[60:63], v46 offset:8192
    s_waitcnt lgkmcnt(3)
    v_mfma_f32_32x32x16_bf16 v[96:111], v[160:163], v[72:75], v[96:111]
    v_xor_b32 v47, 128, v43
    ds_read_b128 v[64:67], v47 offset:8192
    s_waitcnt lgkmcnt(3)
    v_mfma_f32_32x32x16_bf16 v[96:111], v[164:167], v[76:79], v[96:111]
    v_xor_b32 v45, 160, v43
    ds_read_b128 v[68:71], v45 offset:8192
    s_waitcnt lgkmcnt(3)
    v_mfma_f32_32x32x16_bf16 v[96:111], v[168:171], v[56:59], v[96:111]
    v_xor_b32 v46, 192, v43
    ds_read_b128 v[72:75], v46 offset:8192
    s_waitcnt lgkmcnt(3)
    v_mfma_f32_32x32x16_bf16 v[96:111], v[172:175], v[60:63], v[96:111]
    v_xor_b32 v47, 224, v43
    ds_read_b128 v[76:79], v47 offset:8192
    s_waitcnt lgkmcnt(3)
    v_mfma_f32_32x32x16_bf16 v[96:111], v[176:179], v[64:67], v[96:111]
    ds_read_b128 v[56:59], v43 offset:16384
    s_waitcnt lgkmcnt(3)
    v_mfma_f32_32x32x16_bf16 v[96:111], v[180:183], v[68:71], v[96:111]
    v_xor_b32 v46, 32, v43
    ds_read_b128 v[60:63], v46 offset:16384
    s_waitcnt lgkmcnt(3)
    v_mfma_f32_32x32x16_bf16 v[96:111], v[184:187], v[72:75], v[96:111]
    v_xor_b32 v47, 64, v43
    ds_read_b128 v[64:67], v47 offset:16384
    s_waitcnt lgkmcnt(3)
    v_mfma_f32_32x32x16_bf16 v[96:111], v[188:191], v[76:79], v[96:111]
    v_xor_b32 v45, 96, v43
    ds_read_b128 v[68:71], v45 offset:16384
    s_waitcnt lgkmcnt(3)
    v_mfma_f32_32x32x16_bf16 v[96:111], v[192:195], v[56:59], v[96:111]
    v_xor_b32 v46, 128, v43
    ds_read_b128 v[72:75], v46 offset:16384
    s_waitcnt lgkmcnt(3)
    v_mfma_f32_32x32x16_bf16 v[96:111], v[196:199], v[60:63], v[96:111]
    v_xor_b32 v47, 160, v43
    ds_read_b128 v[76:79], v47 offset:16384
    s_waitcnt lgkmcnt(3)
    v_mfma_f32_32x32x16_bf16 v[96:111], v[200:203], v[64:67], v[96:111]
    v_xor_b32 v45, 192, v43
    ds_read_b128 v[56:59], v45 offset:16384
    s_waitcnt lgkmcnt(3)
    v_mfma_f32_32x32x16_bf16 v[96:111], v[204:207], v[68:71], v[96:111]
    v_xor_b32 v46, 224, v43
    ds_read_b128 v[60:63], v46 offset:16384
    v_cvt_pk_bf16_f32 v52, v88, v89
    v_cvt_pk_bf16_f32 v53, v90, v91
    s_waitcnt vmcnt(12)
    s_barrier
    s_add_u32 m0, s40, 131072
    s_add_u32 s36, s38, 229376
    buffer_load_dwordx4 v36, s[24:27], s36 offen lds
    s_add_u32 m0, s40, 139264
    s_add_u32 s36, s38, 229632
    buffer_load_dwordx4 v36, s[24:27], s36 offen lds
    s_add_u32 m0, s40, 147456
    s_add_u32 s36, s38, 229888
    buffer_load_dwordx4 v36, s[24:27], s36 offen lds
    s_add_u32 m0, s40, 155648
    s_add_u32 s36, s38, 230144
    buffer_load_dwordx4 v36, s[24:27], s36 offen lds
    v_add_u32 v44, 0, v40
    s_waitcnt lgkmcnt(3)
    v_mfma_f32_32x32x16_bf16 v[96:111], v[208:211], v[72:75], v[96:111]
    ds_read_b128 v[64:67], v43 offset:24576
    v_cvt_pk_bf16_f32 v54, v92, v93
    v_cvt_pk_bf16_f32 v55, v94, v95
    s_lshr_b32 s67, s2, 3
    s_sub_u32 s67, s67, 4
    s_max_i32 s67, s67, 0
    s_waitcnt lgkmcnt(3)
    v_mfma_f32_32x32x16_bf16 v[96:111], v[212:215], v[76:79], v[96:111]
    v_xor_b32 v45, 32, v43
    ds_read_b128 v[68:71], v45 offset:24576
    s_add_u32 s43, s42, 41984
    buffer_store_dwordx4 v[52:55], v41, s[60:63], s43 offen sc1
    s_mul_i32 s5, s67, 37
    s_lshr_b32 s5, s5, 8
    s_lshl_b32 s64, s14, 2
    s_waitcnt lgkmcnt(3)
    v_mfma_f32_32x32x16_bf16 v[96:111], v[216:219], v[56:59], v[96:111]
    v_xor_b32 v46, 64, v43
    ds_read_b128 v[72:75], v46 offset:24576
    s_add_u32 s64, s64, s5
    s_mul_i32 s5, s5, 7
    s_sub_u32 s67, s67, s5
    s_waitcnt lgkmcnt(3)
    v_mfma_f32_32x32x16_bf16 v[96:111], v[220:223], v[60:63], v[96:111]
    v_xor_b32 v47, 96, v43
    ds_read_b128 v[76:79], v47 offset:24576
    s_lshl_b32 s64, s64, 8
    s_lshl_b32 s65, s3, 16
    s_add_u32 s64, s64, s65
    s_waitcnt lgkmcnt(3)
    v_mfma_f32_32x32x16_bf16 v[96:111], v[224:227], v[64:67], v[96:111]
    v_xor_b32 v45, 128, v43
    ds_read_b128 v[56:59], v45 offset:24576
    s_lshl_b32 s65, s3, 11
    s_sub_u32 s66, 15, s67
    s_add_u32 s5, s67, 4
    s_waitcnt lgkmcnt(3)
    v_mfma_f32_32x32x16_bf16 v[96:111], v[228:231], v[68:71], v[96:111]
    v_xor_b32 v46, 160, v43
    ds_read_b128 v[60:63], v46 offset:24576
    s_cmp_eq_u32 s67, 6
    s_cselect_b32 s66, 3, s66
    s_cselect_b32 s5, 0, s5
    s_cmp_lt_u32 s3, 4
    s_cselect_b32 s66, s5, s66
    s_lshl_b32 s66, s66, 2
    s_waitcnt lgkmcnt(3)
    v_mfma_f32_32x32x16_bf16 v[96:111], v[232:235], v[72:75], v[96:111]
    v_xor_b32 v47, 192, v43
    ds_read_b128 v[64:67], v47 offset:24576
    s_and_b32 s5, s3, 3
    s_add_u32 s66, s66, s5
    s_lshl_b32 s66, s66, 15
    s_waitcnt lgkmcnt(3)
    v_mfma_f32_32x32x16_bf16 v[96:111], v[236:239], v[76:79], v[96:111]
    v_xor_b32 v45, 224, v43
    ds_read_b128 v[68:71], v45 offset:24576
    s_mov_b32 s24, s52
    s_mov_b32 s25, s53
    s_mov_b32 s27, 0x00020000
    s_waitcnt lgkmcnt(3)
    v_mfma_f32_32x32x16_bf16 v[96:111], v[240:243], v[56:59], v[96:111]
    ds_read_b128 v[72:75], v44 offset:0
    s_add_u32 s20, s12, 0x0
    s_addc_u32 s21, s13, 0
    s_mov_b32 s23, 0x00020000
    s_cmp_ge_u32 s2, 32
    s_cselect_b32 s26, 0x400000, 0
    s_cselect_b32 s22, 0x200000, 0
    s_waitcnt lgkmcnt(3)
    v_mfma_f32_32x32x16_bf16 v[96:111], v[244:247], v[60:63], v[96:111]
    v_xor_b32 v47, 32, v44
    ds_read_b128 v[76:79], v47 offset:0
    v_lshrrev_b32 v29, 4, v1
    v_and_b32 v30, 15, v1
    v_lshlrev_b32 v28, 13, v29
    s_waitcnt lgkmcnt(3)
    v_mfma_f32_32x32x16_bf16 v[96:111], v[248:251], v[64:67], v[96:111]
    v_xor_b32 v45, 64, v44
    ds_read_b128 v[56:59], v45 offset:0
    v_lshlrev_b32 v29, 2, v29
    v_xor_b32 v30, v30, v29
    v_lshlrev_b32 v30, 4, v30
    s_waitcnt lgkmcnt(3)
    v_mfma_f32_32x32x16_bf16 v[96:111], v[252:255], v[68:71], v[96:111]
    v_xor_b32 v46, 96, v44
    ds_read_b128 v[60:63], v46 offset:0
    v_or_b32 v28, v28, v30
    s_waitcnt lgkmcnt(3)
    v_mfma_f32_32x32x16_bf16 v[112:127], v[128:131], v[72:75], 0
    v_xor_b32 v47, 128, v44
    ds_read_b128 v[64:67], v47 offset:0
    s_waitcnt lgkmcnt(3)
    v_mfma_f32_32x32x16_bf16 v[112:127], v[132:135], v[76:79], v[112:127]
    v_xor_b32 v45, 160, v44
    ds_read_b128 v[68:71], v45 offset:0
    s_waitcnt lgkmcnt(3)
    v_mfma_f32_32x32x16_bf16 v[112:127], v[136:139], v[56:59], v[112:127]
    v_xor_b32 v46, 192, v44
    ds_read_b128 v[72:75], v46 offset:0
    s_waitcnt lgkmcnt(3)
    v_mfma_f32_32x32x16_bf16 v[112:127], v[140:143], v[60:63], v[112:127]
    v_xor_b32 v47, 224, v44
    ds_read_b128 v[76:79], v47 offset:0
    v_cvt_pk_bf16_f32 v48, v96, v97
    v_cvt_pk_bf16_f32 v49, v98, v99
    s_waitcnt lgkmcnt(3)
    v_mfma_f32_32x32x16_bf16 v[112:127], v[144:147], v[64:67], v[112:127]
    ds_read_b128 v[56:59], v44 offset:8192
    v_cvt_pk_bf16_f32 v50, v100, v101
    v_cvt_pk_bf16_f32 v51, v102, v103
    s_waitcnt lgkmcnt(3)
    v_mfma_f32_32x32x16_bf16 v[112:127], v[148:151], v[68:71], v[112:127]
    v_xor_b32 v46, 32, v44
    ds_read_b128 v[60:63], v46 offset:8192
    s_add_u32 s43, s42, 65536
    buffer_store_dwordx4 v[48:51], v41, s[60:63], s43 offen sc1
    s_waitcnt lgkmcnt(3)
    v_mfma_f32_32x32x16_bf16 v[112:127], v[152:155], v[72:75], v[112:127]
    v_xor_b32 v47, 64, v44
    ds_read_b128 v[64:67], v47 offset:8192
    s_waitcnt lgkmcnt(3)
    v_mfma_f32_32x32x16_bf16 v[112:127], v[156:159], v[76:79], v[112:127]
    v_xor_b32 v45, 96, v44
    ds_read_b128 v[68:71], v45 offset:8192
    s_waitcnt lgkmcnt(3)
    v_mfma_f32_32x32x16_bf16 v[112:127], v[160:163], v[56:59], v[112:127]
    v_xor_b32 v46, 128, v44
    ds_read_b128 v[72:75], v46 offset:8192
    s_waitcnt lgkmcnt(3)
    v_mfma_f32_32x32x16_bf16 v[112:127], v[164:167], v[60:63], v[112:127]
    v_xor_b32 v47, 160, v44
    ds_read_b128 v[76:79], v47 offset:8192
    s_waitcnt lgkmcnt(3)
    v_mfma_f32_32x32x16_bf16 v[112:127], v[168:171], v[64:67], v[112:127]
    v_xor_b32 v45, 192, v44
    ds_read_b128 v[56:59], v45 offset:8192
    s_waitcnt lgkmcnt(3)
    v_mfma_f32_32x32x16_bf16 v[112:127], v[172:175], v[68:71], v[112:127]
    v_xor_b32 v46, 224, v44
    ds_read_b128 v[60:63], v46 offset:8192
    s_waitcnt lgkmcnt(3)
    v_mfma_f32_32x32x16_bf16 v[112:127], v[176:179], v[72:75], v[112:127]
    ds_read_b128 v[64:67], v44 offset:16384
    s_waitcnt lgkmcnt(3)
    v_mfma_f32_32x32x16_bf16 v[112:127], v[180:183], v[76:79], v[112:127]
    v_xor_b32 v45, 32, v44
    ds_read_b128 v[68:71], v45 offset:16384
    s_waitcnt lgkmcnt(3)
    v_mfma_f32_32x32x16_bf16 v[112:127], v[184:187], v[56:59], v[112:127]
    v_xor_b32 v46, 64, v44
    ds_read_b128 v[72:75], v46 offset:16384
    s_waitcnt lgkmcnt(3)
    v_mfma_f32_32x32x16_bf16 v[112:127], v[188:191], v[60:63], v[112:127]
    v_xor_b32 v47, 96, v44
    ds_read_b128 v[76:79], v47 offset:16384
    s_waitcnt lgkmcnt(3)
    v_mfma_f32_32x32x16_bf16 v[112:127], v[192:195], v[64:67], v[112:127]
    v_xor_b32 v45, 128, v44
    ds_read_b128 v[56:59], v45 offset:16384
    s_waitcnt lgkmcnt(3)
    v_mfma_f32_32x32x16_bf16 v[112:127], v[196:199], v[68:71], v[112:127]
    v_xor_b32 v46, 160, v44
    ds_read_b128 v[60:63], v46 offset:16384
    s_cmp_lg_u32 s3, 0
    s_cbranch_scc1 F_NOPI
    s_lshr_b32 s36, s2, 3
    s_sub_u32 s36, s36, 4
    s_max_i32 s36, s36, 0
    s_mul_i32 s4, s36, 37
    s_lshr_b32 s4, s4, 8
    s_lshl_b32 s37, s14, 2
    s_add_u32 s37, s37, s4
    s_mul_i32 s4, s4, 7
    s_sub_u32 s36, s36, s4
    s_sub_u32 s37, 15, s36
    s_add_u32 s4, s36, 4
    v_lshrrev_b32 v4, 4, v1
    v_mov_b32 v2, s37
    v_mov_b32 v5, s4
    v_cmp_lt_u32 vcc, 1, v4
    s_nop 1
    v_cndmask_b32 v2, v2, v5, vcc
    s_cmp_eq_u32 s36, 6
    s_cbranch_scc0 F_PI_1637
    v_cmp_eq_u32 vcc, 0, v4
    v_mov_b32 v5, 3
    s_nop 0
    v_cndmask_b32 v2, v2, v5, vcc
    v_cmp_eq_u32 vcc, 1, v4
    v_mov_b32 v5, 0
    s_nop 0
    v_cndmask_b32 v2, v2, v5, vcc
    v_cmp_eq_u32 vcc, 2, v4
    v_mov_b32 v5, 2
    s_nop 0
    v_cndmask_b32 v2, v2, v5, vcc
    v_cmp_eq_u32 vcc, 3, v4
    v_mov_b32 v5, 1
    s_nop 0
    v_cndmask_b32 v2, v2, v5, vcc
F_PI_1637:
    v_lshlrev_b32 v2, 7, v2
    v_and_b32 v4, 15, v1
    v_lshlrev_b32 v4, 2, v4
    v_add_u32 v2, v2, v4
    v_add_u32 v2, 0, v2
    global_load_dword v3, v2, s[100:101] sc1
F_NOPI:
    s_waitcnt lgkmcnt(3)
    v_mfma_f32_32x32x16_bf16 v[112:127], v[200:203], v[72:75], v[112:127]
    v_xor_b32 v47, 192, v44
    ds_read_b128 v[64:67], v47 offset:16384
    s_waitcnt lgkmcnt(3)
    v_mfma_f32_32x32x16_bf16 v[112:127], v[204:207], v[76:79], v[112:127]
    v_xor_b32 v45, 224, v44
    ds_read_b128 v[68:71], v45 offset:16384
    v_cvt_pk_bf16_f32 v52, v104, v105
    v_cvt_pk_bf16_f32 v53, v106, v107
    s_waitcnt vmcnt(8)
    s_barrier
    s_lshl_b32 s36, s2, 2
    s_add_u32 s36, s36, 6144
    s_cmp_lg_u32 s3, 0
    s_cbranch_scc1 L1_XEV
    v_mov_b32 v4, s36
    v_mov_b32 v5, s77
    s_mov_b64 exec, 1
    global_store_dword v4, v5, s[100:101] sc1
    s_mov_b64 exec, -1
L1_XEV:
    v_add_u32 v42, 32768, v40
    s_waitcnt lgkmcnt(3)
    v_mfma_f32_32x32x16_bf16 v[112:127], v[208:211], v[56:59], v[112:127]
    ds_read_b128 v[72:75], v44 offset:24576
    v_cvt_pk_bf16_f32 v54, v108, v109
    v_cvt_pk_bf16_f32 v55, v110, v111
    s_add_u32 m0, s65, 65536
    s_add_u32 s36, s64, 2097152
    buffer_load_dwordx4 v28, s[24:27], s36 offen lds
    s_add_u32 s36, s36, 31744
    buffer_load_dwordx4 v28, s[24:27], s36 offen offset:1024 lds
    s_waitcnt lgkmcnt(3)
    v_mfma_f32_32x32x16_bf16 v[112:127], v[212:215], v[60:63], v[112:127]
    v_xor_b32 v47, 32, v44
    ds_read_b128 v[76:79], v47 offset:24576
    s_add_u32 s43, s42, 66560
    buffer_store_dwordx4 v[52:55], v41, s[60:63], s43 offen sc1
    s_waitcnt lgkmcnt(3)
    v_mfma_f32_32x32x16_bf16 v[112:127], v[216:219], v[64:67], v[112:127]
    v_xor_b32 v45, 64, v44
    ds_read_b128 v[56:59], v45 offset:24576
    s_add_u32 m0, s65, 81920
    s_add_u32 s36, s64, 2621440
    buffer_load_dwordx4 v28, s[24:27], s36 offen lds
    s_add_u32 s36, s36, 31744
    buffer_load_dwordx4 v28, s[24:27], s36 offen offset:1024 lds
    s_waitcnt lgkmcnt(3)
    v_mfma_f32_32x32x16_bf16 v[112:127], v[220:223], v[68:71], v[112:127]
    v_xor_b32 v46, 96, v44
    ds_read_b128 v[60:63], v46 offset:24576
    s_waitcnt lgkmcnt(3)
    v_mfma_f32_32x32x16_bf16 v[112:127], v[224:227], v[72:75], v[112:127]
    v_xor_b32 v47, 128, v44
    ds_read_b128 v[64:67], v47 offset:24576
    s_add_u32 m0, s65, 98304
    s_add_u32 s36, s64, 3145728
    buffer_load_dwordx4 v28, s[24:27], s36 offen lds
    s_add_u32 s36, s36, 31744
    buffer_load_dwordx4 v28, s[24:27], s36 offen offset:1024 lds
    s_waitcnt lgkmcnt(3)
    v_mfma_f32_32x32x16_bf16 v[112:127], v[228:231], v[76:79], v[112:127]
    v_xor_b32 v45, 160, v44
    ds_read_b128 v[68:71], v45 offset:24576
    s_waitcnt lgkmcnt(3)
    v_mfma_f32_32x32x16_bf16 v[112:127], v[232:235], v[56:59], v[112:127]
    v_xor_b32 v46, 192, v44
    ds_read_b128 v[72:75], v46 offset:24576
    s_add_u32 m0, s65, 114688
    s_add_u32 s36, s64, 3670016
    buffer_load_dwordx4 v28, s[24:27], s36 offen lds
    s_add_u32 s36, s36, 31744
    buffer_load_dwordx4 v28, s[24:27], s36 offen offset:1024 lds
    s_waitcnt lgkmcnt(3)
    v_mfma_f32_32x32x16_bf16 v[112:127], v[236:239], v[60:63], v[112:127]
    v_xor_b32 v47, 224, v44
    ds_read_b128 v[76:79], v47 offset:24576
    s_waitcnt lgkmcnt(3)
    v_mfma_f32_32x32x16_bf16 v[112:127], v[240:243], v[64:67], v[112:127]
    ds_read_b128 v[56:59], v42 offset:0
    s_waitcnt lgkmcnt(3)
    v_mfma_f32_32x32x16_bf16 v[112:127], v[244:247], v[68:71], v[112:127]
    v_xor_b32 v46, 32, v42
    ds_read_b128 v[60:63], v46 offset:0
    s_waitcnt lgkmcnt(3)
    v_mfma_f32_32x32x16_bf16 v[112:127], v[248:251], v[72:75], v[112:127]
    v_xor_b32 v47, 64, v42
    ds_read_b128 v[64:67], v47 offset:0
    s_waitcnt lgkmcnt(3)
    v_mfma_f32_32x32x16_bf16 v[112:127], v[252:255], v[76:79], v[112:127]
    v_xor_b32 v45, 96, v42
    ds_read_b128 v[68:71], v45 offset:0
    s_waitcnt lgkmcnt(3)
    v_mfma_f32_32x32x16_bf16 v[80:95], v[128:131], v[56:59], 0
    v_xor_b32 v46, 128, v42
    ds_read_b128 v[72:75], v46 offset:0
    s_waitcnt lgkmcnt(3)
    v_mfma_f32_32x32x16_bf16 v[80:95], v[132:135], v[60:63], v[80:95]
    v_xor_b32 v47, 160, v42
    ds_read_b128 v[76:79], v47 offset:0
    s_waitcnt lgkmcnt(3)
    v_mfma_f32_32x32x16_bf16 v[80:95], v[136:139], v[64:67], v[80:95]
    v_xor_b32 v45, 192, v42
    ds_read_b128 v[56:59], v45 offset:0
    s_waitcnt lgkmcnt(3)
    v_mfma_f32_32x32x16_bf16 v[80:95], v[140:143], v[68:71], v[80:95]
    v_xor_b32 v46, 224, v42
    ds_read_b128 v[60:63], v46 offset:0
    v_cvt_pk_bf16_f32 v48, v112, v113
    v_cvt_pk_bf16_f32 v49, v114, v115
    s_waitcnt lgkmcnt(3)
    v_mfma_f32_32x32x16_bf16 v[80:95], v[144:147], v[72:75], v[80:95]
    ds_read_b128 v[64:67], v42 offset:8192
    v_cvt_pk_bf16_f32 v50, v116, v117
    v_cvt_pk_bf16_f32 v51, v118, v119
    s_waitcnt lgkmcnt(3)
    v_mfma_f32_32x32x16_bf16 v[80:95], v[148:151], v[76:79], v[80:95]
    v_xor_b32 v45, 32, v42
    ds_read_b128 v[68:71], v45 offset:8192
    s_add_u32 s43, s42, 73728
    buffer_store_dwordx4 v[48:51], v41, s[60:63], s43 offen sc1
    s_waitcnt lgkmcnt(3)
    v_mfma_f32_32x32x16_bf16 v[80:95], v[152:155], v[56:59], v[80:95]
    v_xor_b32 v46, 64, v42
    ds_read_b128 v[72:75], v46 offset:8192
    s_waitcnt lgkmcnt(3)
    v_mfma_f32_32x32x16_bf16 v[80:95], v[156:159], v[60:63], v[80:95]
    v_xor_b32 v47, 96, v42
    ds_read_b128 v[76:79], v47 offset:8192
    s_waitcnt lgkmcnt(3)
    v_mfma_f32_32x32x16_bf16 v[80:95], v[160:163], v[64:67], v[80:95]
    v_xor_b32 v45, 128, v42
    ds_read_b128 v[56:59], v45 offset:8192
    s_waitcnt lgkmcnt(3)
    v_mfma_f32_32x32x16_bf16 v[80:95], v[164:167], v[68:71], v[80:95]
    v_xor_b32 v46, 160, v42
    ds_read_b128 v[60:63], v46 offset:8192
    s_waitcnt lgkmcnt(3)
    v_mfma_f32_32x32x16_bf16 v[80:95], v[168:171], v[72:75], v[80:95]
    v_xor_b32 v47, 192, v42
    ds_read_b128 v[64:67], v47 offset:8192
    s_waitcnt lgkmcnt(3)
    v_mfma_f32_32x32x16_bf16 v[80:95], v[172:175], v[76:79], v[80:95]
    v_xor_b32 v45, 224, v42
    ds_read_b128 v[68:71], v45 offset:8192
    s_waitcnt lgkmcnt(3)
    v_mfma_f32_32x32x16_bf16 v[80:95], v[176:179], v[56:59], v[80:95]
    ds_read_b128 v[72:75], v42 offset:16384
    s_waitcnt lgkmcnt(3)
    v_mfma_f32_32x32x16_bf16 v[80:95], v[180:183], v[60:63], v[80:95]
    v_xor_b32 v47, 32, v42
    ds_read_b128 v[76:79], v47 offset:16384
    s_waitcnt lgkmcnt(3)
    v_mfma_f32_32x32x16_bf16 v[80:95], v[184:187], v[64:67], v[80:95]
    v_xor_b32 v45, 64, v42
    ds_read_b128 v[56:59], v45 offset:16384
    s_waitcnt lgkmcnt(3)
    v_mfma_f32_32x32x16_bf16 v[80:95], v[188:191], v[68:71], v[80:95]
    v_xor_b32 v46, 96, v42
    ds_read_b128 v[60:63], v46 offset:16384
    s_waitcnt lgkmcnt(3)
    v_mfma_f32_32x32x16_bf16 v[80:95], v[192:195], v[72:75], v[80:95]
    v_xor_b32 v47, 128, v42
    ds_read_b128 v[64:67], v47 offset:16384
    s_waitcnt lgkmcnt(3)
    v_mfma_f32_32x32x16_bf16 v[80:95], v[196:199], v[76:79], v[80:95]
    v_xor_b32 v45, 160, v42
    ds_read_b128 v[68:71], v45 offset:16384
    s_waitcnt lgkmcnt(3)
    v_mfma_f32_32x32x16_bf16 v[80:95], v[200:203], v[56:59], v[80:95]
    v_xor_b32 v46, 192, v42
    ds_read_b128 v[72:75], v46 offset:16384
    s_waitcnt lgkmcnt(3)
    v_mfma_f32_32x32x16_bf16 v[80:95], v[204:207], v[60:63], v[80:95]
    v_xor_b32 v47, 224, v42
    ds_read_b128 v[76:79], v47 offset:16384
    v_cvt_pk_bf16_f32 v52, v120, v121
    v_cvt_pk_bf16_f32 v53, v122, v123
    s_cmp_lg_u32 s3, 0
    s_cbranch_scc1 F_XOK
    s_waitcnt vmcnt(10)
    v_cmp_ne_u32 vcc, s77, v3
    s_cbranch_vccnz F_XSLOW
F_XOK:
    s_waitcnt vmcnt(12)
    s_barrier
    v_add_u32 v43, 131072, v40
    s_waitcnt lgkmcnt(3)
    v_mfma_f32_32x32x16_bf16 v[80:95], v[208:211], v[64:67], v[80:95]
    ds_read_b128 v[56:59], v42 offset:24576
    v_cvt_pk_bf16_f32 v54, v124, v125
    v_cvt_pk_bf16_f32 v55, v126, v127
    s_add_u32 m0, s65, 0
    s_add_u32 s36, s64, 0
    buffer_load_dwordx4 v28, s[24:27], s36 offen lds
    s_add_u32 s36, s36, 31744
    buffer_load_dwordx4 v28, s[24:27], s36 offen offset:1024 lds
    s_add_u32 m0, s65, 16384
    s_add_u32 s36, s64, 524288
    buffer_load_dwordx4 v28, s[24:27], s36 offen lds
    s_add_u32 s36, s36, 31744
    buffer_load_dwordx4 v28, s[24:27], s36 offen offset:1024 lds
    s_waitcnt lgkmcnt(3)
    v_mfma_f32_32x32x16_bf16 v[80:95], v[212:215], v[68:71], v[80:95]
    v_xor_b32 v46, 32, v42
    ds_read_b128 v[60:63], v46 offset:24576
    s_add_u32 s43, s42, 74752
    buffer_store_dwordx4 v[52:55], v41, s[60:63], s43 offen sc1
    s_waitcnt lgkmcnt(3)
    v_mfma_f32_32x32x16_bf16 v[80:95], v[216:219], v[72:75], v[80:95]
    v_xor_b32 v47, 64, v42
    ds_read_b128 v[64:67], v47 offset:24576
    s_waitcnt lgkmcnt(3)
    v_mfma_f32_32x32x16_bf16 v[80:95], v[220:223], v[76:79], v[80:95]
    v_xor_b32 v45, 96, v42
    ds_read_b128 v[68:71], v45 offset:24576
    s_waitcnt lgkmcnt(3)
    v_mfma_f32_32x32x16_bf16 v[80:95], v[224:227], v[56:59], v[80:95]
    v_xor_b32 v46, 128, v42
    ds_read_b128 v[72:75], v46 offset:24576
    s_waitcnt lgkmcnt(3)
    v_mfma_f32_32x32x16_bf16 v[80:95], v[228:231], v[60:63], v[80:95]
    v_xor_b32 v47, 160, v42
    ds_read_b128 v[76:79], v47 offset:24576
    s_waitcnt lgkmcnt(3)
    v_mfma_f32_32x32x16_bf16 v[80:95], v[232:235], v[64:67], v[80:95]
    v_xor_b32 v45, 192, v42
    ds_read_b128 v[56:59], v45 offset:24576
    s_waitcnt lgkmcnt(3)
    v_mfma_f32_32x32x16_bf16 v[80:95], v[236:239], v[68:71], v[80:95]
    v_xor_b32 v46, 224, v42
    ds_read_b128 v[60:63], v46 offset:24576
    s_waitcnt lgkmcnt(3)
    v_mfma_f32_32x32x16_bf16 v[80:95], v[240:243], v[72:75], v[80:95]
    ds_read_b128 v[64:67], v43 offset:0
    s_waitcnt lgkmcnt(3)
    v_mfma_f32_32x32x16_bf16 v[80:95], v[244:247], v[76:79], v[80:95]
    v_xor_b32 v45, 32, v43
    ds_read_b128 v[68:71], v45 offset:0
    s_waitcnt lgkmcnt(3)
    v_mfma_f32_32x32x16_bf16 v[80:95], v[248:251], v[56:59], v[80:95]
    v_xor_b32 v46, 64, v43
    ds_read_b128 v[72:75], v46 offset:0
    s_waitcnt lgkmcnt(3)
    v_mfma_f32_32x32x16_bf16 v[80:95], v[252:255], v[60:63], v[80:95]
    v_xor_b32 v47, 96, v43
    ds_read_b128 v[76:79], v47 offset:0
    s_waitcnt lgkmcnt(3)
    v_mfma_f32_32x32x16_bf16 v[96:111], v[128:131], v[64:67], 0
    v_xor_b32 v45, 128, v43
    ds_read_b128 v[56:59], v45 offset:0
    s_barrier
    s_add_u32 m0, s65, 32768
    s_add_u32 s36, s64, 1048576
    buffer_load_dwordx4 v28, s[24:27], s36 offen lds
    s_add_u32 s36, s36, 31744
    buffer_load_dwordx4 v28, s[24:27], s36 offen offset:1024 lds
    s_add_u32 s36, s66, 0
    buffer_load_dwordx4 v[128:131], v41, s[20:23], s36 offen offset:0 sc1
    s_waitcnt lgkmcnt(3)
    v_mfma_f32_32x32x16_bf16 v[96:111], v[132:135], v[68:71], v[96:111]
    v_xor_b32 v46, 160, v43
    ds_read_b128 v[60:63], v46 offset:0
    s_add_u32 m0, s65, 49152
    s_add_u32 s36, s64, 1572864
    buffer_load_dwordx4 v28, s[24:27], s36 offen lds
    s_add_u32 s36, s36, 31744
    buffer_load_dwordx4 v28, s[24:27], s36 offen offset:1024 lds
    s_add_u32 s36, s66, 0
    buffer_load_dwordx4 v[132:135], v41, s[20:23], s36 offen offset:1024 sc1
    s_waitcnt lgkmcnt(3)
    v_mfma_f32_32x32x16_bf16 v[96:111], v[136:139], v[72:75], v[96:111]
    v_xor_b32 v47, 192, v43
    ds_read_b128 v[64:67], v47 offset:0
    s_add_u32 s36, s66, 0
    buffer_load_dwordx4 v[136:139], v41, s[20:23], s36 offen offset:2048 sc1
    s_waitcnt lgkmcnt(3)
    v_mfma_f32_32x32x16_bf16 v[96:111], v[140:143], v[76:79], v[96:111]
    v_xor_b32 v45, 224, v43
    ds_read_b128 v[68:71], v45 offset:0
    v_cvt_pk_bf16_f32 v48, v80, v81
    v_cvt_pk_bf16_f32 v49, v82, v83
    s_add_u32 s36, s66, 0
    buffer_load_dwordx4 v[140:143], v41, s[20:23], s36 offen offset:3072 sc1
    s_waitcnt lgkmcnt(3)
    v_mfma_f32_32x32x16_bf16 v[96:111], v[144:147], v[56:59], v[96:111]
    ds_read_b128 v[72:75], v43 offset:8192
    v_cvt_pk_bf16_f32 v50, v84, v85
    v_cvt_pk_bf16_f32 v51, v86, v87
    s_add_u32 s36, s66, 4096
    buffer_load_dwordx4 v[144:147], v41, s[20:23], s36 offen offset:0 sc1
    s_waitcnt lgkmcnt(3)
    v_mfma_f32_32x32x16_bf16 v[96:111], v[148:151], v[60:63], v[96:111]
    v_xor_b32 v47, 32, v43
    ds_read_b128 v[76:79], v47 offset:8192
    s_add_u32 s43, s42, 98304
    buffer_store_dwordx4 v[48:51], v41, s[60:63], s43 offen sc1
    s_add_u32 s36, s66, 4096
    buffer_load_dwordx4 v[148:151], v41, s[20:23], s36 offen offset:1024 sc1
    s_waitcnt lgkmcnt(3)
    v_mfma_f32_32x32x16_bf16 v[96:111], v[152:155], v[64:67], v[96:111]
    v_xor_b32 v45, 64, v43
    ds_read_b128 v[56:59], v45 offset:8192
    s_add_u32 s36, s66, 4096
    buffer_load_dwordx4 v[152:155], v41, s[20:23], s36 offen offset:2048 sc1
    s_waitcnt lgkmcnt(3)
    v_mfma_f32_32x32x16_bf16 v[96:111], v[156:159], v[68:71], v[96:111]
    v_xor_b32 v46, 96, v43
    ds_read_b128 v[60:63], v46 offset:8192
    s_add_u32 s36, s66, 4096
    buffer_load_dwordx4 v[156:159], v41, s[20:23], s36 offen offset:3072 sc1
    s_waitcnt lgkmcnt(3)
    v_mfma_f32_32x32x16_bf16 v[96:111], v[160:163], v[72:75], v[96:111]
    v_xor_b32 v47, 128, v43
    ds_read_b128 v[64:67], v47 offset:8192
    s_add_u32 s36, s66, 8192
    buffer_load_dwordx4 v[160:163], v41, s[20:23], s36 offen offset:0 sc1
    s_waitcnt lgkmcnt(3)
    v_mfma_f32_32x32x16_bf16 v[96:111], v[164:167], v[76:79], v[96:111]
    v_xor_b32 v45, 160, v43
    ds_read_b128 v[68:71], v45 offset:8192
    s_add_u32 s36, s66, 8192
    buffer_load_dwordx4 v[164:167], v41, s[20:23], s36 offen offset:1024 sc1
    s_waitcnt lgkmcnt(3)
    v_mfma_f32_32x32x16_bf16 v[96:111], v[168:171], v[56:59], v[96:111]
    v_xor_b32 v46, 192, v43
    ds_read_b128 v[72:75], v46 offset:8192
    s_add_u32 s36, s66, 8192
    buffer_load_dwordx4 v[168:171], v41, s[20:23], s36 offen offset:2048 sc1
    s_waitcnt lgkmcnt(3)
    v_mfma_f32_32x32x16_bf16 v[96:111], v[172:175], v[60:63], v[96:111]
    v_xor_b32 v47, 224, v43
    ds_read_b128 v[76:79], v47 offset:8192
    s_add_u32 s36, s66, 8192
    buffer_load_dwordx4 v[172:175], v41, s[20:23], s36 offen offset:3072 sc1
    s_waitcnt lgkmcnt(3)
    v_mfma_f32_32x32x16_bf16 v[96:111], v[176:179], v[64:67], v[96:111]
    ds_read_b128 v[56:59], v43 offset:16384
    s_add_u32 s36, s66, 12288
    buffer_load_dwordx4 v[176:179], v41, s[20:23], s36 offen offset:0 sc1
    s_waitcnt lgkmcnt(3)
    v_mfma_f32_32x32x16_bf16 v[96:111], v[180:183], v[68:71], v[96:111]
    v_xor_b32 v46, 32, v43
    ds_read_b128 v[60:63], v46 offset:16384
    s_add_u32 s36, s66, 12288
    buffer_load_dwordx4 v[180:183], v41, s[20:23], s36 offen offset:1024 sc1
    s_waitcnt lgkmcnt(3)
    v_mfma_f32_32x32x16_bf16 v[96:111], v[184:187], v[72:75], v[96:111]
    v_xor_b32 v47, 64, v43
    ds_read_b128 v[64:67], v47 offset:16384
    s_add_u32 s36, s66, 12288
    buffer_load_dwordx4 v[184:187], v41, s[20:23], s36 offen offset:2048 sc1
    s_waitcnt lgkmcnt(3)
    v_mfma_f32_32x32x16_bf16 v[96:111], v[188:191], v[76:79], v[96:111]
    v_xor_b32 v45, 96, v43
    ds_read_b128 v[68:71], v45 offset:16384
    s_add_u32 s36, s66, 12288
    buffer_load_dwordx4 v[188:191], v41, s[20:23], s36 offen offset:3072 sc1
    s_waitcnt lgkmcnt(3)
    v_mfma_f32_32x32x16_bf16 v[96:111], v[192:195], v[56:59], v[96:111]
    v_xor_b32 v46, 128, v43
    ds_read_b128 v[72:75], v46 offset:16384
    s_waitcnt lgkmcnt(3)
    v_mfma_f32_32x32x16_bf16 v[96:111], v[196:199], v[60:63], v[96:111]
    v_xor_b32 v47, 160, v43
    ds_read_b128 v[76:79], v47 offset:16384
    s_waitcnt lgkmcnt(3)
    v_mfma_f32_32x32x16_bf16 v[96:111], v[200:203], v[64:67], v[96:111]
    v_xor_b32 v45, 192, v43
    ds_read_b128 v[56:59], v45 offset:16384
    s_waitcnt lgkmcnt(3)
    v_mfma_f32_32x32x16_bf16 v[96:111], v[204:207], v[68:71], v[96:111]
    v_xor_b32 v46, 224, v43
    ds_read_b128 v[60:63], v46 offset:16384
    v_cvt_pk_bf16_f32 v52, v88, v89
    v_cvt_pk_bf16_f32 v53, v90, v91
    s_waitcnt lgkmcnt(3)
    v_mfma_f32_32x32x16_bf16 v[96:111], v[208:211], v[72:75], v[96:111]
    ds_read_b128 v[64:67], v43 offset:24576
    v_cvt_pk_bf16_f32 v54, v92, v93
    v_cvt_pk_bf16_f32 v55, v94, v95
    s_waitcnt lgkmcnt(3)
    v_mfma_f32_32x32x16_bf16 v[96:111], v[212:215], v[76:79], v[96:111]
    v_xor_b32 v45, 32, v43
    ds_read_b128 v[68:71], v45 offset:24576
    s_add_u32 s43, s42, 99328
    buffer_store_dwordx4 v[52:55], v41, s[60:63], s43 offen sc1
    s_waitcnt lgkmcnt(3)
    v_mfma_f32_32x32x16_bf16 v[96:111], v[216:219], v[56:59], v[96:111]
    v_xor_b32 v46, 64, v43
    ds_read_b128 v[72:75], v46 offset:24576
    s_waitcnt lgkmcnt(3)
    v_mfma_f32_32x32x16_bf16 v[96:111], v[220:223], v[60:63], v[96:111]
    v_xor_b32 v47, 96, v43
    ds_read_b128 v[76:79], v47 offset:24576
    s_waitcnt lgkmcnt(3)
    v_mfma_f32_32x32x16_bf16 v[96:111], v[224:227], v[64:67], v[96:111]
    v_xor_b32 v45, 128, v43
    ds_read_b128 v[56:59], v45 offset:24576
    s_waitcnt lgkmcnt(3)
    v_mfma_f32_32x32x16_bf16 v[96:111], v[228:231], v[68:71], v[96:111]
    v_xor_b32 v46, 160, v43
    ds_read_b128 v[60:63], v46 offset:24576
    s_waitcnt lgkmcnt(3)
    v_mfma_f32_32x32x16_bf16 v[96:111], v[232:235], v[72:75], v[96:111]
    v_xor_b32 v47, 192, v43
    ds_read_b128 v[64:67], v47 offset:24576
    s_waitcnt lgkmcnt(3)
    v_mfma_f32_32x32x16_bf16 v[96:111], v[236:239], v[76:79], v[96:111]
    v_xor_b32 v45, 224, v43
    ds_read_b128 v[68:71], v45 offset:24576
    s_waitcnt lgkmcnt(3)
    v_mfma_f32_32x32x16_bf16 v[96:111], v[240:243], v[56:59], v[96:111]
    s_waitcnt lgkmcnt(2)
    v_mfma_f32_32x32x16_bf16 v[96:111], v[244:247], v[60:63], v[96:111]
    s_waitcnt lgkmcnt(1)
    v_mfma_f32_32x32x16_bf16 v[96:111], v[248:251], v[64:67], v[96:111]
    s_waitcnt lgkmcnt(0)
    v_mfma_f32_32x32x16_bf16 v[96:111], v[252:255], v[68:71], v[96:111]
    s_nop 11
    v_cvt_pk_bf16_f32 v48, v96, v97
    v_cvt_pk_bf16_f32 v49, v98, v99
    v_cvt_pk_bf16_f32 v50, v100, v101
    v_cvt_pk_bf16_f32 v51, v102, v103
    s_add_u32 s43, s42, 106496
    buffer_store_dwordx4 v[48:51], v41, s[60:63], s43 offen sc1
    v_cvt_pk_bf16_f32 v52, v104, v105
    v_cvt_pk_bf16_f32 v53, v106, v107
    v_cvt_pk_bf16_f32 v54, v108, v109
    v_cvt_pk_bf16_f32 v55, v110, v111
    s_add_u32 s43, s42, 107520
    buffer_store_dwordx4 v[52:55], v41, s[60:63], s43 offen sc1
    s_waitcnt vmcnt(16)
    s_branch F_DISP
L1_V:
    v_add_u32 v42, 0, v40
    v_add_u32 v43, 32768, v40
    s_waitcnt lgkmcnt(0)
    s_waitcnt vmcnt(11)
    s_barrier
    s_mov_b32 s5, 32768
    ds_read_b64_tr_b16 v[128:129], v38 offset:0
    ds_read_b64_tr_b16 v[130:131], v38 offset:1024
    ds_read_b64_tr_b16 v[132:133], v38 offset:4096
    ds_read_b64_tr_b16 v[134:135], v38 offset:5120
    ds_read_b64_tr_b16 v[136:137], v38 offset:8192
    ds_read_b64_tr_b16 v[138:139], v38 offset:9216
    ds_read_b64_tr_b16 v[140:141], v38 offset:12288
    ds_read_b64_tr_b16 v[142:143], v38 offset:13312
    ds_read_b128 v[56:59], v42 offset:0
    ds_read_b128 v[60:63], v43 offset:0
    v_xor_b32 v47, 32, v42
    ds_read_b128 v[64:67], v47 offset:0
    v_xor_b32 v45, 32, v43
    ds_read_b128 v[68:71], v45 offset:0
    v_lshrrev_b32 v6, 3, v1
    v_add_u32 v7, v6, v1
    v_and_b32 v7, 7, v7
    v_lshlrev_b32 v7, 4, v7
    v_lshlrev_b32 v6, 7, v6
    s_lshl_b32 s36, s3, 10
    s_add_u32 s36, s36, 24576
    v_add3_u32 v6, v6, v7, s36
    ds_read_b128 v[28:31], v6
    ds_read_b128 v[32:35], v6 offset:32768
    v_lshrrev_b32 v6, 4, v1
    v_lshlrev_b32 v6, 10, v6
    v_bfe_u32 v7, v1, 3, 1
    v_lshlrev_b32 v7, 9, v7
    v_or_b32 v6, v6, v7
    v_and_b32 v7, 7, v1
    v_lshlrev_b32 v7, 4, v7
    v_or_b32 v6, v6, v7
    s_waitcnt lgkmcnt(6)
    s_waitcnt lgkmcnt(5)
    v_mfma_f32_32x32x16_bf16 v[80:95], v[56:59], v[128:131], 0
    v_xor_b32 v46, 64, v42
    ds_read_b128 v[72:75], v46 offset:0
    s_waitcnt lgkmcnt(5)
    v_mfma_f32_32x32x16_bf16 v[96:111], v[60:63], v[128:131], 0
    v_xor_b32 v47, 64, v43
    ds_read_b128 v[76:79], v47 offset:0
    s_waitcnt lgkmcnt(2)
    buffer_store_dwordx4 v[28:31], v6, s[32:35], s45 offen sc1
    s_add_u32 s45, s45, 2097152
    buffer_store_dwordx4 v[32:35], v6, s[32:35], s45 offen sc1
    s_waitcnt lgkmcnt(5)
    v_mfma_f32_32x32x16_bf16 v[80:95], v[64:67], v[132:135], v[80:95]
    v_xor_b32 v45, 96, v42
    ds_read_b128 v[56:59], v45 offset:0
    s_waitcnt lgkmcnt(5)
    v_mfma_f32_32x32x16_bf16 v[96:111], v[68:71], v[132:135], v[96:111]
    v_xor_b32 v46, 96, v43
    ds_read_b128 v[60:63], v46 offset:0
    s_waitcnt vmcnt(9)
    s_barrier
    s_add_u32 m0, s41, 65536
    s_add_u32 s36, s39, 1572864
    buffer_load_dwordx4 v37, s[28:31], s36 offen offset:0 lds
    s_add_u32 s36, s39, 1604608
    buffer_load_dwordx4 v37, s[28:31], s36 offen offset:1024 lds
    s_add_u32 s36, s39, 1636352
    buffer_load_dwordx4 v37, s[28:31], s36 offen offset:2048 lds
    s_add_u32 s36, s39, 1668096
    buffer_load_dwordx4 v37, s[28:31], s36 offen offset:3072 lds
    ds_read_b64_tr_b16 v[144:145], v38 offset:32768
    ds_read_b64_tr_b16 v[146:147], v38 offset:33792
    ds_read_b64_tr_b16 v[148:149], v38 offset:36864
    ds_read_b64_tr_b16 v[150:151], v38 offset:37888
    ds_read_b64_tr_b16 v[152:153], v38 offset:40960
    ds_read_b64_tr_b16 v[154:155], v38 offset:41984
    ds_read_b64_tr_b16 v[156:157], v38 offset:45056
    ds_read_b64_tr_b16 v[158:159], v38 offset:46080
    s_waitcnt lgkmcnt(11)
    v_mfma_f32_32x32x16_bf16 v[80:95], v[72:75], v[136:139], v[80:95]
    v_xor_b32 v47, 128, v42
    ds_read_b128 v[64:67], v47 offset:0
    s_waitcnt lgkmcnt(11)
    v_mfma_f32_32x32x16_bf16 v[96:111], v[76:79], v[136:139], v[96:111]
    v_xor_b32 v45, 128, v43
    ds_read_b128 v[68:71], v45 offset:0
    s_waitcnt vmcnt(23)
    s_waitcnt lgkmcnt(11)
    v_mfma_f32_32x32x16_bf16 v[80:95], v[56:59], v[140:143], v[80:95]
    v_xor_b32 v46, 160, v42
    ds_read_b128 v[72:75], v46 offset:0
    s_waitcnt lgkmcnt(11)
    v_mfma_f32_32x32x16_bf16 v[96:111], v[60:63], v[140:143], v[96:111]
    v_xor_b32 v47, 160, v43
    ds_read_b128 v[76:79], v47 offset:0
    s_waitcnt lgkmcnt(4)
    s_waitcnt lgkmcnt(3)
    v_mfma_f32_32x32x16_bf16 v[80:95], v[64:67], v[144:147], v[80:95]
    v_xor_b32 v45, 192, v42
    ds_read_b128 v[56:59], v45 offset:0
    s_waitcnt lgkmcnt(3)
    v_mfma_f32_32x32x16_bf16 v[96:111], v[68:71], v[144:147], v[96:111]
    v_xor_b32 v46, 192, v43
    ds_read_b128 v[60:63], v46 offset:0
    s_waitcnt lgkmcnt(3)
    v_mfma_f32_32x32x16_bf16 v[80:95], v[72:75], v[148:151], v[80:95]
    v_xor_b32 v47, 224, v42
    ds_read_b128 v[64:67], v47 offset:0
    s_waitcnt lgkmcnt(3)
    v_mfma_f32_32x32x16_bf16 v[96:111], v[76:79], v[148:151], v[96:111]
    v_xor_b32 v45, 224, v43
    ds_read_b128 v[68:71], v45 offset:0
    s_waitcnt vmcnt(6)
    s_barrier
    s_add_u32 m0, s41, 98304
    s_add_u32 s36, s39, 2097152
    buffer_load_dwordx4 v37, s[28:31], s36 offen offset:0 lds
    s_add_u32 s36, s39, 2128896
    buffer_load_dwordx4 v37, s[28:31], s36 offen offset:1024 lds
    s_add_u32 s36, s39, 2160640
    buffer_load_dwordx4 v37, s[28:31], s36 offen offset:2048 lds
    s_add_u32 s36, s39, 2192384
    buffer_load_dwordx4 v37, s[28:31], s36 offen offset:3072 lds
    ds_read_b64_tr_b16 v[160:161], v39 offset:0
    ds_read_b64_tr_b16 v[162:163], v39 offset:1024
    ds_read_b64_tr_b16 v[164:165], v39 offset:4096
    ds_read_b64_tr_b16 v[166:167], v39 offset:5120
    ds_read_b64_tr_b16 v[168:169], v39 offset:8192
    ds_read_b64_tr_b16 v[170:171], v39 offset:9216
    ds_read_b64_tr_b16 v[172:173], v39 offset:12288
    ds_read_b64_tr_b16 v[174:175], v39 offset:13312
    s_waitcnt lgkmcnt(11)
    v_mfma_f32_32x32x16_bf16 v[80:95], v[56:59], v[152:155], v[80:95]
    ds_read_b128 v[72:75], v42 offset:8192
    s_add_u32 m0, s40, 16384
    s_add_u32 s36, s38, 512
    buffer_load_dwordx4 v36, s[24:27], s36 offen lds
    s_waitcnt lgkmcnt(11)
    v_mfma_f32_32x32x16_bf16 v[96:111], v[60:63], v[152:155], v[96:111]
    ds_read_b128 v[76:79], v43 offset:8192
    s_add_u32 m0, s40, 49152
    s_add_u32 s36, s38, 33280
    buffer_load_dwordx4 v36, s[24:27], s36 offen lds
    s_waitcnt lgkmcnt(11)
    v_mfma_f32_32x32x16_bf16 v[80:95], v[64:67], v[156:159], v[80:95]
    v_xor_b32 v45, 32, v42
    ds_read_b128 v[56:59], v45 offset:8192
    s_waitcnt lgkmcnt(11)
    v_mfma_f32_32x32x16_bf16 v[96:111], v[68:71], v[156:159], v[96:111]
    v_xor_b32 v46, 32, v43
    ds_read_b128 v[60:63], v46 offset:8192
    s_waitcnt lgkmcnt(4)
    s_waitcnt lgkmcnt(3)
    v_mfma_f32_32x32x16_bf16 v[80:95], v[72:75], v[160:163], v[80:95]
    v_xor_b32 v47, 64, v42
    ds_read_b128 v[64:67], v47 offset:8192
    s_waitcnt lgkmcnt(3)
    v_mfma_f32_32x32x16_bf16 v[96:111], v[76:79], v[160:163], v[96:111]
    v_xor_b32 v45, 64, v43
    ds_read_b128 v[68:71], v45 offset:8192
    s_waitcnt lgkmcnt(3)
    v_mfma_f32_32x32x16_bf16 v[80:95], v[56:59], v[164:167], v[80:95]
    v_xor_b32 v46, 96, v42
    ds_read_b128 v[72:75], v46 offset:8192
    s_waitcnt lgkmcnt(3)
    v_mfma_f32_32x32x16_bf16 v[96:111], v[60:63], v[164:167], v[96:111]
    v_xor_b32 v47, 96, v43
    ds_read_b128 v[76:79], v47 offset:8192
    s_waitcnt vmcnt(6)
    s_barrier
    s_add_u32 m0, s41, 131072
    s_add_u32 s36, s39, 2621440
    buffer_load_dwordx4 v37, s[28:31], s36 offen offset:0 lds
    s_add_u32 s36, s39, 2653184
    buffer_load_dwordx4 v37, s[28:31], s36 offen offset:1024 lds
    s_add_u32 s36, s39, 2684928
    buffer_load_dwordx4 v37, s[28:31], s36 offen offset:2048 lds
    s_add_u32 s36, s39, 2716672
    buffer_load_dwordx4 v37, s[28:31], s36 offen offset:3072 lds
    ds_read_b64_tr_b16 v[176:177], v38 offset:0
    ds_read_b64_tr_b16 v[178:179], v38 offset:1024
    ds_read_b64_tr_b16 v[180:181], v38 offset:4096
    ds_read_b64_tr_b16 v[182:183], v38 offset:5120
    ds_read_b64_tr_b16 v[184:185], v38 offset:8192
    ds_read_b64_tr_b16 v[186:187], v38 offset:9216
    ds_read_b64_tr_b16 v[188:189], v38 offset:12288
    ds_read_b64_tr_b16 v[190:191], v38 offset:13312
    s_waitcnt lgkmcnt(11)
    v_mfma_f32_32x32x16_bf16 v[80:95], v[64:67], v[168:171], v[80:95]
    v_xor_b32 v45, 128, v42
    ds_read_b128 v[56:59], v45 offset:8192
    s_waitcnt lgkmcnt(11)
    v_mfma_f32_32x32x16_bf16 v[96:111], v[68:71], v[168:171], v[96:111]
    v_xor_b32 v46, 128, v43
    ds_read_b128 v[60:63], v46 offset:8192
    s_waitcnt lgkmcnt(11)
    v_mfma_f32_32x32x16_bf16 v[80:95], v[72:75], v[172:175], v[80:95]
    v_xor_b32 v47, 160, v42
    ds_read_b128 v[64:67], v47 offset:8192
    s_waitcnt lgkmcnt(11)
    v_mfma_f32_32x32x16_bf16 v[96:111], v[76:79], v[172:175], v[96:111]
    v_xor_b32 v45, 160, v43
    ds_read_b128 v[68:71], v45 offset:8192
    s_waitcnt lgkmcnt(4)
    s_waitcnt lgkmcnt(3)
    v_mfma_f32_32x32x16_bf16 v[80:95], v[56:59], v[176:179], v[80:95]
    v_xor_b32 v46, 192, v42
    ds_read_b128 v[72:75], v46 offset:8192
    s_waitcnt lgkmcnt(3)
    v_mfma_f32_32x32x16_bf16 v[96:111], v[60:63], v[176:179], v[96:111]
    v_xor_b32 v47, 192, v43
    ds_read_b128 v[76:79], v47 offset:8192
    s_waitcnt lgkmcnt(3)
    v_mfma_f32_32x32x16_bf16 v[80:95], v[64:67], v[180:183], v[80:95]
    v_xor_b32 v45, 224, v42
    ds_read_b128 v[56:59], v45 offset:8192
    s_waitcnt lgkmcnt(3)
    v_mfma_f32_32x32x16_bf16 v[96:111], v[68:71], v[180:183], v[96:111]
    v_xor_b32 v46, 224, v43
    ds_read_b128 v[60:63], v46 offset:8192
    s_waitcnt vmcnt(4)
    s_barrier
    s_add_u32 m0, s41, 65536
    s_add_u32 s36, s39, 3145728
    buffer_load_dwordx4 v37, s[28:31], s36 offen offset:0 lds
    s_add_u32 s36, s39, 3177472
    buffer_load_dwordx4 v37, s[28:31], s36 offen offset:1024 lds
    s_add_u32 s36, s39, 3209216
    buffer_load_dwordx4 v37, s[28:31], s36 offen offset:2048 lds
    s_add_u32 s36, s39, 3240960
    buffer_load_dwordx4 v37, s[28:31], s36 offen offset:3072 lds
    ds_read_b64_tr_b16 v[192:193], v38 offset:32768
    ds_read_b64_tr_b16 v[194:195], v38 offset:33792
    ds_read_b64_tr_b16 v[196:197], v38 offset:36864
    ds_read_b64_tr_b16 v[198:199], v38 offset:37888
    ds_read_b64_tr_b16 v[200:201], v38 offset:40960
    ds_read_b64_tr_b16 v[202:203], v38 offset:41984
    ds_read_b64_tr_b16 v[204:205], v38 offset:45056
    ds_read_b64_tr_b16 v[206:207], v38 offset:46080
    s_waitcnt lgkmcnt(11)
    v_mfma_f32_32x32x16_bf16 v[80:95], v[72:75], v[184:187], v[80:95]
    ds_read_b128 v[64:67], v42 offset:16384
    s_add_u32 m0, s40, 24576
    s_add_u32 s36, s38, 768
    buffer_load_dwordx4 v36, s[24:27], s36 offen lds
    s_waitcnt lgkmcnt(11)
    v_mfma_f32_32x32x16_bf16 v[96:111], v[76:79], v[184:187], v[96:111]
    ds_read_b128 v[68:71], v43 offset:16384
    s_add_u32 m0, s40, 57344
    s_add_u32 s36, s38, 33536
    buffer_load_dwordx4 v36, s[24:27], s36 offen lds
    s_waitcnt lgkmcnt(11)
    v_mfma_f32_32x32x16_bf16 v[80:95], v[56:59], v[188:191], v[80:95]
    v_xor_b32 v46, 32, v42
    ds_read_b128 v[72:75], v46 offset:16384
    s_waitcnt lgkmcnt(11)
    v_mfma_f32_32x32x16_bf16 v[96:111], v[60:63], v[188:191], v[96:111]
    v_xor_b32 v47, 32, v43
    ds_read_b128 v[76:79], v47 offset:16384
    s_waitcnt lgkmcnt(4)
    s_waitcnt lgkmcnt(3)
    v_mfma_f32_32x32x16_bf16 v[80:95], v[64:67], v[192:195], v[80:95]
    v_xor_b32 v45, 64, v42
    ds_read_b128 v[56:59], v45 offset:16384
    s_waitcnt lgkmcnt(3)
    v_mfma_f32_32x32x16_bf16 v[96:111], v[68:71], v[192:195], v[96:111]
    v_xor_b32 v46, 64, v43
    ds_read_b128 v[60:63], v46 offset:16384
    s_waitcnt lgkmcnt(3)
    v_mfma_f32_32x32x16_bf16 v[80:95], v[72:75], v[196:199], v[80:95]
    v_xor_b32 v47, 96, v42
    ds_read_b128 v[64:67], v47 offset:16384
    s_waitcnt lgkmcnt(3)
    v_mfma_f32_32x32x16_bf16 v[96:111], v[76:79], v[196:199], v[96:111]
    v_xor_b32 v45, 96, v43
    ds_read_b128 v[68:71], v45 offset:16384
    s_waitcnt vmcnt(6)
    s_barrier
    s_add_u32 m0, s41, 98304
    s_add_u32 s36, s39, 3670016
    buffer_load_dwordx4 v37, s[28:31], s36 offen offset:0 lds
    s_add_u32 s36, s39, 3701760
    buffer_load_dwordx4 v37, s[28:31], s36 offen offset:1024 lds
    s_add_u32 s36, s39, 3733504
    buffer_load_dwordx4 v37, s[28:31], s36 offen offset:2048 lds
    s_add_u32 s36, s39, 3765248
    buffer_load_dwordx4 v37, s[28:31], s36 offen offset:3072 lds
    ds_read_b64_tr_b16 v[208:209], v39 offset:0
    ds_read_b64_tr_b16 v[210:211], v39 offset:1024
    ds_read_b64_tr_b16 v[212:213], v39 offset:4096
    ds_read_b64_tr_b16 v[214:215], v39 offset:5120
    ds_read_b64_tr_b16 v[216:217], v39 offset:8192
    ds_read_b64_tr_b16 v[218:219], v39 offset:9216
    ds_read_b64_tr_b16 v[220:221], v39 offset:12288
    ds_read_b64_tr_b16 v[222:223], v39 offset:13312
    s_waitcnt lgkmcnt(11)
    v_mfma_f32_32x32x16_bf16 v[80:95], v[56:59], v[200:203], v[80:95]
    v_xor_b32 v46, 128, v42
    ds_read_b128 v[72:75], v46 offset:16384
    s_waitcnt lgkmcnt(11)
    v_mfma_f32_32x32x16_bf16 v[96:111], v[60:63], v[200:203], v[96:111]
    v_xor_b32 v47, 128, v43
    ds_read_b128 v[76:79], v47 offset:16384
    s_waitcnt lgkmcnt(11)
    v_mfma_f32_32x32x16_bf16 v[80:95], v[64:67], v[204:207], v[80:95]
    v_xor_b32 v45, 160, v42
    ds_read_b128 v[56:59], v45 offset:16384
    s_waitcnt lgkmcnt(11)
    v_mfma_f32_32x32x16_bf16 v[96:111], v[68:71], v[204:207], v[96:111]
    v_xor_b32 v46, 160, v43
    ds_read_b128 v[60:63], v46 offset:16384
    s_waitcnt lgkmcnt(4)
    s_waitcnt lgkmcnt(3)
    v_mfma_f32_32x32x16_bf16 v[80:95], v[72:75], v[208:211], v[80:95]
    v_xor_b32 v47, 192, v42
    ds_read_b128 v[64:67], v47 offset:16384
    s_waitcnt lgkmcnt(3)
    v_mfma_f32_32x32x16_bf16 v[96:111], v[76:79], v[208:211], v[96:111]
    v_xor_b32 v45, 192, v43
    ds_read_b128 v[68:71], v45 offset:16384
    s_waitcnt lgkmcnt(3)
    v_mfma_f32_32x32x16_bf16 v[80:95], v[56:59], v[212:215], v[80:95]
    v_xor_b32 v46, 224, v42
    ds_read_b128 v[72:75], v46 offset:16384
    s_waitcnt lgkmcnt(3)
    v_mfma_f32_32x32x16_bf16 v[96:111], v[60:63], v[212:215], v[96:111]
    v_xor_b32 v47, 224, v43
    ds_read_b128 v[76:79], v47 offset:16384
    s_waitcnt vmcnt(4)
    s_barrier
    s_add_u32 m0, s40, 131072
    s_add_u32 s36, s38, 65536
    buffer_load_dwordx4 v36, s[24:27], s36 offen lds
    s_add_u32 m0, s40, 139264
    s_add_u32 s36, s38, 65792
    buffer_load_dwordx4 v36, s[24:27], s36 offen lds
    s_add_u32 m0, s40, 147456
    s_add_u32 s36, s38, 66048
    buffer_load_dwordx4 v36, s[24:27], s36 offen lds
    s_add_u32 m0, s40, 155648
    s_add_u32 s36, s38, 66304
    buffer_load_dwordx4 v36, s[24:27], s36 offen lds
    ds_read_b64_tr_b16 v[224:225], v38 offset:0
    ds_read_b64_tr_b16 v[226:227], v38 offset:1024
    ds_read_b64_tr_b16 v[228:229], v38 offset:4096
    ds_read_b64_tr_b16 v[230:231], v38 offset:5120
    ds_read_b64_tr_b16 v[232:233], v38 offset:8192
    ds_read_b64_tr_b16 v[234:235], v38 offset:9216
    ds_read_b64_tr_b16 v[236:237], v38 offset:12288
    ds_read_b64_tr_b16 v[238:239], v38 offset:13312
    s_waitcnt lgkmcnt(11)
    v_mfma_f32_32x32x16_bf16 v[80:95], v[64:67], v[216:219], v[80:95]
    ds_read_b128 v[56:59], v42 offset:24576
    s_waitcnt lgkmcnt(11)
    v_mfma_f32_32x32x16_bf16 v[96:111], v[68:71], v[216:219], v[96:111]
    ds_read_b128 v[60:63], v43 offset:24576
    s_waitcnt lgkmcnt(11)
    v_mfma_f32_32x32x16_bf16 v[80:95], v[72:75], v[220:223], v[80:95]
    v_xor_b32 v47, 32, v42
    ds_read_b128 v[64:67], v47 offset:24576
    s_waitcnt lgkmcnt(11)
    v_mfma_f32_32x32x16_bf16 v[96:111], v[76:79], v[220:223], v[96:111]
    v_xor_b32 v45, 32, v43
    ds_read_b128 v[68:71], v45 offset:24576
    s_waitcnt lgkmcnt(4)
    s_waitcnt lgkmcnt(3)
    v_mfma_f32_32x32x16_bf16 v[80:95], v[56:59], v[224:227], v[80:95]
    v_xor_b32 v46, 64, v42
    ds_read_b128 v[72:75], v46 offset:24576
    s_waitcnt lgkmcnt(3)
    v_mfma_f32_32x32x16_bf16 v[96:111], v[60:63], v[224:227], v[96:111]
    v_xor_b32 v47, 64, v43
    ds_read_b128 v[76:79], v47 offset:24576
    s_waitcnt lgkmcnt(3)
    v_mfma_f32_32x32x16_bf16 v[80:95], v[64:67], v[228:231], v[80:95]
    v_xor_b32 v45, 96, v42
    ds_read_b128 v[56:59], v45 offset:24576
    s_waitcnt lgkmcnt(3)
    v_mfma_f32_32x32x16_bf16 v[96:111], v[68:71], v[228:231], v[96:111]
    v_xor_b32 v46, 96, v43
    ds_read_b128 v[60:63], v46 offset:24576
    s_waitcnt vmcnt(4)
    s_barrier
    s_add_u32 m0, s40, 65536
    s_add_u32 s36, s38, 98304
    buffer_load_dwordx4 v36, s[24:27], s36 offen lds
    s_add_u32 m0, s40, 73728
    s_add_u32 s36, s38, 98560
    buffer_load_dwordx4 v36, s[24:27], s36 offen lds
    s_add_u32 m0, s40, 81920
    s_add_u32 s36, s38, 98816
    buffer_load_dwordx4 v36, s[24:27], s36 offen lds
    s_add_u32 m0, s40, 90112
    s_add_u32 s36, s38, 99072
    buffer_load_dwordx4 v36, s[24:27], s36 offen lds
    ds_read_b64_tr_b16 v[240:241], v38 offset:32768
    ds_read_b64_tr_b16 v[242:243], v38 offset:33792
    ds_read_b64_tr_b16 v[244:245], v38 offset:36864
    ds_read_b64_tr_b16 v[246:247], v38 offset:37888
    ds_read_b64_tr_b16 v[248:249], v38 offset:40960
    ds_read_b64_tr_b16 v[250:251], v38 offset:41984
    ds_read_b64_tr_b16 v[252:253], v38 offset:45056
    ds_read_b64_tr_b16 v[254:255], v38 offset:46080
    s_waitcnt lgkmcnt(11)
    v_mfma_f32_32x32x16_bf16 v[80:95], v[72:75], v[232:235], v[80:95]
    v_xor_b32 v47, 128, v42
    ds_read_b128 v[64:67], v47 offset:24576
    s_waitcnt lgkmcnt(11)
    v_mfma_f32_32x32x16_bf16 v[96:111], v[76:79], v[232:235], v[96:111]
    v_xor_b32 v45, 128, v43
    ds_read_b128 v[68:71], v45 offset:24576
    s_waitcnt lgkmcnt(11)
    v_mfma_f32_32x32x16_bf16 v[80:95], v[56:59], v[236:239], v[80:95]
    v_xor_b32 v46, 160, v42
    ds_read_b128 v[72:75], v46 offset:24576
    s_waitcnt lgkmcnt(11)
    v_mfma_f32_32x32x16_bf16 v[96:111], v[60:63], v[236:239], v[96:111]
    v_xor_b32 v47, 160, v43
    ds_read_b128 v[76:79], v47 offset:24576
    s_waitcnt lgkmcnt(4)
    s_waitcnt lgkmcnt(3)
    v_mfma_f32_32x32x16_bf16 v[80:95], v[64:67], v[240:243], v[80:95]
    v_xor_b32 v45, 192, v42
    ds_read_b128 v[56:59], v45 offset:24576
    s_waitcnt lgkmcnt(3)
    v_mfma_f32_32x32x16_bf16 v[96:111], v[68:71], v[240:243], v[96:111]
    v_xor_b32 v46, 192, v43
    ds_read_b128 v[60:63], v46 offset:24576
    s_waitcnt lgkmcnt(3)
    v_mfma_f32_32x32x16_bf16 v[80:95], v[72:75], v[244:247], v[80:95]
    v_xor_b32 v47, 224, v42
    ds_read_b128 v[64:67], v47 offset:24576
    s_waitcnt lgkmcnt(3)
    v_mfma_f32_32x32x16_bf16 v[96:111], v[76:79], v[244:247], v[96:111]
    v_xor_b32 v45, 224, v43
    ds_read_b128 v[68:71], v45 offset:24576
    s_waitcnt vmcnt(4)
    s_barrier
    s_add_u32 m0, s40, 98304
    s_add_u32 s36, s38, 131072
    buffer_load_dwordx4 v36, s[24:27], s36 offen lds
    s_add_u32 m0, s40, 106496
    s_add_u32 s36, s38, 131328
    buffer_load_dwordx4 v36, s[24:27], s36 offen lds
    s_add_u32 m0, s40, 114688
    s_add_u32 s36, s38, 131584
    buffer_load_dwordx4 v36, s[24:27], s36 offen lds
    s_add_u32 m0, s40, 122880
    s_add_u32 s36, s38, 131840
    buffer_load_dwordx4 v36, s[24:27], s36 offen lds
    v_add_u32 v44, 131072, v40
    s_waitcnt lgkmcnt(3)
    v_mfma_f32_32x32x16_bf16 v[80:95], v[56:59], v[248:251], v[80:95]
    ds_read_b128 v[72:75], v44 offset:0
    s_waitcnt lgkmcnt(3)
    v_mfma_f32_32x32x16_bf16 v[96:111], v[60:63], v[248:251], v[96:111]
    v_xor_b32 v47, 32, v44
    ds_read_b128 v[76:79], v47 offset:0
    s_waitcnt lgkmcnt(3)
    v_mfma_f32_32x32x16_bf16 v[80:95], v[64:67], v[252:255], v[80:95]
    v_xor_b32 v45, 64, v44
    ds_read_b128 v[56:59], v45 offset:0
    s_waitcnt lgkmcnt(3)
    v_mfma_f32_32x32x16_bf16 v[96:111], v[68:71], v[252:255], v[96:111]
    v_xor_b32 v46, 96, v44
    ds_read_b128 v[60:63], v46 offset:0
    s_waitcnt lgkmcnt(3)
    v_mfma_f32_32x32x16_bf16 v[112:127], v[72:75], v[128:131], 0
    v_xor_b32 v47, 128, v44
    ds_read_b128 v[64:67], v47 offset:0
    s_lshl_b32 s36, s3, 11
    s_add_u32 m0, s36, 32768
    s_nop 0
    buffer_load_dwordx4 v26, s[64:67], s72 offen lds
    s_add_u32 m0, s36, 33792
    s_nop 0
    buffer_load_dwordx4 v27, s[68:71], s73 offen lds
    s_waitcnt lgkmcnt(3)
    v_mfma_f32_32x32x16_bf16 v[112:127], v[76:79], v[132:135], v[112:127]
    v_xor_b32 v45, 160, v44
    ds_read_b128 v[68:71], v45 offset:0
    s_waitcnt lgkmcnt(3)
    v_mfma_f32_32x32x16_bf16 v[112:127], v[56:59], v[136:139], v[112:127]
    v_xor_b32 v46, 192, v44
    ds_read_b128 v[72:75], v46 offset:0
    s_waitcnt lgkmcnt(3)
    v_mfma_f32_32x32x16_bf16 v[112:127], v[60:63], v[140:143], v[112:127]
    v_xor_b32 v47, 224, v44
    ds_read_b128 v[76:79], v47 offset:0
    s_waitcnt lgkmcnt(3)
    v_mfma_f32_32x32x16_bf16 v[112:127], v[64:67], v[144:147], v[112:127]
    ds_read_b128 v[56:59], v44 offset:8192
    v_cvt_pk_bf16_f32 v48, v80, v81
    v_cvt_pk_bf16_f32 v49, v82, v83
    s_waitcnt lgkmcnt(3)
    v_mfma_f32_32x32x16_bf16 v[112:127], v[68:71], v[148:151], v[112:127]
    v_xor_b32 v46, 32, v44
    ds_read_b128 v[60:63], v46 offset:8192
    v_cvt_pk_bf16_f32 v50, v84, v85
    v_cvt_pk_bf16_f32 v51, v86, v87
    s_waitcnt lgkmcnt(3)
    v_mfma_f32_32x32x16_bf16 v[112:127], v[72:75], v[152:155], v[112:127]
    v_xor_b32 v47, 64, v44
    ds_read_b128 v[64:67], v47 offset:8192
    s_add_u32 s43, s42, 0
    buffer_store_dwordx4 v[48:51], v41, s[60:63], s43 offen sc1
    s_waitcnt lgkmcnt(3)
    v_mfma_f32_32x32x16_bf16 v[112:127], v[76:79], v[156:159], v[112:127]
    v_xor_b32 v45, 96, v44
    ds_read_b128 v[68:71], v45 offset:8192
    s_waitcnt lgkmcnt(3)
    v_mfma_f32_32x32x16_bf16 v[112:127], v[56:59], v[160:163], v[112:127]
    v_xor_b32 v46, 128, v44
    ds_read_b128 v[72:75], v46 offset:8192
    s_waitcnt lgkmcnt(3)
    v_mfma_f32_32x32x16_bf16 v[112:127], v[60:63], v[164:167], v[112:127]
    v_xor_b32 v47, 160, v44
    ds_read_b128 v[76:79], v47 offset:8192
    s_waitcnt lgkmcnt(3)
    v_mfma_f32_32x32x16_bf16 v[112:127], v[64:67], v[168:171], v[112:127]
    v_xor_b32 v45, 192, v44
    ds_read_b128 v[56:59], v45 offset:8192
    s_waitcnt lgkmcnt(3)
    v_mfma_f32_32x32x16_bf16 v[112:127], v[68:71], v[172:175], v[112:127]
    v_xor_b32 v46, 224, v44
    ds_read_b128 v[60:63], v46 offset:8192
    s_waitcnt lgkmcnt(3)
    v_mfma_f32_32x32x16_bf16 v[112:127], v[72:75], v[176:179], v[112:127]
    ds_read_b128 v[64:67], v44 offset:16384
    v_cvt_pk_bf16_f32 v52, v88, v89
    v_cvt_pk_bf16_f32 v53, v90, v91
    s_waitcnt lgkmcnt(3)
    v_mfma_f32_32x32x16_bf16 v[112:127], v[76:79], v[180:183], v[112:127]
    v_xor_b32 v45, 32, v44
    ds_read_b128 v[68:71], v45 offset:16384
    v_cvt_pk_bf16_f32 v54, v92, v93
    v_cvt_pk_bf16_f32 v55, v94, v95
    s_waitcnt lgkmcnt(3)
    v_mfma_f32_32x32x16_bf16 v[112:127], v[56:59], v[184:187], v[112:127]
    v_xor_b32 v46, 64, v44
    ds_read_b128 v[72:75], v46 offset:16384
    s_add_u32 s43, s42, 1024
    buffer_store_dwordx4 v[52:55], v41, s[60:63], s43 offen sc1
    s_waitcnt lgkmcnt(3)
    v_mfma_f32_32x32x16_bf16 v[112:127], v[60:63], v[188:191], v[112:127]
    v_xor_b32 v47, 96, v44
    ds_read_b128 v[76:79], v47 offset:16384
    s_waitcnt lgkmcnt(3)
    v_mfma_f32_32x32x16_bf16 v[112:127], v[64:67], v[192:195], v[112:127]
    v_xor_b32 v45, 128, v44
    ds_read_b128 v[56:59], v45 offset:16384
    s_waitcnt lgkmcnt(3)
    v_mfma_f32_32x32x16_bf16 v[112:127], v[68:71], v[196:199], v[112:127]
    v_xor_b32 v46, 160, v44
    ds_read_b128 v[60:63], v46 offset:16384
    s_waitcnt lgkmcnt(3)
    v_mfma_f32_32x32x16_bf16 v[112:127], v[72:75], v[200:203], v[112:127]
    v_xor_b32 v47, 192, v44
    ds_read_b128 v[64:67], v47 offset:16384
    s_waitcnt lgkmcnt(3)
    v_mfma_f32_32x32x16_bf16 v[112:127], v[76:79], v[204:207], v[112:127]
    v_xor_b32 v45, 224, v44
    ds_read_b128 v[68:71], v45 offset:16384
    s_waitcnt vmcnt(8)
    s_barrier
    s_add_u32 m0, s40, 0
    s_add_u32 s36, s38, 163840
    buffer_load_dwordx4 v36, s[24:27], s36 offen lds
    s_add_u32 m0, s40, 8192
    s_add_u32 s36, s38, 164096
    buffer_load_dwordx4 v36, s[24:27], s36 offen lds
    s_add_u32 m0, s40, 16384
    s_add_u32 s36, s38, 164352
    buffer_load_dwordx4 v36, s[24:27], s36 offen lds
    s_add_u32 m0, s40, 24576
    s_add_u32 s36, s38, 164608
    buffer_load_dwordx4 v36, s[24:27], s36 offen lds
    v_add_u32 v42, 65536, v40
    s_waitcnt lgkmcnt(3)
    v_mfma_f32_32x32x16_bf16 v[112:127], v[56:59], v[208:211], v[112:127]
    ds_read_b128 v[72:75], v44 offset:24576
    v_cvt_pk_bf16_f32 v48, v96, v97
    v_cvt_pk_bf16_f32 v49, v98, v99
    s_waitcnt lgkmcnt(3)
    v_mfma_f32_32x32x16_bf16 v[112:127], v[60:63], v[212:215], v[112:127]
    v_xor_b32 v47, 32, v44
    ds_read_b128 v[76:79], v47 offset:24576
    v_cvt_pk_bf16_f32 v50, v100, v101
    v_cvt_pk_bf16_f32 v51, v102, v103
    s_waitcnt lgkmcnt(3)
    v_mfma_f32_32x32x16_bf16 v[112:127], v[64:67], v[216:219], v[112:127]
    v_xor_b32 v45, 64, v44
    ds_read_b128 v[56:59], v45 offset:24576
    s_add_u32 s43, s42, 2048
    buffer_store_dwordx4 v[48:51], v41, s[60:63], s43 offen sc1
    s_waitcnt lgkmcnt(3)
    v_mfma_f32_32x32x16_bf16 v[112:127], v[68:71], v[220:223], v[112:127]
    v_xor_b32 v46, 96, v44
    ds_read_b128 v[60:63], v46 offset:24576
    s_waitcnt lgkmcnt(3)
    v_mfma_f32_32x32x16_bf16 v[112:127], v[72:75], v[224:227], v[112:127]
    v_xor_b32 v47, 128, v44
    ds_read_b128 v[64:67], v47 offset:24576
    s_waitcnt lgkmcnt(3)
    v_mfma_f32_32x32x16_bf16 v[112:127], v[76:79], v[228:231], v[112:127]
    v_xor_b32 v45, 160, v44
    ds_read_b128 v[68:71], v45 offset:24576
    s_waitcnt lgkmcnt(3)
    v_mfma_f32_32x32x16_bf16 v[112:127], v[56:59], v[232:235], v[112:127]
    v_xor_b32 v46, 192, v44
    ds_read_b128 v[72:75], v46 offset:24576
    s_waitcnt lgkmcnt(3)
    v_mfma_f32_32x32x16_bf16 v[112:127], v[60:63], v[236:239], v[112:127]
    v_xor_b32 v47, 224, v44
    ds_read_b128 v[76:79], v47 offset:24576
    s_waitcnt lgkmcnt(3)
    v_mfma_f32_32x32x16_bf16 v[112:127], v[64:67], v[240:243], v[112:127]
    ds_read_b128 v[56:59], v42 offset:0
    v_cvt_pk_bf16_f32 v52, v104, v105
    v_cvt_pk_bf16_f32 v53, v106, v107
    s_waitcnt lgkmcnt(3)
    v_mfma_f32_32x32x16_bf16 v[112:127], v[68:71], v[244:247], v[112:127]
    v_xor_b32 v46, 32, v42
    ds_read_b128 v[60:63], v46 offset:0
    v_cvt_pk_bf16_f32 v54, v108, v109
    v_cvt_pk_bf16_f32 v55, v110, v111
    s_waitcnt lgkmcnt(3)
    v_mfma_f32_32x32x16_bf16 v[112:127], v[72:75], v[248:251], v[112:127]
    v_xor_b32 v47, 64, v42
    ds_read_b128 v[64:67], v47 offset:0
    s_add_u32 s43, s42, 3072
    buffer_store_dwordx4 v[52:55], v41, s[60:63], s43 offen sc1
    s_waitcnt lgkmcnt(3)
    v_mfma_f32_32x32x16_bf16 v[112:127], v[76:79], v[252:255], v[112:127]
    v_xor_b32 v45, 96, v42
    ds_read_b128 v[68:71], v45 offset:0
    v_lshrrev_b32 v16, 5, v1
    v_lshlrev_b32 v16, 8, v16
    v_bfe_u32 v17, v1, 2, 2
    v_lshlrev_b32 v17, 6, v17
    v_or_b32 v16, v16, v17
    v_bfe_u32 v17, v1, 4, 1
    v_lshlrev_b32 v17, 5, v17
    v_or_b32 v16, v16, v17
    v_and_b32 v17, 3, v1
    v_lshlrev_b32 v17, 3, v17
    v_or_b32 v16, v16, v17
    s_lshl_b32 s36, s3, 11
    s_add_u32 s36, s36, 32768
    v_add_u32 v16, s36, v16
    v_and_b32 v18, 0x40000000, v27
    v_or_b32 v18, v18, v41
    s_waitcnt lgkmcnt(3)
    v_mfma_f32_32x32x16_bf16 v[80:95], v[56:59], v[128:131], 0
    v_xor_b32 v46, 128, v42
    ds_read_b128 v[72:75], v46 offset:0
    s_waitcnt lgkmcnt(3)
    v_mfma_f32_32x32x16_bf16 v[80:95], v[60:63], v[132:135], v[80:95]
    v_xor_b32 v47, 160, v42
    ds_read_b128 v[76:79], v47 offset:0
    s_waitcnt lgkmcnt(3)
    v_mfma_f32_32x32x16_bf16 v[80:95], v[64:67], v[136:139], v[80:95]
    v_xor_b32 v45, 192, v42
    ds_read_b128 v[56:59], v45 offset:0
    s_waitcnt lgkmcnt(3)
    v_mfma_f32_32x32x16_bf16 v[80:95], v[68:71], v[140:143], v[80:95]
    v_xor_b32 v46, 224, v42
    ds_read_b128 v[60:63], v46 offset:0
    s_waitcnt lgkmcnt(3)
    v_mfma_f32_32x32x16_bf16 v[80:95], v[72:75], v[144:147], v[80:95]
    ds_read_b128 v[64:67], v42 offset:8192
    buffer_load_dword v24, v0, s[48:51], s47 offen
    s_waitcnt lgkmcnt(3)
    v_mfma_f32_32x32x16_bf16 v[80:95], v[76:79], v[148:151], v[80:95]
    v_xor_b32 v45, 32, v42
    ds_read_b128 v[68:71], v45 offset:8192
    s_waitcnt lgkmcnt(3)
    v_mfma_f32_32x32x16_bf16 v[80:95], v[56:59], v[152:155], v[80:95]
    v_xor_b32 v46, 64, v42
    ds_read_b128 v[72:75], v46 offset:8192
    s_waitcnt lgkmcnt(3)
    v_mfma_f32_32x32x16_bf16 v[80:95], v[60:63], v[156:159], v[80:95]
    v_xor_b32 v47, 96, v42
    ds_read_b128 v[76:79], v47 offset:8192
    s_waitcnt lgkmcnt(3)
    v_mfma_f32_32x32x16_bf16 v[80:95], v[64:67], v[160:163], v[80:95]
    v_xor_b32 v45, 128, v42
    ds_read_b128 v[56:59], v45 offset:8192
    s_waitcnt lgkmcnt(3)
    v_mfma_f32_32x32x16_bf16 v[80:95], v[68:71], v[164:167], v[80:95]
    v_xor_b32 v46, 160, v42
    ds_read_b128 v[60:63], v46 offset:8192
    s_waitcnt lgkmcnt(3)
    v_mfma_f32_32x32x16_bf16 v[80:95], v[72:75], v[168:171], v[80:95]
    v_xor_b32 v47, 192, v42
    ds_read_b128 v[64:67], v47 offset:8192
    s_waitcnt lgkmcnt(3)
    v_mfma_f32_32x32x16_bf16 v[80:95], v[76:79], v[172:175], v[80:95]
    v_xor_b32 v45, 224, v42
    ds_read_b128 v[68:71], v45 offset:8192
    v_cvt_pk_bf16_f32 v48, v112, v113
    v_cvt_pk_bf16_f32 v49, v114, v115
    s_waitcnt vmcnt(9)
    ds_read_b64_tr_b16 v[8:9], v16 offset:0
    ds_read_b64_tr_b16 v[10:11], v16 offset:512
    ds_read_b64_tr_b16 v[12:13], v16 offset:1024
    ds_read_b64_tr_b16 v[14:15], v16 offset:1536
    s_waitcnt lgkmcnt(7)
    v_mfma_f32_32x32x16_bf16 v[80:95], v[56:59], v[176:179], v[80:95]
    ds_read_b128 v[72:75], v42 offset:16384
    v_cvt_pk_bf16_f32 v50, v116, v117
    v_cvt_pk_bf16_f32 v51, v118, v119
    s_waitcnt lgkmcnt(7)
    v_mfma_f32_32x32x16_bf16 v[80:95], v[60:63], v[180:183], v[80:95]
    v_xor_b32 v47, 32, v42
    ds_read_b128 v[76:79], v47 offset:16384
    s_add_u32 s43, s42, 32768
    buffer_store_dwordx4 v[48:51], v41, s[60:63], s43 offen sc1
    s_waitcnt lgkmcnt(7)
    v_mfma_f32_32x32x16_bf16 v[80:95], v[64:67], v[184:187], v[80:95]
    v_xor_b32 v45, 64, v42
    ds_read_b128 v[56:59], v45 offset:16384
    s_waitcnt lgkmcnt(7)
    v_mfma_f32_32x32x16_bf16 v[80:95], v[68:71], v[188:191], v[80:95]
    v_xor_b32 v46, 96, v42
    ds_read_b128 v[60:63], v46 offset:16384
    s_waitcnt lgkmcnt(3)
    v_mfma_f32_32x32x16_bf16 v[80:95], v[72:75], v[192:195], v[80:95]
    v_xor_b32 v47, 128, v42
    ds_read_b128 v[64:67], v47 offset:16384
    s_waitcnt lgkmcnt(5)
    buffer_store_dwordx4 v[8:11], v41, s[32:35], s74 offen sc1
    buffer_store_dwordx4 v[12:15], v18, s[32:35], s75 offen sc1
    s_waitcnt lgkmcnt(3)
    v_mfma_f32_32x32x16_bf16 v[80:95], v[76:79], v[196:199], v[80:95]
    v_xor_b32 v45, 160, v42
    ds_read_b128 v[68:71], v45 offset:16384
    s_waitcnt lgkmcnt(3)
    v_mfma_f32_32x32x16_bf16 v[80:95], v[56:59], v[200:203], v[80:95]
    v_xor_b32 v46, 192, v42
    ds_read_b128 v[72:75], v46 offset:16384
    s_waitcnt lgkmcnt(3)
    v_mfma_f32_32x32x16_bf16 v[80:95], v[60:63], v[204:207], v[80:95]
    v_xor_b32 v47, 224, v42
    ds_read_b128 v[76:79], v47 offset:16384
    s_waitcnt vmcnt(14)
    s_barrier
    s_add_u32 m0, s40, 32768
    s_add_u32 s36, s38, 196608
    buffer_load_dwordx4 v36, s[24:27], s36 offen lds
    s_add_u32 m0, s40, 40960
    s_add_u32 s36, s38, 196864
    buffer_load_dwordx4 v36, s[24:27], s36 offen lds
    s_add_u32 m0, s40, 49152
    s_add_u32 s36, s38, 197120
    buffer_load_dwordx4 v36, s[24:27], s36 offen lds
    s_add_u32 m0, s40, 57344
    s_add_u32 s36, s38, 197376
    buffer_load_dwordx4 v36, s[24:27], s36 offen lds
    v_add_u32 v43, 98304, v40
    s_waitcnt lgkmcnt(3)
    v_mfma_f32_32x32x16_bf16 v[80:95], v[64:67], v[208:211], v[80:95]
    ds_read_b128 v[56:59], v42 offset:24576
    s_waitcnt lgkmcnt(3)
    v_mfma_f32_32x32x16_bf16 v[80:95], v[68:71], v[212:215], v[80:95]
    v_xor_b32 v46, 32, v42
    ds_read_b128 v[60:63], v46 offset:24576
    s_waitcnt lgkmcnt(3)
    v_mfma_f32_32x32x16_bf16 v[80:95], v[72:75], v[216:219], v[80:95]
    v_xor_b32 v47, 64, v42
    ds_read_b128 v[64:67], v47 offset:24576
    s_waitcnt lgkmcnt(3)
    v_mfma_f32_32x32x16_bf16 v[80:95], v[76:79], v[220:223], v[80:95]
    v_xor_b32 v45, 96, v42
    ds_read_b128 v[68:71], v45 offset:24576
    s_waitcnt lgkmcnt(3)
    v_mfma_f32_32x32x16_bf16 v[80:95], v[56:59], v[224:227], v[80:95]
    v_xor_b32 v46, 128, v42
    ds_read_b128 v[72:75], v46 offset:24576
    s_waitcnt lgkmcnt(3)
    v_mfma_f32_32x32x16_bf16 v[80:95], v[60:63], v[228:231], v[80:95]
    v_xor_b32 v47, 160, v42
    ds_read_b128 v[76:79], v47 offset:24576
    s_waitcnt lgkmcnt(3)
    v_mfma_f32_32x32x16_bf16 v[80:95], v[64:67], v[232:235], v[80:95]
    v_xor_b32 v45, 192, v42
    ds_read_b128 v[56:59], v45 offset:24576
    s_waitcnt lgkmcnt(3)
    v_mfma_f32_32x32x16_bf16 v[80:95], v[68:71], v[236:239], v[80:95]
    v_xor_b32 v46, 224, v42
    ds_read_b128 v[60:63], v46 offset:24576
    v_cvt_pk_bf16_f32 v52, v120, v121
    v_cvt_pk_bf16_f32 v53, v122, v123
    s_waitcnt lgkmcnt(3)
    v_mfma_f32_32x32x16_bf16 v[80:95], v[72:75], v[240:243], v[80:95]
    ds_read_b128 v[64:67], v43 offset:0
    v_cvt_pk_bf16_f32 v54, v124, v125
    v_cvt_pk_bf16_f32 v55, v126, v127
    s_waitcnt lgkmcnt(3)
    v_mfma_f32_32x32x16_bf16 v[80:95], v[76:79], v[244:247], v[80:95]
    v_xor_b32 v45, 32, v43
    ds_read_b128 v[68:71], v45 offset:0
    s_add_u32 s43, s42, 33792
    buffer_store_dwordx4 v[52:55], v41, s[60:63], s43 offen sc1
    s_waitcnt lgkmcnt(3)
    v_mfma_f32_32x32x16_bf16 v[80:95], v[56:59], v[248:251], v[80:95]
    v_xor_b32 v46, 64, v43
    ds_read_b128 v[72:75], v46 offset:0
    s_waitcnt lgkmcnt(3)
    v_mfma_f32_32x32x16_bf16 v[80:95], v[60:63], v[252:255], v[80:95]
    v_xor_b32 v47, 96, v43
    ds_read_b128 v[76:79], v47 offset:0
    s_waitcnt lgkmcnt(3)
    v_mfma_f32_32x32x16_bf16 v[96:111], v[64:67], v[128:131], 0
    v_xor_b32 v45, 128, v43
    ds_read_b128 v[56:59], v45 offset:0
    s_waitcnt lgkmcnt(3)
    v_mfma_f32_32x32x16_bf16 v[96:111], v[68:71], v[132:135], v[96:111]
    v_xor_b32 v46, 160, v43
    ds_read_b128 v[60:63], v46 offset:0
    s_waitcnt lgkmcnt(3)
    v_mfma_f32_32x32x16_bf16 v[96:111], v[72:75], v[136:139], v[96:111]
    v_xor_b32 v47, 192, v43
    ds_read_b128 v[64:67], v47 offset:0
    s_waitcnt lgkmcnt(3)
    v_mfma_f32_32x32x16_bf16 v[96:111], v[76:79], v[140:143], v[96:111]
    v_xor_b32 v45, 224, v43
    ds_read_b128 v[68:71], v45 offset:0
    s_waitcnt lgkmcnt(3)
    v_mfma_f32_32x32x16_bf16 v[96:111], v[56:59], v[144:147], v[96:111]
    ds_read_b128 v[72:75], v43 offset:8192
    s_waitcnt lgkmcnt(3)
    v_mfma_f32_32x32x16_bf16 v[96:111], v[60:63], v[148:151], v[96:111]
    v_xor_b32 v47, 32, v43
    ds_read_b128 v[76:79], v47 offset:8192
    s_waitcnt lgkmcnt(3)
    v_mfma_f32_32x32x16_bf16 v[96:111], v[64:67], v[152:155], v[96:111]
    v_xor_b32 v45, 64, v43
    ds_read_b128 v[56:59], v45 offset:8192
    s_waitcnt lgkmcnt(3)
    v_mfma_f32_32x32x16_bf16 v[96:111], v[68:71], v[156:159], v[96:111]
    v_xor_b32 v46, 96, v43
    ds_read_b128 v[60:63], v46 offset:8192
    s_waitcnt lgkmcnt(3)
    v_mfma_f32_32x32x16_bf16 v[96:111], v[72:75], v[160:163], v[96:111]
    v_xor_b32 v47, 128, v43
    ds_read_b128 v[64:67], v47 offset:8192
    s_waitcnt lgkmcnt(3)
    v_mfma_f32_32x32x16_bf16 v[96:111], v[76:79], v[164:167], v[96:111]
    v_xor_b32 v45, 160, v43
    ds_read_b128 v[68:71], v45 offset:8192
    s_waitcnt lgkmcnt(3)
    v_mfma_f32_32x32x16_bf16 v[96:111], v[56:59], v[168:171], v[96:111]
    v_xor_b32 v46, 192, v43
    ds_read_b128 v[72:75], v46 offset:8192
    s_waitcnt lgkmcnt(3)
    v_mfma_f32_32x32x16_bf16 v[96:111], v[60:63], v[172:175], v[96:111]
    v_xor_b32 v47, 224, v43
    ds_read_b128 v[76:79], v47 offset:8192
    v_cvt_pk_bf16_f32 v48, v80, v81
    v_cvt_pk_bf16_f32 v49, v82, v83
    s_waitcnt lgkmcnt(3)
    v_mfma_f32_32x32x16_bf16 v[96:111], v[64:67], v[176:179], v[96:111]
    ds_read_b128 v[56:59], v43 offset:16384
    v_cvt_pk_bf16_f32 v50, v84, v85
    v_cvt_pk_bf16_f32 v51, v86, v87
    s_waitcnt lgkmcnt(3)
    v_mfma_f32_32x32x16_bf16 v[96:111], v[68:71], v[180:183], v[96:111]
    v_xor_b32 v46, 32, v43
    ds_read_b128 v[60:63], v46 offset:16384
    s_add_u32 s43, s42, 34816
    buffer_store_dwordx4 v[48:51], v41, s[60:63], s43 offen sc1
    s_waitcnt lgkmcnt(3)
    v_mfma_f32_32x32x16_bf16 v[96:111], v[72:75], v[184:187], v[96:111]
    v_xor_b32 v47, 64, v43
    ds_read_b128 v[64:67], v47 offset:16384
    s_waitcnt lgkmcnt(3)
    v_mfma_f32_32x32x16_bf16 v[96:111], v[76:79], v[188:191], v[96:111]
    v_xor_b32 v45, 96, v43
    ds_read_b128 v[68:71], v45 offset:16384
    s_waitcnt lgkmcnt(3)
    v_mfma_f32_32x32x16_bf16 v[96:111], v[56:59], v[192:195], v[96:111]
    v_xor_b32 v46, 128, v43
    ds_read_b128 v[72:75], v46 offset:16384
    s_waitcnt lgkmcnt(3)
    v_mfma_f32_32x32x16_bf16 v[96:111], v[60:63], v[196:199], v[96:111]
    v_xor_b32 v47, 160, v43
    ds_read_b128 v[76:79], v47 offset:16384
    s_waitcnt lgkmcnt(3)
    v_mfma_f32_32x32x16_bf16 v[96:111], v[64:67], v[200:203], v[96:111]
    v_xor_b32 v45, 192, v43
    ds_read_b128 v[56:59], v45 offset:16384
    s_waitcnt lgkmcnt(3)
    v_mfma_f32_32x32x16_bf16 v[96:111], v[68:71], v[204:207], v[96:111]
    v_xor_b32 v46, 224, v43
    ds_read_b128 v[60:63], v46 offset:16384
    s_waitcnt vmcnt(12)
    s_barrier
    s_add_u32 m0, s40, 131072
    s_add_u32 s36, s38, 229376
    buffer_load_dwordx4 v36, s[24:27], s36 offen lds
    s_add_u32 m0, s40, 139264
    s_add_u32 s36, s38, 229632
    buffer_load_dwordx4 v36, s[24:27], s36 offen lds
    s_add_u32 m0, s40, 147456
    s_add_u32 s36, s38, 229888
    buffer_load_dwordx4 v36, s[24:27], s36 offen lds
    s_add_u32 m0, s40, 155648
    s_add_u32 s36, s38, 230144
    buffer_load_dwordx4 v36, s[24:27], s36 offen lds
    v_add_u32 v44, 0, v40
    s_waitcnt lgkmcnt(3)
    v_mfma_f32_32x32x16_bf16 v[96:111], v[72:75], v[208:211], v[96:111]
    ds_read_b128 v[64:67], v43 offset:24576
    s_lshr_b32 s67, s2, 3
    s_sub_u32 s67, s67, 4
    s_max_i32 s67, s67, 0
    s_waitcnt lgkmcnt(3)
    v_mfma_f32_32x32x16_bf16 v[96:111], v[76:79], v[212:215], v[96:111]
    v_xor_b32 v45, 32, v43
    ds_read_b128 v[68:71], v45 offset:24576
    s_mul_i32 s5, s67, 37
    s_lshr_b32 s5, s5, 8
    s_lshl_b32 s64, s14, 2
    s_waitcnt lgkmcnt(3)
    v_mfma_f32_32x32x16_bf16 v[96:111], v[56:59], v[216:219], v[96:111]
    v_xor_b32 v46, 64, v43
    ds_read_b128 v[72:75], v46 offset:24576
    s_add_u32 s64, s64, s5
    s_mul_i32 s5, s5, 7
    s_sub_u32 s67, s67, s5
    s_waitcnt lgkmcnt(3)
    v_mfma_f32_32x32x16_bf16 v[96:111], v[60:63], v[220:223], v[96:111]
    v_xor_b32 v47, 96, v43
    ds_read_b128 v[76:79], v47 offset:24576
    s_lshl_b32 s64, s64, 8
    s_lshl_b32 s65, s3, 16
    s_add_u32 s64, s64, s65
    s_waitcnt lgkmcnt(3)
    v_mfma_f32_32x32x16_bf16 v[96:111], v[64:67], v[224:227], v[96:111]
    v_xor_b32 v45, 128, v43
    ds_read_b128 v[56:59], v45 offset:24576
    s_lshl_b32 s65, s3, 11
    s_sub_u32 s66, 15, s67
    s_add_u32 s5, s67, 4
    s_waitcnt lgkmcnt(3)
    v_mfma_f32_32x32x16_bf16 v[96:111], v[68:71], v[228:231], v[96:111]
    v_xor_b32 v46, 160, v43
    ds_read_b128 v[60:63], v46 offset:24576
    s_cmp_eq_u32 s67, 6
    s_cselect_b32 s66, 3, s66
    s_cselect_b32 s5, 0, s5
    s_cmp_lt_u32 s3, 4
    s_cselect_b32 s66, s5, s66
    s_lshl_b32 s66, s66, 2
    s_waitcnt lgkmcnt(3)
    v_mfma_f32_32x32x16_bf16 v[96:111], v[72:75], v[232:235], v[96:111]
    v_xor_b32 v47, 192, v43
    ds_read_b128 v[64:67], v47 offset:24576
    s_and_b32 s5, s3, 3
    s_add_u32 s66, s66, s5
    s_lshl_b32 s66, s66, 15
    s_waitcnt lgkmcnt(3)
    v_mfma_f32_32x32x16_bf16 v[96:111], v[76:79], v[236:239], v[96:111]
    v_xor_b32 v45, 224, v43
    ds_read_b128 v[68:71], v45 offset:24576
    v_cvt_pk_bf16_f32 v52, v88, v89
    v_cvt_pk_bf16_f32 v53, v90, v91
    s_mov_b32 s24, s52
    s_mov_b32 s25, s53
    s_mov_b32 s27, 0x00020000
    s_waitcnt lgkmcnt(3)
    v_mfma_f32_32x32x16_bf16 v[96:111], v[56:59], v[240:243], v[96:111]
    ds_read_b128 v[72:75], v44 offset:0
    v_cvt_pk_bf16_f32 v54, v92, v93
    v_cvt_pk_bf16_f32 v55, v94, v95
    s_add_u32 s20, s12, 0x0
    s_addc_u32 s21, s13, 0
    s_mov_b32 s23, 0x00020000
    s_cmp_ge_u32 s2, 32
    s_cselect_b32 s26, 0x400000, 0
    s_cselect_b32 s22, 0x200000, 0
    s_waitcnt lgkmcnt(3)
    v_mfma_f32_32x32x16_bf16 v[96:111], v[60:63], v[244:247], v[96:111]
    v_xor_b32 v47, 32, v44
    ds_read_b128 v[76:79], v47 offset:0
    s_add_u32 s43, s42, 35840
    buffer_store_dwordx4 v[52:55], v41, s[60:63], s43 offen sc1
    v_lshrrev_b32 v29, 4, v1
    v_and_b32 v30, 15, v1
    v_lshlrev_b32 v28, 13, v29
    s_waitcnt lgkmcnt(3)
    v_mfma_f32_32x32x16_bf16 v[96:111], v[64:67], v[248:251], v[96:111]
    v_xor_b32 v45, 64, v44
    ds_read_b128 v[56:59], v45 offset:0
    v_lshlrev_b32 v29, 2, v29
    v_xor_b32 v30, v30, v29
    v_lshlrev_b32 v30, 4, v30
    s_waitcnt lgkmcnt(3)
    v_mfma_f32_32x32x16_bf16 v[96:111], v[68:71], v[252:255], v[96:111]
    v_xor_b32 v46, 96, v44
    ds_read_b128 v[60:63], v46 offset:0
    v_or_b32 v28, v28, v30
    s_waitcnt lgkmcnt(3)
    v_mfma_f32_32x32x16_bf16 v[112:127], v[72:75], v[128:131], 0
    v_xor_b32 v47, 128, v44
    ds_read_b128 v[64:67], v47 offset:0
    s_waitcnt lgkmcnt(3)
    v_mfma_f32_32x32x16_bf16 v[112:127], v[76:79], v[132:135], v[112:127]
    v_xor_b32 v45, 160, v44
    ds_read_b128 v[68:71], v45 offset:0
    s_waitcnt lgkmcnt(3)
    v_mfma_f32_32x32x16_bf16 v[112:127], v[56:59], v[136:139], v[112:127]
    v_xor_b32 v46, 192, v44
    ds_read_b128 v[72:75], v46 offset:0
    s_waitcnt lgkmcnt(3)
    v_mfma_f32_32x32x16_bf16 v[112:127], v[60:63], v[140:143], v[112:127]
    v_xor_b32 v47, 224, v44
    ds_read_b128 v[76:79], v47 offset:0
    s_waitcnt lgkmcnt(3)
    v_mfma_f32_32x32x16_bf16 v[112:127], v[64:67], v[144:147], v[112:127]
    ds_read_b128 v[56:59], v44 offset:8192
    s_waitcnt lgkmcnt(3)
    v_mfma_f32_32x32x16_bf16 v[112:127], v[68:71], v[148:151], v[112:127]
    v_xor_b32 v46, 32, v44
    ds_read_b128 v[60:63], v46 offset:8192
    s_waitcnt lgkmcnt(3)
    v_mfma_f32_32x32x16_bf16 v[112:127], v[72:75], v[152:155], v[112:127]
    v_xor_b32 v47, 64, v44
    ds_read_b128 v[64:67], v47 offset:8192
    s_waitcnt lgkmcnt(3)
    v_mfma_f32_32x32x16_bf16 v[112:127], v[76:79], v[156:159], v[112:127]
    v_xor_b32 v45, 96, v44
    ds_read_b128 v[68:71], v45 offset:8192
    s_waitcnt lgkmcnt(3)
    v_mfma_f32_32x32x16_bf16 v[112:127], v[56:59], v[160:163], v[112:127]
    v_xor_b32 v46, 128, v44
    ds_read_b128 v[72:75], v46 offset:8192
    s_waitcnt lgkmcnt(3)
    v_mfma_f32_32x32x16_bf16 v[112:127], v[60:63], v[164:167], v[112:127]
    v_xor_b32 v47, 160, v44
    ds_read_b128 v[76:79], v47 offset:8192
    s_waitcnt lgkmcnt(3)
    v_mfma_f32_32x32x16_bf16 v[112:127], v[64:67], v[168:171], v[112:127]
    v_xor_b32 v45, 192, v44
    ds_read_b128 v[56:59], v45 offset:8192
    s_waitcnt lgkmcnt(3)
    v_mfma_f32_32x32x16_bf16 v[112:127], v[68:71], v[172:175], v[112:127]
    v_xor_b32 v46, 224, v44
    ds_read_b128 v[60:63], v46 offset:8192
    v_cvt_pk_bf16_f32 v48, v96, v97
    v_cvt_pk_bf16_f32 v49, v98, v99
    s_waitcnt lgkmcnt(3)
    v_mfma_f32_32x32x16_bf16 v[112:127], v[72:75], v[176:179], v[112:127]
    ds_read_b128 v[64:67], v44 offset:16384
    v_cvt_pk_bf16_f32 v50, v100, v101
    v_cvt_pk_bf16_f32 v51, v102, v103
    s_waitcnt lgkmcnt(3)
    v_mfma_f32_32x32x16_bf16 v[112:127], v[76:79], v[180:183], v[112:127]
    v_xor_b32 v45, 32, v44
    ds_read_b128 v[68:71], v45 offset:16384
    s_add_u32 s43, s42, 65536
    buffer_store_dwordx4 v[48:51], v41, s[60:63], s43 offen sc1
    s_waitcnt lgkmcnt(3)
    v_mfma_f32_32x32x16_bf16 v[112:127], v[56:59], v[184:187], v[112:127]
    v_xor_b32 v46, 64, v44
    ds_read_b128 v[72:75], v46 offset:16384
    s_waitcnt lgkmcnt(3)
    v_mfma_f32_32x32x16_bf16 v[112:127], v[60:63], v[188:191], v[112:127]
    v_xor_b32 v47, 96, v44
    ds_read_b128 v[76:79], v47 offset:16384
    s_waitcnt lgkmcnt(3)
    v_mfma_f32_32x32x16_bf16 v[112:127], v[64:67], v[192:195], v[112:127]
    v_xor_b32 v45, 128, v44
    ds_read_b128 v[56:59], v45 offset:16384
    s_waitcnt lgkmcnt(3)
    v_mfma_f32_32x32x16_bf16 v[112:127], v[68:71], v[196:199], v[112:127]
    v_xor_b32 v46, 160, v44
    ds_read_b128 v[60:63], v46 offset:16384
    s_waitcnt lgkmcnt(3)
    v_mfma_f32_32x32x16_bf16 v[112:127], v[72:75], v[200:203], v[112:127]
    v_xor_b32 v47, 192, v44
    ds_read_b128 v[64:67], v47 offset:16384
    s_waitcnt lgkmcnt(3)
    v_mfma_f32_32x32x16_bf16 v[112:127], v[76:79], v[204:207], v[112:127]
    v_xor_b32 v45, 224, v44
    ds_read_b128 v[68:71], v45 offset:16384
    s_waitcnt vmcnt(8)
    s_barrier
    v_add_u32 v42, 32768, v40
    s_waitcnt lgkmcnt(3)
    v_mfma_f32_32x32x16_bf16 v[112:127], v[56:59], v[208:211], v[112:127]
    ds_read_b128 v[72:75], v44 offset:24576
    s_add_u32 m0, s65, 65536
    s_add_u32 s36, s64, 2097152
    buffer_load_dwordx4 v28, s[24:27], s36 offen lds
    s_add_u32 s36, s36, 31744
    buffer_load_dwordx4 v28, s[24:27], s36 offen offset:1024 lds
    s_waitcnt lgkmcnt(3)
    v_mfma_f32_32x32x16_bf16 v[112:127], v[60:63], v[212:215], v[112:127]
    v_xor_b32 v47, 32, v44
    ds_read_b128 v[76:79], v47 offset:24576
    s_waitcnt lgkmcnt(3)
    v_mfma_f32_32x32x16_bf16 v[112:127], v[64:67], v[216:219], v[112:127]
    v_xor_b32 v45, 64, v44
    ds_read_b128 v[56:59], v45 offset:24576
    s_add_u32 m0, s65, 81920
    s_add_u32 s36, s64, 2621440
    buffer_load_dwordx4 v28, s[24:27], s36 offen lds
    s_add_u32 s36, s36, 31744
    buffer_load_dwordx4 v28, s[24:27], s36 offen offset:1024 lds
    s_waitcnt lgkmcnt(3)
    v_mfma_f32_32x32x16_bf16 v[112:127], v[68:71], v[220:223], v[112:127]
    v_xor_b32 v46, 96, v44
    ds_read_b128 v[60:63], v46 offset:24576
    s_waitcnt lgkmcnt(3)
    v_mfma_f32_32x32x16_bf16 v[112:127], v[72:75], v[224:227], v[112:127]
    v_xor_b32 v47, 128, v44
    ds_read_b128 v[64:67], v47 offset:24576
    s_add_u32 m0, s65, 98304
    s_add_u32 s36, s64, 3145728
    buffer_load_dwordx4 v28, s[24:27], s36 offen lds
    s_add_u32 s36, s36, 31744
    buffer_load_dwordx4 v28, s[24:27], s36 offen offset:1024 lds
    s_waitcnt lgkmcnt(3)
    v_mfma_f32_32x32x16_bf16 v[112:127], v[76:79], v[228:231], v[112:127]
    v_xor_b32 v45, 160, v44
    ds_read_b128 v[68:71], v45 offset:24576
    s_waitcnt lgkmcnt(3)
    v_mfma_f32_32x32x16_bf16 v[112:127], v[56:59], v[232:235], v[112:127]
    v_xor_b32 v46, 192, v44
    ds_read_b128 v[72:75], v46 offset:24576
    s_add_u32 m0, s65, 114688
    s_add_u32 s36, s64, 3670016
    buffer_load_dwordx4 v28, s[24:27], s36 offen lds
    s_add_u32 s36, s36, 31744
    buffer_load_dwordx4 v28, s[24:27], s36 offen offset:1024 lds
    s_waitcnt lgkmcnt(3)
    v_mfma_f32_32x32x16_bf16 v[112:127], v[60:63], v[236:239], v[112:127]
    v_xor_b32 v47, 224, v44
    ds_read_b128 v[76:79], v47 offset:24576
    v_cvt_pk_bf16_f32 v52, v104, v105
    v_cvt_pk_bf16_f32 v53, v106, v107
    s_waitcnt lgkmcnt(3)
    v_mfma_f32_32x32x16_bf16 v[112:127], v[64:67], v[240:243], v[112:127]
    ds_read_b128 v[56:59], v42 offset:0
    v_cvt_pk_bf16_f32 v54, v108, v109
    v_cvt_pk_bf16_f32 v55, v110, v111
    s_waitcnt lgkmcnt(3)
    v_mfma_f32_32x32x16_bf16 v[112:127], v[68:71], v[244:247], v[112:127]
    v_xor_b32 v46, 32, v42
    ds_read_b128 v[60:63], v46 offset:0
    s_add_u32 s43, s42, 66560
    buffer_store_dwordx4 v[52:55], v41, s[60:63], s43 offen sc1
    s_waitcnt lgkmcnt(3)
    v_mfma_f32_32x32x16_bf16 v[112:127], v[72:75], v[248:251], v[112:127]
    v_xor_b32 v47, 64, v42
    ds_read_b128 v[64:67], v47 offset:0
    s_waitcnt lgkmcnt(3)
    v_mfma_f32_32x32x16_bf16 v[112:127], v[76:79], v[252:255], v[112:127]
    v_xor_b32 v45, 96, v42
    ds_read_b128 v[68:71], v45 offset:0
    s_waitcnt lgkmcnt(3)
    v_mfma_f32_32x32x16_bf16 v[80:95], v[56:59], v[128:131], 0
    v_xor_b32 v46, 128, v42
    ds_read_b128 v[72:75], v46 offset:0
    s_waitcnt lgkmcnt(3)
    v_mfma_f32_32x32x16_bf16 v[80:95], v[60:63], v[132:135], v[80:95]
    v_xor_b32 v47, 160, v42
    ds_read_b128 v[76:79], v47 offset:0
    s_waitcnt lgkmcnt(3)
    v_mfma_f32_32x32x16_bf16 v[80:95], v[64:67], v[136:139], v[80:95]
    v_xor_b32 v45, 192, v42
    ds_read_b128 v[56:59], v45 offset:0
    s_waitcnt lgkmcnt(3)
    v_mfma_f32_32x32x16_bf16 v[80:95], v[68:71], v[140:143], v[80:95]
    v_xor_b32 v46, 224, v42
    ds_read_b128 v[60:63], v46 offset:0
    s_waitcnt lgkmcnt(3)
    v_mfma_f32_32x32x16_bf16 v[80:95], v[72:75], v[144:147], v[80:95]
    ds_read_b128 v[64:67], v42 offset:8192
    s_waitcnt lgkmcnt(3)
    v_mfma_f32_32x32x16_bf16 v[80:95], v[76:79], v[148:151], v[80:95]
    v_xor_b32 v45, 32, v42
    ds_read_b128 v[68:71], v45 offset:8192
    s_waitcnt lgkmcnt(3)
    v_mfma_f32_32x32x16_bf16 v[80:95], v[56:59], v[152:155], v[80:95]
    v_xor_b32 v46, 64, v42
    ds_read_b128 v[72:75], v46 offset:8192
    s_waitcnt lgkmcnt(3)
    v_mfma_f32_32x32x16_bf16 v[80:95], v[60:63], v[156:159], v[80:95]
    v_xor_b32 v47, 96, v42
    ds_read_b128 v[76:79], v47 offset:8192
    s_waitcnt lgkmcnt(3)
    v_mfma_f32_32x32x16_bf16 v[80:95], v[64:67], v[160:163], v[80:95]
    v_xor_b32 v45, 128, v42
    ds_read_b128 v[56:59], v45 offset:8192
    s_waitcnt lgkmcnt(3)
    v_mfma_f32_32x32x16_bf16 v[80:95], v[68:71], v[164:167], v[80:95]
    v_xor_b32 v46, 160, v42
    ds_read_b128 v[60:63], v46 offset:8192
    s_waitcnt lgkmcnt(3)
    v_mfma_f32_32x32x16_bf16 v[80:95], v[72:75], v[168:171], v[80:95]
    v_xor_b32 v47, 192, v42
    ds_read_b128 v[64:67], v47 offset:8192
    s_waitcnt lgkmcnt(3)
    v_mfma_f32_32x32x16_bf16 v[80:95], v[76:79], v[172:175], v[80:95]
    v_xor_b32 v45, 224, v42
    ds_read_b128 v[68:71], v45 offset:8192
    v_cvt_pk_bf16_f32 v48, v112, v113
    v_cvt_pk_bf16_f32 v49, v114, v115
    s_waitcnt lgkmcnt(3)
    v_mfma_f32_32x32x16_bf16 v[80:95], v[56:59], v[176:179], v[80:95]
    ds_read_b128 v[72:75], v42 offset:16384
    v_cvt_pk_bf16_f32 v50, v116, v117
    v_cvt_pk_bf16_f32 v51, v118, v119
    s_waitcnt lgkmcnt(3)
    v_mfma_f32_32x32x16_bf16 v[80:95], v[60:63], v[180:183], v[80:95]
    v_xor_b32 v47, 32, v42
    ds_read_b128 v[76:79], v47 offset:16384
    s_add_u32 s43, s42, 67584
    buffer_store_dwordx4 v[48:51], v41, s[60:63], s43 offen sc1
    s_waitcnt lgkmcnt(3)
    v_mfma_f32_32x32x16_bf16 v[80:95], v[64:67], v[184:187], v[80:95]
    v_xor_b32 v45, 64, v42
    ds_read_b128 v[56:59], v45 offset:16384
    s_waitcnt lgkmcnt(3)
    v_mfma_f32_32x32x16_bf16 v[80:95], v[68:71], v[188:191], v[80:95]
    v_xor_b32 v46, 96, v42
    ds_read_b128 v[60:63], v46 offset:16384
    s_waitcnt lgkmcnt(3)
    v_mfma_f32_32x32x16_bf16 v[80:95], v[72:75], v[192:195], v[80:95]
    v_xor_b32 v47, 128, v42
    ds_read_b128 v[64:67], v47 offset:16384
    s_waitcnt lgkmcnt(3)
    v_mfma_f32_32x32x16_bf16 v[80:95], v[76:79], v[196:199], v[80:95]
    v_xor_b32 v45, 160, v42
    ds_read_b128 v[68:71], v45 offset:16384
    s_waitcnt lgkmcnt(3)
    v_mfma_f32_32x32x16_bf16 v[80:95], v[56:59], v[200:203], v[80:95]
    v_xor_b32 v46, 192, v42
    ds_read_b128 v[72:75], v46 offset:16384
    s_waitcnt lgkmcnt(3)
    v_mfma_f32_32x32x16_bf16 v[80:95], v[60:63], v[204:207], v[80:95]
    v_xor_b32 v47, 224, v42
    ds_read_b128 v[76:79], v47 offset:16384
    s_waitcnt vmcnt(12)
    s_barrier
    v_add_u32 v43, 131072, v40
    s_waitcnt lgkmcnt(3)
    v_mfma_f32_32x32x16_bf16 v[80:95], v[64:67], v[208:211], v[80:95]
    ds_read_b128 v[56:59], v42 offset:24576
    s_add_u32 m0, s65, 0
    s_add_u32 s36, s64, 0
    buffer_load_dwordx4 v28, s[24:27], s36 offen lds
    s_add_u32 s36, s36, 31744
    buffer_load_dwordx4 v28, s[24:27], s36 offen offset:1024 lds
    s_add_u32 m0, s65, 16384
    s_add_u32 s36, s64, 524288
    buffer_load_dwordx4 v28, s[24:27], s36 offen lds
    s_add_u32 s36, s36, 31744
    buffer_load_dwordx4 v28, s[24:27], s36 offen offset:1024 lds
    s_waitcnt lgkmcnt(3)
    v_mfma_f32_32x32x16_bf16 v[80:95], v[68:71], v[212:215], v[80:95]
    v_xor_b32 v46, 32, v42
    ds_read_b128 v[60:63], v46 offset:24576
    s_waitcnt lgkmcnt(3)
    v_mfma_f32_32x32x16_bf16 v[80:95], v[72:75], v[216:219], v[80:95]
    v_xor_b32 v47, 64, v42
    ds_read_b128 v[64:67], v47 offset:24576
    s_waitcnt lgkmcnt(3)
    v_mfma_f32_32x32x16_bf16 v[80:95], v[76:79], v[220:223], v[80:95]
    v_xor_b32 v45, 96, v42
    ds_read_b128 v[68:71], v45 offset:24576
    s_waitcnt lgkmcnt(3)
    v_mfma_f32_32x32x16_bf16 v[80:95], v[56:59], v[224:227], v[80:95]
    v_xor_b32 v46, 128, v42
    ds_read_b128 v[72:75], v46 offset:24576
    s_waitcnt lgkmcnt(3)
    v_mfma_f32_32x32x16_bf16 v[80:95], v[60:63], v[228:231], v[80:95]
    v_xor_b32 v47, 160, v42
    ds_read_b128 v[76:79], v47 offset:24576
    s_waitcnt lgkmcnt(3)
    v_mfma_f32_32x32x16_bf16 v[80:95], v[64:67], v[232:235], v[80:95]
    v_xor_b32 v45, 192, v42
    ds_read_b128 v[56:59], v45 offset:24576
    s_waitcnt lgkmcnt(3)
    v_mfma_f32_32x32x16_bf16 v[80:95], v[68:71], v[236:239], v[80:95]
    v_xor_b32 v46, 224, v42
    ds_read_b128 v[60:63], v46 offset:24576
    v_cvt_pk_bf16_f32 v52, v120, v121
    v_cvt_pk_bf16_f32 v53, v122, v123
    s_waitcnt lgkmcnt(3)
    v_mfma_f32_32x32x16_bf16 v[80:95], v[72:75], v[240:243], v[80:95]
    ds_read_b128 v[64:67], v43 offset:0
    v_cvt_pk_bf16_f32 v54, v124, v125
    v_cvt_pk_bf16_f32 v55, v126, v127
    s_waitcnt lgkmcnt(3)
    v_mfma_f32_32x32x16_bf16 v[80:95], v[76:79], v[244:247], v[80:95]
    v_xor_b32 v45, 32, v43
    ds_read_b128 v[68:71], v45 offset:0
    s_add_u32 s43, s42, 68608
    buffer_store_dwordx4 v[52:55], v41, s[60:63], s43 offen sc1
    s_waitcnt lgkmcnt(3)
    v_mfma_f32_32x32x16_bf16 v[80:95], v[56:59], v[248:251], v[80:95]
    v_xor_b32 v46, 64, v43
    ds_read_b128 v[72:75], v46 offset:0
    s_waitcnt lgkmcnt(3)
    v_mfma_f32_32x32x16_bf16 v[80:95], v[60:63], v[252:255], v[80:95]
    v_xor_b32 v47, 96, v43
    ds_read_b128 v[76:79], v47 offset:0
    s_waitcnt lgkmcnt(3)
    v_mfma_f32_32x32x16_bf16 v[96:111], v[64:67], v[128:131], 0
    v_xor_b32 v45, 128, v43
    ds_read_b128 v[56:59], v45 offset:0
    s_barrier
    s_add_u32 m0, s65, 32768
    s_add_u32 s36, s64, 1048576
    buffer_load_dwordx4 v28, s[24:27], s36 offen lds
    s_add_u32 s36, s36, 31744
    buffer_load_dwordx4 v28, s[24:27], s36 offen offset:1024 lds
    s_add_u32 s36, s66, 0
    buffer_load_dwordx4 v[128:131], v41, s[20:23], s36 offen offset:0 sc1
    s_waitcnt lgkmcnt(3)
    v_mfma_f32_32x32x16_bf16 v[96:111], v[68:71], v[132:135], v[96:111]
    v_xor_b32 v46, 160, v43
    ds_read_b128 v[60:63], v46 offset:0
    s_add_u32 m0, s65, 49152
    s_add_u32 s36, s64, 1572864
    buffer_load_dwordx4 v28, s[24:27], s36 offen lds
    s_add_u32 s36, s36, 31744
    buffer_load_dwordx4 v28, s[24:27], s36 offen offset:1024 lds
    s_add_u32 s36, s66, 0
    buffer_load_dwordx4 v[132:135], v41, s[20:23], s36 offen offset:1024 sc1
    s_waitcnt lgkmcnt(3)
    v_mfma_f32_32x32x16_bf16 v[96:111], v[72:75], v[136:139], v[96:111]
    v_xor_b32 v47, 192, v43
    ds_read_b128 v[64:67], v47 offset:0
    s_add_u32 s36, s66, 0
    buffer_load_dwordx4 v[136:139], v41, s[20:23], s36 offen offset:2048 sc1
    s_waitcnt lgkmcnt(3)
    v_mfma_f32_32x32x16_bf16 v[96:111], v[76:79], v[140:143], v[96:111]
    v_xor_b32 v45, 224, v43
    ds_read_b128 v[68:71], v45 offset:0
    s_add_u32 s36, s66, 0
    buffer_load_dwordx4 v[140:143], v41, s[20:23], s36 offen offset:3072 sc1
    s_waitcnt lgkmcnt(3)
    v_mfma_f32_32x32x16_bf16 v[96:111], v[56:59], v[144:147], v[96:111]
    ds_read_b128 v[72:75], v43 offset:8192
    s_add_u32 s36, s66, 4096
    buffer_load_dwordx4 v[144:147], v41, s[20:23], s36 offen offset:0 sc1
    s_waitcnt lgkmcnt(3)
    v_mfma_f32_32x32x16_bf16 v[96:111], v[60:63], v[148:151], v[96:111]
    v_xor_b32 v47, 32, v43
    ds_read_b128 v[76:79], v47 offset:8192
    s_add_u32 s36, s66, 4096
    buffer_load_dwordx4 v[148:151], v41, s[20:23], s36 offen offset:1024 sc1
    s_waitcnt lgkmcnt(3)
    v_mfma_f32_32x32x16_bf16 v[96:111], v[64:67], v[152:155], v[96:111]
    v_xor_b32 v45, 64, v43
    ds_read_b128 v[56:59], v45 offset:8192
    s_add_u32 s36, s66, 4096
    buffer_load_dwordx4 v[152:155], v41, s[20:23], s36 offen offset:2048 sc1
    s_waitcnt lgkmcnt(3)
    v_mfma_f32_32x32x16_bf16 v[96:111], v[68:71], v[156:159], v[96:111]
    v_xor_b32 v46, 96, v43
    ds_read_b128 v[60:63], v46 offset:8192
    s_add_u32 s36, s66, 4096
    buffer_load_dwordx4 v[156:159], v41, s[20:23], s36 offen offset:3072 sc1
    s_waitcnt lgkmcnt(3)
    v_mfma_f32_32x32x16_bf16 v[96:111], v[72:75], v[160:163], v[96:111]
    v_xor_b32 v47, 128, v43
    ds_read_b128 v[64:67], v47 offset:8192
    s_add_u32 s36, s66, 8192
    buffer_load_dwordx4 v[160:163], v41, s[20:23], s36 offen offset:0 sc1
    s_waitcnt lgkmcnt(3)
    v_mfma_f32_32x32x16_bf16 v[96:111], v[76:79], v[164:167], v[96:111]
    v_xor_b32 v45, 160, v43
    ds_read_b128 v[68:71], v45 offset:8192
    s_add_u32 s36, s66, 8192
    buffer_load_dwordx4 v[164:167], v41, s[20:23], s36 offen offset:1024 sc1
    s_waitcnt lgkmcnt(3)
    v_mfma_f32_32x32x16_bf16 v[96:111], v[56:59], v[168:171], v[96:111]
    v_xor_b32 v46, 192, v43
    ds_read_b128 v[72:75], v46 offset:8192
    s_add_u32 s36, s66, 8192
    buffer_load_dwordx4 v[168:171], v41, s[20:23], s36 offen offset:2048 sc1
    s_waitcnt lgkmcnt(3)
    v_mfma_f32_32x32x16_bf16 v[96:111], v[60:63], v[172:175], v[96:111]
    v_xor_b32 v47, 224, v43
    ds_read_b128 v[76:79], v47 offset:8192
    v_cvt_pk_bf16_f32 v48, v80, v81
    v_cvt_pk_bf16_f32 v49, v82, v83
    s_add_u32 s36, s66, 8192
    buffer_load_dwordx4 v[172:175], v41, s[20:23], s36 offen offset:3072 sc1
    s_waitcnt lgkmcnt(3)
    v_mfma_f32_32x32x16_bf16 v[96:111], v[64:67], v[176:179], v[96:111]
    ds_read_b128 v[56:59], v43 offset:16384
    v_cvt_pk_bf16_f32 v50, v84, v85
    v_cvt_pk_bf16_f32 v51, v86, v87
    s_add_u32 s36, s66, 12288
    buffer_load_dwordx4 v[176:179], v41, s[20:23], s36 offen offset:0 sc1
    s_waitcnt lgkmcnt(3)
    v_mfma_f32_32x32x16_bf16 v[96:111], v[68:71], v[180:183], v[96:111]
    v_xor_b32 v46, 32, v43
    ds_read_b128 v[60:63], v46 offset:16384
    s_add_u32 s43, s42, 98304
    buffer_store_dwordx4 v[48:51], v41, s[60:63], s43 offen sc1
    s_add_u32 s36, s66, 12288
    buffer_load_dwordx4 v[180:183], v41, s[20:23], s36 offen offset:1024 sc1
    s_waitcnt lgkmcnt(3)
    v_mfma_f32_32x32x16_bf16 v[96:111], v[72:75], v[184:187], v[96:111]
    v_xor_b32 v47, 64, v43
    ds_read_b128 v[64:67], v47 offset:16384
    s_add_u32 s36, s66, 12288
    buffer_load_dwordx4 v[184:187], v41, s[20:23], s36 offen offset:2048 sc1
    s_waitcnt lgkmcnt(3)
    v_mfma_f32_32x32x16_bf16 v[96:111], v[76:79], v[188:191], v[96:111]
    v_xor_b32 v45, 96, v43
    ds_read_b128 v[68:71], v45 offset:16384
    s_add_u32 s36, s66, 12288
    buffer_load_dwordx4 v[188:191], v41, s[20:23], s36 offen offset:3072 sc1
    s_waitcnt lgkmcnt(3)
    v_mfma_f32_32x32x16_bf16 v[96:111], v[56:59], v[192:195], v[96:111]
    v_xor_b32 v46, 128, v43
    ds_read_b128 v[72:75], v46 offset:16384
    s_waitcnt lgkmcnt(3)
    v_mfma_f32_32x32x16_bf16 v[96:111], v[60:63], v[196:199], v[96:111]
    v_xor_b32 v47, 160, v43
    ds_read_b128 v[76:79], v47 offset:16384
    s_waitcnt lgkmcnt(3)
    v_mfma_f32_32x32x16_bf16 v[96:111], v[64:67], v[200:203], v[96:111]
    v_xor_b32 v45, 192, v43
    ds_read_b128 v[56:59], v45 offset:16384
    s_waitcnt lgkmcnt(3)
    v_mfma_f32_32x32x16_bf16 v[96:111], v[68:71], v[204:207], v[96:111]
    v_xor_b32 v46, 224, v43
    ds_read_b128 v[60:63], v46 offset:16384
    s_waitcnt lgkmcnt(3)
    v_mfma_f32_32x32x16_bf16 v[96:111], v[72:75], v[208:211], v[96:111]
    ds_read_b128 v[64:67], v43 offset:24576
    s_waitcnt lgkmcnt(3)
    v_mfma_f32_32x32x16_bf16 v[96:111], v[76:79], v[212:215], v[96:111]
    v_xor_b32 v45, 32, v43
    ds_read_b128 v[68:71], v45 offset:24576
    s_waitcnt lgkmcnt(3)
    v_mfma_f32_32x32x16_bf16 v[96:111], v[56:59], v[216:219], v[96:111]
    v_xor_b32 v46, 64, v43
    ds_read_b128 v[72:75], v46 offset:24576
    s_waitcnt lgkmcnt(3)
    v_mfma_f32_32x32x16_bf16 v[96:111], v[60:63], v[220:223], v[96:111]
    v_xor_b32 v47, 96, v43
    ds_read_b128 v[76:79], v47 offset:24576
    s_waitcnt lgkmcnt(3)
    v_mfma_f32_32x32x16_bf16 v[96:111], v[64:67], v[224:227], v[96:111]
    v_xor_b32 v45, 128, v43
    ds_read_b128 v[56:59], v45 offset:24576
    s_waitcnt lgkmcnt(3)
    v_mfma_f32_32x32x16_bf16 v[96:111], v[68:71], v[228:231], v[96:111]
    v_xor_b32 v46, 160, v43
    ds_read_b128 v[60:63], v46 offset:24576
    s_waitcnt lgkmcnt(3)
    v_mfma_f32_32x32x16_bf16 v[96:111], v[72:75], v[232:235], v[96:111]
    v_xor_b32 v47, 192, v43
    ds_read_b128 v[64:67], v47 offset:24576
    s_waitcnt lgkmcnt(3)
    v_mfma_f32_32x32x16_bf16 v[96:111], v[76:79], v[236:239], v[96:111]
    v_xor_b32 v45, 224, v43
    ds_read_b128 v[68:71], v45 offset:24576
    v_cvt_pk_bf16_f32 v52, v88, v89
    v_cvt_pk_bf16_f32 v53, v90, v91
    s_waitcnt lgkmcnt(3)
    v_mfma_f32_32x32x16_bf16 v[96:111], v[56:59], v[240:243], v[96:111]
    v_cvt_pk_bf16_f32 v54, v92, v93
    v_cvt_pk_bf16_f32 v55, v94, v95
    s_waitcnt lgkmcnt(2)
    v_mfma_f32_32x32x16_bf16 v[96:111], v[60:63], v[244:247], v[96:111]
    s_add_u32 s43, s42, 99328
    buffer_store_dwordx4 v[52:55], v41, s[60:63], s43 offen sc1
    s_waitcnt lgkmcnt(1)
    v_mfma_f32_32x32x16_bf16 v[96:111], v[64:67], v[248:251], v[96:111]
    s_waitcnt lgkmcnt(0)
    v_mfma_f32_32x32x16_bf16 v[96:111], v[68:71], v[252:255], v[96:111]
    s_nop 11
    v_cvt_pk_bf16_f32 v48, v96, v97
    v_cvt_pk_bf16_f32 v49, v98, v99
    v_cvt_pk_bf16_f32 v50, v100, v101
    v_cvt_pk_bf16_f32 v51, v102, v103
    s_add_u32 s43, s42, 100352
    buffer_store_dwordx4 v[48:51], v41, s[60:63], s43 offen sc1
    v_cvt_pk_bf16_f32 v52, v104, v105
    v_cvt_pk_bf16_f32 v53, v106, v107
    v_cvt_pk_bf16_f32 v54, v108, v109
    v_cvt_pk_bf16_f32 v55, v110, v111
    s_add_u32 s43, s42, 101376
    buffer_store_dwordx4 v[52:55], v41, s[60:63], s43 offen sc1
    s_waitcnt vmcnt(16)
    s_branch F_DISP
L1_CSLOW:
    s_mov_b32 s4, 100000
L1_CP:
    global_load_dword v5, v4, s[6:7] sc1
    s_waitcnt vmcnt(0)
    v_cmp_eq_u32 vcc, 0, v5
    s_cbranch_vccz L1_COK
    s_sleep 4
    s_sub_u32 s4, s4, 1
    s_cmp_lg_u32 s4, 0
    s_cbranch_scc1 L1_CP
    s_branch L1_COK
F_XSLOW:
    s_mov_b32 s4, 100000
F_XP:
    global_load_dword v3, v2, s[100:101] sc1
    s_waitcnt vmcnt(0)
    v_cmp_ne_u32 vcc, s77, v3
    s_cbranch_vccz F_XP_D
    s_sleep 4
    s_sub_u32 s4, s4, 1
    s_cmp_lg_u32 s4, 0
    s_cbranch_scc1 F_XP
F_XP_D:
    s_branch F_XOK
F_DISP:
    s_lshr_b32 s64, s2, 3
    s_cmp_lt_u32 s64, 4
    s_cbranch_scc1 L2_B
    s_mov_b32 s4, s52
    s_mov_b32 s5, s53
    s_mov_b32 s6, s12
    s_mov_b32 s7, s13
    s_and_b32 s36, s2, 7
    s_lshr_b32 s37, s2, 3
    s_sub_u32 s37, s37, 4
    s_lshl_b32 s66, s37, 3
    s_add_u32 s66, s66, s3
    s_mul_i32 s38, s37, 37
    s_lshr_b32 s38, s38, 8
    s_lshl_b32 s14, s36, 2
    s_add_u32 s14, s14, s38
    s_mul_i32 s38, s38, 7
    s_sub_u32 s37, s37, s38
    s_sub_u32 s16, 15, s37
    s_add_u32 s17, 4, s37
    s_cmp_eq_u32 s37, 6
    s_cselect_b32 s16, 3, s16
    s_cselect_b32 s17, 0, s17
    s_cselect_b32 s15, 1, 0
    s_and_b32 s12, s3, 3
    s_lshr_b32 s13, s3, 2
    s_mov_b32 s39, 0x3e0293ee
    s_mov_b32 s40, 0x4e800000
    s_mov_b32 s74, 0x3e0293ee
    s_mov_b32 s75, 0x3e0293ee
    s_lshl_b32 s42, s14, 8
    s_lshl_b32 s36, s3, 16
    s_add_u32 s42, s42, s36
    s_lshl_b32 s43, s3, 11
    v_lshlrev_b32 v10, 4, v1
    v_lshrrev_b32 v3, 4, v1
    v_and_b32 v4, 15, v1
    v_lshlrev_b32 v2, 13, v3
    v_lshlrev_b32 v3, 2, v3
    v_xor_b32 v4, v4, v3
    v_lshlrev_b32 v4, 4, v4
    v_or_b32 v22, v2, v4
    v_lshrrev_b32 v3, 5, v1
    v_lshrrev_b32 v2, 2, v1
    v_and_b32 v2, 3, v2
    v_lshlrev_b32 v4, 2, v3
    v_add_u32 v4, v4, v2
    v_lshlrev_b32 v4, 8, v4
    v_lshrrev_b32 v5, 4, v1
    v_and_b32 v5, 1, v5
    v_lshlrev_b32 v5, 5, v5
    v_and_b32 v6, 3, v1
    v_lshlrev_b32 v6, 3, v6
    v_or_b32 v4, v4, v5
    v_or_b32 v4, v4, v6
    v_lshlrev_b32 v5, 6, v2
    v_or_b32 v18, v4, v5
    v_xor_b32 v19, 64, v18
    v_xor_b32 v20, 128, v18
    v_xor_b32 v21, 192, v18
    v_and_b32 v2, 31, v1
    v_lshlrev_b32 v3, 2, v3
    v_sub_u32 v13, v2, v3
    v_mov_b32 v14, 0xff800000
    s_waitcnt lgkmcnt(0)
    s_mov_b32 s24, s4
    s_mov_b32 s25, s5
    s_mov_b32 s26, 0x400000
    s_mov_b32 s27, 0x00020000
    s_add_u32 s20, s6, 0x0
    s_addc_u32 s21, s7, 0
    s_mov_b32 s22, 0x200000
    s_mov_b32 s23, 0x00020000
    s_add_u32 s28, s6, 0x1000000
    s_addc_u32 s29, s7, 0
    s_mov_b32 s30, 0x2000000
    s_mov_b32 s31, 0x00020000
    s_add_u32 s32, s6, 0x3000000
    s_addc_u32 s33, s7, 0
    s_mov_b32 s34, 0x1000000
    s_mov_b32 s35, 0x00020000
    s_add_u32 s68, s6, 0x4000000
    s_addc_u32 s69, s7, 0
    s_mov_b32 s70, 0x800000
    s_mov_b32 s71, 0x00020000
    s_mov_b32 s66, -1
A_JOB:
    s_mul_i32 s36, s14, 12288
    s_lshl_b32 s37, s3, 10
    s_add_u32 s36, s36, s37
    s_mul_i32 s72, s16, 393216
    s_add_u32 s72, s72, s36
    s_mul_i32 s75, s17, 393216
    s_add_u32 s75, s75, s36
    s_add_u32 s73, s72, 8192
    s_sub_u32 s37, s75, 4096
    s_cmp_lt_u32 s3, 4
    s_cselect_b32 s73, s73, s37
    s_add_u32 s75, s75, 4096
    s_lshl_b32 s18, s17, 1
    s_add_u32 s18, s18, 2
    s_sub_u32 s19, s16, s17
    s_cmp_eq_u32 s13, 0
    s_cselect_b32 s36, s17, s16
    s_lshl_b32 s54, s36, 2
    s_add_u32 s54, s54, s12
    s_lshl_b32 s41, s54, 15
    s_mul_i32 s36, s18, 43691
    s_lshr_b32 s36, s36, 17
    s_mul_i32 s36, s36, 3
    s_sub_u32 s36, s18, s36
    s_sub_u32 s36, 3, s36
    s_cmp_eq_u32 s36, 3
    s_cselect_b32 s36, 0, s36
    s_lshl_b32 s44, s36, 14
    s_mov_b32 s49, s44
    s_add_u32 s51, s44, 49152
    s_sub_u32 s45, s51, 16384
    s_add_u32 s36, s45, 49152
    s_cmp_lt_u32 s45, 49152
    s_cselect_b32 s45, s36, s45
    s_mov_b32 s46, 0
    s_mov_b32 s47, 0
    s_lshl_b32 s57, s3, 11
    s_lshl_b32 s52, s14, 20
    s_add_u32 s52, s52, s57
    s_cmp_lg_i32 s76, -1
    s_cbranch_scc1 A_PRE_D
    s_add_u32 m0, s43, 0
    s_add_u32 s36, s42, 0
    buffer_load_dwordx4 v22, s[24:27], s36 offen lds
    s_add_u32 s36, s36, 31744
    buffer_load_dwordx4 v22, s[24:27], s36 offen offset:1024 lds
    s_add_u32 s36, s41, 0
    buffer_load_dwordx4 v[128:131], v10, s[20:23], s36 offen offset:0 sc1
    s_add_u32 s36, s41, 0
    buffer_load_dwordx4 v[132:135], v10, s[20:23], s36 offen offset:1024 sc1
    s_add_u32 s36, s41, 0
    buffer_load_dwordx4 v[136:139], v10, s[20:23], s36 offen offset:2048 sc1
    s_add_u32 s36, s41, 0
    buffer_load_dwordx4 v[140:143], v10, s[20:23], s36 offen offset:3072 sc1
    s_add_u32 m0, s43, 16384
    s_add_u32 s36, s42, 524288
    buffer_load_dwordx4 v22, s[24:27], s36 offen lds
    s_add_u32 s36, s36, 31744
    buffer_load_dwordx4 v22, s[24:27], s36 offen offset:1024 lds
    s_add_u32 s36, s41, 4096
    buffer_load_dwordx4 v[144:147], v10, s[20:23], s36 offen offset:0 sc1
    s_add_u32 s36, s41, 4096
    buffer_load_dwordx4 v[148:151], v10, s[20:23], s36 offen offset:1024 sc1
    s_add_u32 s36, s41, 4096
    buffer_load_dwordx4 v[152:155], v10, s[20:23], s36 offen offset:2048 sc1
    s_add_u32 s36, s41, 4096
    buffer_load_dwordx4 v[156:159], v10, s[20:23], s36 offen offset:3072 sc1
    s_add_u32 m0, s43, 32768
    s_add_u32 s36, s42, 1048576
    buffer_load_dwordx4 v22, s[24:27], s36 offen lds
    s_add_u32 s36, s36, 31744
    buffer_load_dwordx4 v22, s[24:27], s36 offen offset:1024 lds
    s_add_u32 m0, s43, 49152
    s_add_u32 s36, s42, 1572864
    buffer_load_dwordx4 v22, s[24:27], s36 offen lds
    s_add_u32 s36, s36, 31744
    buffer_load_dwordx4 v22, s[24:27], s36 offen offset:1024 lds
    s_add_u32 m0, s43, 65536
    s_add_u32 s36, s42, 2097152
    buffer_load_dwordx4 v22, s[24:27], s36 offen lds
    s_add_u32 s36, s36, 31744
    buffer_load_dwordx4 v22, s[24:27], s36 offen offset:1024 lds
    s_add_u32 m0, s43, 81920
    s_add_u32 s36, s42, 2621440
    buffer_load_dwordx4 v22, s[24:27], s36 offen lds
    s_add_u32 s36, s36, 31744
    buffer_load_dwordx4 v22, s[24:27], s36 offen offset:1024 lds
    s_add_u32 m0, s43, 98304
    s_add_u32 s36, s42, 3145728
    buffer_load_dwordx4 v22, s[24:27], s36 offen lds
    s_add_u32 s36, s36, 31744
    buffer_load_dwordx4 v22, s[24:27], s36 offen offset:1024 lds
    s_add_u32 m0, s43, 114688
    s_add_u32 s36, s42, 3670016
    buffer_load_dwordx4 v22, s[24:27], s36 offen lds
    s_add_u32 s36, s36, 31744
    buffer_load_dwordx4 v22, s[24:27], s36 offen offset:1024 lds
    s_add_u32 s36, s41, 8192
    buffer_load_dwordx4 v[160:163], v10, s[20:23], s36 offen offset:0 sc1
    s_add_u32 s36, s41, 8192
    buffer_load_dwordx4 v[164:167], v10, s[20:23], s36 offen offset:1024 sc1
    s_add_u32 s36, s41, 8192
    buffer_load_dwordx4 v[168:171], v10, s[20:23], s36 offen offset:2048 sc1
    s_add_u32 s36, s41, 8192
    buffer_load_dwordx4 v[172:175], v10, s[20:23], s36 offen offset:3072 sc1
    s_add_u32 s36, s41, 12288
    buffer_load_dwordx4 v[176:179], v10, s[20:23], s36 offen offset:0 sc1
    s_add_u32 s36, s41, 12288
    buffer_load_dwordx4 v[180:183], v10, s[20:23], s36 offen offset:1024 sc1
    s_add_u32 s36, s41, 12288
    buffer_load_dwordx4 v[184:187], v10, s[20:23], s36 offen offset:2048 sc1
    s_add_u32 s36, s41, 12288
    buffer_load_dwordx4 v[188:191], v10, s[20:23], s36 offen offset:3072 sc1
A_PRE_D:
    s_waitcnt vmcnt(30)
    s_barrier
    v_and_b32 v4, 7, v1
    v_lshlrev_b32 v4, 2, v4
    s_lshl_b32 s36, s14, 7
    s_add_u32 s36, s36, 2048
    v_add_u32 v4, s36, v4
    ds_read_b64_tr_b16 v[192:193], v18 offset:0
    ds_read_b64_tr_b16 v[194:195], v18 offset:2048
    ds_read_b64_tr_b16 v[196:197], v19 offset:0
    ds_read_b64_tr_b16 v[198:199], v19 offset:2048
    ds_read_b64_tr_b16 v[200:201], v20 offset:0
    ds_read_b64_tr_b16 v[202:203], v20 offset:2048
    ds_read_b64_tr_b16 v[204:205], v21 offset:0
    ds_read_b64_tr_b16 v[206:207], v21 offset:2048
    s_waitcnt vmcnt(29)
    s_waitcnt lgkmcnt(6)
    v_mfma_f32_32x32x16_bf16 v[64:79], v[192:195], v[128:131], 0
    ds_read_b64_tr_b16 v[208:209], v18 offset:4096
    ds_read_b64_tr_b16 v[210:211], v18 offset:6144
    ds_read_b64_tr_b16 v[212:213], v19 offset:4096
    ds_read_b64_tr_b16 v[214:215], v19 offset:6144
    s_waitcnt lgkmcnt(8)
    v_mfma_f32_32x32x16_bf16 v[80:95], v[196:199], v[128:131], 0
    ds_read_b64_tr_b16 v[216:217], v20 offset:4096
    ds_read_b64_tr_b16 v[218:219], v20 offset:6144
    ds_read_b64_tr_b16 v[220:221], v21 offset:4096
    ds_read_b64_tr_b16 v[222:223], v21 offset:6144
    s_add_u32 s36, s41, 16384
    buffer_load_dwordx4 v[224:227], v10, s[20:23], s36 offen offset:0 sc1
    s_waitcnt lgkmcnt(10)
    v_mfma_f32_32x32x16_bf16 v[96:111], v[200:203], v[128:131], 0
    ds_read_b64_tr_b16 v[192:193], v18 offset:8192
    ds_read_b64_tr_b16 v[194:195], v18 offset:10240
    s_waitcnt lgkmcnt(10)
    v_mfma_f32_32x32x16_bf16 v[112:127], v[204:207], v[128:131], 0
    ds_read_b64_tr_b16 v[196:197], v19 offset:8192
    ds_read_b64_tr_b16 v[198:199], v19 offset:10240
    s_add_u32 s36, s41, 16384
    buffer_load_dwordx4 v[228:231], v10, s[20:23], s36 offen offset:1024 sc1
    s_waitcnt vmcnt(30)
    s_waitcnt lgkmcnt(10)
    v_mfma_f32_32x32x16_bf16 v[64:79], v[208:211], v[132:135], v[64:79]
    ds_read_b64_tr_b16 v[200:201], v20 offset:8192
    ds_read_b64_tr_b16 v[202:203], v20 offset:10240
    s_waitcnt lgkmcnt(10)
    v_mfma_f32_32x32x16_bf16 v[80:95], v[212:215], v[132:135], v[80:95]
    ds_read_b64_tr_b16 v[204:205], v21 offset:8192
    ds_read_b64_tr_b16 v[206:207], v21 offset:10240
    s_add_u32 s36, s41, 16384
    buffer_load_dwordx4 v[232:235], v10, s[20:23], s36 offen offset:2048 sc1
    s_waitcnt lgkmcnt(10)
    v_mfma_f32_32x32x16_bf16 v[96:111], v[216:219], v[132:135], v[96:111]
    ds_read_b64_tr_b16 v[208:209], v18 offset:12288
    ds_read_b64_tr_b16 v[210:211], v18 offset:14336
    s_waitcnt lgkmcnt(10)
    v_mfma_f32_32x32x16_bf16 v[112:127], v[220:223], v[132:135], v[112:127]
    ds_read_b64_tr_b16 v[212:213], v19 offset:12288
    ds_read_b64_tr_b16 v[214:215], v19 offset:14336
    s_add_u32 s36, s41, 16384
    buffer_load_dwordx4 v[236:239], v10, s[20:23], s36 offen offset:3072 sc1
    s_waitcnt vmcnt(31)
    s_waitcnt lgkmcnt(10)
    v_mfma_f32_32x32x16_bf16 v[64:79], v[192:195], v[136:139], v[64:79]
    ds_read_b64_tr_b16 v[216:217], v20 offset:12288
    ds_read_b64_tr_b16 v[218:219], v20 offset:14336
    s_waitcnt lgkmcnt(10)
    v_mfma_f32_32x32x16_bf16 v[80:95], v[196:199], v[136:139], v[80:95]
    ds_read_b64_tr_b16 v[220:221], v21 offset:12288
    ds_read_b64_tr_b16 v[222:223], v21 offset:14336
    s_add_u32 s36, s41, 20480
    buffer_load_dwordx4 v[240:243], v10, s[20:23], s36 offen offset:0 sc1
    s_waitcnt vmcnt(29)
    s_barrier
    s_waitcnt lgkmcnt(10)
    v_mfma_f32_32x32x16_bf16 v[96:111], v[200:203], v[136:139], v[96:111]
    ds_read_b64_tr_b16 v[192:193], v18 offset:16384
    ds_read_b64_tr_b16 v[194:195], v18 offset:18432
    s_waitcnt lgkmcnt(10)
    v_mfma_f32_32x32x16_bf16 v[112:127], v[204:207], v[136:139], v[112:127]
    ds_read_b64_tr_b16 v[196:197], v19 offset:16384
    ds_read_b64_tr_b16 v[198:199], v19 offset:18432
    s_add_u32 s36, s41, 20480
    buffer_load_dwordx4 v[244:247], v10, s[20:23], s36 offen offset:1024 sc1
    s_waitcnt vmcnt(32)
    s_waitcnt lgkmcnt(10)
    v_mfma_f32_32x32x16_bf16 v[64:79], v[208:211], v[140:143], v[64:79]
    ds_read_b64_tr_b16 v[200:201], v20 offset:16384
    ds_read_b64_tr_b16 v[202:203], v20 offset:18432
    s_waitcnt lgkmcnt(10)
    v_mfma_f32_32x32x16_bf16 v[80:95], v[212:215], v[140:143], v[80:95]
    ds_read_b64_tr_b16 v[204:205], v21 offset:16384
    ds_read_b64_tr_b16 v[206:207], v21 offset:18432
    s_add_u32 s36, s41, 20480
    buffer_load_dwordx4 v[248:251], v10, s[20:23], s36 offen offset:2048 sc1
    s_waitcnt lgkmcnt(10)
    v_mfma_f32_32x32x16_bf16 v[96:111], v[216:219], v[140:143], v[96:111]
    ds_read_b64_tr_b16 v[208:209], v18 offset:20480
    ds_read_b64_tr_b16 v[210:211], v18 offset:22528
    s_waitcnt lgkmcnt(10)
    v_mfma_f32_32x32x16_bf16 v[112:127], v[220:223], v[140:143], v[112:127]
    ds_read_b64_tr_b16 v[212:213], v19 offset:20480
    ds_read_b64_tr_b16 v[214:215], v19 offset:22528
    s_add_u32 s36, s41, 20480
    buffer_load_dwordx4 v[252:255], v10, s[20:23], s36 offen offset:3072 sc1
    s_waitcnt vmcnt(31)
    s_waitcnt lgkmcnt(10)
    v_mfma_f32_32x32x16_bf16 v[64:79], v[192:195], v[144:147], v[64:79]
    ds_read_b64_tr_b16 v[216:217], v20 offset:20480
    ds_read_b64_tr_b16 v[218:219], v20 offset:22528
    s_waitcnt lgkmcnt(10)
    v_mfma_f32_32x32x16_bf16 v[80:95], v[196:199], v[144:147], v[80:95]
    ds_read_b64_tr_b16 v[220:221], v21 offset:20480
    ds_read_b64_tr_b16 v[222:223], v21 offset:22528
    s_add_u32 s36, s41, 24576
    buffer_load_dwordx4 v[128:131], v10, s[20:23], s36 offen offset:0 sc1
    s_waitcnt lgkmcnt(10)
    v_mfma_f32_32x32x16_bf16 v[96:111], v[200:203], v[144:147], v[96:111]
    ds_read_b64_tr_b16 v[192:193], v18 offset:24576
    ds_read_b64_tr_b16 v[194:195], v18 offset:26624
    s_waitcnt lgkmcnt(10)
    v_mfma_f32_32x32x16_bf16 v[112:127], v[204:207], v[144:147], v[112:127]
    ds_read_b64_tr_b16 v[196:197], v19 offset:24576
    ds_read_b64_tr_b16 v[198:199], v19 offset:26624
    s_waitcnt vmcnt(31)
    s_waitcnt lgkmcnt(10)
    v_mfma_f32_32x32x16_bf16 v[64:79], v[208:211], v[148:151], v[64:79]
    ds_read_b64_tr_b16 v[200:201], v20 offset:24576
    ds_read_b64_tr_b16 v[202:203], v20 offset:26624
    s_waitcnt lgkmcnt(10)
    v_mfma_f32_32x32x16_bf16 v[80:95], v[212:215], v[148:151], v[80:95]
    ds_read_b64_tr_b16 v[204:205], v21 offset:24576
    ds_read_b64_tr_b16 v[206:207], v21 offset:26624
    s_add_u32 s36, s41, 24576
    buffer_load_dwordx4 v[132:135], v10, s[20:23], s36 offen offset:1024 sc1
    s_waitcnt lgkmcnt(10)
    v_mfma_f32_32x32x16_bf16 v[96:111], v[216:219], v[148:151], v[96:111]
    ds_read_b64_tr_b16 v[208:209], v18 offset:28672
    ds_read_b64_tr_b16 v[210:211], v18 offset:30720
    s_waitcnt lgkmcnt(10)
    v_mfma_f32_32x32x16_bf16 v[112:127], v[220:223], v[148:151], v[112:127]
    ds_read_b64_tr_b16 v[212:213], v19 offset:28672
    ds_read_b64_tr_b16 v[214:215], v19 offset:30720
    s_waitcnt vmcnt(31)
    s_waitcnt lgkmcnt(10)
    v_mfma_f32_32x32x16_bf16 v[64:79], v[192:195], v[152:155], v[64:79]
    ds_read_b64_tr_b16 v[216:217], v20 offset:28672
    ds_read_b64_tr_b16 v[218:219], v20 offset:30720
    s_waitcnt lgkmcnt(10)
    v_mfma_f32_32x32x16_bf16 v[80:95], v[196:199], v[152:155], v[80:95]
    ds_read_b64_tr_b16 v[220:221], v21 offset:28672
    ds_read_b64_tr_b16 v[222:223], v21 offset:30720
    s_add_u32 s36, s41, 24576
    buffer_load_dwordx4 v[136:139], v10, s[20:23], s36 offen offset:2048 sc1
    s_waitcnt vmcnt(29)
    s_barrier
    s_waitcnt lgkmcnt(10)
    v_mfma_f32_32x32x16_bf16 v[96:111], v[200:203], v[152:155], v[96:111]
    ds_read_b64_tr_b16 v[192:193], v18 offset:32768
    ds_read_b64_tr_b16 v[194:195], v18 offset:34816
    s_waitcnt lgkmcnt(10)
    v_mfma_f32_32x32x16_bf16 v[112:127], v[204:207], v[152:155], v[112:127]
    ds_read_b64_tr_b16 v[196:197], v19 offset:32768
    ds_read_b64_tr_b16 v[198:199], v19 offset:34816
    s_waitcnt vmcnt(31)
    s_waitcnt lgkmcnt(10)
    v_mfma_f32_32x32x16_bf16 v[64:79], v[208:211], v[156:159], v[64:79]
    ds_read_b64_tr_b16 v[200:201], v20 offset:32768
    ds_read_b64_tr_b16 v[202:203], v20 offset:34816
    s_waitcnt lgkmcnt(10)
    v_mfma_f32_32x32x16_bf16 v[80:95], v[212:215], v[156:159], v[80:95]
    ds_read_b64_tr_b16 v[204:205], v21 offset:32768
    ds_read_b64_tr_b16 v[206:207], v21 offset:34816
    s_add_u32 s36, s41, 24576
    buffer_load_dwordx4 v[140:143], v10, s[20:23], s36 offen offset:3072 sc1
    s_waitcnt lgkmcnt(10)
    v_mfma_f32_32x32x16_bf16 v[96:111], v[216:219], v[156:159], v[96:111]
    ds_read_b64_tr_b16 v[208:209], v18 offset:36864
    ds_read_b64_tr_b16 v[210:211], v18 offset:38912
    s_waitcnt lgkmcnt(10)
    v_mfma_f32_32x32x16_bf16 v[112:127], v[220:223], v[156:159], v[112:127]
    ds_read_b64_tr_b16 v[212:213], v19 offset:36864
    ds_read_b64_tr_b16 v[214:215], v19 offset:38912
    s_waitcnt vmcnt(19)
    s_waitcnt lgkmcnt(10)
    v_mfma_f32_32x32x16_bf16 v[64:79], v[192:195], v[160:163], v[64:79]
    ds_read_b64_tr_b16 v[216:217], v20 offset:36864
    ds_read_b64_tr_b16 v[218:219], v20 offset:38912
    s_waitcnt lgkmcnt(10)
    v_mfma_f32_32x32x16_bf16 v[80:95], v[196:199], v[160:163], v[80:95]
    ds_read_b64_tr_b16 v[220:221], v21 offset:36864
    ds_read_b64_tr_b16 v[222:223], v21 offset:38912
    s_add_u32 s36, s41, 28672
    buffer_load_dwordx4 v[144:147], v10, s[20:23], s36 offen offset:0 sc1
    s_waitcnt lgkmcnt(10)
    v_mfma_f32_32x32x16_bf16 v[96:111], v[200:203], v[160:163], v[96:111]
    ds_read_b64_tr_b16 v[192:193], v18 offset:40960
    ds_read_b64_tr_b16 v[194:195], v18 offset:43008
    s_waitcnt lgkmcnt(10)
    v_mfma_f32_32x32x16_bf16 v[112:127], v[204:207], v[160:163], v[112:127]
    ds_read_b64_tr_b16 v[196:197], v19 offset:40960
    ds_read_b64_tr_b16 v[198:199], v19 offset:43008
    s_waitcnt vmcnt(19)
    s_waitcnt lgkmcnt(10)
    v_mfma_f32_32x32x16_bf16 v[64:79], v[208:211], v[164:167], v[64:79]
    ds_read_b64_tr_b16 v[200:201], v20 offset:40960
    ds_read_b64_tr_b16 v[202:203], v20 offset:43008
    s_waitcnt lgkmcnt(10)
    v_mfma_f32_32x32x16_bf16 v[80:95], v[212:215], v[164:167], v[80:95]
    ds_read_b64_tr_b16 v[204:205], v21 offset:40960
    ds_read_b64_tr_b16 v[206:207], v21 offset:43008
    s_add_u32 s36, s41, 28672
    buffer_load_dwordx4 v[148:151], v10, s[20:23], s36 offen offset:1024 sc1
    s_waitcnt lgkmcnt(10)
    v_mfma_f32_32x32x16_bf16 v[96:111], v[216:219], v[164:167], v[96:111]
    ds_read_b64_tr_b16 v[208:209], v18 offset:45056
    ds_read_b64_tr_b16 v[210:211], v18 offset:47104
    s_waitcnt lgkmcnt(10)
    v_mfma_f32_32x32x16_bf16 v[112:127], v[220:223], v[164:167], v[112:127]
    ds_read_b64_tr_b16 v[212:213], v19 offset:45056
    ds_read_b64_tr_b16 v[214:215], v19 offset:47104
    s_waitcnt vmcnt(19)
    s_waitcnt lgkmcnt(10)
    v_mfma_f32_32x32x16_bf16 v[64:79], v[192:195], v[168:171], v[64:79]
    ds_read_b64_tr_b16 v[216:217], v20 offset:45056
    ds_read_b64_tr_b16 v[218:219], v20 offset:47104
    s_waitcnt lgkmcnt(10)
    v_mfma_f32_32x32x16_bf16 v[80:95], v[196:199], v[168:171], v[80:95]
    ds_read_b64_tr_b16 v[220:221], v21 offset:45056
    ds_read_b64_tr_b16 v[222:223], v21 offset:47104
    s_add_u32 s36, s41, 28672
    buffer_load_dwordx4 v[152:155], v10, s[20:23], s36 offen offset:2048 sc1
    s_waitcnt vmcnt(15)
    s_barrier
    s_cmp_lg_u32 s3, 0
    s_cbranch_scc1 A_KEV
    s_cmp_eq_i32 s76, -1
    s_cbranch_scc1 A_KEV
    v_mov_b32 v2, s76
    v_mov_b32 v3, s77
    s_mov_b64 exec, 1
    global_store_dword v2, v3, s[100:101] sc1
    s_mov_b64 exec, -1
A_KEV:
    s_mov_b32 s76, -1
    s_cmp_eq_i32 s66, -1
    s_cbranch_scc1 A_CF1
    v_mov_b32 v8, s66
    v_mov_b32 v9, s67
    v_cmp_eq_u32 vcc, 0, v1
    s_nop 1
    v_cndmask_b32 v8, v9, v8, vcc
    s_cmp_lg_u32 s3, 0
    s_cbranch_scc1 A_CF1
    v_mov_b32 v9, s77
    s_mov_b64 exec, 3
    global_store_dword v8, v9, s[100:101] sc1
    s_mov_b64 exec, -1
A_CF1:
    s_mov_b32 s66, -1
    s_waitcnt lgkmcnt(10)
    v_mfma_f32_32x32x16_bf16 v[96:111], v[200:203], v[168:171], v[96:111]
    ds_read_b64_tr_b16 v[192:193], v18 offset:49152
    ds_read_b64_tr_b16 v[194:195], v18 offset:51200
    s_waitcnt lgkmcnt(10)
    v_mfma_f32_32x32x16_bf16 v[112:127], v[204:207], v[168:171], v[112:127]
    ds_read_b64_tr_b16 v[196:197], v19 offset:49152
    ds_read_b64_tr_b16 v[198:199], v19 offset:51200
    s_waitcnt vmcnt(19)
    s_waitcnt lgkmcnt(10)
    v_mfma_f32_32x32x16_bf16 v[64:79], v[208:211], v[172:175], v[64:79]
    ds_read_b64_tr_b16 v[200:201], v20 offset:49152
    ds_read_b64_tr_b16 v[202:203], v20 offset:51200
    s_waitcnt lgkmcnt(10)
    v_mfma_f32_32x32x16_bf16 v[80:95], v[212:215], v[172:175], v[80:95]
    ds_read_b64_tr_b16 v[204:205], v21 offset:49152
    ds_read_b64_tr_b16 v[206:207], v21 offset:51200
    s_add_u32 s36, s41, 28672
    buffer_load_dwordx4 v[156:159], v10, s[20:23], s36 offen offset:3072 sc1
    s_waitcnt lgkmcnt(10)
    v_mfma_f32_32x32x16_bf16 v[96:111], v[216:219], v[172:175], v[96:111]
    ds_read_b64_tr_b16 v[208:209], v18 offset:53248
    ds_read_b64_tr_b16 v[210:211], v18 offset:55296
    s_waitcnt lgkmcnt(10)
    v_mfma_f32_32x32x16_bf16 v[112:127], v[220:223], v[172:175], v[112:127]
    ds_read_b64_tr_b16 v[212:213], v19 offset:53248
    ds_read_b64_tr_b16 v[214:215], v19 offset:55296
    s_waitcnt vmcnt(19)
    s_waitcnt lgkmcnt(10)
    v_mfma_f32_32x32x16_bf16 v[64:79], v[192:195], v[176:179], v[64:79]
    ds_read_b64_tr_b16 v[216:217], v20 offset:53248
    ds_read_b64_tr_b16 v[218:219], v20 offset:55296
    s_waitcnt lgkmcnt(10)
    v_mfma_f32_32x32x16_bf16 v[80:95], v[196:199], v[176:179], v[80:95]
    ds_read_b64_tr_b16 v[220:221], v21 offset:53248
    ds_read_b64_tr_b16 v[222:223], v21 offset:55296
    s_waitcnt lgkmcnt(10)
    v_mfma_f32_32x32x16_bf16 v[96:111], v[200:203], v[176:179], v[96:111]
    ds_read_b64_tr_b16 v[192:193], v18 offset:57344
    ds_read_b64_tr_b16 v[194:195], v18 offset:59392
    s_waitcnt lgkmcnt(10)
    v_mfma_f32_32x32x16_bf16 v[112:127], v[204:207], v[176:179], v[112:127]
    ds_read_b64_tr_b16 v[196:197], v19 offset:57344
    ds_read_b64_tr_b16 v[198:199], v19 offset:59392
    s_waitcnt vmcnt(18)
    s_waitcnt lgkmcnt(10)
    v_mfma_f32_32x32x16_bf16 v[64:79], v[208:211], v[180:183], v[64:79]
    ds_read_b64_tr_b16 v[200:201], v20 offset:57344
    ds_read_b64_tr_b16 v[202:203], v20 offset:59392
    s_waitcnt lgkmcnt(10)
    v_mfma_f32_32x32x16_bf16 v[80:95], v[212:215], v[180:183], v[80:95]
    ds_read_b64_tr_b16 v[204:205], v21 offset:57344
    ds_read_b64_tr_b16 v[206:207], v21 offset:59392
    s_waitcnt lgkmcnt(10)
    v_mfma_f32_32x32x16_bf16 v[96:111], v[216:219], v[180:183], v[96:111]
    ds_read_b64_tr_b16 v[208:209], v18 offset:61440
    ds_read_b64_tr_b16 v[210:211], v18 offset:63488
    s_waitcnt lgkmcnt(10)
    v_mfma_f32_32x32x16_bf16 v[112:127], v[220:223], v[180:183], v[112:127]
    ds_read_b64_tr_b16 v[212:213], v19 offset:61440
    ds_read_b64_tr_b16 v[214:215], v19 offset:63488
    s_waitcnt vmcnt(17)
    s_waitcnt lgkmcnt(10)
    v_mfma_f32_32x32x16_bf16 v[64:79], v[192:195], v[184:187], v[64:79]
    ds_read_b64_tr_b16 v[216:217], v20 offset:61440
    ds_read_b64_tr_b16 v[218:219], v20 offset:63488
    s_waitcnt lgkmcnt(10)
    v_mfma_f32_32x32x16_bf16 v[80:95], v[196:199], v[184:187], v[80:95]
    ds_read_b64_tr_b16 v[220:221], v21 offset:61440
    ds_read_b64_tr_b16 v[222:223], v21 offset:63488
    s_waitcnt vmcnt(30)
    s_barrier
    s_waitcnt lgkmcnt(10)
    v_mfma_f32_32x32x16_bf16 v[96:111], v[200:203], v[184:187], v[96:111]
    v_add_u32 v18, 0x10000, v18
    v_add_u32 v19, 0x10000, v19
    v_add_u32 v20, 0x10000, v20
    v_add_u32 v21, 0x10000, v21
    ds_read_b64_tr_b16 v[192:193], v18 offset:0
    ds_read_b64_tr_b16 v[194:195], v18 offset:2048
    s_waitcnt lgkmcnt(10)
    v_mfma_f32_32x32x16_bf16 v[112:127], v[204:207], v[184:187], v[112:127]
    ds_read_b64_tr_b16 v[196:197], v19 offset:0
    ds_read_b64_tr_b16 v[198:199], v19 offset:2048
    s_waitcnt vmcnt(16)
    s_waitcnt lgkmcnt(10)
    v_mfma_f32_32x32x16_bf16 v[64:79], v[208:211], v[188:191], v[64:79]
    ds_read_b64_tr_b16 v[200:201], v20 offset:0
    ds_read_b64_tr_b16 v[202:203], v20 offset:2048
    s_waitcnt lgkmcnt(10)
    v_mfma_f32_32x32x16_bf16 v[80:95], v[212:215], v[188:191], v[80:95]
    ds_read_b64_tr_b16 v[204:205], v21 offset:0
    ds_read_b64_tr_b16 v[206:207], v21 offset:2048
    s_waitcnt lgkmcnt(10)
    v_mfma_f32_32x32x16_bf16 v[96:111], v[216:219], v[188:191], v[96:111]
    ds_read_b64_tr_b16 v[208:209], v18 offset:4096
    ds_read_b64_tr_b16 v[210:211], v18 offset:6144
    s_waitcnt lgkmcnt(10)
    v_mfma_f32_32x32x16_bf16 v[112:127], v[220:223], v[188:191], v[112:127]
    ds_read_b64_tr_b16 v[212:213], v19 offset:4096
    ds_read_b64_tr_b16 v[214:215], v19 offset:6144
    s_cmp_lg_u32 s3, 0
    s_cbranch_scc1 A_NOKP
    global_load_dword v5, v4, s[100:101] sc1
A_NOKP:
    s_waitcnt vmcnt(15)
    s_waitcnt lgkmcnt(10)
    v_mfma_f32_32x32x16_bf16 v[64:79], v[192:195], v[224:227], v[64:79]
    ds_read_b64_tr_b16 v[216:217], v20 offset:4096
    ds_read_b64_tr_b16 v[218:219], v20 offset:6144
    s_waitcnt lgkmcnt(10)
    v_mfma_f32_32x32x16_bf16 v[80:95], v[196:199], v[224:227], v[80:95]
    ds_read_b64_tr_b16 v[220:221], v21 offset:4096
    ds_read_b64_tr_b16 v[222:223], v21 offset:6144
    s_waitcnt lgkmcnt(10)
    v_mfma_f32_32x32x16_bf16 v[96:111], v[200:203], v[224:227], v[96:111]
    ds_read_b64_tr_b16 v[192:193], v18 offset:8192
    ds_read_b64_tr_b16 v[194:195], v18 offset:10240
    s_waitcnt lgkmcnt(10)
    v_mfma_f32_32x32x16_bf16 v[112:127], v[204:207], v[224:227], v[112:127]
    ds_read_b64_tr_b16 v[196:197], v19 offset:8192
    ds_read_b64_tr_b16 v[198:199], v19 offset:10240
    s_waitcnt vmcnt(14)
    s_waitcnt lgkmcnt(10)
    v_mfma_f32_32x32x16_bf16 v[64:79], v[208:211], v[228:231], v[64:79]
    ds_read_b64_tr_b16 v[200:201], v20 offset:8192
    ds_read_b64_tr_b16 v[202:203], v20 offset:10240
    s_waitcnt lgkmcnt(10)
    v_mfma_f32_32x32x16_bf16 v[80:95], v[212:215], v[228:231], v[80:95]
    ds_read_b64_tr_b16 v[204:205], v21 offset:8192
    ds_read_b64_tr_b16 v[206:207], v21 offset:10240
    s_waitcnt lgkmcnt(10)
    v_mfma_f32_32x32x16_bf16 v[96:111], v[216:219], v[228:231], v[96:111]
    ds_read_b64_tr_b16 v[208:209], v18 offset:12288
    ds_read_b64_tr_b16 v[210:211], v18 offset:14336
    s_waitcnt lgkmcnt(10)
    v_mfma_f32_32x32x16_bf16 v[112:127], v[220:223], v[228:231], v[112:127]
    ds_read_b64_tr_b16 v[212:213], v19 offset:12288
    ds_read_b64_tr_b16 v[214:215], v19 offset:14336
    s_waitcnt vmcnt(13)
    s_waitcnt lgkmcnt(10)
    v_mfma_f32_32x32x16_bf16 v[64:79], v[192:195], v[232:235], v[64:79]
    ds_read_b64_tr_b16 v[216:217], v20 offset:12288
    ds_read_b64_tr_b16 v[218:219], v20 offset:14336
    s_waitcnt lgkmcnt(10)
    v_mfma_f32_32x32x16_bf16 v[80:95], v[196:199], v[232:235], v[80:95]
    ds_read_b64_tr_b16 v[220:221], v21 offset:12288
    ds_read_b64_tr_b16 v[222:223], v21 offset:14336
    s_waitcnt vmcnt(28)
    s_barrier
    s_waitcnt lgkmcnt(10)
    v_mfma_f32_32x32x16_bf16 v[96:111], v[200:203], v[232:235], v[96:111]
    ds_read_b64_tr_b16 v[192:193], v18 offset:16384
    ds_read_b64_tr_b16 v[194:195], v18 offset:18432
    s_waitcnt lgkmcnt(10)
    v_mfma_f32_32x32x16_bf16 v[112:127], v[204:207], v[232:235], v[112:127]
    ds_read_b64_tr_b16 v[196:197], v19 offset:16384
    ds_read_b64_tr_b16 v[198:199], v19 offset:18432
    s_waitcnt vmcnt(12)
    s_waitcnt lgkmcnt(10)
    v_mfma_f32_32x32x16_bf16 v[64:79], v[208:211], v[236:239], v[64:79]
    ds_read_b64_tr_b16 v[200:201], v20 offset:16384
    ds_read_b64_tr_b16 v[202:203], v20 offset:18432
    s_waitcnt lgkmcnt(10)
    v_mfma_f32_32x32x16_bf16 v[80:95], v[212:215], v[236:239], v[80:95]
    ds_read_b64_tr_b16 v[204:205], v21 offset:16384
    ds_read_b64_tr_b16 v[206:207], v21 offset:18432
    s_waitcnt lgkmcnt(10)
    v_mfma_f32_32x32x16_bf16 v[96:111], v[216:219], v[236:239], v[96:111]
    ds_read_b64_tr_b16 v[208:209], v18 offset:20480
    ds_read_b64_tr_b16 v[210:211], v18 offset:22528
    s_waitcnt lgkmcnt(10)
    v_mfma_f32_32x32x16_bf16 v[112:127], v[220:223], v[236:239], v[112:127]
    ds_read_b64_tr_b16 v[212:213], v19 offset:20480
    ds_read_b64_tr_b16 v[214:215], v19 offset:22528
    s_waitcnt vmcnt(11)
    s_waitcnt lgkmcnt(10)
    v_mfma_f32_32x32x16_bf16 v[64:79], v[192:195], v[240:243], v[64:79]
    ds_read_b64_tr_b16 v[216:217], v20 offset:20480
    ds_read_b64_tr_b16 v[218:219], v20 offset:22528
    s_waitcnt lgkmcnt(10)
    v_mfma_f32_32x32x16_bf16 v[80:95], v[196:199], v[240:243], v[80:95]
    ds_read_b64_tr_b16 v[220:221], v21 offset:20480
    ds_read_b64_tr_b16 v[222:223], v21 offset:22528
    s_waitcnt lgkmcnt(10)
    v_mfma_f32_32x32x16_bf16 v[96:111], v[200:203], v[240:243], v[96:111]
    ds_read_b64_tr_b16 v[192:193], v18 offset:24576
    ds_read_b64_tr_b16 v[194:195], v18 offset:26624
    s_waitcnt lgkmcnt(10)
    v_mfma_f32_32x32x16_bf16 v[112:127], v[204:207], v[240:243], v[112:127]
    ds_read_b64_tr_b16 v[196:197], v19 offset:24576
    ds_read_b64_tr_b16 v[198:199], v19 offset:26624
    s_waitcnt vmcnt(10)
    s_waitcnt lgkmcnt(10)
    v_mfma_f32_32x32x16_bf16 v[64:79], v[208:211], v[244:247], v[64:79]
    ds_read_b64_tr_b16 v[200:201], v20 offset:24576
    ds_read_b64_tr_b16 v[202:203], v20 offset:26624
    s_waitcnt lgkmcnt(10)
    v_mfma_f32_32x32x16_bf16 v[80:95], v[212:215], v[244:247], v[80:95]
    ds_read_b64_tr_b16 v[204:205], v21 offset:24576
    ds_read_b64_tr_b16 v[206:207], v21 offset:26624
    s_waitcnt lgkmcnt(10)
    v_mfma_f32_32x32x16_bf16 v[96:111], v[216:219], v[244:247], v[96:111]
    ds_read_b64_tr_b16 v[208:209], v18 offset:28672
    ds_read_b64_tr_b16 v[210:211], v18 offset:30720
    s_waitcnt lgkmcnt(10)
    v_mfma_f32_32x32x16_bf16 v[112:127], v[220:223], v[244:247], v[112:127]
    ds_read_b64_tr_b16 v[212:213], v19 offset:28672
    ds_read_b64_tr_b16 v[214:215], v19 offset:30720
    s_waitcnt vmcnt(9)
    s_waitcnt lgkmcnt(10)
    v_mfma_f32_32x32x16_bf16 v[64:79], v[192:195], v[248:251], v[64:79]
    ds_read_b64_tr_b16 v[216:217], v20 offset:28672
    ds_read_b64_tr_b16 v[218:219], v20 offset:30720
    s_waitcnt lgkmcnt(10)
    v_mfma_f32_32x32x16_bf16 v[80:95], v[196:199], v[248:251], v[80:95]
    ds_read_b64_tr_b16 v[220:221], v21 offset:28672
    ds_read_b64_tr_b16 v[222:223], v21 offset:30720
    s_waitcnt vmcnt(26)
    s_cmp_lg_u32 s3, 0
    s_cbranch_scc1 A_KOK
    s_waitcnt vmcnt(0)
    v_cmp_ne_u32 vcc, s77, v5
    s_cbranch_vccnz A_KSLOW
A_KOK:
    s_barrier
    s_waitcnt lgkmcnt(10)
    v_mfma_f32_32x32x16_bf16 v[96:111], v[200:203], v[248:251], v[96:111]
    ds_read_b64_tr_b16 v[192:193], v18 offset:32768
    ds_read_b64_tr_b16 v[194:195], v18 offset:34816
    s_lshl_b32 s48, s46, 15
    s_add_u32 s36, s48, 0x10000
    s_cmp_ge_u32 s46, s18
    s_cselect_b32 s48, s36, s48
    s_sub_u32 s36, s48, 114688
    s_add_u32 s37, s18, 2
    s_cmp_eq_u32 s46, s37
    s_cselect_b32 s48, s36, s48
    s_add_u32 s48, s48, s52
    s_add_u32 s46, s46, 1
    s_add_u32 m0, s49, s57
    s_nop 0
    buffer_load_dwordx4 v10, s[28:31], s48 offen offset:0 sc1 lds
    buffer_load_dwordx4 v10, s[28:31], s48 offen offset:1024 sc1 lds
    s_add_u32 s49, s49, 16384
    s_cmp_eq_u32 s49, 49152
    s_cselect_b32 s49, 0, s49
    s_waitcnt lgkmcnt(10)
    v_mfma_f32_32x32x16_bf16 v[112:127], v[204:207], v[248:251], v[112:127]
    ds_read_b64_tr_b16 v[196:197], v19 offset:32768
    ds_read_b64_tr_b16 v[198:199], v19 offset:34816
    s_waitcnt vmcnt(10)
    s_waitcnt lgkmcnt(10)
    v_mfma_f32_32x32x16_bf16 v[64:79], v[208:211], v[252:255], v[64:79]
    ds_read_b64_tr_b16 v[200:201], v20 offset:32768
    ds_read_b64_tr_b16 v[202:203], v20 offset:34816
    s_waitcnt lgkmcnt(10)
    v_mfma_f32_32x32x16_bf16 v[80:95], v[212:215], v[252:255], v[80:95]
    ds_read_b64_tr_b16 v[204:205], v21 offset:32768
    ds_read_b64_tr_b16 v[206:207], v21 offset:34816
    s_waitcnt lgkmcnt(10)
    v_mfma_f32_32x32x16_bf16 v[96:111], v[216:219], v[252:255], v[96:111]
    ds_read_b64_tr_b16 v[208:209], v18 offset:36864
    ds_read_b64_tr_b16 v[210:211], v18 offset:38912
    s_lshl_b32 s48, s46, 15
    s_add_u32 s36, s48, 0x10000
    s_cmp_ge_u32 s46, s18
    s_cselect_b32 s48, s36, s48
    s_sub_u32 s36, s48, 114688
    s_add_u32 s37, s18, 2
    s_cmp_eq_u32 s46, s37
    s_cselect_b32 s48, s36, s48
    s_add_u32 s48, s48, s52
    s_add_u32 s46, s46, 1
    s_add_u32 m0, s49, s57
    s_nop 0
    buffer_load_dwordx4 v10, s[28:31], s48 offen offset:0 sc1 lds
    buffer_load_dwordx4 v10, s[28:31], s48 offen offset:1024 sc1 lds
    s_add_u32 s49, s49, 16384
    s_cmp_eq_u32 s49, 49152
    s_cselect_b32 s49, 0, s49
    s_waitcnt lgkmcnt(10)
    v_mfma_f32_32x32x16_bf16 v[112:127], v[220:223], v[252:255], v[112:127]
    ds_read_b64_tr_b16 v[212:213], v19 offset:36864
    ds_read_b64_tr_b16 v[214:215], v19 offset:38912
    s_waitcnt vmcnt(11)
    s_waitcnt lgkmcnt(10)
    v_mfma_f32_32x32x16_bf16 v[64:79], v[192:195], v[128:131], v[64:79]
    ds_read_b64_tr_b16 v[216:217], v20 offset:36864
    ds_read_b64_tr_b16 v[218:219], v20 offset:38912
    s_waitcnt lgkmcnt(10)
    v_mfma_f32_32x32x16_bf16 v[80:95], v[196:199], v[128:131], v[80:95]
    ds_read_b64_tr_b16 v[220:221], v21 offset:36864
    ds_read_b64_tr_b16 v[222:223], v21 offset:38912
    s_waitcnt lgkmcnt(10)
    v_mfma_f32_32x32x16_bf16 v[96:111], v[200:203], v[128:131], v[96:111]
    ds_read_b64_tr_b16 v[192:193], v18 offset:40960
    ds_read_b64_tr_b16 v[194:195], v18 offset:43008
    s_lshl_b32 s48, s46, 15
    s_add_u32 s36, s48, 0x10000
    s_cmp_ge_u32 s46, s18
    s_cselect_b32 s48, s36, s48
    s_sub_u32 s36, s48, 114688
    s_add_u32 s37, s18, 2
    s_cmp_eq_u32 s46, s37
    s_cselect_b32 s48, s36, s48
    s_add_u32 s48, s48, s52
    s_add_u32 s46, s46, 1
    s_add_u32 m0, s49, s57
    s_nop 0
    buffer_load_dwordx4 v10, s[28:31], s48 offen offset:0 sc1 lds
    buffer_load_dwordx4 v10, s[28:31], s48 offen offset:1024 sc1 lds
    s_add_u32 s49, s49, 16384
    s_cmp_eq_u32 s49, 49152
    s_cselect_b32 s49, 0, s49
    s_waitcnt lgkmcnt(10)
    v_mfma_f32_32x32x16_bf16 v[112:127], v[204:207], v[128:131], v[112:127]
    ds_read_b64_tr_b16 v[196:197], v19 offset:40960
    ds_read_b64_tr_b16 v[198:199], v19 offset:43008
    s_waitcnt vmcnt(12)
    s_waitcnt lgkmcnt(10)
    v_mfma_f32_32x32x16_bf16 v[64:79], v[208:211], v[132:135], v[64:79]
    ds_read_b64_tr_b16 v[200:201], v20 offset:40960
    ds_read_b64_tr_b16 v[202:203], v20 offset:43008
    s_waitcnt lgkmcnt(10)
    v_mfma_f32_32x32x16_bf16 v[80:95], v[212:215], v[132:135], v[80:95]
    ds_read_b64_tr_b16 v[204:205], v21 offset:40960
    ds_read_b64_tr_b16 v[206:207], v21 offset:43008
    s_waitcnt lgkmcnt(10)
    v_mfma_f32_32x32x16_bf16 v[96:111], v[216:219], v[132:135], v[96:111]
    ds_read_b64_tr_b16 v[208:209], v18 offset:45056
    ds_read_b64_tr_b16 v[210:211], v18 offset:47104
    s_waitcnt lgkmcnt(10)
    v_mfma_f32_32x32x16_bf16 v[112:127], v[220:223], v[132:135], v[112:127]
    ds_read_b64_tr_b16 v[212:213], v19 offset:45056
    ds_read_b64_tr_b16 v[214:215], v19 offset:47104
    s_waitcnt vmcnt(11)
    s_waitcnt lgkmcnt(10)
    v_mfma_f32_32x32x16_bf16 v[64:79], v[192:195], v[136:139], v[64:79]
    ds_read_b64_tr_b16 v[216:217], v20 offset:45056
    ds_read_b64_tr_b16 v[218:219], v20 offset:47104
    s_waitcnt lgkmcnt(10)
    v_mfma_f32_32x32x16_bf16 v[80:95], v[196:199], v[136:139], v[80:95]
    ds_read_b64_tr_b16 v[220:221], v21 offset:45056
    ds_read_b64_tr_b16 v[222:223], v21 offset:47104
    s_waitcnt vmcnt(30)
    s_barrier
    s_waitcnt lgkmcnt(10)
    v_mfma_f32_32x32x16_bf16 v[96:111], v[200:203], v[136:139], v[96:111]
    ds_read_b64_tr_b16 v[192:193], v18 offset:49152
    ds_read_b64_tr_b16 v[194:195], v18 offset:51200
    s_lshl_b32 s50, s47, 15
    s_add_u32 s36, s50, 0x8000
    s_cmp_ge_u32 s47, s18
    s_cselect_b32 s50, s36, s50
    s_add_u32 s50, s50, 0x4000
    s_add_u32 s50, s50, s52
    s_add_u32 s47, s47, 1
    s_add_u32 m0, s51, s57
    s_nop 0
    buffer_load_dwordx4 v10, s[28:31], s50 offen offset:0 sc1 lds
    buffer_load_dwordx4 v10, s[28:31], s50 offen offset:1024 sc1 lds
    s_add_u32 s51, s51, 16384
    s_cmp_eq_u32 s51, 98304
    s_cselect_b32 s51, 49152, s51
    s_waitcnt lgkmcnt(10)
    v_mfma_f32_32x32x16_bf16 v[112:127], v[204:207], v[136:139], v[112:127]
    ds_read_b64_tr_b16 v[196:197], v19 offset:49152
    ds_read_b64_tr_b16 v[198:199], v19 offset:51200
    s_waitcnt vmcnt(12)
    s_waitcnt lgkmcnt(10)
    v_mfma_f32_32x32x16_bf16 v[64:79], v[208:211], v[140:143], v[64:79]
    ds_read_b64_tr_b16 v[200:201], v20 offset:49152
    ds_read_b64_tr_b16 v[202:203], v20 offset:51200
    s_waitcnt lgkmcnt(10)
    v_mfma_f32_32x32x16_bf16 v[80:95], v[212:215], v[140:143], v[80:95]
    ds_read_b64_tr_b16 v[204:205], v21 offset:49152
    ds_read_b64_tr_b16 v[206:207], v21 offset:51200
    s_waitcnt lgkmcnt(10)
    v_mfma_f32_32x32x16_bf16 v[96:111], v[216:219], v[140:143], v[96:111]
    ds_read_b64_tr_b16 v[208:209], v18 offset:53248
    ds_read_b64_tr_b16 v[210:211], v18 offset:55296
    s_lshl_b32 s50, s47, 15
    s_add_u32 s36, s50, 0x8000
    s_cmp_ge_u32 s47, s18
    s_cselect_b32 s50, s36, s50
    s_add_u32 s50, s50, 0x4000
    s_add_u32 s50, s50, s52
    s_add_u32 s47, s47, 1
    s_add_u32 m0, s51, s57
    s_nop 0
    buffer_load_dwordx4 v10, s[28:31], s50 offen offset:0 sc1 lds
    buffer_load_dwordx4 v10, s[28:31], s50 offen offset:1024 sc1 lds
    s_add_u32 s51, s51, 16384
    s_cmp_eq_u32 s51, 98304
    s_cselect_b32 s51, 49152, s51
    s_waitcnt lgkmcnt(10)
    v_mfma_f32_32x32x16_bf16 v[112:127], v[220:223], v[140:143], v[112:127]
    ds_read_b64_tr_b16 v[212:213], v19 offset:53248
    ds_read_b64_tr_b16 v[214:215], v19 offset:55296
    s_waitcnt vmcnt(13)
    s_waitcnt lgkmcnt(10)
    v_mfma_f32_32x32x16_bf16 v[64:79], v[192:195], v[144:147], v[64:79]
    ds_read_b64_tr_b16 v[216:217], v20 offset:53248
    ds_read_b64_tr_b16 v[218:219], v20 offset:55296
    s_waitcnt lgkmcnt(10)
    v_mfma_f32_32x32x16_bf16 v[80:95], v[196:199], v[144:147], v[80:95]
    ds_read_b64_tr_b16 v[220:221], v21 offset:53248
    ds_read_b64_tr_b16 v[222:223], v21 offset:55296
    s_waitcnt lgkmcnt(10)
    v_mfma_f32_32x32x16_bf16 v[96:111], v[200:203], v[144:147], v[96:111]
    ds_read_b64_tr_b16 v[192:193], v18 offset:57344
    ds_read_b64_tr_b16 v[194:195], v18 offset:59392
    s_waitcnt lgkmcnt(10)
    v_mfma_f32_32x32x16_bf16 v[112:127], v[204:207], v[144:147], v[112:127]
    ds_read_b64_tr_b16 v[196:197], v19 offset:57344
    ds_read_b64_tr_b16 v[198:199], v19 offset:59392
    s_waitcnt vmcnt(12)
    s_waitcnt lgkmcnt(10)
    v_mfma_f32_32x32x16_bf16 v[64:79], v[208:211], v[148:151], v[64:79]
    ds_read_b64_tr_b16 v[200:201], v20 offset:57344
    ds_read_b64_tr_b16 v[202:203], v20 offset:59392
    s_waitcnt lgkmcnt(10)
    v_mfma_f32_32x32x16_bf16 v[80:95], v[212:215], v[148:151], v[80:95]
    ds_read_b64_tr_b16 v[204:205], v21 offset:57344
    ds_read_b64_tr_b16 v[206:207], v21 offset:59392
    s_waitcnt lgkmcnt(10)
    v_mfma_f32_32x32x16_bf16 v[96:111], v[216:219], v[148:151], v[96:111]
    ds_read_b64_tr_b16 v[208:209], v18 offset:61440
    ds_read_b64_tr_b16 v[210:211], v18 offset:63488
    s_waitcnt lgkmcnt(10)
    v_mfma_f32_32x32x16_bf16 v[112:127], v[220:223], v[148:151], v[112:127]
    ds_read_b64_tr_b16 v[212:213], v19 offset:61440
    ds_read_b64_tr_b16 v[214:215], v19 offset:63488
    s_waitcnt vmcnt(11)
    s_waitcnt lgkmcnt(10)
    v_mfma_f32_32x32x16_bf16 v[64:79], v[192:195], v[152:155], v[64:79]
    ds_read_b64_tr_b16 v[216:217], v20 offset:61440
    ds_read_b64_tr_b16 v[218:219], v20 offset:63488
    s_waitcnt lgkmcnt(10)
    v_mfma_f32_32x32x16_bf16 v[80:95], v[196:199], v[152:155], v[80:95]
    ds_read_b64_tr_b16 v[220:221], v21 offset:61440
    ds_read_b64_tr_b16 v[222:223], v21 offset:63488
    s_waitcnt lgkmcnt(10)
    v_mfma_f32_32x32x16_bf16 v[96:111], v[200:203], v[152:155], v[96:111]
    s_waitcnt lgkmcnt(8)
    v_mfma_f32_32x32x16_bf16 v[112:127], v[204:207], v[152:155], v[112:127]
    s_waitcnt vmcnt(10)
    s_waitcnt lgkmcnt(6)
    v_mfma_f32_32x32x16_bf16 v[64:79], v[208:211], v[156:159], v[64:79]
    s_waitcnt lgkmcnt(4)
    v_mfma_f32_32x32x16_bf16 v[80:95], v[212:215], v[156:159], v[80:95]
    s_waitcnt lgkmcnt(2)
    v_mfma_f32_32x32x16_bf16 v[96:111], v[216:219], v[156:159], v[96:111]
    s_waitcnt lgkmcnt(0)
    v_mfma_f32_32x32x16_bf16 v[112:127], v[220:223], v[156:159], v[112:127]
    v_subrev_u32 v18, 0x10000, v18
    v_subrev_u32 v19, 0x10000, v19
    v_subrev_u32 v20, 0x10000, v20
    v_subrev_u32 v21, 0x10000, v21
    s_nop 1
    v_mul_f32 v64, s39, v64
    v_mul_f32 v65, s39, v65
    v_mul_f32 v66, s39, v66
    v_mul_f32 v67, s39, v67
    v_mul_f32 v68, s39, v68
    v_mul_f32 v69, s39, v69
    v_mul_f32 v70, s39, v70
    v_mul_f32 v71, s39, v71
    v_mul_f32 v72, s39, v72
    v_mul_f32 v73, s39, v73
    v_mul_f32 v74, s39, v74
    v_mul_f32 v75, s39, v75
    v_mul_f32 v76, s39, v76
    v_mul_f32 v77, s39, v77
    v_mul_f32 v78, s39, v78
    v_mul_f32 v79, s39, v79
    v_mul_f32 v80, s39, v80
    v_mul_f32 v81, s39, v81
    v_mul_f32 v82, s39, v82
    v_mul_f32 v83, s39, v83
    v_mul_f32 v84, s39, v84
    v_mul_f32 v85, s39, v85
    v_mul_f32 v86, s39, v86
    v_mul_f32 v87, s39, v87
    v_mul_f32 v88, s39, v88
    v_mul_f32 v89, s39, v89
    v_mul_f32 v90, s39, v90
    v_mul_f32 v91, s39, v91
    v_mul_f32 v92, s39, v92
    v_mul_f32 v93, s39, v93
    v_mul_f32 v94, s39, v94
    v_mul_f32 v95, s39, v95
    v_mul_f32 v96, s39, v96
    v_mul_f32 v97, s39, v97
    v_mul_f32 v98, s39, v98
    v_mul_f32 v99, s39, v99
    v_mul_f32 v100, s39, v100
    v_mul_f32 v101, s39, v101
    v_mul_f32 v102, s39, v102
    v_mul_f32 v103, s39, v103
    v_mul_f32 v104, s39, v104
    v_mul_f32 v105, s39, v105
    v_mul_f32 v106, s39, v106
    v_mul_f32 v107, s39, v107
    v_mul_f32 v108, s39, v108
    v_mul_f32 v109, s39, v109
    v_mul_f32 v110, s39, v110
    v_mul_f32 v111, s39, v111
    v_mul_f32 v112, s39, v112
    v_mul_f32 v113, s39, v113
    v_mul_f32 v114, s39, v114
    v_mul_f32 v115, s39, v115
    v_mul_f32 v116, s39, v116
    v_mul_f32 v117, s39, v117
    v_mul_f32 v118, s39, v118
    v_mul_f32 v119, s39, v119
    v_mul_f32 v120, s39, v120
    v_mul_f32 v121, s39, v121
    v_mul_f32 v122, s39, v122
    v_mul_f32 v123, s39, v123
    v_mul_f32 v124, s39, v124
    v_mul_f32 v125, s39, v125
    v_mul_f32 v126, s39, v126
    v_mul_f32 v127, s39, v127
    v_cvt_pk_bf16_f32 v32, v64, v65
    v_cvt_pk_bf16_f32 v33, v66, v67
    v_cvt_pk_bf16_f32 v34, v68, v69
    v_cvt_pk_bf16_f32 v35, v70, v71
    v_cvt_pk_bf16_f32 v36, v72, v73
    v_cvt_pk_bf16_f32 v37, v74, v75
    v_cvt_pk_bf16_f32 v38, v76, v77
    v_cvt_pk_bf16_f32 v39, v78, v79
    v_cvt_pk_bf16_f32 v40, v80, v81
    v_cvt_pk_bf16_f32 v41, v82, v83
    v_cvt_pk_bf16_f32 v42, v84, v85
    v_cvt_pk_bf16_f32 v43, v86, v87
    v_cvt_pk_bf16_f32 v44, v88, v89
    v_cvt_pk_bf16_f32 v45, v90, v91
    v_cvt_pk_bf16_f32 v46, v92, v93
    v_cvt_pk_bf16_f32 v47, v94, v95
    v_cvt_pk_bf16_f32 v48, v96, v97
    v_cvt_pk_bf16_f32 v49, v98, v99
    v_cvt_pk_bf16_f32 v50, v100, v101
    v_cvt_pk_bf16_f32 v51, v102, v103
    v_cvt_pk_bf16_f32 v52, v104, v105
    v_cvt_pk_bf16_f32 v53, v106, v107
    v_cvt_pk_bf16_f32 v54, v108, v109
    v_cvt_pk_bf16_f32 v55, v110, v111
    v_cvt_pk_bf16_f32 v56, v112, v113
    v_cvt_pk_bf16_f32 v57, v114, v115
    v_cvt_pk_bf16_f32 v58, v116, v117
    v_cvt_pk_bf16_f32 v59, v118, v119
    v_cvt_pk_bf16_f32 v60, v120, v121
    v_cvt_pk_bf16_f32 v61, v122, v123
    v_cvt_pk_bf16_f32 v62, v124, v125
    v_cvt_pk_bf16_f32 v63, v126, v127
    v_mov_b32 v64, 0
    v_mov_b32 v65, 0
    v_mov_b32 v66, 0
    v_mov_b32 v67, 0
    v_mov_b32 v68, 0
    v_mov_b32 v69, 0
    v_mov_b32 v70, 0
    v_mov_b32 v71, 0
    v_mov_b32 v72, 0
    v_mov_b32 v73, 0
    v_mov_b32 v74, 0
    v_mov_b32 v75, 0
    v_mov_b32 v76, 0
    v_mov_b32 v77, 0
    v_mov_b32 v78, 0
    v_mov_b32 v79, 0
    v_mov_b32 v80, 0
    v_mov_b32 v81, 0
    v_mov_b32 v82, 0
    v_mov_b32 v83, 0
    v_mov_b32 v84, 0
    v_mov_b32 v85, 0
    v_mov_b32 v86, 0
    v_mov_b32 v87, 0
    v_mov_b32 v88, 0
    v_mov_b32 v89, 0
    v_mov_b32 v90, 0
    v_mov_b32 v91, 0
    v_mov_b32 v92, 0
    v_mov_b32 v93, 0
    v_mov_b32 v94, 0
    v_mov_b32 v95, 0
    v_mov_b32 v96, 0
    v_mov_b32 v97, 0
    v_mov_b32 v98, 0
    v_mov_b32 v99, 0
    v_mov_b32 v100, 0
    v_mov_b32 v101, 0
    v_mov_b32 v102, 0
    v_mov_b32 v103, 0
    v_mov_b32 v104, 0
    v_mov_b32 v105, 0
    v_mov_b32 v106, 0
    v_mov_b32 v107, 0
    v_mov_b32 v108, 0
    v_mov_b32 v109, 0
    v_mov_b32 v110, 0
    v_mov_b32 v111, 0
    v_mov_b32 v112, 0
    v_mov_b32 v113, 0
    v_mov_b32 v114, 0
    v_mov_b32 v115, 0
    v_mov_b32 v116, 0
    v_mov_b32 v117, 0
    v_mov_b32 v118, 0
    v_mov_b32 v119, 0
    v_mov_b32 v120, 0
    v_mov_b32 v121, 0
    v_mov_b32 v122, 0
    v_mov_b32 v123, 0
    v_mov_b32 v124, 0
    v_mov_b32 v125, 0
    v_mov_b32 v126, 0
    v_mov_b32 v127, 0
    v_mov_b32 v128, 0
    v_mov_b32 v129, 0
    v_mov_b32 v130, 0
    v_mov_b32 v131, 0
    v_mov_b32 v132, 0
    v_mov_b32 v133, 0
    v_mov_b32 v134, 0
    v_mov_b32 v135, 0
    v_mov_b32 v136, 0
    v_mov_b32 v137, 0
    v_mov_b32 v138, 0
    v_mov_b32 v139, 0
    v_mov_b32 v140, 0
    v_mov_b32 v141, 0
    v_mov_b32 v142, 0
    v_mov_b32 v143, 0
    v_mov_b32 v15, 0
    v_mov_b32 v224, -1
    v_mov_b32 v225, -1
    v_mov_b32 v226, -1
    v_mov_b32 v227, -1
    s_cmp_eq_u32 s13, 0
    s_cbranch_scc1 A_NOQW
    s_lshl_b32 s36, s12, 13
    s_add_u32 s36, s36, 131072
    v_add_u32 v2, s36, v10
    ds_write_b128 v2, v[32:35] offset:0
    ds_write_b128 v2, v[36:39] offset:1024
    ds_write_b128 v2, v[40:43] offset:2048
    ds_write_b128 v2, v[44:47] offset:3072
    ds_write_b128 v2, v[48:51] offset:4096
    ds_write_b128 v2, v[52:55] offset:5120
    ds_write_b128 v2, v[56:59] offset:6144
    ds_write_b128 v2, v[60:63] offset:7168
A_NOQW:
    s_waitcnt vmcnt(4) lgkmcnt(0)
    s_barrier
    s_lshl_b32 s36, s18, 15
    s_add_u32 s36, s36, s52
    s_add_u32 m0, s57, 98304
    s_nop 0
    buffer_load_dwordx4 v10, s[28:31], s36 offen offset:0 sc1 lds
    buffer_load_dwordx4 v10, s[28:31], s36 offen offset:1024 sc1 lds
    s_add_u32 s36, s36, 0x8000
    s_add_u32 m0, s57, 114688
    s_nop 0
    buffer_load_dwordx4 v10, s[28:31], s36 offen offset:0 sc1 lds
    buffer_load_dwordx4 v10, s[28:31], s36 offen offset:1024 sc1 lds
    v_add_u32 v11, s44, v10
    s_mov_b32 s53, 0
    s_mov_b32 s56, 1
    ds_read_b128 v[192:195], v11 offset:0
    ds_read_b128 v[200:203], v11 offset:1024
    ds_read_b128 v[208:211], v11 offset:2048
    ds_read_b128 v[216:219], v11 offset:3072
    s_waitcnt lgkmcnt(3)
    v_mfma_f32_32x32x16_bf16 v[144:159], v[192:195], v[32:35], v[128:143]
    s_waitcnt lgkmcnt(2)
    v_mfma_f32_32x32x16_bf16 v[144:159], v[200:203], v[36:39], v[144:159]
    ds_read_b128 v[192:195], v11 offset:4096
    s_waitcnt lgkmcnt(2)
    v_mfma_f32_32x32x16_bf16 v[144:159], v[208:211], v[40:43], v[144:159]
    ds_read_b128 v[200:203], v11 offset:5120
    s_waitcnt lgkmcnt(2)
    v_mfma_f32_32x32x16_bf16 v[144:159], v[216:219], v[44:47], v[144:159]
    ds_read_b128 v[208:211], v11 offset:6144
    s_waitcnt lgkmcnt(2)
    v_mfma_f32_32x32x16_bf16 v[144:159], v[192:195], v[48:51], v[144:159]
    ds_read_b128 v[216:219], v11 offset:7168
    s_waitcnt lgkmcnt(2)
    v_mfma_f32_32x32x16_bf16 v[144:159], v[200:203], v[52:55], v[144:159]
    ds_read_b128 v[192:195], v11 offset:8192
    s_waitcnt lgkmcnt(2)
    v_mfma_f32_32x32x16_bf16 v[144:159], v[208:211], v[56:59], v[144:159]
    ds_read_b128 v[200:203], v11 offset:9216
    s_add_u32 s49, s44, s57
    s_add_u32 s51, s45, s57
    s_waitcnt lgkmcnt(2)
    v_mfma_f32_32x32x16_bf16 v[144:159], v[216:219], v[60:63], v[144:159]
    ds_read_b128 v[208:211], v11 offset:10240
    s_add_u32 s44, s44, 16384
    s_cmp_eq_u32 s44, 49152
    s_cselect_b32 s44, 0, s44
    s_add_u32 s45, s45, 16384
    s_cmp_eq_u32 s45, 98304
    s_cselect_b32 s45, 49152, s45
    s_lshl_b32 s48, s46, 15
    s_add_u32 s36, s48, 0x10000
    s_cmp_ge_u32 s53, s54
    s_cbranch_scc1 A_MASK_1
A_MRET_2:
    s_cmp_eq_u32 s56, 0
    s_cbranch_scc1 A_NOTFRESH_3
    v_max3_f32 v24, v144, v145, v146
    v_max3_f32 v25, v147, v148, v149
    v_max3_f32 v24, v24, v150, v151
    v_max3_f32 v25, v25, v152, v153
    v_max3_f32 v24, v24, v154, v155
    v_max3_f32 v25, v25, v156, v157
    v_max3_f32 v24, v24, v158, v159
    v_max_f32 v24, v24, v25
    v_mov_b32 v25, v24
    s_nop 1
    v_permlane32_swap_b32 v24, v25
    v_max_f32 v24, v24, v25
    v_sub_f32 v144, v144, v24
    v_sub_f32 v128, 0, v24
    v_sub_f32 v145, v145, v24
    v_sub_f32 v129, 0, v24
    v_sub_f32 v146, v146, v24
    v_sub_f32 v130, 0, v24
    v_sub_f32 v147, v147, v24
    v_sub_f32 v131, 0, v24
    v_sub_f32 v148, v148, v24
    v_sub_f32 v132, 0, v24
    v_sub_f32 v149, v149, v24
    v_sub_f32 v133, 0, v24
    v_sub_f32 v150, v150, v24
    v_sub_f32 v134, 0, v24
    v_sub_f32 v151, v151, v24
    v_sub_f32 v135, 0, v24
    v_sub_f32 v152, v152, v24
    v_sub_f32 v136, 0, v24
    v_sub_f32 v153, v153, v24
    v_sub_f32 v137, 0, v24
    v_sub_f32 v154, v154, v24
    v_sub_f32 v138, 0, v24
    v_sub_f32 v155, v155, v24
    v_sub_f32 v139, 0, v24
    v_sub_f32 v156, v156, v24
    v_sub_f32 v140, 0, v24
    v_sub_f32 v157, v157, v24
    v_sub_f32 v141, 0, v24
    v_sub_f32 v158, v158, v24
    v_sub_f32 v142, 0, v24
    v_sub_f32 v159, v159, v24
    v_sub_f32 v143, 0, v24
A_NOTFRESH_3:
    s_waitcnt lgkmcnt(2)
    s_nop 0
    v_mfma_f32_32x32x16_bf16 v[160:175], v[192:195], v[32:35], v[128:143]
    ds_read_b128 v[216:219], v11 offset:11264
    s_cmp_ge_u32 s46, s18
    s_cselect_b32 s48, s36, s48
    s_sub_u32 s36, s48, 114688
    s_add_u32 s37, s18, 2
    s_cmp_eq_u32 s46, s37
    s_cselect_b32 s48, s36, s48
    s_waitcnt lgkmcnt(2)
    v_mfma_f32_32x32x16_bf16 v[160:175], v[200:203], v[36:39], v[160:175]
    ds_read_b128 v[192:195], v11 offset:12288
    s_add_u32 s53, s53, 1
    v_exp_f32 v24, v144
    v_exp_f32 v25, v145
    s_add_u32 s48, s48, s52
    s_add_u32 s46, s46, 1
    v_exp_f32 v26, v146
    v_exp_f32 v27, v147
    s_lshl_b32 s50, s47, 15
    s_add_u32 s36, s50, 0x8000
    s_waitcnt lgkmcnt(2)
    v_mfma_f32_32x32x16_bf16 v[160:175], v[208:211], v[40:43], v[160:175]
    ds_read_b128 v[200:203], v11 offset:13312
    ds_read_b128 v[208:211], v11 offset:14336
    v_cvt_pk_bf16_f32 v176, v24, v25
    v_exp_f32 v28, v148
    v_exp_f32 v29, v149
    s_cmp_ge_u32 s47, s18
    s_cselect_b32 s50, s36, s50
    s_add_u32 s50, s50, 0x4000
    v_cvt_pk_bf16_f32 v177, v26, v27
    v_add_f32 v30, v24, v26
    v_add_f32 v31, v25, v27
    v_exp_f32 v24, v150
    s_add_u32 s50, s50, s52
    s_add_u32 s47, s47, 1
    s_waitcnt lgkmcnt(3)
    v_mfma_f32_32x32x16_bf16 v[160:175], v[216:219], v[44:47], v[160:175]
    ds_read_b128 v[216:219], v11 offset:15360
    v_exp_f32 v25, v151
    v_cvt_pk_bf16_f32 v178, v28, v29
    v_add_f32 v30, v30, v28
    v_add_f32 v31, v31, v29
    v_exp_f32 v26, v152
    v_exp_f32 v27, v153
    s_waitcnt lgkmcnt(3)
    v_mfma_f32_32x32x16_bf16 v[160:175], v[192:195], v[48:51], v[160:175]
    v_cvt_pk_bf16_f32 v179, v24, v25
    v_add_f32 v30, v30, v24
    v_add_f32 v31, v31, v25
    v_exp_f32 v28, v154
    v_exp_f32 v29, v155
    v_cvt_pk_bf16_f32 v180, v26, v27
    v_add_f32 v30, v30, v26
    s_waitcnt lgkmcnt(2)
    v_mfma_f32_32x32x16_bf16 v[160:175], v[200:203], v[52:55], v[160:175]
    v_add_f32 v31, v31, v27
    v_exp_f32 v24, v156
    v_exp_f32 v25, v157
    v_add_u32 v11, s44, v10
    v_add_u32 v12, s45, v10
    v_cvt_pk_bf16_f32 v181, v28, v29
    v_add_f32 v30, v30, v28
    v_add_f32 v31, v31, v29
    v_exp_f32 v26, v158
    s_waitcnt vmcnt(4) lgkmcnt(0)
    s_barrier
    s_waitcnt lgkmcnt(1)
    v_mfma_f32_32x32x16_bf16 v[160:175], v[208:211], v[56:59], v[160:175]
    ds_read_b128 v[192:195], v11 offset:0
    ds_read_b128 v[196:199], v12 offset:0
    v_exp_f32 v27, v159
    v_cvt_pk_bf16_f32 v182, v24, v25
    v_add_f32 v30, v30, v24
    ds_read_b128 v[200:203], v11 offset:1024
    ds_read_b128 v[204:207], v12 offset:4096
    v_add_f32 v31, v31, v25
    v_cvt_pk_bf16_f32 v183, v26, v27
    v_add_f32 v30, v30, v26
    v_add_f32 v31, v31, v27
    s_mov_b32 m0, s49
    s_nop 0
    buffer_load_dwordx4 v10, s[28:31], s48 offen offset:0 sc1 lds
    s_waitcnt lgkmcnt(4)
    v_mfma_f32_32x32x16_bf16 v[160:175], v[216:219], v[60:63], v[160:175]
    ds_read_b128 v[208:211], v11 offset:2048
    v_add_f32 v16, v30, v31
    ds_read_b128 v[212:215], v12 offset:8192
    v_cmp_nge_f32 vcc, s40, v16
    s_cbranch_vccnz A_RARE_4
A_RRET_5:
    v_add_f32 v15, v15, v16
    buffer_load_dwordx4 v10, s[28:31], s48 offen offset:1024 sc1 lds
    s_sub_u32 s55, s18, 1
    s_cmp_eq_u32 s55, 0
    s_cbranch_scc1 A_DRAIN_P1
A_LOOP_P1:
    s_waitcnt lgkmcnt(5)
    v_mfma_f32_32x32x16_bf16 v[144:159], v[192:195], v[32:35], v[128:143]
    ds_read_b128 v[216:219], v11 offset:3072
    s_waitcnt lgkmcnt(5)
    v_mfma_f32_32x32x16_bf16 v[64:79], v[196:199], v[176:179], v[64:79]
    ds_read_b128 v[220:223], v12 offset:12288
    s_mov_b32 m0, s51
    s_nop 0
    buffer_load_dwordx4 v10, s[28:31], s50 offen offset:0 sc1 lds
    s_waitcnt lgkmcnt(5)
    v_mfma_f32_32x32x16_bf16 v[144:159], v[200:203], v[36:39], v[144:159]
    ds_read_b128 v[192:195], v11 offset:4096
    s_cmp_ge_u32 s53, s54
    s_cbranch_scc1 A_MASK_6
A_MRET_7:
    s_add_u32 s53, s53, 1
    v_exp_f32 v24, v160
    v_exp_f32 v25, v161
    s_waitcnt lgkmcnt(5)
    v_mfma_f32_32x32x16_bf16 v[80:95], v[204:207], v[176:179], v[80:95]
    ds_read_b128 v[196:199], v12 offset:1024
    v_exp_f32 v26, v162
    v_exp_f32 v27, v163
    buffer_load_dwordx4 v10, s[28:31], s50 offen offset:1024 sc1 lds
    s_waitcnt lgkmcnt(5)
    v_mfma_f32_32x32x16_bf16 v[144:159], v[208:211], v[40:43], v[144:159]
    ds_read_b128 v[200:203], v11 offset:5120
    v_cvt_pk_bf16_f32 v184, v24, v25
    v_exp_f32 v28, v164
    v_exp_f32 v29, v165
    s_waitcnt lgkmcnt(5)
    v_mfma_f32_32x32x16_bf16 v[96:111], v[212:215], v[176:179], v[96:111]
    ds_read_b128 v[204:207], v12 offset:5120
    v_cvt_pk_bf16_f32 v185, v26, v27
    v_add_f32 v30, v24, v26
    v_add_f32 v31, v25, v27
    v_exp_f32 v24, v166
    s_waitcnt lgkmcnt(5)
    v_mfma_f32_32x32x16_bf16 v[144:159], v[216:219], v[44:47], v[144:159]
    ds_read_b128 v[208:211], v11 offset:6144
    v_exp_f32 v25, v167
    v_cvt_pk_bf16_f32 v186, v28, v29
    v_add_f32 v30, v30, v28
    s_waitcnt lgkmcnt(5)
    v_mfma_f32_32x32x16_bf16 v[112:127], v[220:223], v[176:179], v[112:127]
    ds_read_b128 v[212:215], v12 offset:9216
    v_add_f32 v31, v31, v29
    v_exp_f32 v26, v168
    v_exp_f32 v27, v169
    s_waitcnt lgkmcnt(5)
    v_mfma_f32_32x32x16_bf16 v[144:159], v[192:195], v[48:51], v[144:159]
    ds_read_b128 v[216:219], v11 offset:7168
    v_cvt_pk_bf16_f32 v187, v24, v25
    v_add_f32 v30, v30, v24
    v_add_f32 v31, v31, v25
    v_exp_f32 v28, v170
    s_waitcnt lgkmcnt(5)
    v_mfma_f32_32x32x16_bf16 v[64:79], v[196:199], v[180:183], v[64:79]
    ds_read_b128 v[220:223], v12 offset:13312
    v_exp_f32 v29, v171
    v_cvt_pk_bf16_f32 v188, v26, v27
    v_add_f32 v30, v30, v26
    s_waitcnt lgkmcnt(5)
    v_mfma_f32_32x32x16_bf16 v[144:159], v[200:203], v[52:55], v[144:159]
    ds_read_b128 v[192:195], v11 offset:8192
    v_add_f32 v31, v31, v27
    v_exp_f32 v24, v172
    v_exp_f32 v25, v173
    s_waitcnt lgkmcnt(5)
    v_mfma_f32_32x32x16_bf16 v[80:95], v[204:207], v[180:183], v[80:95]
    ds_read_b128 v[196:199], v12 offset:2048
    v_cvt_pk_bf16_f32 v189, v28, v29
    v_add_f32 v30, v30, v28
    v_add_f32 v31, v31, v29
    v_exp_f32 v26, v174
    s_waitcnt lgkmcnt(5)
    v_mfma_f32_32x32x16_bf16 v[144:159], v[208:211], v[56:59], v[144:159]
    ds_read_b128 v[200:203], v11 offset:9216
    v_exp_f32 v27, v175
    v_cvt_pk_bf16_f32 v190, v24, v25
    v_add_f32 v30, v30, v24
    s_waitcnt lgkmcnt(5)
    v_mfma_f32_32x32x16_bf16 v[96:111], v[212:215], v[180:183], v[96:111]
    ds_read_b128 v[204:207], v12 offset:6144
    v_add_f32 v31, v31, v25
    v_cvt_pk_bf16_f32 v191, v26, v27
    v_add_f32 v30, v30, v26
    v_add_f32 v31, v31, v27
    s_add_u32 s49, s44, s57
    s_add_u32 s51, s45, s57
    s_waitcnt lgkmcnt(5)
    v_mfma_f32_32x32x16_bf16 v[144:159], v[216:219], v[60:63], v[144:159]
    ds_read_b128 v[208:211], v11 offset:10240
    v_add_f32 v16, v30, v31
    s_add_u32 s44, s44, 16384
    s_cmp_eq_u32 s44, 49152
    s_cselect_b32 s44, 0, s44
    s_add_u32 s45, s45, 16384
    s_cmp_eq_u32 s45, 98304
    s_cselect_b32 s45, 49152, s45
    s_waitcnt lgkmcnt(5)
    v_mfma_f32_32x32x16_bf16 v[112:127], v[220:223], v[180:183], v[112:127]
    ds_read_b128 v[212:215], v12 offset:10240
    v_cmp_nge_f32 vcc, s40, v16
    s_cbranch_vccnz A_RARE_8
A_RRET_9:
    v_add_f32 v15, v15, v16
    s_lshl_b32 s48, s46, 15
    s_add_u32 s36, s48, 0x10000
    s_waitcnt lgkmcnt(5)
    v_mfma_f32_32x32x16_bf16 v[160:175], v[192:195], v[32:35], v[128:143]
    ds_read_b128 v[216:219], v11 offset:11264
    s_cmp_ge_u32 s46, s18
    s_cselect_b32 s48, s36, s48
    s_sub_u32 s36, s48, 114688
    s_waitcnt lgkmcnt(5)
    v_mfma_f32_32x32x16_bf16 v[64:79], v[196:199], v[184:187], v[64:79]
    ds_read_b128 v[220:223], v12 offset:14336
    s_add_u32 s37, s18, 2
    s_cmp_eq_u32 s46, s37
    s_cselect_b32 s48, s36, s48
    s_waitcnt lgkmcnt(5)
    v_mfma_f32_32x32x16_bf16 v[160:175], v[200:203], v[36:39], v[160:175]
    ds_read_b128 v[192:195], v11 offset:12288
    s_cmp_ge_u32 s53, s54
    s_cbranch_scc1 A_MASK_10
A_MRET_11:
    s_add_u32 s53, s53, 1
    v_exp_f32 v24, v144
    v_exp_f32 v25, v145
    s_add_u32 s48, s48, s52
    s_add_u32 s46, s46, 1
    s_waitcnt lgkmcnt(5)
    v_mfma_f32_32x32x16_bf16 v[80:95], v[204:207], v[184:187], v[80:95]
    ds_read_b128 v[196:199], v12 offset:3072
    v_exp_f32 v26, v146
    v_exp_f32 v27, v147
    s_lshl_b32 s50, s47, 15
    s_add_u32 s36, s50, 0x8000
    s_waitcnt lgkmcnt(5)
    v_mfma_f32_32x32x16_bf16 v[160:175], v[208:211], v[40:43], v[160:175]
    ds_read_b128 v[200:203], v11 offset:13312
    ds_read_b128 v[204:207], v12 offset:7168
    v_cvt_pk_bf16_f32 v176, v24, v25
    v_exp_f32 v28, v148
    v_exp_f32 v29, v149
    s_cmp_ge_u32 s47, s18
    s_cselect_b32 s50, s36, s50
    s_add_u32 s50, s50, 0x4000
    s_waitcnt lgkmcnt(6)
    v_mfma_f32_32x32x16_bf16 v[96:111], v[212:215], v[184:187], v[96:111]
    ds_read_b128 v[208:211], v11 offset:14336
    ds_read_b128 v[212:215], v12 offset:11264
    v_cvt_pk_bf16_f32 v177, v26, v27
    v_add_f32 v30, v24, v26
    v_add_f32 v31, v25, v27
    v_exp_f32 v24, v150
    s_add_u32 s50, s50, s52
    s_add_u32 s47, s47, 1
    s_waitcnt lgkmcnt(7)
    v_mfma_f32_32x32x16_bf16 v[160:175], v[216:219], v[44:47], v[160:175]
    ds_read_b128 v[216:219], v11 offset:15360
    v_exp_f32 v25, v151
    v_cvt_pk_bf16_f32 v178, v28, v29
    v_add_f32 v30, v30, v28
    s_waitcnt lgkmcnt(7)
    v_mfma_f32_32x32x16_bf16 v[112:127], v[220:223], v[184:187], v[112:127]
    ds_read_b128 v[220:223], v12 offset:15360
    v_add_f32 v31, v31, v29
    v_exp_f32 v26, v152
    v_exp_f32 v27, v153
    s_waitcnt lgkmcnt(7)
    v_mfma_f32_32x32x16_bf16 v[160:175], v[192:195], v[48:51], v[160:175]
    v_cvt_pk_bf16_f32 v179, v24, v25
    v_add_f32 v30, v30, v24
    v_add_f32 v31, v31, v25
    v_exp_f32 v28, v154
    s_waitcnt lgkmcnt(6)
    v_mfma_f32_32x32x16_bf16 v[64:79], v[196:199], v[188:191], v[64:79]
    v_exp_f32 v29, v155
    v_cvt_pk_bf16_f32 v180, v26, v27
    v_add_f32 v30, v30, v26
    s_waitcnt lgkmcnt(5)
    v_mfma_f32_32x32x16_bf16 v[160:175], v[200:203], v[52:55], v[160:175]
    v_add_f32 v31, v31, v27
    v_exp_f32 v24, v156
    v_exp_f32 v25, v157
    v_add_u32 v11, s44, v10
    v_add_u32 v12, s45, v10
    s_waitcnt lgkmcnt(4)
    v_mfma_f32_32x32x16_bf16 v[80:95], v[204:207], v[188:191], v[80:95]
    v_cvt_pk_bf16_f32 v181, v28, v29
    v_add_f32 v30, v30, v28
    v_add_f32 v31, v31, v29
    v_exp_f32 v26, v158
    s_waitcnt vmcnt(4) lgkmcnt(0)
    s_barrier
    buffer_store_dwordx4 v[224:227], v10, s[68:71], s72 offen sc1
    s_mov_b32 s72, s73
    s_mov_b32 s73, s75
    s_mov_b32 s75, 0x7f000000
    s_waitcnt lgkmcnt(3)
    v_mfma_f32_32x32x16_bf16 v[160:175], v[208:211], v[56:59], v[160:175]
    ds_read_b128 v[192:195], v11 offset:0
    ds_read_b128 v[196:199], v12 offset:0
    v_exp_f32 v27, v159
    v_cvt_pk_bf16_f32 v182, v24, v25
    v_add_f32 v30, v30, v24
    s_waitcnt lgkmcnt(4)
    v_mfma_f32_32x32x16_bf16 v[96:111], v[212:215], v[188:191], v[96:111]
    ds_read_b128 v[200:203], v11 offset:1024
    ds_read_b128 v[204:207], v12 offset:4096
    v_add_f32 v31, v31, v25
    v_cvt_pk_bf16_f32 v183, v26, v27
    v_add_f32 v30, v30, v26
    v_add_f32 v31, v31, v27
    s_mov_b32 m0, s49
    s_nop 0
    buffer_load_dwordx4 v10, s[28:31], s48 offen offset:0 sc1 lds
    s_waitcnt lgkmcnt(5)
    v_mfma_f32_32x32x16_bf16 v[160:175], v[216:219], v[60:63], v[160:175]
    ds_read_b128 v[208:211], v11 offset:2048
    v_add_f32 v16, v30, v31
    s_waitcnt lgkmcnt(5)
    v_mfma_f32_32x32x16_bf16 v[112:127], v[220:223], v[188:191], v[112:127]
    ds_read_b128 v[212:215], v12 offset:8192
    v_cmp_nge_f32 vcc, s40, v16
    s_cbranch_vccnz A_RARE_12
A_RRET_13:
    v_add_f32 v15, v15, v16
    buffer_load_dwordx4 v10, s[28:31], s48 offen offset:1024 sc1 lds
    s_sub_u32 s55, s55, 1
    s_cmp_lg_u32 s55, 0
    s_cbranch_scc1 A_LOOP_P1
A_DRAIN_P1:
    s_waitcnt lgkmcnt(4)
    v_mfma_f32_32x32x16_bf16 v[64:79], v[196:199], v[176:179], v[64:79]
    ds_read_b128 v[220:223], v12 offset:12288
    s_mov_b32 m0, s51
    s_nop 0
    buffer_load_dwordx4 v10, s[28:31], s50 offen offset:0 sc1 lds
    s_cmp_ge_u32 s53, s54
    s_cbranch_scc1 A_MASK_14
A_MRET_15:
    s_add_u32 s53, s53, 1
    v_exp_f32 v24, v160
    v_exp_f32 v25, v161
    s_waitcnt lgkmcnt(3)
    v_mfma_f32_32x32x16_bf16 v[80:95], v[204:207], v[176:179], v[80:95]
    ds_read_b128 v[196:199], v12 offset:1024
    v_exp_f32 v26, v162
    v_exp_f32 v27, v163
    buffer_load_dwordx4 v10, s[28:31], s50 offen offset:1024 sc1 lds
    v_cvt_pk_bf16_f32 v184, v24, v25
    v_exp_f32 v28, v164
    v_exp_f32 v29, v165
    s_waitcnt lgkmcnt(2)
    v_mfma_f32_32x32x16_bf16 v[96:111], v[212:215], v[176:179], v[96:111]
    ds_read_b128 v[204:207], v12 offset:5120
    v_cvt_pk_bf16_f32 v185, v26, v27
    v_add_f32 v30, v24, v26
    v_add_f32 v31, v25, v27
    v_exp_f32 v24, v166
    v_exp_f32 v25, v167
    v_cvt_pk_bf16_f32 v186, v28, v29
    v_add_f32 v30, v30, v28
    s_waitcnt lgkmcnt(2)
    v_mfma_f32_32x32x16_bf16 v[112:127], v[220:223], v[176:179], v[112:127]
    ds_read_b128 v[212:215], v12 offset:9216
    v_add_f32 v31, v31, v29
    v_exp_f32 v26, v168
    v_exp_f32 v27, v169
    v_cvt_pk_bf16_f32 v187, v24, v25
    v_add_f32 v30, v30, v24
    v_add_f32 v31, v31, v25
    v_exp_f32 v28, v170
    s_waitcnt lgkmcnt(2)
    v_mfma_f32_32x32x16_bf16 v[64:79], v[196:199], v[180:183], v[64:79]
    ds_read_b128 v[220:223], v12 offset:13312
    v_exp_f32 v29, v171
    v_cvt_pk_bf16_f32 v188, v26, v27
    v_add_f32 v30, v30, v26
    v_add_f32 v31, v31, v27
    v_exp_f32 v24, v172
    v_exp_f32 v25, v173
    s_waitcnt lgkmcnt(2)
    v_mfma_f32_32x32x16_bf16 v[80:95], v[204:207], v[180:183], v[80:95]
    ds_read_b128 v[196:199], v12 offset:2048
    v_cvt_pk_bf16_f32 v189, v28, v29
    v_add_f32 v30, v30, v28
    v_add_f32 v31, v31, v29
    v_exp_f32 v26, v174
    v_exp_f32 v27, v175
    v_cvt_pk_bf16_f32 v190, v24, v25
    v_add_f32 v30, v30, v24
    s_waitcnt lgkmcnt(2)
    v_mfma_f32_32x32x16_bf16 v[96:111], v[212:215], v[180:183], v[96:111]
    ds_read_b128 v[204:207], v12 offset:6144
    v_add_f32 v31, v31, v25
    v_cvt_pk_bf16_f32 v191, v26, v27
    v_add_f32 v30, v30, v26
    v_add_f32 v31, v31, v27
    v_add_f32 v16, v30, v31
    s_waitcnt lgkmcnt(2)
    v_mfma_f32_32x32x16_bf16 v[112:127], v[220:223], v[180:183], v[112:127]
    ds_read_b128 v[212:215], v12 offset:10240
    v_cmp_nge_f32 vcc, s40, v16
    s_cbranch_vccnz A_RARE_16
A_RRET_17:
    v_add_f32 v15, v15, v16
    s_waitcnt lgkmcnt(2)
    v_mfma_f32_32x32x16_bf16 v[64:79], v[196:199], v[184:187], v[64:79]
    ds_read_b128 v[220:223], v12 offset:14336
    s_waitcnt lgkmcnt(2)
    v_mfma_f32_32x32x16_bf16 v[80:95], v[204:207], v[184:187], v[80:95]
    ds_read_b128 v[196:199], v12 offset:3072
    ds_read_b128 v[204:207], v12 offset:7168
    s_waitcnt lgkmcnt(3)
    v_mfma_f32_32x32x16_bf16 v[96:111], v[212:215], v[184:187], v[96:111]
    ds_read_b128 v[212:215], v12 offset:11264
    s_waitcnt lgkmcnt(3)
    v_mfma_f32_32x32x16_bf16 v[112:127], v[220:223], v[184:187], v[112:127]
    ds_read_b128 v[220:223], v12 offset:15360
    s_waitcnt lgkmcnt(3)
    v_mfma_f32_32x32x16_bf16 v[64:79], v[196:199], v[188:191], v[64:79]
    s_waitcnt lgkmcnt(2)
    v_mfma_f32_32x32x16_bf16 v[80:95], v[204:207], v[188:191], v[80:95]
    s_waitcnt lgkmcnt(1)
    v_mfma_f32_32x32x16_bf16 v[96:111], v[212:215], v[188:191], v[96:111]
    s_waitcnt lgkmcnt(0)
    v_mfma_f32_32x32x16_bf16 v[112:127], v[220:223], v[188:191], v[112:127]
    s_load_dwordx2 s[4:5], s[0:1], 40
    s_load_dwordx2 s[6:7], s[0:1], 80
    s_cmp_lg_u32 s13, 0
    s_cbranch_scc1 A_TRB
    v_mov_b32 v24, v15
    v_mov_b32 v25, v15
    s_nop 1
    v_permlane32_swap_b32 v24, v25
    v_add_f32 v24, v24, v25
    v_rcp_f32 v24, v24
    s_nop 0
    v_mov_b32 v25, v24
    s_lshl_b32 s64, s54, 18
    s_lshl_b32 s36, s14, 13
    s_add_u32 s64, s64, s36
    v_mul_f32 v64, v64, v24
    v_mul_f32 v65, v65, v24
    v_mul_f32 v66, v66, v24
    v_mul_f32 v67, v67, v24
    v_mul_f32 v68, v68, v24
    v_mul_f32 v69, v69, v24
    v_mul_f32 v70, v70, v24
    v_mul_f32 v71, v71, v24
    v_cvt_pk_bf16_f32 v144, v64, v65
    v_cvt_pk_bf16_f32 v145, v66, v67
    v_cvt_pk_bf16_f32 v146, v68, v69
    v_cvt_pk_bf16_f32 v147, v70, v71
    buffer_store_dwordx4 v[144:147], v10, s[32:35], s64 offen offset:0 sc1
    v_mul_f32 v72, v72, v24
    v_mul_f32 v73, v73, v24
    v_mul_f32 v74, v74, v24
    v_mul_f32 v75, v75, v24
    v_mul_f32 v76, v76, v24
    v_mul_f32 v77, v77, v24
    v_mul_f32 v78, v78, v24
    v_mul_f32 v79, v79, v24
    v_cvt_pk_bf16_f32 v148, v72, v73
    v_cvt_pk_bf16_f32 v149, v74, v75
    v_cvt_pk_bf16_f32 v150, v76, v77
    v_cvt_pk_bf16_f32 v151, v78, v79
    buffer_store_dwordx4 v[148:151], v10, s[32:35], s64 offen offset:1024 sc1
    v_mul_f32 v80, v80, v24
    v_mul_f32 v81, v81, v24
    v_mul_f32 v82, v82, v24
    v_mul_f32 v83, v83, v24
    v_mul_f32 v84, v84, v24
    v_mul_f32 v85, v85, v24
    v_mul_f32 v86, v86, v24
    v_mul_f32 v87, v87, v24
    v_cvt_pk_bf16_f32 v152, v80, v81
    v_cvt_pk_bf16_f32 v153, v82, v83
    v_cvt_pk_bf16_f32 v154, v84, v85
    v_cvt_pk_bf16_f32 v155, v86, v87
    buffer_store_dwordx4 v[152:155], v10, s[32:35], s64 offen offset:2048 sc1
    v_mul_f32 v88, v88, v24
    v_mul_f32 v89, v89, v24
    v_mul_f32 v90, v90, v24
    v_mul_f32 v91, v91, v24
    v_mul_f32 v92, v92, v24
    v_mul_f32 v93, v93, v24
    v_mul_f32 v94, v94, v24
    v_mul_f32 v95, v95, v24
    v_cvt_pk_bf16_f32 v156, v88, v89
    v_cvt_pk_bf16_f32 v157, v90, v91
    v_cvt_pk_bf16_f32 v158, v92, v93
    v_cvt_pk_bf16_f32 v159, v94, v95
    buffer_store_dwordx4 v[156:159], v10, s[32:35], s64 offen offset:3072 sc1
    v_mul_f32 v96, v96, v24
    v_mul_f32 v97, v97, v24
    v_mul_f32 v98, v98, v24
    v_mul_f32 v99, v99, v24
    v_mul_f32 v100, v100, v24
    v_mul_f32 v101, v101, v24
    v_mul_f32 v102, v102, v24
    v_mul_f32 v103, v103, v24
    v_cvt_pk_bf16_f32 v144, v96, v97
    v_cvt_pk_bf16_f32 v145, v98, v99
    v_cvt_pk_bf16_f32 v146, v100, v101
    v_cvt_pk_bf16_f32 v147, v102, v103
    s_add_u32 s36, s64, 4096
    buffer_store_dwordx4 v[144:147], v10, s[32:35], s36 offen offset:0 sc1
    v_mul_f32 v104, v104, v24
    v_mul_f32 v105, v105, v24
    v_mul_f32 v106, v106, v24
    v_mul_f32 v107, v107, v24
    v_mul_f32 v108, v108, v24
    v_mul_f32 v109, v109, v24
    v_mul_f32 v110, v110, v24
    v_mul_f32 v111, v111, v24
    v_cvt_pk_bf16_f32 v148, v104, v105
    v_cvt_pk_bf16_f32 v149, v106, v107
    v_cvt_pk_bf16_f32 v150, v108, v109
    v_cvt_pk_bf16_f32 v151, v110, v111
    s_add_u32 s36, s64, 4096
    buffer_store_dwordx4 v[148:151], v10, s[32:35], s36 offen offset:1024 sc1
    v_mul_f32 v112, v112, v24
    v_mul_f32 v113, v113, v24
    v_mul_f32 v114, v114, v24
    v_mul_f32 v115, v115, v24
    v_mul_f32 v116, v116, v24
    v_mul_f32 v117, v117, v24
    v_mul_f32 v118, v118, v24
    v_mul_f32 v119, v119, v24
    v_cvt_pk_bf16_f32 v152, v112, v113
    v_cvt_pk_bf16_f32 v153, v114, v115
    v_cvt_pk_bf16_f32 v154, v116, v117
    v_cvt_pk_bf16_f32 v155, v118, v119
    s_add_u32 s36, s64, 4096
    buffer_store_dwordx4 v[152:155], v10, s[32:35], s36 offen offset:2048 sc1
    v_mul_f32 v120, v120, v24
    v_mul_f32 v121, v121, v24
    v_mul_f32 v122, v122, v24
    v_mul_f32 v123, v123, v24
    v_mul_f32 v124, v124, v24
    v_mul_f32 v125, v125, v24
    v_mul_f32 v126, v126, v24
    v_mul_f32 v127, v127, v24
    v_cvt_pk_bf16_f32 v156, v120, v121
    v_cvt_pk_bf16_f32 v157, v122, v123
    v_cvt_pk_bf16_f32 v158, v124, v125
    v_cvt_pk_bf16_f32 v159, v126, v127
    s_add_u32 s36, s64, 4096
    buffer_store_dwordx4 v[156:159], v10, s[32:35], s36 offen offset:3072 sc1
    s_lshl_b32 s36, s12, 13
    s_add_u32 s36, s36, 131072
    v_add_u32 v2, s36, v10
    ds_read_b128 v[32:35], v2 offset:0
    ds_read_b128 v[36:39], v2 offset:1024
    ds_read_b128 v[40:43], v2 offset:2048
    ds_read_b128 v[44:47], v2 offset:3072
    ds_read_b128 v[48:51], v2 offset:4096
    ds_read_b128 v[52:55], v2 offset:5120
    ds_read_b128 v[56:59], v2 offset:6144
    ds_read_b128 v[60:63], v2 offset:7168
    v_mov_b32 v64, 0
    v_mov_b32 v65, 0
    v_mov_b32 v66, 0
    v_mov_b32 v67, 0
    v_mov_b32 v68, 0
    v_mov_b32 v69, 0
    v_mov_b32 v70, 0
    v_mov_b32 v71, 0
    v_mov_b32 v72, 0
    v_mov_b32 v73, 0
    v_mov_b32 v74, 0
    v_mov_b32 v75, 0
    v_mov_b32 v76, 0
    v_mov_b32 v77, 0
    v_mov_b32 v78, 0
    v_mov_b32 v79, 0
    v_mov_b32 v80, 0
    v_mov_b32 v81, 0
    v_mov_b32 v82, 0
    v_mov_b32 v83, 0
    v_mov_b32 v84, 0
    v_mov_b32 v85, 0
    v_mov_b32 v86, 0
    v_mov_b32 v87, 0
    v_mov_b32 v88, 0
    v_mov_b32 v89, 0
    v_mov_b32 v90, 0
    v_mov_b32 v91, 0
    v_mov_b32 v92, 0
    v_mov_b32 v93, 0
    v_mov_b32 v94, 0
    v_mov_b32 v95, 0
    v_mov_b32 v96, 0
    v_mov_b32 v97, 0
    v_mov_b32 v98, 0
    v_mov_b32 v99, 0
    v_mov_b32 v100, 0
    v_mov_b32 v101, 0
    v_mov_b32 v102, 0
    v_mov_b32 v103, 0
    v_mov_b32 v104, 0
    v_mov_b32 v105, 0
    v_mov_b32 v106, 0
    v_mov_b32 v107, 0
    v_mov_b32 v108, 0
    v_mov_b32 v109, 0
    v_mov_b32 v110, 0
    v_mov_b32 v111, 0
    v_mov_b32 v112, 0
    v_mov_b32 v113, 0
    v_mov_b32 v114, 0
    v_mov_b32 v115, 0
    v_mov_b32 v116, 0
    v_mov_b32 v117, 0
    v_mov_b32 v118, 0
    v_mov_b32 v119, 0
    v_mov_b32 v120, 0
    v_mov_b32 v121, 0
    v_mov_b32 v122, 0
    v_mov_b32 v123, 0
    v_mov_b32 v124, 0
    v_mov_b32 v125, 0
    v_mov_b32 v126, 0
    v_mov_b32 v127, 0
    v_mov_b32 v128, 0
    v_mov_b32 v129, 0
    v_mov_b32 v130, 0
    v_mov_b32 v131, 0
    v_mov_b32 v132, 0
    v_mov_b32 v133, 0
    v_mov_b32 v134, 0
    v_mov_b32 v135, 0
    v_mov_b32 v136, 0
    v_mov_b32 v137, 0
    v_mov_b32 v138, 0
    v_mov_b32 v139, 0
    v_mov_b32 v140, 0
    v_mov_b32 v141, 0
    v_mov_b32 v142, 0
    v_mov_b32 v143, 0
    v_mov_b32 v15, 0
    s_lshl_b32 s54, s16, 2
    s_add_u32 s54, s54, s12
    s_waitcnt lgkmcnt(0)
A_TRB:
    s_xor_b32 s56, s13, 1
    s_add_u32 s36, s13, 6
    s_lshl_b32 s44, s36, 14
    s_add_u32 s36, s13, 4
    s_lshl_b32 s45, s36, 14
    s_lshl_b32 s57, s12, 12
    s_add_u32 s36, s18, s13
    s_lshl_b32 s53, s36, 1
    s_lshl_b32 s36, s36, 15
    s_lshl_b32 s52, s14, 20
    s_add_u32 s52, s52, s57
    s_add_u32 s36, s36, s52
    s_add_u32 s48, s36, 0x10000
    s_add_u32 s50, s36, 0x4000
    v_add_u32 v11, s44, v10
    ds_read_b128 v[192:195], v11 offset:0
    ds_read_b128 v[200:203], v11 offset:1024
    ds_read_b128 v[208:211], v11 offset:2048
    ds_read_b128 v[216:219], v11 offset:3072
    s_waitcnt lgkmcnt(3)
    v_mfma_f32_32x32x16_bf16 v[144:159], v[192:195], v[32:35], v[128:143]
    s_waitcnt lgkmcnt(2)
    v_mfma_f32_32x32x16_bf16 v[144:159], v[200:203], v[36:39], v[144:159]
    ds_read_b128 v[192:195], v11 offset:4096
    s_waitcnt lgkmcnt(2)
    v_mfma_f32_32x32x16_bf16 v[144:159], v[208:211], v[40:43], v[144:159]
    ds_read_b128 v[200:203], v11 offset:5120
    s_waitcnt lgkmcnt(2)
    v_mfma_f32_32x32x16_bf16 v[144:159], v[216:219], v[44:47], v[144:159]
    ds_read_b128 v[208:211], v11 offset:6144
    s_waitcnt lgkmcnt(2)
    v_mfma_f32_32x32x16_bf16 v[144:159], v[192:195], v[48:51], v[144:159]
    ds_read_b128 v[216:219], v11 offset:7168
    s_waitcnt lgkmcnt(2)
    v_mfma_f32_32x32x16_bf16 v[144:159], v[200:203], v[52:55], v[144:159]
    ds_read_b128 v[192:195], v11 offset:8192
    s_waitcnt lgkmcnt(2)
    v_mfma_f32_32x32x16_bf16 v[144:159], v[208:211], v[56:59], v[144:159]
    ds_read_b128 v[200:203], v11 offset:9216
    s_add_u32 s49, s44, s57
    s_add_u32 s51, s45, s57
    s_waitcnt lgkmcnt(2)
    v_mfma_f32_32x32x16_bf16 v[144:159], v[216:219], v[60:63], v[144:159]
    ds_read_b128 v[208:211], v11 offset:10240
    s_xor_b32 s44, s44, 98304
    s_xor_b32 s45, s45, 98304
    s_add_u32 s48, s48, 0x10000
    s_add_u32 s50, s50, 0x10000
    s_cmp_ge_u32 s53, s54
    s_cbranch_scc1 A_MASK_18
A_MRET_19:
    s_cmp_eq_u32 s56, 0
    s_cbranch_scc1 A_NOTFRESH_20
    s_nop 2
    v_max3_f32 v24, v144, v145, v146
    v_max3_f32 v25, v147, v148, v149
    v_max3_f32 v24, v24, v150, v151
    v_max3_f32 v25, v25, v152, v153
    v_max3_f32 v24, v24, v154, v155
    v_max3_f32 v25, v25, v156, v157
    v_max3_f32 v24, v24, v158, v159
    v_max_f32 v24, v24, v25
    v_mov_b32 v25, v24
    s_nop 1
    v_permlane32_swap_b32 v24, v25
    v_max_f32 v24, v24, v25
    v_sub_f32 v144, v144, v24
    v_sub_f32 v128, 0, v24
    v_sub_f32 v145, v145, v24
    v_sub_f32 v129, 0, v24
    v_sub_f32 v146, v146, v24
    v_sub_f32 v130, 0, v24
    v_sub_f32 v147, v147, v24
    v_sub_f32 v131, 0, v24
    v_sub_f32 v148, v148, v24
    v_sub_f32 v132, 0, v24
    v_sub_f32 v149, v149, v24
    v_sub_f32 v133, 0, v24
    v_sub_f32 v150, v150, v24
    v_sub_f32 v134, 0, v24
    v_sub_f32 v151, v151, v24
    v_sub_f32 v135, 0, v24
    v_sub_f32 v152, v152, v24
    v_sub_f32 v136, 0, v24
    v_sub_f32 v153, v153, v24
    v_sub_f32 v137, 0, v24
    v_sub_f32 v154, v154, v24
    v_sub_f32 v138, 0, v24
    v_sub_f32 v155, v155, v24
    v_sub_f32 v139, 0, v24
    v_sub_f32 v156, v156, v24
    v_sub_f32 v140, 0, v24
    v_sub_f32 v157, v157, v24
    v_sub_f32 v141, 0, v24
    v_sub_f32 v158, v158, v24
    v_sub_f32 v142, 0, v24
    v_sub_f32 v159, v159, v24
    v_sub_f32 v143, 0, v24
A_NOTFRESH_20:
    s_waitcnt lgkmcnt(2)
    s_nop 0
    v_mfma_f32_32x32x16_bf16 v[160:175], v[192:195], v[32:35], v[128:143]
    ds_read_b128 v[216:219], v11 offset:11264
    s_waitcnt lgkmcnt(2)
    v_mfma_f32_32x32x16_bf16 v[160:175], v[200:203], v[36:39], v[160:175]
    ds_read_b128 v[192:195], v11 offset:12288
    s_add_u32 s53, s53, 1
    v_exp_f32 v24, v144
    v_exp_f32 v25, v145
    v_exp_f32 v26, v146
    v_exp_f32 v27, v147
    s_waitcnt lgkmcnt(2)
    v_mfma_f32_32x32x16_bf16 v[160:175], v[208:211], v[40:43], v[160:175]
    ds_read_b128 v[200:203], v11 offset:13312
    ds_read_b128 v[208:211], v11 offset:14336
    v_cvt_pk_bf16_f32 v176, v24, v25
    v_exp_f32 v28, v148
    v_exp_f32 v29, v149
    v_cvt_pk_bf16_f32 v177, v26, v27
    v_add_f32 v30, v24, v26
    v_add_f32 v31, v25, v27
    v_exp_f32 v24, v150
    s_waitcnt lgkmcnt(3)
    v_mfma_f32_32x32x16_bf16 v[160:175], v[216:219], v[44:47], v[160:175]
    ds_read_b128 v[216:219], v11 offset:15360
    v_exp_f32 v25, v151
    v_cvt_pk_bf16_f32 v178, v28, v29
    v_add_f32 v30, v30, v28
    v_add_f32 v31, v31, v29
    v_exp_f32 v26, v152
    v_exp_f32 v27, v153
    s_waitcnt lgkmcnt(3)
    v_mfma_f32_32x32x16_bf16 v[160:175], v[192:195], v[48:51], v[160:175]
    v_cvt_pk_bf16_f32 v179, v24, v25
    v_add_f32 v30, v30, v24
    v_add_f32 v31, v31, v25
    v_exp_f32 v28, v154
    v_exp_f32 v29, v155
    v_cvt_pk_bf16_f32 v180, v26, v27
    v_add_f32 v30, v30, v26
    s_waitcnt lgkmcnt(2)
    v_mfma_f32_32x32x16_bf16 v[160:175], v[200:203], v[52:55], v[160:175]
    v_add_f32 v31, v31, v27
    v_exp_f32 v24, v156
    v_exp_f32 v25, v157
    v_add_u32 v11, s44, v10
    v_add_u32 v12, s45, v10
    v_cvt_pk_bf16_f32 v181, v28, v29
    v_add_f32 v30, v30, v28
    v_add_f32 v31, v31, v29
    v_exp_f32 v26, v158
    s_waitcnt vmcnt(0) lgkmcnt(0)
    s_barrier
    s_waitcnt lgkmcnt(1)
    v_mfma_f32_32x32x16_bf16 v[160:175], v[208:211], v[56:59], v[160:175]
    ds_read_b128 v[192:195], v11 offset:0
    ds_read_b128 v[196:199], v12 offset:0
    v_exp_f32 v27, v159
    v_cvt_pk_bf16_f32 v182, v24, v25
    v_add_f32 v30, v30, v24
    ds_read_b128 v[200:203], v11 offset:1024
    ds_read_b128 v[204:207], v12 offset:4096
    v_add_f32 v31, v31, v25
    v_cvt_pk_bf16_f32 v183, v26, v27
    v_add_f32 v30, v30, v26
    v_add_f32 v31, v31, v27
    s_mov_b32 m0, s49
    s_nop 0
    buffer_load_dwordx4 v10, s[28:31], s48 offen offset:0 sc1 lds
    s_waitcnt lgkmcnt(4)
    v_mfma_f32_32x32x16_bf16 v[160:175], v[216:219], v[60:63], v[160:175]
    ds_read_b128 v[208:211], v11 offset:2048
    v_add_f32 v16, v30, v31
    ds_read_b128 v[212:215], v12 offset:8192
    v_cmp_nge_f32 vcc, s40, v16
    s_cbranch_vccnz A_RARE_21
A_RRET_22:
    v_add_f32 v15, v15, v16
    buffer_load_dwordx4 v10, s[28:31], s48 offen offset:1024 sc1 lds
    s_sub_u32 s55, s19, 1
    s_cmp_eq_u32 s55, 0
    s_cbranch_scc1 A_DRAIN_P2
A_LOOP_P2:
    s_waitcnt lgkmcnt(5)
    v_mfma_f32_32x32x16_bf16 v[144:159], v[192:195], v[32:35], v[128:143]
    ds_read_b128 v[216:219], v11 offset:3072
    s_waitcnt lgkmcnt(5)
    v_mfma_f32_32x32x16_bf16 v[64:79], v[196:199], v[176:179], v[64:79]
    ds_read_b128 v[220:223], v12 offset:12288
    buffer_load_dwordx4 v10, s[28:31], s48 offen offset:2048 sc1 lds
    s_waitcnt lgkmcnt(5)
    v_mfma_f32_32x32x16_bf16 v[144:159], v[200:203], v[36:39], v[144:159]
    ds_read_b128 v[192:195], v11 offset:4096
    s_cmp_ge_u32 s53, s54
    s_cbranch_scc1 A_MASK_23
A_MRET_24:
    s_add_u32 s53, s53, 3
    v_exp_f32 v24, v160
    v_exp_f32 v25, v161
    s_waitcnt lgkmcnt(5)
    v_mfma_f32_32x32x16_bf16 v[80:95], v[204:207], v[176:179], v[80:95]
    ds_read_b128 v[196:199], v12 offset:1024
    v_exp_f32 v26, v162
    v_exp_f32 v27, v163
    buffer_load_dwordx4 v10, s[28:31], s48 offen offset:3072 sc1 lds
    s_waitcnt lgkmcnt(5)
    v_mfma_f32_32x32x16_bf16 v[144:159], v[208:211], v[40:43], v[144:159]
    ds_read_b128 v[200:203], v11 offset:5120
    v_cvt_pk_bf16_f32 v184, v24, v25
    v_exp_f32 v28, v164
    v_exp_f32 v29, v165
    s_waitcnt lgkmcnt(5)
    v_mfma_f32_32x32x16_bf16 v[96:111], v[212:215], v[176:179], v[96:111]
    ds_read_b128 v[204:207], v12 offset:5120
    v_cvt_pk_bf16_f32 v185, v26, v27
    v_add_f32 v30, v24, v26
    v_add_f32 v31, v25, v27
    v_exp_f32 v24, v166
    s_mov_b32 m0, s51
    s_nop 0
    buffer_load_dwordx4 v10, s[28:31], s50 offen offset:0 sc1 lds
    s_waitcnt lgkmcnt(5)
    v_mfma_f32_32x32x16_bf16 v[144:159], v[216:219], v[44:47], v[144:159]
    ds_read_b128 v[208:211], v11 offset:6144
    v_exp_f32 v25, v167
    v_cvt_pk_bf16_f32 v186, v28, v29
    v_add_f32 v30, v30, v28
    s_waitcnt lgkmcnt(5)
    v_mfma_f32_32x32x16_bf16 v[112:127], v[220:223], v[176:179], v[112:127]
    ds_read_b128 v[212:215], v12 offset:9216
    v_add_f32 v31, v31, v29
    v_exp_f32 v26, v168
    v_exp_f32 v27, v169
    buffer_load_dwordx4 v10, s[28:31], s50 offen offset:1024 sc1 lds
    s_waitcnt lgkmcnt(5)
    v_mfma_f32_32x32x16_bf16 v[144:159], v[192:195], v[48:51], v[144:159]
    ds_read_b128 v[216:219], v11 offset:7168
    v_cvt_pk_bf16_f32 v187, v24, v25
    v_add_f32 v30, v30, v24
    v_add_f32 v31, v31, v25
    v_exp_f32 v28, v170
    s_waitcnt lgkmcnt(5)
    v_mfma_f32_32x32x16_bf16 v[64:79], v[196:199], v[180:183], v[64:79]
    ds_read_b128 v[220:223], v12 offset:13312
    v_exp_f32 v29, v171
    v_cvt_pk_bf16_f32 v188, v26, v27
    v_add_f32 v30, v30, v26
    buffer_load_dwordx4 v10, s[28:31], s50 offen offset:2048 sc1 lds
    s_waitcnt lgkmcnt(5)
    v_mfma_f32_32x32x16_bf16 v[144:159], v[200:203], v[52:55], v[144:159]
    ds_read_b128 v[192:195], v11 offset:8192
    v_add_f32 v31, v31, v27
    v_exp_f32 v24, v172
    v_exp_f32 v25, v173
    s_waitcnt lgkmcnt(5)
    v_mfma_f32_32x32x16_bf16 v[80:95], v[204:207], v[180:183], v[80:95]
    ds_read_b128 v[196:199], v12 offset:2048
    v_cvt_pk_bf16_f32 v189, v28, v29
    v_add_f32 v30, v30, v28
    v_add_f32 v31, v31, v29
    v_exp_f32 v26, v174
    buffer_load_dwordx4 v10, s[28:31], s50 offen offset:3072 sc1 lds
    s_waitcnt lgkmcnt(5)
    v_mfma_f32_32x32x16_bf16 v[144:159], v[208:211], v[56:59], v[144:159]
    ds_read_b128 v[200:203], v11 offset:9216
    v_exp_f32 v27, v175
    v_cvt_pk_bf16_f32 v190, v24, v25
    v_add_f32 v30, v30, v24
    s_waitcnt lgkmcnt(5)
    v_mfma_f32_32x32x16_bf16 v[96:111], v[212:215], v[180:183], v[96:111]
    ds_read_b128 v[204:207], v12 offset:6144
    v_add_f32 v31, v31, v25
    v_cvt_pk_bf16_f32 v191, v26, v27
    v_add_f32 v30, v30, v26
    v_add_f32 v31, v31, v27
    s_add_u32 s49, s44, s57
    s_add_u32 s51, s45, s57
    s_waitcnt lgkmcnt(5)
    v_mfma_f32_32x32x16_bf16 v[144:159], v[216:219], v[60:63], v[144:159]
    ds_read_b128 v[208:211], v11 offset:10240
    v_add_f32 v16, v30, v31
    s_xor_b32 s44, s44, 98304
    s_xor_b32 s45, s45, 98304
    s_waitcnt lgkmcnt(5)
    v_mfma_f32_32x32x16_bf16 v[112:127], v[220:223], v[180:183], v[112:127]
    ds_read_b128 v[212:215], v12 offset:10240
    v_cmp_nge_f32 vcc, s40, v16
    s_cbranch_vccnz A_RARE_25
A_RRET_26:
    v_add_f32 v15, v15, v16
    s_add_u32 s48, s48, 0x10000
    s_add_u32 s50, s50, 0x10000
    s_waitcnt lgkmcnt(5)
    v_mfma_f32_32x32x16_bf16 v[160:175], v[192:195], v[32:35], v[128:143]
    ds_read_b128 v[216:219], v11 offset:11264
    s_waitcnt lgkmcnt(5)
    v_mfma_f32_32x32x16_bf16 v[64:79], v[196:199], v[184:187], v[64:79]
    ds_read_b128 v[220:223], v12 offset:14336
    s_waitcnt lgkmcnt(5)
    v_mfma_f32_32x32x16_bf16 v[160:175], v[200:203], v[36:39], v[160:175]
    ds_read_b128 v[192:195], v11 offset:12288
    s_cmp_ge_u32 s53, s54
    s_cbranch_scc1 A_MASK_27
A_MRET_28:
    s_add_u32 s53, s53, 1
    v_exp_f32 v24, v144
    v_exp_f32 v25, v145
    s_waitcnt lgkmcnt(5)
    v_mfma_f32_32x32x16_bf16 v[80:95], v[204:207], v[184:187], v[80:95]
    ds_read_b128 v[196:199], v12 offset:3072
    v_exp_f32 v26, v146
    v_exp_f32 v27, v147
    s_waitcnt lgkmcnt(5)
    v_mfma_f32_32x32x16_bf16 v[160:175], v[208:211], v[40:43], v[160:175]
    ds_read_b128 v[200:203], v11 offset:13312
    ds_read_b128 v[204:207], v12 offset:7168
    v_cvt_pk_bf16_f32 v176, v24, v25
    v_exp_f32 v28, v148
    v_exp_f32 v29, v149
    s_waitcnt lgkmcnt(6)
    v_mfma_f32_32x32x16_bf16 v[96:111], v[212:215], v[184:187], v[96:111]
    ds_read_b128 v[208:211], v11 offset:14336
    ds_read_b128 v[212:215], v12 offset:11264
    v_cvt_pk_bf16_f32 v177, v26, v27
    v_add_f32 v30, v24, v26
    v_add_f32 v31, v25, v27
    v_exp_f32 v24, v150
    s_waitcnt lgkmcnt(7)
    v_mfma_f32_32x32x16_bf16 v[160:175], v[216:219], v[44:47], v[160:175]
    ds_read_b128 v[216:219], v11 offset:15360
    v_exp_f32 v25, v151
    v_cvt_pk_bf16_f32 v178, v28, v29
    v_add_f32 v30, v30, v28
    s_waitcnt lgkmcnt(7)
    v_mfma_f32_32x32x16_bf16 v[112:127], v[220:223], v[184:187], v[112:127]
    ds_read_b128 v[220:223], v12 offset:15360
    v_add_f32 v31, v31, v29
    v_exp_f32 v26, v152
    v_exp_f32 v27, v153
    s_waitcnt lgkmcnt(7)
    v_mfma_f32_32x32x16_bf16 v[160:175], v[192:195], v[48:51], v[160:175]
    v_cvt_pk_bf16_f32 v179, v24, v25
    v_add_f32 v30, v30, v24
    v_add_f32 v31, v31, v25
    v_exp_f32 v28, v154
    s_waitcnt lgkmcnt(6)
    v_mfma_f32_32x32x16_bf16 v[64:79], v[196:199], v[188:191], v[64:79]
    v_exp_f32 v29, v155
    v_cvt_pk_bf16_f32 v180, v26, v27
    v_add_f32 v30, v30, v26
    s_waitcnt lgkmcnt(5)
    v_mfma_f32_32x32x16_bf16 v[160:175], v[200:203], v[52:55], v[160:175]
    v_add_f32 v31, v31, v27
    v_exp_f32 v24, v156
    v_exp_f32 v25, v157
    v_add_u32 v11, s44, v10
    v_add_u32 v12, s45, v10
    s_waitcnt lgkmcnt(4)
    v_mfma_f32_32x32x16_bf16 v[80:95], v[204:207], v[188:191], v[80:95]
    v_cvt_pk_bf16_f32 v181, v28, v29
    v_add_f32 v30, v30, v28
    v_add_f32 v31, v31, v29
    v_exp_f32 v26, v158
    s_waitcnt vmcnt(0) lgkmcnt(0)
    s_barrier
    buffer_store_dwordx4 v[224:227], v10, s[68:71], s72 offen sc1
    s_mov_b32 s72, s73
    s_mov_b32 s73, s75
    s_mov_b32 s75, 0x7f000000
    s_waitcnt lgkmcnt(3)
    v_mfma_f32_32x32x16_bf16 v[160:175], v[208:211], v[56:59], v[160:175]
    ds_read_b128 v[192:195], v11 offset:0
    ds_read_b128 v[196:199], v12 offset:0
    v_exp_f32 v27, v159
    v_cvt_pk_bf16_f32 v182, v24, v25
    v_add_f32 v30, v30, v24
    s_waitcnt lgkmcnt(4)
    v_mfma_f32_32x32x16_bf16 v[96:111], v[212:215], v[188:191], v[96:111]
    ds_read_b128 v[200:203], v11 offset:1024
    ds_read_b128 v[204:207], v12 offset:4096
    v_add_f32 v31, v31, v25
    v_cvt_pk_bf16_f32 v183, v26, v27
    v_add_f32 v30, v30, v26
    v_add_f32 v31, v31, v27
    s_mov_b32 m0, s49
    s_nop 0
    buffer_load_dwordx4 v10, s[28:31], s48 offen offset:0 sc1 lds
    s_waitcnt lgkmcnt(5)
    v_mfma_f32_32x32x16_bf16 v[160:175], v[216:219], v[60:63], v[160:175]
    ds_read_b128 v[208:211], v11 offset:2048
    v_add_f32 v16, v30, v31
    s_waitcnt lgkmcnt(5)
    v_mfma_f32_32x32x16_bf16 v[112:127], v[220:223], v[188:191], v[112:127]
    ds_read_b128 v[212:215], v12 offset:8192
    v_cmp_nge_f32 vcc, s40, v16
    s_cbranch_vccnz A_RARE_29
A_RRET_30:
    v_add_f32 v15, v15, v16
    buffer_load_dwordx4 v10, s[28:31], s48 offen offset:1024 sc1 lds
    s_sub_u32 s55, s55, 1
    s_cmp_lg_u32 s55, 0
    s_cbranch_scc1 A_LOOP_P2
A_DRAIN_P2:
    s_cmp_lg_u32 s15, 0
    s_cbranch_scc1 A_NOWF3
    s_lshr_b32 s36, s2, 3
    s_lshl_b32 s37, s36, 3
    s_add_u32 s37, s37, s3
    s_mul_i32 s37, s37, 6144
    s_and_b32 s38, s2, 3
    v_and_b32 v18, 63, v1
    v_lshlrev_b32 v18, 7, v18
    s_mov_b32 s8, s4
    s_mov_b32 s9, s5
    s_mov_b32 s10, 0x400000
    s_mov_b32 s11, 0x00020000
    s_cmp_eq_u32 s38, 2
    s_cselect_b32 s8, s6, s8
    s_cselect_b32 s9, s7, s9
    s_cselect_b32 s10, 0x158000, s10
    s_cselect_b32 s38, 0, s38
    s_cmp_eq_u32 s38, 3
    s_mul_i32 s38, s38, 1572864
    s_cselect_b32 s38, 2883584, s38
    s_add_u32 s37, s37, s38
    s_mov_b32 exec_hi, 65535
    buffer_load_dword v17, v18, s[8:11], s37 offen
    s_mov_b32 exec_hi, -1
A_NOWF3:
    s_waitcnt lgkmcnt(4)
    v_mfma_f32_32x32x16_bf16 v[64:79], v[196:199], v[176:179], v[64:79]
    ds_read_b128 v[220:223], v12 offset:12288
    s_cmp_ge_u32 s53, s54
    s_cbranch_scc1 A_MASK_31
A_MRET_32:
    s_add_u32 s53, s53, 3
    v_exp_f32 v24, v160
    v_exp_f32 v25, v161
    s_waitcnt lgkmcnt(3)
    v_mfma_f32_32x32x16_bf16 v[80:95], v[204:207], v[176:179], v[80:95]
    ds_read_b128 v[196:199], v12 offset:1024
    v_exp_f32 v26, v162
    v_exp_f32 v27, v163
    v_cvt_pk_bf16_f32 v184, v24, v25
    v_exp_f32 v28, v164
    v_exp_f32 v29, v165
    s_waitcnt lgkmcnt(2)
    v_mfma_f32_32x32x16_bf16 v[96:111], v[212:215], v[176:179], v[96:111]
    ds_read_b128 v[204:207], v12 offset:5120
    v_cvt_pk_bf16_f32 v185, v26, v27
    v_add_f32 v30, v24, v26
    v_add_f32 v31, v25, v27
    v_exp_f32 v24, v166
    v_exp_f32 v25, v167
    v_cvt_pk_bf16_f32 v186, v28, v29
    v_add_f32 v30, v30, v28
    s_waitcnt lgkmcnt(2)
    v_mfma_f32_32x32x16_bf16 v[112:127], v[220:223], v[176:179], v[112:127]
    ds_read_b128 v[212:215], v12 offset:9216
    v_add_f32 v31, v31, v29
    v_exp_f32 v26, v168
    v_exp_f32 v27, v169
    v_cvt_pk_bf16_f32 v187, v24, v25
    v_add_f32 v30, v30, v24
    v_add_f32 v31, v31, v25
    v_exp_f32 v28, v170
    s_waitcnt lgkmcnt(2)
    v_mfma_f32_32x32x16_bf16 v[64:79], v[196:199], v[180:183], v[64:79]
    ds_read_b128 v[220:223], v12 offset:13312
    v_exp_f32 v29, v171
    v_cvt_pk_bf16_f32 v188, v26, v27
    v_add_f32 v30, v30, v26
    v_add_f32 v31, v31, v27
    v_exp_f32 v24, v172
    v_exp_f32 v25, v173
    s_waitcnt lgkmcnt(2)
    v_mfma_f32_32x32x16_bf16 v[80:95], v[204:207], v[180:183], v[80:95]
    ds_read_b128 v[196:199], v12 offset:2048
    v_cvt_pk_bf16_f32 v189, v28, v29
    v_add_f32 v30, v30, v28
    v_add_f32 v31, v31, v29
    v_exp_f32 v26, v174
    v_exp_f32 v27, v175
    v_cvt_pk_bf16_f32 v190, v24, v25
    v_add_f32 v30, v30, v24
    s_waitcnt lgkmcnt(2)
    v_mfma_f32_32x32x16_bf16 v[96:111], v[212:215], v[180:183], v[96:111]
    ds_read_b128 v[204:207], v12 offset:6144
    v_add_f32 v31, v31, v25
    v_cvt_pk_bf16_f32 v191, v26, v27
    v_add_f32 v30, v30, v26
    v_add_f32 v31, v31, v27
    v_add_f32 v16, v30, v31
    s_waitcnt lgkmcnt(2)
    v_mfma_f32_32x32x16_bf16 v[112:127], v[220:223], v[180:183], v[112:127]
    ds_read_b128 v[212:215], v12 offset:10240
    v_cmp_nge_f32 vcc, s40, v16
    s_cbranch_vccnz A_RARE_33
A_RRET_34:
    v_add_f32 v15, v15, v16
    s_waitcnt lgkmcnt(2)
    v_mfma_f32_32x32x16_bf16 v[64:79], v[196:199], v[184:187], v[64:79]
    ds_read_b128 v[220:223], v12 offset:14336
    s_waitcnt lgkmcnt(2)
    v_mfma_f32_32x32x16_bf16 v[80:95], v[204:207], v[184:187], v[80:95]
    ds_read_b128 v[196:199], v12 offset:3072
    ds_read_b128 v[204:207], v12 offset:7168
    s_waitcnt lgkmcnt(3)
    v_mfma_f32_32x32x16_bf16 v[96:111], v[212:215], v[184:187], v[96:111]
    ds_read_b128 v[212:215], v12 offset:11264
    s_waitcnt lgkmcnt(3)
    v_mfma_f32_32x32x16_bf16 v[112:127], v[220:223], v[184:187], v[112:127]
    ds_read_b128 v[220:223], v12 offset:15360
    s_waitcnt lgkmcnt(3)
    v_mfma_f32_32x32x16_bf16 v[64:79], v[196:199], v[188:191], v[64:79]
    s_waitcnt lgkmcnt(2)
    v_mfma_f32_32x32x16_bf16 v[80:95], v[204:207], v[188:191], v[80:95]
    s_waitcnt lgkmcnt(1)
    v_mfma_f32_32x32x16_bf16 v[96:111], v[212:215], v[188:191], v[96:111]
    s_waitcnt lgkmcnt(0)
    v_mfma_f32_32x32x16_bf16 v[112:127], v[220:223], v[188:191], v[112:127]
    s_cmp_lg_u32 s15, 0
    s_cbranch_scc1 A_NOWF1
    s_waitcnt vmcnt(1) lgkmcnt(0)
    s_branch A_NOWF2
A_NOWF1:
    s_waitcnt vmcnt(0) lgkmcnt(0)
A_NOWF2:
    s_barrier
    s_lshl_b32 s36, s3, 13
    v_add_u32 v2, s36, v10
    s_xor_b32 s37, s3, 4
    s_lshl_b32 s36, s37, 13
    v_add_u32 v3, s36, v10
    v_lshlrev_b32 v4, 3, v1
    s_lshl_b32 s36, s3, 9
    s_add_u32 s36, s36, 65536
    v_add_u32 v5, s36, v4
    s_lshl_b32 s36, s37, 9
    s_add_u32 s36, s36, 65536
    v_add_u32 v4, s36, v4
    v_mov_b32 v6, v128
    v_mov_b32 v7, v15
    ds_write_b64 v5, v[6:7]
    s_cmp_eq_u32 s13, 0
    s_cbranch_scc1 A_MWA
    ds_write_b128 v2, v[64:67] offset:0
    ds_write_b128 v2, v[68:71] offset:1024
    ds_write_b128 v2, v[72:75] offset:2048
    ds_write_b128 v2, v[76:79] offset:3072
    ds_write_b128 v2, v[80:83] offset:4096
    ds_write_b128 v2, v[84:87] offset:5120
    ds_write_b128 v2, v[88:91] offset:6144
    ds_write_b128 v2, v[92:95] offset:7168
    s_branch A_MWD
A_MWA:
    ds_write_b128 v2, v[96:99] offset:0
    ds_write_b128 v2, v[100:103] offset:1024
    ds_write_b128 v2, v[104:107] offset:2048
    ds_write_b128 v2, v[108:111] offset:3072
    ds_write_b128 v2, v[112:115] offset:4096
    ds_write_b128 v2, v[116:119] offset:5120
    ds_write_b128 v2, v[120:123] offset:6144
    ds_write_b128 v2, v[124:127] offset:7168
A_MWD:
    s_waitcnt lgkmcnt(0)
    s_barrier
    ds_read_b64 v[8:9], v4
    ds_read_b128 v[144:147], v3 offset:0
    ds_read_b128 v[148:151], v3 offset:1024
    ds_read_b128 v[152:155], v3 offset:2048
    ds_read_b128 v[156:159], v3 offset:3072
    ds_read_b128 v[160:163], v3 offset:4096
    ds_read_b128 v[164:167], v3 offset:5120
    ds_read_b128 v[168:171], v3 offset:6144
    ds_read_b128 v[172:175], v3 offset:7168
    s_waitcnt lgkmcnt(8)
    v_min_f32 v2, v6, v8
    v_sub_f32 v6, v2, v6
    v_sub_f32 v8, v2, v8
    v_exp_f32 v6, v6
    v_exp_f32 v8, v8
    s_nop 0
    v_mul_f32 v7, v7, v6
    v_fmac_f32 v7, v9, v8
    v_mov_b32 v24, v7
    v_mov_b32 v25, v7
    s_nop 1
    v_permlane32_swap_b32 v24, v25
    v_add_f32 v24, v24, v25
    v_rcp_f32 v24, v24
    s_nop 0
    v_mul_f32 v6, v6, v24
    v_mul_f32 v8, v8, v24
    v_mov_b32 v7, v6
    v_mov_b32 v9, v8
    s_waitcnt lgkmcnt(0)
    s_lshl_b32 s64, s54, 18
    s_lshl_b32 s36, s14, 13
    s_add_u32 s64, s64, s36
    s_lshl_b32 s36, s13, 12
    s_add_u32 s64, s64, s36
    s_cmp_eq_u32 s13, 0
    s_cbranch_scc1 A_MSA
    v_mul_f32 v144, v144, v8
    v_mul_f32 v145, v145, v8
    v_mul_f32 v146, v146, v8
    v_mul_f32 v147, v147, v8
    v_mul_f32 v148, v148, v8
    v_mul_f32 v149, v149, v8
    v_mul_f32 v150, v150, v8
    v_mul_f32 v151, v151, v8
    v_fmac_f32 v144, v96, v6
    v_fmac_f32 v145, v97, v6
    v_fmac_f32 v146, v98, v6
    v_fmac_f32 v147, v99, v6
    v_fmac_f32 v148, v100, v6
    v_fmac_f32 v149, v101, v6
    v_fmac_f32 v150, v102, v6
    v_fmac_f32 v151, v103, v6
    v_cvt_pk_bf16_f32 v176, v144, v145
    v_cvt_pk_bf16_f32 v177, v146, v147
    v_cvt_pk_bf16_f32 v178, v148, v149
    v_cvt_pk_bf16_f32 v179, v150, v151
    buffer_store_dwordx4 v[176:179], v10, s[32:35], s64 offen offset:0 sc1
    v_mul_f32 v152, v152, v8
    v_mul_f32 v153, v153, v8
    v_mul_f32 v154, v154, v8
    v_mul_f32 v155, v155, v8
    v_mul_f32 v156, v156, v8
    v_mul_f32 v157, v157, v8
    v_mul_f32 v158, v158, v8
    v_mul_f32 v159, v159, v8
    v_fmac_f32 v152, v104, v6
    v_fmac_f32 v153, v105, v6
    v_fmac_f32 v154, v106, v6
    v_fmac_f32 v155, v107, v6
    v_fmac_f32 v156, v108, v6
    v_fmac_f32 v157, v109, v6
    v_fmac_f32 v158, v110, v6
    v_fmac_f32 v159, v111, v6
    v_cvt_pk_bf16_f32 v180, v152, v153
    v_cvt_pk_bf16_f32 v181, v154, v155
    v_cvt_pk_bf16_f32 v182, v156, v157
    v_cvt_pk_bf16_f32 v183, v158, v159
    buffer_store_dwordx4 v[180:183], v10, s[32:35], s64 offen offset:1024 sc1
    v_mul_f32 v160, v160, v8
    v_mul_f32 v161, v161, v8
    v_mul_f32 v162, v162, v8
    v_mul_f32 v163, v163, v8
    v_mul_f32 v164, v164, v8
    v_mul_f32 v165, v165, v8
    v_mul_f32 v166, v166, v8
    v_mul_f32 v167, v167, v8
    v_fmac_f32 v160, v112, v6
    v_fmac_f32 v161, v113, v6
    v_fmac_f32 v162, v114, v6
    v_fmac_f32 v163, v115, v6
    v_fmac_f32 v164, v116, v6
    v_fmac_f32 v165, v117, v6
    v_fmac_f32 v166, v118, v6
    v_fmac_f32 v167, v119, v6
    v_cvt_pk_bf16_f32 v184, v160, v161
    v_cvt_pk_bf16_f32 v185, v162, v163
    v_cvt_pk_bf16_f32 v186, v164, v165
    v_cvt_pk_bf16_f32 v187, v166, v167
    buffer_store_dwordx4 v[184:187], v10, s[32:35], s64 offen offset:2048 sc1
    v_mul_f32 v168, v168, v8
    v_mul_f32 v169, v169, v8
    v_mul_f32 v170, v170, v8
    v_mul_f32 v171, v171, v8
    v_mul_f32 v172, v172, v8
    v_mul_f32 v173, v173, v8
    v_mul_f32 v174, v174, v8
    v_mul_f32 v175, v175, v8
    v_fmac_f32 v168, v120, v6
    v_fmac_f32 v169, v121, v6
    v_fmac_f32 v170, v122, v6
    v_fmac_f32 v171, v123, v6
    v_fmac_f32 v172, v124, v6
    v_fmac_f32 v173, v125, v6
    v_fmac_f32 v174, v126, v6
    v_fmac_f32 v175, v127, v6
    v_cvt_pk_bf16_f32 v188, v168, v169
    v_cvt_pk_bf16_f32 v189, v170, v171
    v_cvt_pk_bf16_f32 v190, v172, v173
    v_cvt_pk_bf16_f32 v191, v174, v175
    buffer_store_dwordx4 v[188:191], v10, s[32:35], s64 offen offset:3072 sc1
    s_branch A_MSD
A_MSA:
    v_mul_f32 v144, v144, v8
    v_mul_f32 v145, v145, v8
    v_mul_f32 v146, v146, v8
    v_mul_f32 v147, v147, v8
    v_mul_f32 v148, v148, v8
    v_mul_f32 v149, v149, v8
    v_mul_f32 v150, v150, v8
    v_mul_f32 v151, v151, v8
    v_fmac_f32 v144, v64, v6
    v_fmac_f32 v145, v65, v6
    v_fmac_f32 v146, v66, v6
    v_fmac_f32 v147, v67, v6
    v_fmac_f32 v148, v68, v6
    v_fmac_f32 v149, v69, v6
    v_fmac_f32 v150, v70, v6
    v_fmac_f32 v151, v71, v6
    v_cvt_pk_bf16_f32 v176, v144, v145
    v_cvt_pk_bf16_f32 v177, v146, v147
    v_cvt_pk_bf16_f32 v178, v148, v149
    v_cvt_pk_bf16_f32 v179, v150, v151
    buffer_store_dwordx4 v[176:179], v10, s[32:35], s64 offen offset:0 sc1
    v_mul_f32 v152, v152, v8
    v_mul_f32 v153, v153, v8
    v_mul_f32 v154, v154, v8
    v_mul_f32 v155, v155, v8
    v_mul_f32 v156, v156, v8
    v_mul_f32 v157, v157, v8
    v_mul_f32 v158, v158, v8
    v_mul_f32 v159, v159, v8
    v_fmac_f32 v152, v72, v6
    v_fmac_f32 v153, v73, v6
    v_fmac_f32 v154, v74, v6
    v_fmac_f32 v155, v75, v6
    v_fmac_f32 v156, v76, v6
    v_fmac_f32 v157, v77, v6
    v_fmac_f32 v158, v78, v6
    v_fmac_f32 v159, v79, v6
    v_cvt_pk_bf16_f32 v180, v152, v153
    v_cvt_pk_bf16_f32 v181, v154, v155
    v_cvt_pk_bf16_f32 v182, v156, v157
    v_cvt_pk_bf16_f32 v183, v158, v159
    buffer_store_dwordx4 v[180:183], v10, s[32:35], s64 offen offset:1024 sc1
    v_mul_f32 v160, v160, v8
    v_mul_f32 v161, v161, v8
    v_mul_f32 v162, v162, v8
    v_mul_f32 v163, v163, v8
    v_mul_f32 v164, v164, v8
    v_mul_f32 v165, v165, v8
    v_mul_f32 v166, v166, v8
    v_mul_f32 v167, v167, v8
    v_fmac_f32 v160, v80, v6
    v_fmac_f32 v161, v81, v6
    v_fmac_f32 v162, v82, v6
    v_fmac_f32 v163, v83, v6
    v_fmac_f32 v164, v84, v6
    v_fmac_f32 v165, v85, v6
    v_fmac_f32 v166, v86, v6
    v_fmac_f32 v167, v87, v6
    v_cvt_pk_bf16_f32 v184, v160, v161
    v_cvt_pk_bf16_f32 v185, v162, v163
    v_cvt_pk_bf16_f32 v186, v164, v165
    v_cvt_pk_bf16_f32 v187, v166, v167
    buffer_store_dwordx4 v[184:187], v10, s[32:35], s64 offen offset:2048 sc1
    v_mul_f32 v168, v168, v8
    v_mul_f32 v169, v169, v8
    v_mul_f32 v170, v170, v8
    v_mul_f32 v171, v171, v8
    v_mul_f32 v172, v172, v8
    v_mul_f32 v173, v173, v8
    v_mul_f32 v174, v174, v8
    v_mul_f32 v175, v175, v8
    v_fmac_f32 v168, v88, v6
    v_fmac_f32 v169, v89, v6
    v_fmac_f32 v170, v90, v6
    v_fmac_f32 v171, v91, v6
    v_fmac_f32 v172, v92, v6
    v_fmac_f32 v173, v93, v6
    v_fmac_f32 v174, v94, v6
    v_fmac_f32 v175, v95, v6
    v_cvt_pk_bf16_f32 v188, v168, v169
    v_cvt_pk_bf16_f32 v189, v170, v171
    v_cvt_pk_bf16_f32 v190, v172, v173
    v_cvt_pk_bf16_f32 v191, v174, v175
    buffer_store_dwordx4 v[188:191], v10, s[32:35], s64 offen offset:3072 sc1
A_MSD:
    s_cmp_eq_u32 s15, 0
    s_cbranch_scc1 A_END
    s_lshl_b32 s36, s14, 2
    s_add_u32 s36, s36, 8192
    s_lshl_b32 s37, s16, 7
    s_add_u32 s37, s37, s36
    s_lshl_b32 s38, s17, 7
    s_add_u32 s38, s38, s36
    s_mov_b32 s66, s37
    s_mov_b32 s67, s38
    s_mov_b32 s15, 0
    s_mov_b32 s16, 2
    s_mov_b32 s17, 1
    s_barrier
    s_branch A_JOB
A_END:
    s_lshl_b32 s36, s14, 2
    s_add_u32 s36, s36, 8192
    s_lshl_b32 s37, s16, 7
    s_add_u32 s37, s37, s36
    s_lshl_b32 s38, s17, 7
    s_add_u32 s38, s38, s36
    v_mov_b32 v8, s37
    v_mov_b32 v9, s38
    v_cmp_eq_u32 vcc, 0, v1
    s_nop 1
    v_cndmask_b32 v8, v9, v8, vcc
    s_mov_b32 s72, 1
    s_cmp_lg_u32 s16, 2
    s_cbranch_scc1 A_CF3
    s_mov_b32 s72, 0
    s_waitcnt vmcnt(0)
    s_barrier
    s_cmp_lg_u32 s3, 0
    s_cbranch_scc1 A_CF2
    v_mov_b32 v9, s77
    s_mov_b64 exec, 3
    global_store_dword v8, v9, s[100:101] sc1
    s_mov_b64 exec, -1
A_CF2:
A_CF3:
    s_branch L3C_ENTRY
A_KSLOW:
    s_mov_b32 s37, 100000
A_KP:
    global_load_dword v5, v4, s[100:101] sc1
    s_waitcnt vmcnt(0)
    v_cmp_ne_u32 vcc, s77, v5
    s_cbranch_vccz A_KP_D
    s_sleep 4
    s_sub_u32 s37, s37, 1
    s_cmp_lg_u32 s37, 0
    s_cbranch_scc1 A_KP
A_KP_D:
    s_branch A_KOK
A_MASK_1:
    s_nop 7
    s_sub_u32 s38, s54, s53
    s_lshl_b32 s38, s38, 5
    v_add_u32 v16, s38, v13
    v_cmp_le_i32 s[58:59], 0, v16
    v_cmp_le_i32 s[60:61], 1, v16
    v_cmp_le_i32 s[62:63], 2, v16
    v_cndmask_b32 v144, v14, v144, s[58:59]
    v_cndmask_b32 v145, v14, v145, s[60:61]
    v_cndmask_b32 v146, v14, v146, s[62:63]
    v_cmp_le_i32 s[58:59], 3, v16
    v_cmp_le_i32 s[60:61], 8, v16
    v_cmp_le_i32 s[62:63], 9, v16
    v_cndmask_b32 v147, v14, v147, s[58:59]
    v_cndmask_b32 v148, v14, v148, s[60:61]
    v_cndmask_b32 v149, v14, v149, s[62:63]
    v_cmp_le_i32 s[58:59], 10, v16
    v_cmp_le_i32 s[60:61], 11, v16
    v_cmp_le_i32 s[62:63], 16, v16
    v_cndmask_b32 v150, v14, v150, s[58:59]
    v_cndmask_b32 v151, v14, v151, s[60:61]
    v_cndmask_b32 v152, v14, v152, s[62:63]
    v_cmp_le_i32 s[58:59], 17, v16
    v_cmp_le_i32 s[60:61], 18, v16
    v_cmp_le_i32 s[62:63], 19, v16
    v_cndmask_b32 v153, v14, v153, s[58:59]
    v_cndmask_b32 v154, v14, v154, s[60:61]
    v_cndmask_b32 v155, v14, v155, s[62:63]
    v_cmp_le_i32 s[58:59], 24, v16
    v_cmp_le_i32 s[60:61], 25, v16
    v_cmp_le_i32 s[62:63], 26, v16
    v_cndmask_b32 v156, v14, v156, s[58:59]
    v_cndmask_b32 v157, v14, v157, s[60:61]
    v_cndmask_b32 v158, v14, v158, s[62:63]
    v_cmp_le_i32 s[58:59], 27, v16
    s_nop 1
    v_cndmask_b32 v159, v14, v159, s[58:59]
    s_branch A_MRET_2
A_RARE_4:
    s_nop 15
    v_max3_f32 v24, v144, v145, v146
    v_max3_f32 v25, v147, v148, v149
    v_max3_f32 v24, v24, v150, v151
    v_max3_f32 v25, v25, v152, v153
    v_max3_f32 v24, v24, v154, v155
    v_max3_f32 v25, v25, v156, v157
    v_max3_f32 v24, v24, v158, v159
    v_max_f32 v24, v24, v25
    v_mov_b32 v25, v24
    s_nop 1
    v_permlane32_swap_b32 v24, v25
    v_max_f32 v24, v24, v25
    v_max_f32 v24, 0, v24
    v_sub_f32 v144, v144, v24
    v_sub_f32 v160, v160, v24
    v_sub_f32 v128, v128, v24
    v_sub_f32 v145, v145, v24
    v_sub_f32 v161, v161, v24
    v_sub_f32 v129, v129, v24
    v_sub_f32 v146, v146, v24
    v_sub_f32 v162, v162, v24
    v_sub_f32 v130, v130, v24
    v_sub_f32 v147, v147, v24
    v_sub_f32 v163, v163, v24
    v_sub_f32 v131, v131, v24
    v_sub_f32 v148, v148, v24
    v_sub_f32 v164, v164, v24
    v_sub_f32 v132, v132, v24
    v_sub_f32 v149, v149, v24
    v_sub_f32 v165, v165, v24
    v_sub_f32 v133, v133, v24
    v_sub_f32 v150, v150, v24
    v_sub_f32 v166, v166, v24
    v_sub_f32 v134, v134, v24
    v_sub_f32 v151, v151, v24
    v_sub_f32 v167, v167, v24
    v_sub_f32 v135, v135, v24
    v_sub_f32 v152, v152, v24
    v_sub_f32 v168, v168, v24
    v_sub_f32 v136, v136, v24
    v_sub_f32 v153, v153, v24
    v_sub_f32 v169, v169, v24
    v_sub_f32 v137, v137, v24
    v_sub_f32 v154, v154, v24
    v_sub_f32 v170, v170, v24
    v_sub_f32 v138, v138, v24
    v_sub_f32 v155, v155, v24
    v_sub_f32 v171, v171, v24
    v_sub_f32 v139, v139, v24
    v_sub_f32 v156, v156, v24
    v_sub_f32 v172, v172, v24
    v_sub_f32 v140, v140, v24
    v_sub_f32 v157, v157, v24
    v_sub_f32 v173, v173, v24
    v_sub_f32 v141, v141, v24
    v_sub_f32 v158, v158, v24
    v_sub_f32 v174, v174, v24
    v_sub_f32 v142, v142, v24
    v_sub_f32 v159, v159, v24
    v_sub_f32 v175, v175, v24
    v_sub_f32 v143, v143, v24
    v_sub_f32 v24, 0, v24
    v_exp_f32 v24, v24
    s_nop 0
    v_mul_f32 v15, v15, v24
    v_mul_f32 v64, v64, v24
    v_mul_f32 v65, v65, v24
    v_mul_f32 v66, v66, v24
    v_mul_f32 v67, v67, v24
    v_mul_f32 v68, v68, v24
    v_mul_f32 v69, v69, v24
    v_mul_f32 v70, v70, v24
    v_mul_f32 v71, v71, v24
    v_mul_f32 v72, v72, v24
    v_mul_f32 v73, v73, v24
    v_mul_f32 v74, v74, v24
    v_mul_f32 v75, v75, v24
    v_mul_f32 v76, v76, v24
    v_mul_f32 v77, v77, v24
    v_mul_f32 v78, v78, v24
    v_mul_f32 v79, v79, v24
    v_mul_f32 v80, v80, v24
    v_mul_f32 v81, v81, v24
    v_mul_f32 v82, v82, v24
    v_mul_f32 v83, v83, v24
    v_mul_f32 v84, v84, v24
    v_mul_f32 v85, v85, v24
    v_mul_f32 v86, v86, v24
    v_mul_f32 v87, v87, v24
    v_mul_f32 v88, v88, v24
    v_mul_f32 v89, v89, v24
    v_mul_f32 v90, v90, v24
    v_mul_f32 v91, v91, v24
    v_mul_f32 v92, v92, v24
    v_mul_f32 v93, v93, v24
    v_mul_f32 v94, v94, v24
    v_mul_f32 v95, v95, v24
    v_mul_f32 v96, v96, v24
    v_mul_f32 v97, v97, v24
    v_mul_f32 v98, v98, v24
    v_mul_f32 v99, v99, v24
    v_mul_f32 v100, v100, v24
    v_mul_f32 v101, v101, v24
    v_mul_f32 v102, v102, v24
    v_mul_f32 v103, v103, v24
    v_mul_f32 v104, v104, v24
    v_mul_f32 v105, v105, v24
    v_mul_f32 v106, v106, v24
    v_mul_f32 v107, v107, v24
    v_mul_f32 v108, v108, v24
    v_mul_f32 v109, v109, v24
    v_mul_f32 v110, v110, v24
    v_mul_f32 v111, v111, v24
    v_mul_f32 v112, v112, v24
    v_mul_f32 v113, v113, v24
    v_mul_f32 v114, v114, v24
    v_mul_f32 v115, v115, v24
    v_mul_f32 v116, v116, v24
    v_mul_f32 v117, v117, v24
    v_mul_f32 v118, v118, v24
    v_mul_f32 v119, v119, v24
    v_mul_f32 v120, v120, v24
    v_mul_f32 v121, v121, v24
    v_mul_f32 v122, v122, v24
    v_mul_f32 v123, v123, v24
    v_mul_f32 v124, v124, v24
    v_mul_f32 v125, v125, v24
    v_mul_f32 v126, v126, v24
    v_mul_f32 v127, v127, v24
    v_exp_f32 v24, v144
    v_exp_f32 v25, v145
    v_exp_f32 v26, v146
    v_exp_f32 v27, v147
    v_cvt_pk_bf16_f32 v176, v24, v25
    v_exp_f32 v28, v148
    v_exp_f32 v29, v149
    v_cvt_pk_bf16_f32 v177, v26, v27
    v_add_f32 v30, v24, v26
    v_add_f32 v31, v25, v27
    v_exp_f32 v24, v150
    v_exp_f32 v25, v151
    v_cvt_pk_bf16_f32 v178, v28, v29
    v_add_f32 v30, v30, v28
    v_add_f32 v31, v31, v29
    v_exp_f32 v26, v152
    v_exp_f32 v27, v153
    v_cvt_pk_bf16_f32 v179, v24, v25
    v_add_f32 v30, v30, v24
    v_add_f32 v31, v31, v25
    v_exp_f32 v28, v154
    v_exp_f32 v29, v155
    v_cvt_pk_bf16_f32 v180, v26, v27
    v_add_f32 v30, v30, v26
    v_add_f32 v31, v31, v27
    v_exp_f32 v24, v156
    v_exp_f32 v25, v157
    v_cvt_pk_bf16_f32 v181, v28, v29
    v_add_f32 v30, v30, v28
    v_add_f32 v31, v31, v29
    v_exp_f32 v26, v158
    v_exp_f32 v27, v159
    v_cvt_pk_bf16_f32 v182, v24, v25
    v_add_f32 v30, v30, v24
    v_add_f32 v31, v31, v25
    v_cvt_pk_bf16_f32 v183, v26, v27
    v_add_f32 v30, v30, v26
    v_add_f32 v31, v31, v27
    v_add_f32 v16, v30, v31
    s_nop 1
    s_branch A_RRET_5
A_MASK_6:
    s_nop 7
    s_sub_u32 s38, s54, s53
    s_lshl_b32 s38, s38, 5
    v_add_u32 v16, s38, v13
    v_cmp_le_i32 s[58:59], 0, v16
    v_cmp_le_i32 s[60:61], 1, v16
    v_cmp_le_i32 s[62:63], 2, v16
    v_cndmask_b32 v160, v14, v160, s[58:59]
    v_cndmask_b32 v161, v14, v161, s[60:61]
    v_cndmask_b32 v162, v14, v162, s[62:63]
    v_cmp_le_i32 s[58:59], 3, v16
    v_cmp_le_i32 s[60:61], 8, v16
    v_cmp_le_i32 s[62:63], 9, v16
    v_cndmask_b32 v163, v14, v163, s[58:59]
    v_cndmask_b32 v164, v14, v164, s[60:61]
    v_cndmask_b32 v165, v14, v165, s[62:63]
    v_cmp_le_i32 s[58:59], 10, v16
    v_cmp_le_i32 s[60:61], 11, v16
    v_cmp_le_i32 s[62:63], 16, v16
    v_cndmask_b32 v166, v14, v166, s[58:59]
    v_cndmask_b32 v167, v14, v167, s[60:61]
    v_cndmask_b32 v168, v14, v168, s[62:63]
    v_cmp_le_i32 s[58:59], 17, v16
    v_cmp_le_i32 s[60:61], 18, v16
    v_cmp_le_i32 s[62:63], 19, v16
    v_cndmask_b32 v169, v14, v169, s[58:59]
    v_cndmask_b32 v170, v14, v170, s[60:61]
    v_cndmask_b32 v171, v14, v171, s[62:63]
    v_cmp_le_i32 s[58:59], 24, v16
    v_cmp_le_i32 s[60:61], 25, v16
    v_cmp_le_i32 s[62:63], 26, v16
    v_cndmask_b32 v172, v14, v172, s[58:59]
    v_cndmask_b32 v173, v14, v173, s[60:61]
    v_cndmask_b32 v174, v14, v174, s[62:63]
    v_cmp_le_i32 s[58:59], 27, v16
    s_nop 1
    v_cndmask_b32 v175, v14, v175, s[58:59]
    s_branch A_MRET_7
A_RARE_8:
    s_nop 15
    v_max3_f32 v24, v160, v161, v162
    v_max3_f32 v25, v163, v164, v165
    v_max3_f32 v24, v24, v166, v167
    v_max3_f32 v25, v25, v168, v169
    v_max3_f32 v24, v24, v170, v171
    v_max3_f32 v25, v25, v172, v173
    v_max3_f32 v24, v24, v174, v175
    v_max_f32 v24, v24, v25
    v_mov_b32 v25, v24
    s_nop 1
    v_permlane32_swap_b32 v24, v25
    v_max_f32 v24, v24, v25
    v_max_f32 v24, 0, v24
    v_sub_f32 v160, v160, v24
    v_sub_f32 v144, v144, v24
    v_sub_f32 v128, v128, v24
    v_sub_f32 v161, v161, v24
    v_sub_f32 v145, v145, v24
    v_sub_f32 v129, v129, v24
    v_sub_f32 v162, v162, v24
    v_sub_f32 v146, v146, v24
    v_sub_f32 v130, v130, v24
    v_sub_f32 v163, v163, v24
    v_sub_f32 v147, v147, v24
    v_sub_f32 v131, v131, v24
    v_sub_f32 v164, v164, v24
    v_sub_f32 v148, v148, v24
    v_sub_f32 v132, v132, v24
    v_sub_f32 v165, v165, v24
    v_sub_f32 v149, v149, v24
    v_sub_f32 v133, v133, v24
    v_sub_f32 v166, v166, v24
    v_sub_f32 v150, v150, v24
    v_sub_f32 v134, v134, v24
    v_sub_f32 v167, v167, v24
    v_sub_f32 v151, v151, v24
    v_sub_f32 v135, v135, v24
    v_sub_f32 v168, v168, v24
    v_sub_f32 v152, v152, v24
    v_sub_f32 v136, v136, v24
    v_sub_f32 v169, v169, v24
    v_sub_f32 v153, v153, v24
    v_sub_f32 v137, v137, v24
    v_sub_f32 v170, v170, v24
    v_sub_f32 v154, v154, v24
    v_sub_f32 v138, v138, v24
    v_sub_f32 v171, v171, v24
    v_sub_f32 v155, v155, v24
    v_sub_f32 v139, v139, v24
    v_sub_f32 v172, v172, v24
    v_sub_f32 v156, v156, v24
    v_sub_f32 v140, v140, v24
    v_sub_f32 v173, v173, v24
    v_sub_f32 v157, v157, v24
    v_sub_f32 v141, v141, v24
    v_sub_f32 v174, v174, v24
    v_sub_f32 v158, v158, v24
    v_sub_f32 v142, v142, v24
    v_sub_f32 v175, v175, v24
    v_sub_f32 v159, v159, v24
    v_sub_f32 v143, v143, v24
    v_sub_f32 v24, 0, v24
    v_exp_f32 v24, v24
    s_nop 0
    v_mul_f32 v15, v15, v24
    v_mul_f32 v64, v64, v24
    v_mul_f32 v65, v65, v24
    v_mul_f32 v66, v66, v24
    v_mul_f32 v67, v67, v24
    v_mul_f32 v68, v68, v24
    v_mul_f32 v69, v69, v24
    v_mul_f32 v70, v70, v24
    v_mul_f32 v71, v71, v24
    v_mul_f32 v72, v72, v24
    v_mul_f32 v73, v73, v24
    v_mul_f32 v74, v74, v24
    v_mul_f32 v75, v75, v24
    v_mul_f32 v76, v76, v24
    v_mul_f32 v77, v77, v24
    v_mul_f32 v78, v78, v24
    v_mul_f32 v79, v79, v24
    v_mul_f32 v80, v80, v24
    v_mul_f32 v81, v81, v24
    v_mul_f32 v82, v82, v24
    v_mul_f32 v83, v83, v24
    v_mul_f32 v84, v84, v24
    v_mul_f32 v85, v85, v24
    v_mul_f32 v86, v86, v24
    v_mul_f32 v87, v87, v24
    v_mul_f32 v88, v88, v24
    v_mul_f32 v89, v89, v24
    v_mul_f32 v90, v90, v24
    v_mul_f32 v91, v91, v24
    v_mul_f32 v92, v92, v24
    v_mul_f32 v93, v93, v24
    v_mul_f32 v94, v94, v24
    v_mul_f32 v95, v95, v24
    v_mul_f32 v96, v96, v24
    v_mul_f32 v97, v97, v24
    v_mul_f32 v98, v98, v24
    v_mul_f32 v99, v99, v24
    v_mul_f32 v100, v100, v24
    v_mul_f32 v101, v101, v24
    v_mul_f32 v102, v102, v24
    v_mul_f32 v103, v103, v24
    v_mul_f32 v104, v104, v24
    v_mul_f32 v105, v105, v24
    v_mul_f32 v106, v106, v24
    v_mul_f32 v107, v107, v24
    v_mul_f32 v108, v108, v24
    v_mul_f32 v109, v109, v24
    v_mul_f32 v110, v110, v24
    v_mul_f32 v111, v111, v24
    v_mul_f32 v112, v112, v24
    v_mul_f32 v113, v113, v24
    v_mul_f32 v114, v114, v24
    v_mul_f32 v115, v115, v24
    v_mul_f32 v116, v116, v24
    v_mul_f32 v117, v117, v24
    v_mul_f32 v118, v118, v24
    v_mul_f32 v119, v119, v24
    v_mul_f32 v120, v120, v24
    v_mul_f32 v121, v121, v24
    v_mul_f32 v122, v122, v24
    v_mul_f32 v123, v123, v24
    v_mul_f32 v124, v124, v24
    v_mul_f32 v125, v125, v24
    v_mul_f32 v126, v126, v24
    v_mul_f32 v127, v127, v24
    v_exp_f32 v24, v160
    v_exp_f32 v25, v161
    v_exp_f32 v26, v162
    v_exp_f32 v27, v163
    v_cvt_pk_bf16_f32 v184, v24, v25
    v_exp_f32 v28, v164
    v_exp_f32 v29, v165
    v_cvt_pk_bf16_f32 v185, v26, v27
    v_add_f32 v30, v24, v26
    v_add_f32 v31, v25, v27
    v_exp_f32 v24, v166
    v_exp_f32 v25, v167
    v_cvt_pk_bf16_f32 v186, v28, v29
    v_add_f32 v30, v30, v28
    v_add_f32 v31, v31, v29
    v_exp_f32 v26, v168
    v_exp_f32 v27, v169
    v_cvt_pk_bf16_f32 v187, v24, v25
    v_add_f32 v30, v30, v24
    v_add_f32 v31, v31, v25
    v_exp_f32 v28, v170
    v_exp_f32 v29, v171
    v_cvt_pk_bf16_f32 v188, v26, v27
    v_add_f32 v30, v30, v26
    v_add_f32 v31, v31, v27
    v_exp_f32 v24, v172
    v_exp_f32 v25, v173
    v_cvt_pk_bf16_f32 v189, v28, v29
    v_add_f32 v30, v30, v28
    v_add_f32 v31, v31, v29
    v_exp_f32 v26, v174
    v_exp_f32 v27, v175
    v_cvt_pk_bf16_f32 v190, v24, v25
    v_add_f32 v30, v30, v24
    v_add_f32 v31, v31, v25
    v_cvt_pk_bf16_f32 v191, v26, v27
    v_add_f32 v30, v30, v26
    v_add_f32 v31, v31, v27
    v_add_f32 v16, v30, v31
    s_nop 1
    s_branch A_RRET_9
A_MASK_10:
    s_nop 7
    s_sub_u32 s38, s54, s53
    s_lshl_b32 s38, s38, 5
    v_add_u32 v16, s38, v13
    v_cmp_le_i32 s[58:59], 0, v16
    v_cmp_le_i32 s[60:61], 1, v16
    v_cmp_le_i32 s[62:63], 2, v16
    v_cndmask_b32 v144, v14, v144, s[58:59]
    v_cndmask_b32 v145, v14, v145, s[60:61]
    v_cndmask_b32 v146, v14, v146, s[62:63]
    v_cmp_le_i32 s[58:59], 3, v16
    v_cmp_le_i32 s[60:61], 8, v16
    v_cmp_le_i32 s[62:63], 9, v16
    v_cndmask_b32 v147, v14, v147, s[58:59]
    v_cndmask_b32 v148, v14, v148, s[60:61]
    v_cndmask_b32 v149, v14, v149, s[62:63]
    v_cmp_le_i32 s[58:59], 10, v16
    v_cmp_le_i32 s[60:61], 11, v16
    v_cmp_le_i32 s[62:63], 16, v16
    v_cndmask_b32 v150, v14, v150, s[58:59]
    v_cndmask_b32 v151, v14, v151, s[60:61]
    v_cndmask_b32 v152, v14, v152, s[62:63]
    v_cmp_le_i32 s[58:59], 17, v16
    v_cmp_le_i32 s[60:61], 18, v16
    v_cmp_le_i32 s[62:63], 19, v16
    v_cndmask_b32 v153, v14, v153, s[58:59]
    v_cndmask_b32 v154, v14, v154, s[60:61]
    v_cndmask_b32 v155, v14, v155, s[62:63]
    v_cmp_le_i32 s[58:59], 24, v16
    v_cmp_le_i32 s[60:61], 25, v16
    v_cmp_le_i32 s[62:63], 26, v16
    v_cndmask_b32 v156, v14, v156, s[58:59]
    v_cndmask_b32 v157, v14, v157, s[60:61]
    v_cndmask_b32 v158, v14, v158, s[62:63]
    v_cmp_le_i32 s[58:59], 27, v16
    s_nop 1
    v_cndmask_b32 v159, v14, v159, s[58:59]
    s_branch A_MRET_11
A_RARE_12:
    s_nop 15
    v_max3_f32 v24, v144, v145, v146
    v_max3_f32 v25, v147, v148, v149
    v_max3_f32 v24, v24, v150, v151
    v_max3_f32 v25, v25, v152, v153
    v_max3_f32 v24, v24, v154, v155
    v_max3_f32 v25, v25, v156, v157
    v_max3_f32 v24, v24, v158, v159
    v_max_f32 v24, v24, v25
    v_mov_b32 v25, v24
    s_nop 1
    v_permlane32_swap_b32 v24, v25
    v_max_f32 v24, v24, v25
    v_max_f32 v24, 0, v24
    v_sub_f32 v144, v144, v24
    v_sub_f32 v160, v160, v24
    v_sub_f32 v128, v128, v24
    v_sub_f32 v145, v145, v24
    v_sub_f32 v161, v161, v24
    v_sub_f32 v129, v129, v24
    v_sub_f32 v146, v146, v24
    v_sub_f32 v162, v162, v24
    v_sub_f32 v130, v130, v24
    v_sub_f32 v147, v147, v24
    v_sub_f32 v163, v163, v24
    v_sub_f32 v131, v131, v24
    v_sub_f32 v148, v148, v24
    v_sub_f32 v164, v164, v24
    v_sub_f32 v132, v132, v24
    v_sub_f32 v149, v149, v24
    v_sub_f32 v165, v165, v24
    v_sub_f32 v133, v133, v24
    v_sub_f32 v150, v150, v24
    v_sub_f32 v166, v166, v24
    v_sub_f32 v134, v134, v24
    v_sub_f32 v151, v151, v24
    v_sub_f32 v167, v167, v24
    v_sub_f32 v135, v135, v24
    v_sub_f32 v152, v152, v24
    v_sub_f32 v168, v168, v24
    v_sub_f32 v136, v136, v24
    v_sub_f32 v153, v153, v24
    v_sub_f32 v169, v169, v24
    v_sub_f32 v137, v137, v24
    v_sub_f32 v154, v154, v24
    v_sub_f32 v170, v170, v24
    v_sub_f32 v138, v138, v24
    v_sub_f32 v155, v155, v24
    v_sub_f32 v171, v171, v24
    v_sub_f32 v139, v139, v24
    v_sub_f32 v156, v156, v24
    v_sub_f32 v172, v172, v24
    v_sub_f32 v140, v140, v24
    v_sub_f32 v157, v157, v24
    v_sub_f32 v173, v173, v24
    v_sub_f32 v141, v141, v24
    v_sub_f32 v158, v158, v24
    v_sub_f32 v174, v174, v24
    v_sub_f32 v142, v142, v24
    v_sub_f32 v159, v159, v24
    v_sub_f32 v175, v175, v24
    v_sub_f32 v143, v143, v24
    v_sub_f32 v24, 0, v24
    v_exp_f32 v24, v24
    s_nop 0
    v_mul_f32 v15, v15, v24
    v_mul_f32 v64, v64, v24
    v_mul_f32 v65, v65, v24
    v_mul_f32 v66, v66, v24
    v_mul_f32 v67, v67, v24
    v_mul_f32 v68, v68, v24
    v_mul_f32 v69, v69, v24
    v_mul_f32 v70, v70, v24
    v_mul_f32 v71, v71, v24
    v_mul_f32 v72, v72, v24
    v_mul_f32 v73, v73, v24
    v_mul_f32 v74, v74, v24
    v_mul_f32 v75, v75, v24
    v_mul_f32 v76, v76, v24
    v_mul_f32 v77, v77, v24
    v_mul_f32 v78, v78, v24
    v_mul_f32 v79, v79, v24
    v_mul_f32 v80, v80, v24
    v_mul_f32 v81, v81, v24
    v_mul_f32 v82, v82, v24
    v_mul_f32 v83, v83, v24
    v_mul_f32 v84, v84, v24
    v_mul_f32 v85, v85, v24
    v_mul_f32 v86, v86, v24
    v_mul_f32 v87, v87, v24
    v_mul_f32 v88, v88, v24
    v_mul_f32 v89, v89, v24
    v_mul_f32 v90, v90, v24
    v_mul_f32 v91, v91, v24
    v_mul_f32 v92, v92, v24
    v_mul_f32 v93, v93, v24
    v_mul_f32 v94, v94, v24
    v_mul_f32 v95, v95, v24
    v_mul_f32 v96, v96, v24
    v_mul_f32 v97, v97, v24
    v_mul_f32 v98, v98, v24
    v_mul_f32 v99, v99, v24
    v_mul_f32 v100, v100, v24
    v_mul_f32 v101, v101, v24
    v_mul_f32 v102, v102, v24
    v_mul_f32 v103, v103, v24
    v_mul_f32 v104, v104, v24
    v_mul_f32 v105, v105, v24
    v_mul_f32 v106, v106, v24
    v_mul_f32 v107, v107, v24
    v_mul_f32 v108, v108, v24
    v_mul_f32 v109, v109, v24
    v_mul_f32 v110, v110, v24
    v_mul_f32 v111, v111, v24
    v_mul_f32 v112, v112, v24
    v_mul_f32 v113, v113, v24
    v_mul_f32 v114, v114, v24
    v_mul_f32 v115, v115, v24
    v_mul_f32 v116, v116, v24
    v_mul_f32 v117, v117, v24
    v_mul_f32 v118, v118, v24
    v_mul_f32 v119, v119, v24
    v_mul_f32 v120, v120, v24
    v_mul_f32 v121, v121, v24
    v_mul_f32 v122, v122, v24
    v_mul_f32 v123, v123, v24
    v_mul_f32 v124, v124, v24
    v_mul_f32 v125, v125, v24
    v_mul_f32 v126, v126, v24
    v_mul_f32 v127, v127, v24
    v_exp_f32 v24, v144
    v_exp_f32 v25, v145
    v_exp_f32 v26, v146
    v_exp_f32 v27, v147
    v_cvt_pk_bf16_f32 v176, v24, v25
    v_exp_f32 v28, v148
    v_exp_f32 v29, v149
    v_cvt_pk_bf16_f32 v177, v26, v27
    v_add_f32 v30, v24, v26
    v_add_f32 v31, v25, v27
    v_exp_f32 v24, v150
    v_exp_f32 v25, v151
    v_cvt_pk_bf16_f32 v178, v28, v29
    v_add_f32 v30, v30, v28
    v_add_f32 v31, v31, v29
    v_exp_f32 v26, v152
    v_exp_f32 v27, v153
    v_cvt_pk_bf16_f32 v179, v24, v25
    v_add_f32 v30, v30, v24
    v_add_f32 v31, v31, v25
    v_exp_f32 v28, v154
    v_exp_f32 v29, v155
    v_cvt_pk_bf16_f32 v180, v26, v27
    v_add_f32 v30, v30, v26
    v_add_f32 v31, v31, v27
    v_exp_f32 v24, v156
    v_exp_f32 v25, v157
    v_cvt_pk_bf16_f32 v181, v28, v29
    v_add_f32 v30, v30, v28
    v_add_f32 v31, v31, v29
    v_exp_f32 v26, v158
    v_exp_f32 v27, v159
    v_cvt_pk_bf16_f32 v182, v24, v25
    v_add_f32 v30, v30, v24
    v_add_f32 v31, v31, v25
    v_cvt_pk_bf16_f32 v183, v26, v27
    v_add_f32 v30, v30, v26
    v_add_f32 v31, v31, v27
    v_add_f32 v16, v30, v31
    s_nop 1
    s_branch A_RRET_13
A_MASK_14:
    s_nop 7
    s_sub_u32 s38, s54, s53
    s_lshl_b32 s38, s38, 5
    v_add_u32 v16, s38, v13
    v_cmp_le_i32 s[58:59], 0, v16
    v_cmp_le_i32 s[60:61], 1, v16
    v_cmp_le_i32 s[62:63], 2, v16
    v_cndmask_b32 v160, v14, v160, s[58:59]
    v_cndmask_b32 v161, v14, v161, s[60:61]
    v_cndmask_b32 v162, v14, v162, s[62:63]
    v_cmp_le_i32 s[58:59], 3, v16
    v_cmp_le_i32 s[60:61], 8, v16
    v_cmp_le_i32 s[62:63], 9, v16
    v_cndmask_b32 v163, v14, v163, s[58:59]
    v_cndmask_b32 v164, v14, v164, s[60:61]
    v_cndmask_b32 v165, v14, v165, s[62:63]
    v_cmp_le_i32 s[58:59], 10, v16
    v_cmp_le_i32 s[60:61], 11, v16
    v_cmp_le_i32 s[62:63], 16, v16
    v_cndmask_b32 v166, v14, v166, s[58:59]
    v_cndmask_b32 v167, v14, v167, s[60:61]
    v_cndmask_b32 v168, v14, v168, s[62:63]
    v_cmp_le_i32 s[58:59], 17, v16
    v_cmp_le_i32 s[60:61], 18, v16
    v_cmp_le_i32 s[62:63], 19, v16
    v_cndmask_b32 v169, v14, v169, s[58:59]
    v_cndmask_b32 v170, v14, v170, s[60:61]
    v_cndmask_b32 v171, v14, v171, s[62:63]
    v_cmp_le_i32 s[58:59], 24, v16
    v_cmp_le_i32 s[60:61], 25, v16
    v_cmp_le_i32 s[62:63], 26, v16
    v_cndmask_b32 v172, v14, v172, s[58:59]
    v_cndmask_b32 v173, v14, v173, s[60:61]
    v_cndmask_b32 v174, v14, v174, s[62:63]
    v_cmp_le_i32 s[58:59], 27, v16
    s_nop 1
    v_cndmask_b32 v175, v14, v175, s[58:59]
    s_branch A_MRET_15
A_RARE_16:
    s_nop 15
    v_max3_f32 v24, v160, v161, v162
    v_max3_f32 v25, v163, v164, v165
    v_max3_f32 v24, v24, v166, v167
    v_max3_f32 v25, v25, v168, v169
    v_max3_f32 v24, v24, v170, v171
    v_max3_f32 v25, v25, v172, v173
    v_max3_f32 v24, v24, v174, v175
    v_max_f32 v24, v24, v25
    v_mov_b32 v25, v24
    s_nop 1
    v_permlane32_swap_b32 v24, v25
    v_max_f32 v24, v24, v25
    v_max_f32 v24, 0, v24
    v_sub_f32 v160, v160, v24
    v_sub_f32 v144, v144, v24
    v_sub_f32 v128, v128, v24
    v_sub_f32 v161, v161, v24
    v_sub_f32 v145, v145, v24
    v_sub_f32 v129, v129, v24
    v_sub_f32 v162, v162, v24
    v_sub_f32 v146, v146, v24
    v_sub_f32 v130, v130, v24
    v_sub_f32 v163, v163, v24
    v_sub_f32 v147, v147, v24
    v_sub_f32 v131, v131, v24
    v_sub_f32 v164, v164, v24
    v_sub_f32 v148, v148, v24
    v_sub_f32 v132, v132, v24
    v_sub_f32 v165, v165, v24
    v_sub_f32 v149, v149, v24
    v_sub_f32 v133, v133, v24
    v_sub_f32 v166, v166, v24
    v_sub_f32 v150, v150, v24
    v_sub_f32 v134, v134, v24
    v_sub_f32 v167, v167, v24
    v_sub_f32 v151, v151, v24
    v_sub_f32 v135, v135, v24
    v_sub_f32 v168, v168, v24
    v_sub_f32 v152, v152, v24
    v_sub_f32 v136, v136, v24
    v_sub_f32 v169, v169, v24
    v_sub_f32 v153, v153, v24
    v_sub_f32 v137, v137, v24
    v_sub_f32 v170, v170, v24
    v_sub_f32 v154, v154, v24
    v_sub_f32 v138, v138, v24
    v_sub_f32 v171, v171, v24
    v_sub_f32 v155, v155, v24
    v_sub_f32 v139, v139, v24
    v_sub_f32 v172, v172, v24
    v_sub_f32 v156, v156, v24
    v_sub_f32 v140, v140, v24
    v_sub_f32 v173, v173, v24
    v_sub_f32 v157, v157, v24
    v_sub_f32 v141, v141, v24
    v_sub_f32 v174, v174, v24
    v_sub_f32 v158, v158, v24
    v_sub_f32 v142, v142, v24
    v_sub_f32 v175, v175, v24
    v_sub_f32 v159, v159, v24
    v_sub_f32 v143, v143, v24
    v_sub_f32 v24, 0, v24
    v_exp_f32 v24, v24
    s_nop 0
    v_mul_f32 v15, v15, v24
    v_mul_f32 v64, v64, v24
    v_mul_f32 v65, v65, v24
    v_mul_f32 v66, v66, v24
    v_mul_f32 v67, v67, v24
    v_mul_f32 v68, v68, v24
    v_mul_f32 v69, v69, v24
    v_mul_f32 v70, v70, v24
    v_mul_f32 v71, v71, v24
    v_mul_f32 v72, v72, v24
    v_mul_f32 v73, v73, v24
    v_mul_f32 v74, v74, v24
    v_mul_f32 v75, v75, v24
    v_mul_f32 v76, v76, v24
    v_mul_f32 v77, v77, v24
    v_mul_f32 v78, v78, v24
    v_mul_f32 v79, v79, v24
    v_mul_f32 v80, v80, v24
    v_mul_f32 v81, v81, v24
    v_mul_f32 v82, v82, v24
    v_mul_f32 v83, v83, v24
    v_mul_f32 v84, v84, v24
    v_mul_f32 v85, v85, v24
    v_mul_f32 v86, v86, v24
    v_mul_f32 v87, v87, v24
    v_mul_f32 v88, v88, v24
    v_mul_f32 v89, v89, v24
    v_mul_f32 v90, v90, v24
    v_mul_f32 v91, v91, v24
    v_mul_f32 v92, v92, v24
    v_mul_f32 v93, v93, v24
    v_mul_f32 v94, v94, v24
    v_mul_f32 v95, v95, v24
    v_mul_f32 v96, v96, v24
    v_mul_f32 v97, v97, v24
    v_mul_f32 v98, v98, v24
    v_mul_f32 v99, v99, v24
    v_mul_f32 v100, v100, v24
    v_mul_f32 v101, v101, v24
    v_mul_f32 v102, v102, v24
    v_mul_f32 v103, v103, v24
    v_mul_f32 v104, v104, v24
    v_mul_f32 v105, v105, v24
    v_mul_f32 v106, v106, v24
    v_mul_f32 v107, v107, v24
    v_mul_f32 v108, v108, v24
    v_mul_f32 v109, v109, v24
    v_mul_f32 v110, v110, v24
    v_mul_f32 v111, v111, v24
    v_mul_f32 v112, v112, v24
    v_mul_f32 v113, v113, v24
    v_mul_f32 v114, v114, v24
    v_mul_f32 v115, v115, v24
    v_mul_f32 v116, v116, v24
    v_mul_f32 v117, v117, v24
    v_mul_f32 v118, v118, v24
    v_mul_f32 v119, v119, v24
    v_mul_f32 v120, v120, v24
    v_mul_f32 v121, v121, v24
    v_mul_f32 v122, v122, v24
    v_mul_f32 v123, v123, v24
    v_mul_f32 v124, v124, v24
    v_mul_f32 v125, v125, v24
    v_mul_f32 v126, v126, v24
    v_mul_f32 v127, v127, v24
    v_exp_f32 v24, v160
    v_exp_f32 v25, v161
    v_exp_f32 v26, v162
    v_exp_f32 v27, v163
    v_cvt_pk_bf16_f32 v184, v24, v25
    v_exp_f32 v28, v164
    v_exp_f32 v29, v165
    v_cvt_pk_bf16_f32 v185, v26, v27
    v_add_f32 v30, v24, v26
    v_add_f32 v31, v25, v27
    v_exp_f32 v24, v166
    v_exp_f32 v25, v167
    v_cvt_pk_bf16_f32 v186, v28, v29
    v_add_f32 v30, v30, v28
    v_add_f32 v31, v31, v29
    v_exp_f32 v26, v168
    v_exp_f32 v27, v169
    v_cvt_pk_bf16_f32 v187, v24, v25
    v_add_f32 v30, v30, v24
    v_add_f32 v31, v31, v25
    v_exp_f32 v28, v170
    v_exp_f32 v29, v171
    v_cvt_pk_bf16_f32 v188, v26, v27
    v_add_f32 v30, v30, v26
    v_add_f32 v31, v31, v27
    v_exp_f32 v24, v172
    v_exp_f32 v25, v173
    v_cvt_pk_bf16_f32 v189, v28, v29
    v_add_f32 v30, v30, v28
    v_add_f32 v31, v31, v29
    v_exp_f32 v26, v174
    v_exp_f32 v27, v175
    v_cvt_pk_bf16_f32 v190, v24, v25
    v_add_f32 v30, v30, v24
    v_add_f32 v31, v31, v25
    v_cvt_pk_bf16_f32 v191, v26, v27
    v_add_f32 v30, v30, v26
    v_add_f32 v31, v31, v27
    v_add_f32 v16, v30, v31
    s_nop 1
    s_branch A_RRET_17
A_MASK_18:
    s_nop 7
    s_sub_u32 s38, s54, s53
    s_lshl_b32 s38, s38, 5
    v_add_u32 v16, s38, v13
    v_cmp_le_i32 s[58:59], 0, v16
    v_cmp_le_i32 s[60:61], 1, v16
    v_cmp_le_i32 s[62:63], 2, v16
    v_cndmask_b32 v144, v14, v144, s[58:59]
    v_cndmask_b32 v145, v14, v145, s[60:61]
    v_cndmask_b32 v146, v14, v146, s[62:63]
    v_cmp_le_i32 s[58:59], 3, v16
    v_cmp_le_i32 s[60:61], 8, v16
    v_cmp_le_i32 s[62:63], 9, v16
    v_cndmask_b32 v147, v14, v147, s[58:59]
    v_cndmask_b32 v148, v14, v148, s[60:61]
    v_cndmask_b32 v149, v14, v149, s[62:63]
    v_cmp_le_i32 s[58:59], 10, v16
    v_cmp_le_i32 s[60:61], 11, v16
    v_cmp_le_i32 s[62:63], 16, v16
    v_cndmask_b32 v150, v14, v150, s[58:59]
    v_cndmask_b32 v151, v14, v151, s[60:61]
    v_cndmask_b32 v152, v14, v152, s[62:63]
    v_cmp_le_i32 s[58:59], 17, v16
    v_cmp_le_i32 s[60:61], 18, v16
    v_cmp_le_i32 s[62:63], 19, v16
    v_cndmask_b32 v153, v14, v153, s[58:59]
    v_cndmask_b32 v154, v14, v154, s[60:61]
    v_cndmask_b32 v155, v14, v155, s[62:63]
    v_cmp_le_i32 s[58:59], 24, v16
    v_cmp_le_i32 s[60:61], 25, v16
    v_cmp_le_i32 s[62:63], 26, v16
    v_cndmask_b32 v156, v14, v156, s[58:59]
    v_cndmask_b32 v157, v14, v157, s[60:61]
    v_cndmask_b32 v158, v14, v158, s[62:63]
    v_cmp_le_i32 s[58:59], 27, v16
    s_nop 1
    v_cndmask_b32 v159, v14, v159, s[58:59]
    s_branch A_MRET_19
A_RARE_21:
    s_nop 15
    v_max3_f32 v24, v144, v145, v146
    v_max3_f32 v25, v147, v148, v149
    v_max3_f32 v24, v24, v150, v151
    v_max3_f32 v25, v25, v152, v153
    v_max3_f32 v24, v24, v154, v155
    v_max3_f32 v25, v25, v156, v157
    v_max3_f32 v24, v24, v158, v159
    v_max_f32 v24, v24, v25
    v_mov_b32 v25, v24
    s_nop 1
    v_permlane32_swap_b32 v24, v25
    v_max_f32 v24, v24, v25
    v_max_f32 v24, 0, v24
    v_sub_f32 v144, v144, v24
    v_sub_f32 v160, v160, v24
    v_sub_f32 v128, v128, v24
    v_sub_f32 v145, v145, v24
    v_sub_f32 v161, v161, v24
    v_sub_f32 v129, v129, v24
    v_sub_f32 v146, v146, v24
    v_sub_f32 v162, v162, v24
    v_sub_f32 v130, v130, v24
    v_sub_f32 v147, v147, v24
    v_sub_f32 v163, v163, v24
    v_sub_f32 v131, v131, v24
    v_sub_f32 v148, v148, v24
    v_sub_f32 v164, v164, v24
    v_sub_f32 v132, v132, v24
    v_sub_f32 v149, v149, v24
    v_sub_f32 v165, v165, v24
    v_sub_f32 v133, v133, v24
    v_sub_f32 v150, v150, v24
    v_sub_f32 v166, v166, v24
    v_sub_f32 v134, v134, v24
    v_sub_f32 v151, v151, v24
    v_sub_f32 v167, v167, v24
    v_sub_f32 v135, v135, v24
    v_sub_f32 v152, v152, v24
    v_sub_f32 v168, v168, v24
    v_sub_f32 v136, v136, v24
    v_sub_f32 v153, v153, v24
    v_sub_f32 v169, v169, v24
    v_sub_f32 v137, v137, v24
    v_sub_f32 v154, v154, v24
    v_sub_f32 v170, v170, v24
    v_sub_f32 v138, v138, v24
    v_sub_f32 v155, v155, v24
    v_sub_f32 v171, v171, v24
    v_sub_f32 v139, v139, v24
    v_sub_f32 v156, v156, v24
    v_sub_f32 v172, v172, v24
    v_sub_f32 v140, v140, v24
    v_sub_f32 v157, v157, v24
    v_sub_f32 v173, v173, v24
    v_sub_f32 v141, v141, v24
    v_sub_f32 v158, v158, v24
    v_sub_f32 v174, v174, v24
    v_sub_f32 v142, v142, v24
    v_sub_f32 v159, v159, v24
    v_sub_f32 v175, v175, v24
    v_sub_f32 v143, v143, v24
    v_sub_f32 v24, 0, v24
    v_exp_f32 v24, v24
    s_nop 0
    v_mul_f32 v15, v15, v24
    v_mul_f32 v64, v64, v24
    v_mul_f32 v65, v65, v24
    v_mul_f32 v66, v66, v24
    v_mul_f32 v67, v67, v24
    v_mul_f32 v68, v68, v24
    v_mul_f32 v69, v69, v24
    v_mul_f32 v70, v70, v24
    v_mul_f32 v71, v71, v24
    v_mul_f32 v72, v72, v24
    v_mul_f32 v73, v73, v24
    v_mul_f32 v74, v74, v24
    v_mul_f32 v75, v75, v24
    v_mul_f32 v76, v76, v24
    v_mul_f32 v77, v77, v24
    v_mul_f32 v78, v78, v24
    v_mul_f32 v79, v79, v24
    v_mul_f32 v80, v80, v24
    v_mul_f32 v81, v81, v24
    v_mul_f32 v82, v82, v24
    v_mul_f32 v83, v83, v24
    v_mul_f32 v84, v84, v24
    v_mul_f32 v85, v85, v24
    v_mul_f32 v86, v86, v24
    v_mul_f32 v87, v87, v24
    v_mul_f32 v88, v88, v24
    v_mul_f32 v89, v89, v24
    v_mul_f32 v90, v90, v24
    v_mul_f32 v91, v91, v24
    v_mul_f32 v92, v92, v24
    v_mul_f32 v93, v93, v24
    v_mul_f32 v94, v94, v24
    v_mul_f32 v95, v95, v24
    v_mul_f32 v96, v96, v24
    v_mul_f32 v97, v97, v24
    v_mul_f32 v98, v98, v24
    v_mul_f32 v99, v99, v24
    v_mul_f32 v100, v100, v24
    v_mul_f32 v101, v101, v24
    v_mul_f32 v102, v102, v24
    v_mul_f32 v103, v103, v24
    v_mul_f32 v104, v104, v24
    v_mul_f32 v105, v105, v24
    v_mul_f32 v106, v106, v24
    v_mul_f32 v107, v107, v24
    v_mul_f32 v108, v108, v24
    v_mul_f32 v109, v109, v24
    v_mul_f32 v110, v110, v24
    v_mul_f32 v111, v111, v24
    v_mul_f32 v112, v112, v24
    v_mul_f32 v113, v113, v24
    v_mul_f32 v114, v114, v24
    v_mul_f32 v115, v115, v24
    v_mul_f32 v116, v116, v24
    v_mul_f32 v117, v117, v24
    v_mul_f32 v118, v118, v24
    v_mul_f32 v119, v119, v24
    v_mul_f32 v120, v120, v24
    v_mul_f32 v121, v121, v24
    v_mul_f32 v122, v122, v24
    v_mul_f32 v123, v123, v24
    v_mul_f32 v124, v124, v24
    v_mul_f32 v125, v125, v24
    v_mul_f32 v126, v126, v24
    v_mul_f32 v127, v127, v24
    v_exp_f32 v24, v144
    v_exp_f32 v25, v145
    v_exp_f32 v26, v146
    v_exp_f32 v27, v147
    v_cvt_pk_bf16_f32 v176, v24, v25
    v_exp_f32 v28, v148
    v_exp_f32 v29, v149
    v_cvt_pk_bf16_f32 v177, v26, v27
    v_add_f32 v30, v24, v26
    v_add_f32 v31, v25, v27
    v_exp_f32 v24, v150
    v_exp_f32 v25, v151
    v_cvt_pk_bf16_f32 v178, v28, v29
    v_add_f32 v30, v30, v28
    v_add_f32 v31, v31, v29
    v_exp_f32 v26, v152
    v_exp_f32 v27, v153
    v_cvt_pk_bf16_f32 v179, v24, v25
    v_add_f32 v30, v30, v24
    v_add_f32 v31, v31, v25
    v_exp_f32 v28, v154
    v_exp_f32 v29, v155
    v_cvt_pk_bf16_f32 v180, v26, v27
    v_add_f32 v30, v30, v26
    v_add_f32 v31, v31, v27
    v_exp_f32 v24, v156
    v_exp_f32 v25, v157
    v_cvt_pk_bf16_f32 v181, v28, v29
    v_add_f32 v30, v30, v28
    v_add_f32 v31, v31, v29
    v_exp_f32 v26, v158
    v_exp_f32 v27, v159
    v_cvt_pk_bf16_f32 v182, v24, v25
    v_add_f32 v30, v30, v24
    v_add_f32 v31, v31, v25
    v_cvt_pk_bf16_f32 v183, v26, v27
    v_add_f32 v30, v30, v26
    v_add_f32 v31, v31, v27
    v_add_f32 v16, v30, v31
    s_nop 1
    s_branch A_RRET_22
A_MASK_23:
    s_nop 7
    s_sub_u32 s38, s54, s53
    s_lshl_b32 s38, s38, 5
    v_add_u32 v16, s38, v13
    v_cmp_le_i32 s[58:59], 0, v16
    v_cmp_le_i32 s[60:61], 1, v16
    v_cmp_le_i32 s[62:63], 2, v16
    v_cndmask_b32 v160, v14, v160, s[58:59]
    v_cndmask_b32 v161, v14, v161, s[60:61]
    v_cndmask_b32 v162, v14, v162, s[62:63]
    v_cmp_le_i32 s[58:59], 3, v16
    v_cmp_le_i32 s[60:61], 8, v16
    v_cmp_le_i32 s[62:63], 9, v16
    v_cndmask_b32 v163, v14, v163, s[58:59]
    v_cndmask_b32 v164, v14, v164, s[60:61]
    v_cndmask_b32 v165, v14, v165, s[62:63]
    v_cmp_le_i32 s[58:59], 10, v16
    v_cmp_le_i32 s[60:61], 11, v16
    v_cmp_le_i32 s[62:63], 16, v16
    v_cndmask_b32 v166, v14, v166, s[58:59]
    v_cndmask_b32 v167, v14, v167, s[60:61]
    v_cndmask_b32 v168, v14, v168, s[62:63]
    v_cmp_le_i32 s[58:59], 17, v16
    v_cmp_le_i32 s[60:61], 18, v16
    v_cmp_le_i32 s[62:63], 19, v16
    v_cndmask_b32 v169, v14, v169, s[58:59]
    v_cndmask_b32 v170, v14, v170, s[60:61]
    v_cndmask_b32 v171, v14, v171, s[62:63]
    v_cmp_le_i32 s[58:59], 24, v16
    v_cmp_le_i32 s[60:61], 25, v16
    v_cmp_le_i32 s[62:63], 26, v16
    v_cndmask_b32 v172, v14, v172, s[58:59]
    v_cndmask_b32 v173, v14, v173, s[60:61]
    v_cndmask_b32 v174, v14, v174, s[62:63]
    v_cmp_le_i32 s[58:59], 27, v16
    s_nop 1
    v_cndmask_b32 v175, v14, v175, s[58:59]
    s_branch A_MRET_24
A_RARE_25:
    s_nop 15
    v_max3_f32 v24, v160, v161, v162
    v_max3_f32 v25, v163, v164, v165
    v_max3_f32 v24, v24, v166, v167
    v_max3_f32 v25, v25, v168, v169
    v_max3_f32 v24, v24, v170, v171
    v_max3_f32 v25, v25, v172, v173
    v_max3_f32 v24, v24, v174, v175
    v_max_f32 v24, v24, v25
    v_mov_b32 v25, v24
    s_nop 1
    v_permlane32_swap_b32 v24, v25
    v_max_f32 v24, v24, v25
    v_max_f32 v24, 0, v24
    v_sub_f32 v160, v160, v24
    v_sub_f32 v144, v144, v24
    v_sub_f32 v128, v128, v24
    v_sub_f32 v161, v161, v24
    v_sub_f32 v145, v145, v24
    v_sub_f32 v129, v129, v24
    v_sub_f32 v162, v162, v24
    v_sub_f32 v146, v146, v24
    v_sub_f32 v130, v130, v24
    v_sub_f32 v163, v163, v24
    v_sub_f32 v147, v147, v24
    v_sub_f32 v131, v131, v24
    v_sub_f32 v164, v164, v24
    v_sub_f32 v148, v148, v24
    v_sub_f32 v132, v132, v24
    v_sub_f32 v165, v165, v24
    v_sub_f32 v149, v149, v24
    v_sub_f32 v133, v133, v24
    v_sub_f32 v166, v166, v24
    v_sub_f32 v150, v150, v24
    v_sub_f32 v134, v134, v24
    v_sub_f32 v167, v167, v24
    v_sub_f32 v151, v151, v24
    v_sub_f32 v135, v135, v24
    v_sub_f32 v168, v168, v24
    v_sub_f32 v152, v152, v24
    v_sub_f32 v136, v136, v24
    v_sub_f32 v169, v169, v24
    v_sub_f32 v153, v153, v24
    v_sub_f32 v137, v137, v24
    v_sub_f32 v170, v170, v24
    v_sub_f32 v154, v154, v24
    v_sub_f32 v138, v138, v24
    v_sub_f32 v171, v171, v24
    v_sub_f32 v155, v155, v24
    v_sub_f32 v139, v139, v24
    v_sub_f32 v172, v172, v24
    v_sub_f32 v156, v156, v24
    v_sub_f32 v140, v140, v24
    v_sub_f32 v173, v173, v24
    v_sub_f32 v157, v157, v24
    v_sub_f32 v141, v141, v24
    v_sub_f32 v174, v174, v24
    v_sub_f32 v158, v158, v24
    v_sub_f32 v142, v142, v24
    v_sub_f32 v175, v175, v24
    v_sub_f32 v159, v159, v24
    v_sub_f32 v143, v143, v24
    v_sub_f32 v24, 0, v24
    v_exp_f32 v24, v24
    s_nop 0
    v_mul_f32 v15, v15, v24
    v_mul_f32 v64, v64, v24
    v_mul_f32 v65, v65, v24
    v_mul_f32 v66, v66, v24
    v_mul_f32 v67, v67, v24
    v_mul_f32 v68, v68, v24
    v_mul_f32 v69, v69, v24
    v_mul_f32 v70, v70, v24
    v_mul_f32 v71, v71, v24
    v_mul_f32 v72, v72, v24
    v_mul_f32 v73, v73, v24
    v_mul_f32 v74, v74, v24
    v_mul_f32 v75, v75, v24
    v_mul_f32 v76, v76, v24
    v_mul_f32 v77, v77, v24
    v_mul_f32 v78, v78, v24
    v_mul_f32 v79, v79, v24
    v_mul_f32 v80, v80, v24
    v_mul_f32 v81, v81, v24
    v_mul_f32 v82, v82, v24
    v_mul_f32 v83, v83, v24
    v_mul_f32 v84, v84, v24
    v_mul_f32 v85, v85, v24
    v_mul_f32 v86, v86, v24
    v_mul_f32 v87, v87, v24
    v_mul_f32 v88, v88, v24
    v_mul_f32 v89, v89, v24
    v_mul_f32 v90, v90, v24
    v_mul_f32 v91, v91, v24
    v_mul_f32 v92, v92, v24
    v_mul_f32 v93, v93, v24
    v_mul_f32 v94, v94, v24
    v_mul_f32 v95, v95, v24
    v_mul_f32 v96, v96, v24
    v_mul_f32 v97, v97, v24
    v_mul_f32 v98, v98, v24
    v_mul_f32 v99, v99, v24
    v_mul_f32 v100, v100, v24
    v_mul_f32 v101, v101, v24
    v_mul_f32 v102, v102, v24
    v_mul_f32 v103, v103, v24
    v_mul_f32 v104, v104, v24
    v_mul_f32 v105, v105, v24
    v_mul_f32 v106, v106, v24
    v_mul_f32 v107, v107, v24
    v_mul_f32 v108, v108, v24
    v_mul_f32 v109, v109, v24
    v_mul_f32 v110, v110, v24
    v_mul_f32 v111, v111, v24
    v_mul_f32 v112, v112, v24
    v_mul_f32 v113, v113, v24
    v_mul_f32 v114, v114, v24
    v_mul_f32 v115, v115, v24
    v_mul_f32 v116, v116, v24
    v_mul_f32 v117, v117, v24
    v_mul_f32 v118, v118, v24
    v_mul_f32 v119, v119, v24
    v_mul_f32 v120, v120, v24
    v_mul_f32 v121, v121, v24
    v_mul_f32 v122, v122, v24
    v_mul_f32 v123, v123, v24
    v_mul_f32 v124, v124, v24
    v_mul_f32 v125, v125, v24
    v_mul_f32 v126, v126, v24
    v_mul_f32 v127, v127, v24
    v_exp_f32 v24, v160
    v_exp_f32 v25, v161
    v_exp_f32 v26, v162
    v_exp_f32 v27, v163
    v_cvt_pk_bf16_f32 v184, v24, v25
    v_exp_f32 v28, v164
    v_exp_f32 v29, v165
    v_cvt_pk_bf16_f32 v185, v26, v27
    v_add_f32 v30, v24, v26
    v_add_f32 v31, v25, v27
    v_exp_f32 v24, v166
    v_exp_f32 v25, v167
    v_cvt_pk_bf16_f32 v186, v28, v29
    v_add_f32 v30, v30, v28
    v_add_f32 v31, v31, v29
    v_exp_f32 v26, v168
    v_exp_f32 v27, v169
    v_cvt_pk_bf16_f32 v187, v24, v25
    v_add_f32 v30, v30, v24
    v_add_f32 v31, v31, v25
    v_exp_f32 v28, v170
    v_exp_f32 v29, v171
    v_cvt_pk_bf16_f32 v188, v26, v27
    v_add_f32 v30, v30, v26
    v_add_f32 v31, v31, v27
    v_exp_f32 v24, v172
    v_exp_f32 v25, v173
    v_cvt_pk_bf16_f32 v189, v28, v29
    v_add_f32 v30, v30, v28
    v_add_f32 v31, v31, v29
    v_exp_f32 v26, v174
    v_exp_f32 v27, v175
    v_cvt_pk_bf16_f32 v190, v24, v25
    v_add_f32 v30, v30, v24
    v_add_f32 v31, v31, v25
    v_cvt_pk_bf16_f32 v191, v26, v27
    v_add_f32 v30, v30, v26
    v_add_f32 v31, v31, v27
    v_add_f32 v16, v30, v31
    s_nop 1
    s_branch A_RRET_26
A_MASK_27:
    s_nop 7
    s_sub_u32 s38, s54, s53
    s_lshl_b32 s38, s38, 5
    v_add_u32 v16, s38, v13
    v_cmp_le_i32 s[58:59], 0, v16
    v_cmp_le_i32 s[60:61], 1, v16
    v_cmp_le_i32 s[62:63], 2, v16
    v_cndmask_b32 v144, v14, v144, s[58:59]
    v_cndmask_b32 v145, v14, v145, s[60:61]
    v_cndmask_b32 v146, v14, v146, s[62:63]
    v_cmp_le_i32 s[58:59], 3, v16
    v_cmp_le_i32 s[60:61], 8, v16
    v_cmp_le_i32 s[62:63], 9, v16
    v_cndmask_b32 v147, v14, v147, s[58:59]
    v_cndmask_b32 v148, v14, v148, s[60:61]
    v_cndmask_b32 v149, v14, v149, s[62:63]
    v_cmp_le_i32 s[58:59], 10, v16
    v_cmp_le_i32 s[60:61], 11, v16
    v_cmp_le_i32 s[62:63], 16, v16
    v_cndmask_b32 v150, v14, v150, s[58:59]
    v_cndmask_b32 v151, v14, v151, s[60:61]
    v_cndmask_b32 v152, v14, v152, s[62:63]
    v_cmp_le_i32 s[58:59], 17, v16
    v_cmp_le_i32 s[60:61], 18, v16
    v_cmp_le_i32 s[62:63], 19, v16
    v_cndmask_b32 v153, v14, v153, s[58:59]
    v_cndmask_b32 v154, v14, v154, s[60:61]
    v_cndmask_b32 v155, v14, v155, s[62:63]
    v_cmp_le_i32 s[58:59], 24, v16
    v_cmp_le_i32 s[60:61], 25, v16
    v_cmp_le_i32 s[62:63], 26, v16
    v_cndmask_b32 v156, v14, v156, s[58:59]
    v_cndmask_b32 v157, v14, v157, s[60:61]
    v_cndmask_b32 v158, v14, v158, s[62:63]
    v_cmp_le_i32 s[58:59], 27, v16
    s_nop 1
    v_cndmask_b32 v159, v14, v159, s[58:59]
    s_branch A_MRET_28
A_RARE_29:
    s_nop 15
    v_max3_f32 v24, v144, v145, v146
    v_max3_f32 v25, v147, v148, v149
    v_max3_f32 v24, v24, v150, v151
    v_max3_f32 v25, v25, v152, v153
    v_max3_f32 v24, v24, v154, v155
    v_max3_f32 v25, v25, v156, v157
    v_max3_f32 v24, v24, v158, v159
    v_max_f32 v24, v24, v25
    v_mov_b32 v25, v24
    s_nop 1
    v_permlane32_swap_b32 v24, v25
    v_max_f32 v24, v24, v25
    v_max_f32 v24, 0, v24
    v_sub_f32 v144, v144, v24
    v_sub_f32 v160, v160, v24
    v_sub_f32 v128, v128, v24
    v_sub_f32 v145, v145, v24
    v_sub_f32 v161, v161, v24
    v_sub_f32 v129, v129, v24
    v_sub_f32 v146, v146, v24
    v_sub_f32 v162, v162, v24
    v_sub_f32 v130, v130, v24
    v_sub_f32 v147, v147, v24
    v_sub_f32 v163, v163, v24
    v_sub_f32 v131, v131, v24
    v_sub_f32 v148, v148, v24
    v_sub_f32 v164, v164, v24
    v_sub_f32 v132, v132, v24
    v_sub_f32 v149, v149, v24
    v_sub_f32 v165, v165, v24
    v_sub_f32 v133, v133, v24
    v_sub_f32 v150, v150, v24
    v_sub_f32 v166, v166, v24
    v_sub_f32 v134, v134, v24
    v_sub_f32 v151, v151, v24
    v_sub_f32 v167, v167, v24
    v_sub_f32 v135, v135, v24
    v_sub_f32 v152, v152, v24
    v_sub_f32 v168, v168, v24
    v_sub_f32 v136, v136, v24
    v_sub_f32 v153, v153, v24
    v_sub_f32 v169, v169, v24
    v_sub_f32 v137, v137, v24
    v_sub_f32 v154, v154, v24
    v_sub_f32 v170, v170, v24
    v_sub_f32 v138, v138, v24
    v_sub_f32 v155, v155, v24
    v_sub_f32 v171, v171, v24
    v_sub_f32 v139, v139, v24
    v_sub_f32 v156, v156, v24
    v_sub_f32 v172, v172, v24
    v_sub_f32 v140, v140, v24
    v_sub_f32 v157, v157, v24
    v_sub_f32 v173, v173, v24
    v_sub_f32 v141, v141, v24
    v_sub_f32 v158, v158, v24
    v_sub_f32 v174, v174, v24
    v_sub_f32 v142, v142, v24
    v_sub_f32 v159, v159, v24
    v_sub_f32 v175, v175, v24
    v_sub_f32 v143, v143, v24
    v_sub_f32 v24, 0, v24
    v_exp_f32 v24, v24
    s_nop 0
    v_mul_f32 v15, v15, v24
    v_mul_f32 v64, v64, v24
    v_mul_f32 v65, v65, v24
    v_mul_f32 v66, v66, v24
    v_mul_f32 v67, v67, v24
    v_mul_f32 v68, v68, v24
    v_mul_f32 v69, v69, v24
    v_mul_f32 v70, v70, v24
    v_mul_f32 v71, v71, v24
    v_mul_f32 v72, v72, v24
    v_mul_f32 v73, v73, v24
    v_mul_f32 v74, v74, v24
    v_mul_f32 v75, v75, v24
    v_mul_f32 v76, v76, v24
    v_mul_f32 v77, v77, v24
    v_mul_f32 v78, v78, v24
    v_mul_f32 v79, v79, v24
    v_mul_f32 v80, v80, v24
    v_mul_f32 v81, v81, v24
    v_mul_f32 v82, v82, v24
    v_mul_f32 v83, v83, v24
    v_mul_f32 v84, v84, v24
    v_mul_f32 v85, v85, v24
    v_mul_f32 v86, v86, v24
    v_mul_f32 v87, v87, v24
    v_mul_f32 v88, v88, v24
    v_mul_f32 v89, v89, v24
    v_mul_f32 v90, v90, v24
    v_mul_f32 v91, v91, v24
    v_mul_f32 v92, v92, v24
    v_mul_f32 v93, v93, v24
    v_mul_f32 v94, v94, v24
    v_mul_f32 v95, v95, v24
    v_mul_f32 v96, v96, v24
    v_mul_f32 v97, v97, v24
    v_mul_f32 v98, v98, v24
    v_mul_f32 v99, v99, v24
    v_mul_f32 v100, v100, v24
    v_mul_f32 v101, v101, v24
    v_mul_f32 v102, v102, v24
    v_mul_f32 v103, v103, v24
    v_mul_f32 v104, v104, v24
    v_mul_f32 v105, v105, v24
    v_mul_f32 v106, v106, v24
    v_mul_f32 v107, v107, v24
    v_mul_f32 v108, v108, v24
    v_mul_f32 v109, v109, v24
    v_mul_f32 v110, v110, v24
    v_mul_f32 v111, v111, v24
    v_mul_f32 v112, v112, v24
    v_mul_f32 v113, v113, v24
    v_mul_f32 v114, v114, v24
    v_mul_f32 v115, v115, v24
    v_mul_f32 v116, v116, v24
    v_mul_f32 v117, v117, v24
    v_mul_f32 v118, v118, v24
    v_mul_f32 v119, v119, v24
    v_mul_f32 v120, v120, v24
    v_mul_f32 v121, v121, v24
    v_mul_f32 v122, v122, v24
    v_mul_f32 v123, v123, v24
    v_mul_f32 v124, v124, v24
    v_mul_f32 v125, v125, v24
    v_mul_f32 v126, v126, v24
    v_mul_f32 v127, v127, v24
    v_exp_f32 v24, v144
    v_exp_f32 v25, v145
    v_exp_f32 v26, v146
    v_exp_f32 v27, v147
    v_cvt_pk_bf16_f32 v176, v24, v25
    v_exp_f32 v28, v148
    v_exp_f32 v29, v149
    v_cvt_pk_bf16_f32 v177, v26, v27
    v_add_f32 v30, v24, v26
    v_add_f32 v31, v25, v27
    v_exp_f32 v24, v150
    v_exp_f32 v25, v151
    v_cvt_pk_bf16_f32 v178, v28, v29
    v_add_f32 v30, v30, v28
    v_add_f32 v31, v31, v29
    v_exp_f32 v26, v152
    v_exp_f32 v27, v153
    v_cvt_pk_bf16_f32 v179, v24, v25
    v_add_f32 v30, v30, v24
    v_add_f32 v31, v31, v25
    v_exp_f32 v28, v154
    v_exp_f32 v29, v155
    v_cvt_pk_bf16_f32 v180, v26, v27
    v_add_f32 v30, v30, v26
    v_add_f32 v31, v31, v27
    v_exp_f32 v24, v156
    v_exp_f32 v25, v157
    v_cvt_pk_bf16_f32 v181, v28, v29
    v_add_f32 v30, v30, v28
    v_add_f32 v31, v31, v29
    v_exp_f32 v26, v158
    v_exp_f32 v27, v159
    v_cvt_pk_bf16_f32 v182, v24, v25
    v_add_f32 v30, v30, v24
    v_add_f32 v31, v31, v25
    v_cvt_pk_bf16_f32 v183, v26, v27
    v_add_f32 v30, v30, v26
    v_add_f32 v31, v31, v27
    v_add_f32 v16, v30, v31
    s_nop 1
    s_branch A_RRET_30
A_MASK_31:
    s_nop 7
    s_sub_u32 s38, s54, s53
    s_lshl_b32 s38, s38, 5
    v_add_u32 v16, s38, v13
    v_cmp_le_i32 s[58:59], 0, v16
    v_cmp_le_i32 s[60:61], 1, v16
    v_cmp_le_i32 s[62:63], 2, v16
    v_cndmask_b32 v160, v14, v160, s[58:59]
    v_cndmask_b32 v161, v14, v161, s[60:61]
    v_cndmask_b32 v162, v14, v162, s[62:63]
    v_cmp_le_i32 s[58:59], 3, v16
    v_cmp_le_i32 s[60:61], 8, v16
    v_cmp_le_i32 s[62:63], 9, v16
    v_cndmask_b32 v163, v14, v163, s[58:59]
    v_cndmask_b32 v164, v14, v164, s[60:61]
    v_cndmask_b32 v165, v14, v165, s[62:63]
    v_cmp_le_i32 s[58:59], 10, v16
    v_cmp_le_i32 s[60:61], 11, v16
    v_cmp_le_i32 s[62:63], 16, v16
    v_cndmask_b32 v166, v14, v166, s[58:59]
    v_cndmask_b32 v167, v14, v167, s[60:61]
    v_cndmask_b32 v168, v14, v168, s[62:63]
    v_cmp_le_i32 s[58:59], 17, v16
    v_cmp_le_i32 s[60:61], 18, v16
    v_cmp_le_i32 s[62:63], 19, v16
    v_cndmask_b32 v169, v14, v169, s[58:59]
    v_cndmask_b32 v170, v14, v170, s[60:61]
    v_cndmask_b32 v171, v14, v171, s[62:63]
    v_cmp_le_i32 s[58:59], 24, v16
    v_cmp_le_i32 s[60:61], 25, v16
    v_cmp_le_i32 s[62:63], 26, v16
    v_cndmask_b32 v172, v14, v172, s[58:59]
    v_cndmask_b32 v173, v14, v173, s[60:61]
    v_cndmask_b32 v174, v14, v174, s[62:63]
    v_cmp_le_i32 s[58:59], 27, v16
    s_nop 1
    v_cndmask_b32 v175, v14, v175, s[58:59]
    s_branch A_MRET_32
A_RARE_33:
    s_nop 15
    v_max3_f32 v24, v160, v161, v162
    v_max3_f32 v25, v163, v164, v165
    v_max3_f32 v24, v24, v166, v167
    v_max3_f32 v25, v25, v168, v169
    v_max3_f32 v24, v24, v170, v171
    v_max3_f32 v25, v25, v172, v173
    v_max3_f32 v24, v24, v174, v175
    v_max_f32 v24, v24, v25
    v_mov_b32 v25, v24
    s_nop 1
    v_permlane32_swap_b32 v24, v25
    v_max_f32 v24, v24, v25
    v_max_f32 v24, 0, v24
    v_sub_f32 v160, v160, v24
    v_sub_f32 v144, v144, v24
    v_sub_f32 v128, v128, v24
    v_sub_f32 v161, v161, v24
    v_sub_f32 v145, v145, v24
    v_sub_f32 v129, v129, v24
    v_sub_f32 v162, v162, v24
    v_sub_f32 v146, v146, v24
    v_sub_f32 v130, v130, v24
    v_sub_f32 v163, v163, v24
    v_sub_f32 v147, v147, v24
    v_sub_f32 v131, v131, v24
    v_sub_f32 v164, v164, v24
    v_sub_f32 v148, v148, v24
    v_sub_f32 v132, v132, v24
    v_sub_f32 v165, v165, v24
    v_sub_f32 v149, v149, v24
    v_sub_f32 v133, v133, v24
    v_sub_f32 v166, v166, v24
    v_sub_f32 v150, v150, v24
    v_sub_f32 v134, v134, v24
    v_sub_f32 v167, v167, v24
    v_sub_f32 v151, v151, v24
    v_sub_f32 v135, v135, v24
    v_sub_f32 v168, v168, v24
    v_sub_f32 v152, v152, v24
    v_sub_f32 v136, v136, v24
    v_sub_f32 v169, v169, v24
    v_sub_f32 v153, v153, v24
    v_sub_f32 v137, v137, v24
    v_sub_f32 v170, v170, v24
    v_sub_f32 v154, v154, v24
    v_sub_f32 v138, v138, v24
    v_sub_f32 v171, v171, v24
    v_sub_f32 v155, v155, v24
    v_sub_f32 v139, v139, v24
    v_sub_f32 v172, v172, v24
    v_sub_f32 v156, v156, v24
    v_sub_f32 v140, v140, v24
    v_sub_f32 v173, v173, v24
    v_sub_f32 v157, v157, v24
    v_sub_f32 v141, v141, v24
    v_sub_f32 v174, v174, v24
    v_sub_f32 v158, v158, v24
    v_sub_f32 v142, v142, v24
    v_sub_f32 v175, v175, v24
    v_sub_f32 v159, v159, v24
    v_sub_f32 v143, v143, v24
    v_sub_f32 v24, 0, v24
    v_exp_f32 v24, v24
    s_nop 0
    v_mul_f32 v15, v15, v24
    v_mul_f32 v64, v64, v24
    v_mul_f32 v65, v65, v24
    v_mul_f32 v66, v66, v24
    v_mul_f32 v67, v67, v24
    v_mul_f32 v68, v68, v24
    v_mul_f32 v69, v69, v24
    v_mul_f32 v70, v70, v24
    v_mul_f32 v71, v71, v24
    v_mul_f32 v72, v72, v24
    v_mul_f32 v73, v73, v24
    v_mul_f32 v74, v74, v24
    v_mul_f32 v75, v75, v24
    v_mul_f32 v76, v76, v24
    v_mul_f32 v77, v77, v24
    v_mul_f32 v78, v78, v24
    v_mul_f32 v79, v79, v24
    v_mul_f32 v80, v80, v24
    v_mul_f32 v81, v81, v24
    v_mul_f32 v82, v82, v24
    v_mul_f32 v83, v83, v24
    v_mul_f32 v84, v84, v24
    v_mul_f32 v85, v85, v24
    v_mul_f32 v86, v86, v24
    v_mul_f32 v87, v87, v24
    v_mul_f32 v88, v88, v24
    v_mul_f32 v89, v89, v24
    v_mul_f32 v90, v90, v24
    v_mul_f32 v91, v91, v24
    v_mul_f32 v92, v92, v24
    v_mul_f32 v93, v93, v24
    v_mul_f32 v94, v94, v24
    v_mul_f32 v95, v95, v24
    v_mul_f32 v96, v96, v24
    v_mul_f32 v97, v97, v24
    v_mul_f32 v98, v98, v24
    v_mul_f32 v99, v99, v24
    v_mul_f32 v100, v100, v24
    v_mul_f32 v101, v101, v24
    v_mul_f32 v102, v102, v24
    v_mul_f32 v103, v103, v24
    v_mul_f32 v104, v104, v24
    v_mul_f32 v105, v105, v24
    v_mul_f32 v106, v106, v24
    v_mul_f32 v107, v107, v24
    v_mul_f32 v108, v108, v24
    v_mul_f32 v109, v109, v24
    v_mul_f32 v110, v110, v24
    v_mul_f32 v111, v111, v24
    v_mul_f32 v112, v112, v24
    v_mul_f32 v113, v113, v24
    v_mul_f32 v114, v114, v24
    v_mul_f32 v115, v115, v24
    v_mul_f32 v116, v116, v24
    v_mul_f32 v117, v117, v24
    v_mul_f32 v118, v118, v24
    v_mul_f32 v119, v119, v24
    v_mul_f32 v120, v120, v24
    v_mul_f32 v121, v121, v24
    v_mul_f32 v122, v122, v24
    v_mul_f32 v123, v123, v24
    v_mul_f32 v124, v124, v24
    v_mul_f32 v125, v125, v24
    v_mul_f32 v126, v126, v24
    v_mul_f32 v127, v127, v24
    v_exp_f32 v24, v160
    v_exp_f32 v25, v161
    v_exp_f32 v26, v162
    v_exp_f32 v27, v163
    v_cvt_pk_bf16_f32 v184, v24, v25
    v_exp_f32 v28, v164
    v_exp_f32 v29, v165
    v_cvt_pk_bf16_f32 v185, v26, v27
    v_add_f32 v30, v24, v26
    v_add_f32 v31, v25, v27
    v_exp_f32 v24, v166
    v_exp_f32 v25, v167
    v_cvt_pk_bf16_f32 v186, v28, v29
    v_add_f32 v30, v30, v28
    v_add_f32 v31, v31, v29
    v_exp_f32 v26, v168
    v_exp_f32 v27, v169
    v_cvt_pk_bf16_f32 v187, v24, v25
    v_add_f32 v30, v30, v24
    v_add_f32 v31, v31, v25
    v_exp_f32 v28, v170
    v_exp_f32 v29, v171
    v_cvt_pk_bf16_f32 v188, v26, v27
    v_add_f32 v30, v30, v26
    v_add_f32 v31, v31, v27
    v_exp_f32 v24, v172
    v_exp_f32 v25, v173
    v_cvt_pk_bf16_f32 v189, v28, v29
    v_add_f32 v30, v30, v28
    v_add_f32 v31, v31, v29
    v_exp_f32 v26, v174
    v_exp_f32 v27, v175
    v_cvt_pk_bf16_f32 v190, v24, v25
    v_add_f32 v30, v30, v24
    v_add_f32 v31, v31, v25
    v_cvt_pk_bf16_f32 v191, v26, v27
    v_add_f32 v30, v30, v26
    v_add_f32 v31, v31, v27
    v_add_f32 v16, v30, v31
    s_nop 1
    s_branch A_RRET_34
L2_B:
    s_mov_b32 s4, s12
    s_mov_b32 s5, s13
    s_cmp_lg_u32 s3, 0
    s_cbranch_scc1 B_KP_X
    v_lshrrev_b32 v2, 1, v1
    v_lshlrev_b32 v2, 7, v2
    v_and_b32 v3, 1, v1
    v_lshlrev_b32 v3, 4, v3
    v_add_u32 v2, v2, v3
    v_lshlrev_b32 v2, 4, v1
    v_add_u32 v2, 6144, v2
    s_mov_b32 s44, 100000
B_KP:
    global_load_dwordx4 v[4:7], v2, s[100:101] sc1
    s_waitcnt vmcnt(0)
    v_xor_b32 v4, s77, v4
    v_xor_b32 v5, s77, v5
    v_xor_b32 v6, s77, v6
    v_xor_b32 v7, s77, v7
    v_or3_b32 v4, v4, v5, v6
    v_or_b32 v4, v4, v7
    v_cmp_ne_u32 vcc, 0, v4
    s_cbranch_vccz B_KP_D
    s_sleep 4
    s_sub_u32 s44, s44, 1
    s_cmp_lg_u32 s44, 0
    s_cbranch_scc1 B_KP
B_KP_D:
B_KP_X:
    s_barrier
    s_and_b32 s44, s2, 7
    s_lshr_b32 s45, s2, 3
    s_lshl_b32 s44, s44, 2
    s_add_u32 s44, s44, s45
    s_lshl_b32 s47, s44, 1
    s_lshl_b32 s48, s3, 16
    s_lshl_b32 s49, s3, 15
    v_lshlrev_b32 v10, 4, v1
    s_waitcnt lgkmcnt(0)
    s_add_u32 s24, s4, 0xc00000
    s_addc_u32 s25, s5, 0
    s_mov_b32 s26, 0x258000
    s_mov_b32 s27, 0x00020000
    s_add_u32 s16, s4, 0x200000
    s_addc_u32 s17, s5, 0
    s_mov_b32 s18, 0x200000
    s_mov_b32 s19, 0x00020000
    s_add_u32 s20, s4, 0x0
    s_addc_u32 s21, s5, 0
    s_mov_b32 s22, 0x200000
    s_mov_b32 s23, 0x00020000
    s_add_u32 s36, s4, 0x400000
    s_addc_u32 s37, s5, 0
    s_mov_b32 s38, 0x200000
    s_mov_b32 s39, 0x00020000
    s_add_u32 s40, s4, 0x600000
    s_addc_u32 s41, s5, 0
    s_mov_b32 s42, 0x560000
    s_mov_b32 s43, 0x00020000
    s_add_u32 s44, s48, 0
    buffer_load_dwordx4 v[216:219], v10, s[24:27], s44 offen sc1
    s_add_u32 s44, s48, 1024
    buffer_load_dwordx4 v[220:223], v10, s[24:27], s44 offen sc1
    s_add_u32 s44, s48, 2048
    buffer_load_dwordx4 v[160:163], v10, s[24:27], s44 offen sc1
    s_add_u32 s44, s48, 3072
    buffer_load_dwordx4 v[164:167], v10, s[24:27], s44 offen sc1
    s_lshl_b32 s46, s47, 5
    s_sub_u32 s46, s46, 8
    v_add_u32 v2, 0, v1
    v_mul_u32_u24 v3, 205, v2
    v_lshrrev_b32 v3, 15, v3
    v_mul_u32_u24 v4, 160, v3
    v_sub_u32 v2, v2, v4
    v_mul_u32_u24 v4, 410, v2
    v_lshrrev_b32 v4, 15, v4
    v_mul_u32_u24 v5, 80, v4
    v_sub_u32 v2, v2, v5
    v_add_u32 v2, s46, v2
    v_ashrrev_i32 v5, 5, v2
    v_lshlrev_b32 v5, 15, v5
    v_and_b32 v2, 31, v2
    v_lshlrev_b32 v4, 5, v4
    v_add_u32 v2, v2, v4
    v_lshlrev_b32 v2, 4, v2
    v_lshlrev_b32 v3, 10, v3
    v_add_u32 v2, v2, v3
    v_add_u32 v11, v5, v2
    v_add_u32 v2, 64, v1
    v_mul_u32_u24 v3, 205, v2
    v_lshrrev_b32 v3, 15, v3
    v_mul_u32_u24 v4, 160, v3
    v_sub_u32 v2, v2, v4
    v_mul_u32_u24 v4, 410, v2
    v_lshrrev_b32 v4, 15, v4
    v_mul_u32_u24 v5, 80, v4
    v_sub_u32 v2, v2, v5
    v_add_u32 v2, s46, v2
    v_ashrrev_i32 v5, 5, v2
    v_lshlrev_b32 v5, 15, v5
    v_and_b32 v2, 31, v2
    v_lshlrev_b32 v4, 5, v4
    v_add_u32 v2, v2, v4
    v_lshlrev_b32 v2, 4, v2
    v_lshlrev_b32 v3, 10, v3
    v_add_u32 v2, v2, v3
    v_add_u32 v12, v5, v2
    v_add_u32 v2, 128, v1
    v_mul_u32_u24 v3, 205, v2
    v_lshrrev_b32 v3, 15, v3
    v_mul_u32_u24 v4, 160, v3
    v_sub_u32 v2, v2, v4
    v_mul_u32_u24 v4, 410, v2
    v_lshrrev_b32 v4, 15, v4
    v_mul_u32_u24 v5, 80, v4
    v_sub_u32 v2, v2, v5
    v_add_u32 v2, s46, v2
    v_ashrrev_i32 v5, 5, v2
    v_lshlrev_b32 v5, 15, v5
    v_and_b32 v2, 31, v2
    v_lshlrev_b32 v4, 5, v4
    v_add_u32 v2, v2, v4
    v_lshlrev_b32 v2, 4, v2
    v_lshlrev_b32 v3, 10, v3
    v_add_u32 v2, v2, v3
    v_add_u32 v13, v5, v2
    v_add_u32 v2, 192, v1
    v_mul_u32_u24 v3, 205, v2
    v_lshrrev_b32 v3, 15, v3
    v_mul_u32_u24 v4, 160, v3
    v_sub_u32 v2, v2, v4
    v_mul_u32_u24 v4, 410, v2
    v_lshrrev_b32 v4, 15, v4
    v_mul_u32_u24 v5, 80, v4
    v_sub_u32 v2, v2, v5
    v_add_u32 v2, s46, v2
    v_ashrrev_i32 v5, 5, v2
    v_lshlrev_b32 v5, 15, v5
    v_and_b32 v2, 31, v2
    v_lshlrev_b32 v4, 5, v4
    v_add_u32 v2, v2, v4
    v_lshlrev_b32 v2, 4, v2
    v_lshlrev_b32 v3, 10, v3
    v_add_u32 v2, v2, v3
    v_add_u32 v14, v5, v2
    v_add_u32 v2, 256, v1
    v_mul_u32_u24 v3, 205, v2
    v_lshrrev_b32 v3, 15, v3
    v_mul_u32_u24 v4, 160, v3
    v_sub_u32 v2, v2, v4
    v_mul_u32_u24 v4, 410, v2
    v_lshrrev_b32 v4, 15, v4
    v_mul_u32_u24 v5, 80, v4
    v_sub_u32 v2, v2, v5
    v_add_u32 v2, s46, v2
    v_ashrrev_i32 v5, 5, v2
    v_lshlrev_b32 v5, 15, v5
    v_and_b32 v2, 31, v2
    v_lshlrev_b32 v4, 5, v4
    v_add_u32 v2, v2, v4
    v_lshlrev_b32 v2, 4, v2
    v_lshlrev_b32 v3, 10, v3
    v_add_u32 v2, v2, v3
    v_add_u32 v15, v5, v2
    s_add_u32 s45, s3, 0
    s_mul_i32 s46, s45, 5120
    s_lshl_b32 s45, s45, 11
    s_add_u32 m0, s46, 0
    s_nop 0
    buffer_load_dwordx4 v11, s[16:19], s45 offen sc1 lds
    s_add_u32 m0, s46, 1024
    s_nop 0
    buffer_load_dwordx4 v12, s[16:19], s45 offen sc1 lds
    s_add_u32 m0, s46, 2048
    s_nop 0
    buffer_load_dwordx4 v13, s[16:19], s45 offen sc1 lds
    s_add_u32 m0, s46, 3072
    s_nop 0
    buffer_load_dwordx4 v14, s[16:19], s45 offen sc1 lds
    s_add_u32 m0, s46, 4096
    s_nop 0
    buffer_load_dwordx4 v15, s[16:19], s45 offen sc1 lds
    s_add_u32 s44, s48, 4096
    buffer_load_dwordx4 v[168:171], v10, s[24:27], s44 offen sc1
    s_add_u32 s44, s48, 5120
    buffer_load_dwordx4 v[172:175], v10, s[24:27], s44 offen sc1
    s_add_u32 s45, s3, 8
    s_mul_i32 s46, s45, 5120
    s_lshl_b32 s45, s45, 11
    s_add_u32 m0, s46, 0
    s_nop 0
    buffer_load_dwordx4 v11, s[16:19], s45 offen sc1 lds
    s_add_u32 m0, s46, 1024
    s_nop 0
    buffer_load_dwordx4 v12, s[16:19], s45 offen sc1 lds
    s_add_u32 m0, s46, 2048
    s_nop 0
    buffer_load_dwordx4 v13, s[16:19], s45 offen sc1 lds
    s_add_u32 m0, s46, 3072
    s_nop 0
    buffer_load_dwordx4 v14, s[16:19], s45 offen sc1 lds
    s_add_u32 m0, s46, 4096
    s_nop 0
    buffer_load_dwordx4 v15, s[16:19], s45 offen sc1 lds
    s_add_u32 s44, s48, 6144
    buffer_load_dwordx4 v[176:179], v10, s[24:27], s44 offen sc1
    s_add_u32 s44, s48, 7168
    buffer_load_dwordx4 v[180:183], v10, s[24:27], s44 offen sc1
    s_add_u32 s44, s48, 8192
    buffer_load_dwordx4 v[184:187], v10, s[24:27], s44 offen sc1
    s_add_u32 s44, s48, 9216
    buffer_load_dwordx4 v[188:191], v10, s[24:27], s44 offen sc1
    s_mov_b32 s54, 0x3727c5ac
    s_mov_b32 s55, 0x3b000000
    v_and_b32 v2, 31, v1
    v_lshrrev_b32 v3, 5, v1
    s_lshr_b32 s44, s3, 1
    s_lshr_b32 s45, s44, 1
    s_add_u32 s45, s45, 1
    s_and_b32 s44, s44, 1
    s_sub_u32 s46, 8, s45
    s_add_u32 s45, 8, s45
    s_cmp_eq_u32 s44, 0
    s_cselect_b32 s44, s46, s45
    v_add_u32 v4, s44, v2
    v_lshlrev_b32 v4, 4, v4
    v_mul_u32_u24 v5, 1280, v3
    v_add_u32 v16, v4, v5
    v_add_u32 v17, 40960, v16
    v_mov_b32 v18, 0xc0135761
    v_add_u32 v19, 81920, v10
    s_lshl_b32 s44, s3, 13
    v_add_u32 v9, s44, v19
    v_lshlrev_b32 v4, 2, v3
    v_sub_u32 v4, v2, v4
    v_mov_b32 v5, 0x3f80
    v_mov_b32 v6, 0x3f800000
    v_cmp_eq_u32 vcc, 0, v4
    s_nop 1
    v_cndmask_b32 v24, 0, v5, vcc
    v_cmp_eq_u32 vcc, 1, v4
    s_nop 1
    v_cndmask_b32 v24, v24, v6, vcc
    v_cmp_eq_u32 vcc, 2, v4
    s_nop 1
    v_cndmask_b32 v25, 0, v5, vcc
    v_cmp_eq_u32 vcc, 3, v4
    s_nop 1
    v_cndmask_b32 v25, v25, v6, vcc
    v_cmp_eq_u32 vcc, 8, v4
    s_nop 1
    v_cndmask_b32 v26, 0, v5, vcc
    v_cmp_eq_u32 vcc, 9, v4
    s_nop 1
    v_cndmask_b32 v26, v26, v6, vcc
    v_cmp_eq_u32 vcc, 10, v4
    s_nop 1
    v_cndmask_b32 v27, 0, v5, vcc
    v_cmp_eq_u32 vcc, 11, v4
    s_nop 1
    v_cndmask_b32 v27, v27, v6, vcc
    v_cmp_eq_u32 vcc, 16, v4
    s_nop 1
    v_cndmask_b32 v28, 0, v5, vcc
    v_cmp_eq_u32 vcc, 17, v4
    s_nop 1
    v_cndmask_b32 v28, v28, v6, vcc
    v_cmp_eq_u32 vcc, 18, v4
    s_nop 1
    v_cndmask_b32 v29, 0, v5, vcc
    v_cmp_eq_u32 vcc, 19, v4
    s_nop 1
    v_cndmask_b32 v29, v29, v6, vcc
    v_cmp_eq_u32 vcc, 24, v4
    s_nop 1
    v_cndmask_b32 v30, 0, v5, vcc
    v_cmp_eq_u32 vcc, 25, v4
    s_nop 1
    v_cndmask_b32 v30, v30, v6, vcc
    v_cmp_eq_u32 vcc, 26, v4
    s_nop 1
    v_cndmask_b32 v31, 0, v5, vcc
    v_cmp_eq_u32 vcc, 27, v4
    s_nop 1
    v_cndmask_b32 v31, v31, v6, vcc
    s_waitcnt vmcnt(11)
    s_barrier
    s_cmp_lg_u32 s3, 0
    s_cbranch_scc1 B_KEV
    v_mov_b32 v2, s76
    v_mov_b32 v3, s77
    s_mov_b64 exec, 1
    global_store_dword v2, v3, s[100:101] sc1
    s_mov_b64 exec, -1
B_KEV:
    ds_read_b128 v[192:195], v16 offset:0
    ds_read_b128 v[196:199], v16 offset:512
    ds_read_b128 v[200:203], v16 offset:2560
    ds_read_b128 v[204:207], v16 offset:3072
    s_waitcnt vmcnt(19)
    s_waitcnt lgkmcnt(3)
    v_mfma_f32_32x32x16_bf16 v[64:79], v[216:219], v[192:195], 0
    ds_read_b128 v[208:211], v16 offset:5120
    s_waitcnt lgkmcnt(3)
    v_mfma_f32_32x32x16_bf16 v[80:95], v[216:219], v[196:199], 0
    ds_read_b128 v[212:215], v16 offset:5632
    s_add_u32 s44, s48, 10240
    buffer_load_dwordx4 v[216:219], v10, s[24:27], s44 offen sc1
    s_waitcnt vmcnt(19)
    s_waitcnt lgkmcnt(3)
    v_mfma_f32_32x32x16_bf16 v[64:79], v[220:223], v[200:203], v[64:79]
    ds_read_b128 v[192:195], v16 offset:7680
    s_waitcnt lgkmcnt(3)
    v_mfma_f32_32x32x16_bf16 v[80:95], v[220:223], v[204:207], v[80:95]
    ds_read_b128 v[196:199], v16 offset:8192
    s_add_u32 s44, s48, 11264
    buffer_load_dwordx4 v[220:223], v10, s[24:27], s44 offen sc1
    s_waitcnt vmcnt(19)
    s_waitcnt lgkmcnt(3)
    v_mfma_f32_32x32x16_bf16 v[64:79], v[160:163], v[208:211], v[64:79]
    ds_read_b128 v[200:203], v16 offset:10240
    s_waitcnt lgkmcnt(3)
    v_mfma_f32_32x32x16_bf16 v[80:95], v[160:163], v[212:215], v[80:95]
    ds_read_b128 v[204:207], v16 offset:10752
    s_add_u32 s44, s48, 12288
    buffer_load_dwordx4 v[160:163], v10, s[24:27], s44 offen sc1
    s_waitcnt vmcnt(19)
    s_waitcnt lgkmcnt(3)
    v_mfma_f32_32x32x16_bf16 v[64:79], v[164:167], v[192:195], v[64:79]
    ds_read_b128 v[208:211], v16 offset:12800
    s_waitcnt lgkmcnt(3)
    v_mfma_f32_32x32x16_bf16 v[80:95], v[164:167], v[196:199], v[80:95]
    ds_read_b128 v[212:215], v16 offset:13312
    s_add_u32 s44, s48, 13312
    buffer_load_dwordx4 v[164:167], v10, s[24:27], s44 offen sc1
    s_waitcnt vmcnt(14)
    s_waitcnt lgkmcnt(3)
    v_mfma_f32_32x32x16_bf16 v[64:79], v[168:171], v[200:203], v[64:79]
    ds_read_b128 v[192:195], v16 offset:15360
    s_waitcnt lgkmcnt(3)
    v_mfma_f32_32x32x16_bf16 v[80:95], v[168:171], v[204:207], v[80:95]
    ds_read_b128 v[196:199], v16 offset:15872
    s_add_u32 s44, s48, 14336
    buffer_load_dwordx4 v[168:171], v10, s[24:27], s44 offen sc1
    s_waitcnt vmcnt(14)
    s_waitcnt lgkmcnt(3)
    v_mfma_f32_32x32x16_bf16 v[64:79], v[172:175], v[208:211], v[64:79]
    ds_read_b128 v[200:203], v16 offset:17920
    s_waitcnt lgkmcnt(3)
    v_mfma_f32_32x32x16_bf16 v[80:95], v[172:175], v[212:215], v[80:95]
    ds_read_b128 v[204:207], v16 offset:18432
    s_add_u32 s44, s48, 15360
    buffer_load_dwordx4 v[172:175], v10, s[24:27], s44 offen sc1
    s_waitcnt vmcnt(9)
    s_waitcnt lgkmcnt(3)
    v_mfma_f32_32x32x16_bf16 v[64:79], v[176:179], v[192:195], v[64:79]
    ds_read_b128 v[208:211], v16 offset:20480
    s_waitcnt lgkmcnt(3)
    v_mfma_f32_32x32x16_bf16 v[80:95], v[176:179], v[196:199], v[80:95]
    ds_read_b128 v[212:215], v16 offset:20992
    s_add_u32 s44, s48, 16384
    buffer_load_dwordx4 v[176:179], v10, s[24:27], s44 offen sc1
    s_waitcnt vmcnt(9)
    s_waitcnt lgkmcnt(3)
    v_mfma_f32_32x32x16_bf16 v[64:79], v[180:183], v[200:203], v[64:79]
    ds_read_b128 v[192:195], v16 offset:23040
    s_waitcnt lgkmcnt(3)
    v_mfma_f32_32x32x16_bf16 v[80:95], v[180:183], v[204:207], v[80:95]
    ds_read_b128 v[196:199], v16 offset:23552
    s_add_u32 s44, s48, 17408
    buffer_load_dwordx4 v[180:183], v10, s[24:27], s44 offen sc1
    s_waitcnt vmcnt(9)
    s_waitcnt lgkmcnt(3)
    v_mfma_f32_32x32x16_bf16 v[64:79], v[184:187], v[208:211], v[64:79]
    ds_read_b128 v[200:203], v16 offset:25600
    s_waitcnt lgkmcnt(3)
    v_mfma_f32_32x32x16_bf16 v[80:95], v[184:187], v[212:215], v[80:95]
    ds_read_b128 v[204:207], v16 offset:26112
    s_add_u32 s44, s48, 18432
    buffer_load_dwordx4 v[184:187], v10, s[24:27], s44 offen sc1
    s_waitcnt vmcnt(9)
    s_waitcnt lgkmcnt(3)
    v_mfma_f32_32x32x16_bf16 v[64:79], v[188:191], v[192:195], v[64:79]
    ds_read_b128 v[208:211], v16 offset:28160
    s_waitcnt lgkmcnt(3)
    v_mfma_f32_32x32x16_bf16 v[80:95], v[188:191], v[196:199], v[80:95]
    ds_read_b128 v[212:215], v16 offset:28672
    s_add_u32 s44, s48, 19456
    buffer_load_dwordx4 v[188:191], v10, s[24:27], s44 offen sc1
    s_waitcnt vmcnt(9)
    s_waitcnt lgkmcnt(3)
    v_mfma_f32_32x32x16_bf16 v[64:79], v[216:219], v[200:203], v[64:79]
    ds_read_b128 v[192:195], v16 offset:30720
    s_waitcnt lgkmcnt(3)
    v_mfma_f32_32x32x16_bf16 v[80:95], v[216:219], v[204:207], v[80:95]
    ds_read_b128 v[196:199], v16 offset:31232
    s_add_u32 s44, s48, 20480
    buffer_load_dwordx4 v[216:219], v10, s[24:27], s44 offen sc1
    s_waitcnt vmcnt(9)
    s_waitcnt lgkmcnt(3)
    v_mfma_f32_32x32x16_bf16 v[64:79], v[220:223], v[208:211], v[64:79]
    ds_read_b128 v[200:203], v16 offset:33280
    s_waitcnt lgkmcnt(3)
    v_mfma_f32_32x32x16_bf16 v[80:95], v[220:223], v[212:215], v[80:95]
    ds_read_b128 v[204:207], v16 offset:33792
    s_add_u32 s44, s48, 21504
    buffer_load_dwordx4 v[220:223], v10, s[24:27], s44 offen sc1
    s_waitcnt vmcnt(9)
    s_waitcnt lgkmcnt(3)
    v_mfma_f32_32x32x16_bf16 v[64:79], v[160:163], v[192:195], v[64:79]
    ds_read_b128 v[208:211], v16 offset:35840
    s_waitcnt lgkmcnt(3)
    v_mfma_f32_32x32x16_bf16 v[80:95], v[160:163], v[196:199], v[80:95]
    ds_read_b128 v[212:215], v16 offset:36352
    s_add_u32 s44, s48, 22528
    buffer_load_dwordx4 v[160:163], v10, s[24:27], s44 offen sc1
    s_waitcnt vmcnt(9)
    s_waitcnt lgkmcnt(3)
    v_mfma_f32_32x32x16_bf16 v[64:79], v[164:167], v[200:203], v[64:79]
    ds_read_b128 v[192:195], v16 offset:38400
    s_waitcnt lgkmcnt(3)
    v_mfma_f32_32x32x16_bf16 v[80:95], v[164:167], v[204:207], v[80:95]
    ds_read_b128 v[196:199], v16 offset:38912
    s_add_u32 s44, s48, 23552
    buffer_load_dwordx4 v[164:167], v10, s[24:27], s44 offen sc1
    s_waitcnt vmcnt(9)
    s_waitcnt lgkmcnt(3)
    v_mfma_f32_32x32x16_bf16 v[64:79], v[168:171], v[208:211], v[64:79]
    s_waitcnt vmcnt(18)
    s_barrier
    ds_read_b128 v[200:203], v17 offset:0
    s_waitcnt lgkmcnt(3)
    v_mfma_f32_32x32x16_bf16 v[80:95], v[168:171], v[212:215], v[80:95]
    ds_read_b128 v[204:207], v17 offset:512
    s_add_u32 s44, s48, 24576
    buffer_load_dwordx4 v[168:171], v10, s[24:27], s44 offen sc1
    s_waitcnt vmcnt(9)
    s_waitcnt lgkmcnt(3)
    v_mfma_f32_32x32x16_bf16 v[64:79], v[172:175], v[192:195], v[64:79]
    ds_read_b128 v[208:211], v17 offset:2560
    s_waitcnt lgkmcnt(3)
    v_mfma_f32_32x32x16_bf16 v[80:95], v[172:175], v[196:199], v[80:95]
    ds_read_b128 v[212:215], v17 offset:3072
    s_add_u32 s44, s48, 25600
    buffer_load_dwordx4 v[172:175], v10, s[24:27], s44 offen sc1
    s_waitcnt vmcnt(9)
    s_waitcnt lgkmcnt(3)
    v_mfma_f32_32x32x16_bf16 v[64:79], v[176:179], v[200:203], v[64:79]
    ds_read_b128 v[192:195], v17 offset:5120
    s_waitcnt lgkmcnt(3)
    v_mfma_f32_32x32x16_bf16 v[80:95], v[176:179], v[204:207], v[80:95]
    ds_read_b128 v[196:199], v17 offset:5632
    s_add_u32 s44, s48, 26624
    buffer_load_dwordx4 v[176:179], v10, s[24:27], s44 offen sc1
    s_waitcnt vmcnt(9)
    s_waitcnt lgkmcnt(3)
    v_mfma_f32_32x32x16_bf16 v[64:79], v[180:183], v[208:211], v[64:79]
    ds_read_b128 v[200:203], v17 offset:7680
    s_waitcnt lgkmcnt(3)
    v_mfma_f32_32x32x16_bf16 v[80:95], v[180:183], v[212:215], v[80:95]
    ds_read_b128 v[204:207], v17 offset:8192
    s_add_u32 s44, s48, 27648
    buffer_load_dwordx4 v[180:183], v10, s[24:27], s44 offen sc1
    s_waitcnt vmcnt(9)
    s_waitcnt lgkmcnt(3)
    v_mfma_f32_32x32x16_bf16 v[64:79], v[184:187], v[192:195], v[64:79]
    ds_read_b128 v[208:211], v17 offset:10240
    s_waitcnt lgkmcnt(3)
    v_mfma_f32_32x32x16_bf16 v[80:95], v[184:187], v[196:199], v[80:95]
    ds_read_b128 v[212:215], v17 offset:10752
    s_add_u32 s44, s48, 28672
    buffer_load_dwordx4 v[184:187], v10, s[24:27], s44 offen sc1
    s_waitcnt vmcnt(9)
    s_waitcnt lgkmcnt(3)
    v_mfma_f32_32x32x16_bf16 v[64:79], v[188:191], v[200:203], v[64:79]
    ds_read_b128 v[192:195], v17 offset:12800
    s_waitcnt lgkmcnt(3)
    v_mfma_f32_32x32x16_bf16 v[80:95], v[188:191], v[204:207], v[80:95]
    ds_read_b128 v[196:199], v17 offset:13312
    s_add_u32 s44, s48, 29696
    buffer_load_dwordx4 v[188:191], v10, s[24:27], s44 offen sc1
    s_waitcnt vmcnt(9)
    s_waitcnt lgkmcnt(3)
    v_mfma_f32_32x32x16_bf16 v[64:79], v[216:219], v[208:211], v[64:79]
    ds_read_b128 v[200:203], v17 offset:15360
    s_waitcnt lgkmcnt(3)
    v_mfma_f32_32x32x16_bf16 v[80:95], v[216:219], v[212:215], v[80:95]
    ds_read_b128 v[204:207], v17 offset:15872
    s_add_u32 s44, s48, 30720
    buffer_load_dwordx4 v[216:219], v10, s[24:27], s44 offen sc1
    s_waitcnt vmcnt(9)
    s_waitcnt lgkmcnt(3)
    v_mfma_f32_32x32x16_bf16 v[64:79], v[220:223], v[192:195], v[64:79]
    ds_read_b128 v[208:211], v17 offset:17920
    s_waitcnt lgkmcnt(3)
    v_mfma_f32_32x32x16_bf16 v[80:95], v[220:223], v[196:199], v[80:95]
    ds_read_b128 v[212:215], v17 offset:18432
    s_add_u32 s44, s48, 31744
    buffer_load_dwordx4 v[220:223], v10, s[24:27], s44 offen sc1
    s_waitcnt vmcnt(9)
    s_waitcnt lgkmcnt(3)
    v_mfma_f32_32x32x16_bf16 v[64:79], v[160:163], v[200:203], v[64:79]
    ds_read_b128 v[192:195], v17 offset:20480
    s_waitcnt lgkmcnt(3)
    v_mfma_f32_32x32x16_bf16 v[80:95], v[160:163], v[204:207], v[80:95]
    ds_read_b128 v[196:199], v17 offset:20992
    s_add_u32 s44, s48, 32768
    buffer_load_dwordx4 v[160:163], v10, s[24:27], s44 offen sc1
    s_waitcnt vmcnt(9)
    s_waitcnt lgkmcnt(3)
    v_mfma_f32_32x32x16_bf16 v[64:79], v[164:167], v[208:211], v[64:79]
    ds_read_b128 v[200:203], v17 offset:23040
    s_waitcnt lgkmcnt(3)
    v_mfma_f32_32x32x16_bf16 v[80:95], v[164:167], v[212:215], v[80:95]
    ds_read_b128 v[204:207], v17 offset:23552
    s_add_u32 s44, s48, 33792
    buffer_load_dwordx4 v[164:167], v10, s[24:27], s44 offen sc1
    s_waitcnt vmcnt(9)
    s_waitcnt lgkmcnt(3)
    v_mfma_f32_32x32x16_bf16 v[64:79], v[168:171], v[192:195], v[64:79]
    ds_read_b128 v[208:211], v17 offset:25600
    s_waitcnt lgkmcnt(3)
    v_mfma_f32_32x32x16_bf16 v[80:95], v[168:171], v[196:199], v[80:95]
    ds_read_b128 v[212:215], v17 offset:26112
    s_add_u32 s44, s48, 34816
    buffer_load_dwordx4 v[168:171], v10, s[24:27], s44 offen sc1
    s_waitcnt vmcnt(9)
    s_waitcnt lgkmcnt(3)
    v_mfma_f32_32x32x16_bf16 v[64:79], v[172:175], v[200:203], v[64:79]
    ds_read_b128 v[192:195], v17 offset:28160
    s_waitcnt lgkmcnt(3)
    v_mfma_f32_32x32x16_bf16 v[80:95], v[172:175], v[204:207], v[80:95]
    ds_read_b128 v[196:199], v17 offset:28672
    s_add_u32 s44, s48, 35840
    buffer_load_dwordx4 v[172:175], v10, s[24:27], s44 offen sc1
    s_waitcnt vmcnt(9)
    s_waitcnt lgkmcnt(3)
    v_mfma_f32_32x32x16_bf16 v[64:79], v[176:179], v[208:211], v[64:79]
    ds_read_b128 v[200:203], v17 offset:30720
    s_waitcnt lgkmcnt(3)
    v_mfma_f32_32x32x16_bf16 v[80:95], v[176:179], v[212:215], v[80:95]
    ds_read_b128 v[204:207], v17 offset:31232
    s_add_u32 s44, s48, 36864
    buffer_load_dwordx4 v[176:179], v10, s[24:27], s44 offen sc1
    s_waitcnt vmcnt(9)
    s_waitcnt lgkmcnt(3)
    v_mfma_f32_32x32x16_bf16 v[64:79], v[180:183], v[192:195], v[64:79]
    ds_read_b128 v[208:211], v17 offset:33280
    s_waitcnt lgkmcnt(3)
    v_mfma_f32_32x32x16_bf16 v[80:95], v[180:183], v[196:199], v[80:95]
    ds_read_b128 v[212:215], v17 offset:33792
    s_add_u32 s44, s48, 37888
    buffer_load_dwordx4 v[180:183], v10, s[24:27], s44 offen sc1
    s_waitcnt vmcnt(9)
    s_waitcnt lgkmcnt(3)
    v_mfma_f32_32x32x16_bf16 v[64:79], v[184:187], v[200:203], v[64:79]
    ds_read_b128 v[192:195], v17 offset:35840
    s_waitcnt lgkmcnt(3)
    v_mfma_f32_32x32x16_bf16 v[80:95], v[184:187], v[204:207], v[80:95]
    ds_read_b128 v[196:199], v17 offset:36352
    s_add_u32 s44, s48, 38912
    buffer_load_dwordx4 v[184:187], v10, s[24:27], s44 offen sc1
    s_waitcnt vmcnt(9)
    s_waitcnt lgkmcnt(3)
    v_mfma_f32_32x32x16_bf16 v[64:79], v[188:191], v[208:211], v[64:79]
    ds_read_b128 v[200:203], v17 offset:38400
    s_waitcnt lgkmcnt(3)
    v_mfma_f32_32x32x16_bf16 v[80:95], v[188:191], v[212:215], v[80:95]
    ds_read_b128 v[204:207], v17 offset:38912
    s_add_u32 s44, s48, 39936
    buffer_load_dwordx4 v[188:191], v10, s[24:27], s44 offen sc1
    s_waitcnt vmcnt(9)
    s_waitcnt lgkmcnt(3)
    v_mfma_f32_32x32x16_bf16 v[64:79], v[216:219], v[192:195], v[64:79]
    ds_read_b128 v[208:211], v16 offset:0
    s_waitcnt lgkmcnt(3)
    v_mfma_f32_32x32x16_bf16 v[80:95], v[216:219], v[196:199], v[80:95]
    ds_read_b128 v[212:215], v16 offset:512
    s_add_u32 s44, s48, 40960
    buffer_load_dwordx4 v[216:219], v10, s[24:27], s44 offen sc1
    s_waitcnt vmcnt(9)
    s_waitcnt lgkmcnt(3)
    v_mfma_f32_32x32x16_bf16 v[64:79], v[220:223], v[200:203], v[64:79]
    ds_read_b128 v[192:195], v16 offset:2560
    s_waitcnt lgkmcnt(3)
    v_mfma_f32_32x32x16_bf16 v[80:95], v[220:223], v[204:207], v[80:95]
    ds_read_b128 v[196:199], v16 offset:3072
    s_add_u32 s44, s48, 41984
    buffer_load_dwordx4 v[220:223], v10, s[24:27], s44 offen sc1
    s_waitcnt vmcnt(9)
    s_waitcnt lgkmcnt(3)
    v_mfma_f32_32x32x16_bf16 v[128:143], v[160:163], v[208:211], 0
    ds_read_b128 v[200:203], v16 offset:5120
    s_add_u32 s45, s47, 0
    s_lshl_b32 s45, s45, 15
    s_lshl_b32 s46, s3, 12
    s_add_u32 s45, s45, s46
    buffer_load_dwordx4 v[224:227], v10, s[20:23], s45 offen offset:0 sc1
    s_add_u32 s45, s47, 0
    s_lshl_b32 s45, s45, 15
    s_lshl_b32 s46, s3, 12
    s_add_u32 s45, s45, s46
    buffer_load_dwordx4 v[228:231], v10, s[20:23], s45 offen offset:1024 sc1
    s_add_u32 s45, s47, 1
    s_lshl_b32 s45, s45, 15
    s_lshl_b32 s46, s3, 12
    s_add_u32 s45, s45, s46
    buffer_load_dwordx4 v[232:235], v10, s[20:23], s45 offen offset:0 sc1
    s_add_u32 s45, s47, 1
    s_lshl_b32 s45, s45, 15
    s_lshl_b32 s46, s3, 12
    s_add_u32 s45, s45, s46
    buffer_load_dwordx4 v[236:239], v10, s[20:23], s45 offen offset:1024 sc1
    s_add_u32 s45, s47, 0
    s_lshl_b32 s45, s45, 15
    s_lshl_b32 s46, s3, 12
    s_add_u32 s45, s45, s46
    buffer_load_dwordx4 v[240:243], v10, s[20:23], s45 offen offset:2048 sc1
    s_add_u32 s45, s47, 0
    s_lshl_b32 s45, s45, 15
    s_lshl_b32 s46, s3, 12
    s_add_u32 s45, s45, s46
    buffer_load_dwordx4 v[244:247], v10, s[20:23], s45 offen offset:3072 sc1
    s_waitcnt lgkmcnt(3)
    v_mfma_f32_32x32x16_bf16 v[144:159], v[160:163], v[212:215], 0
    ds_read_b128 v[204:207], v16 offset:5632
    s_add_u32 s44, s48, 43008
    buffer_load_dwordx4 v[160:163], v10, s[24:27], s44 offen sc1
    s_add_u32 s45, s47, 1
    s_lshl_b32 s45, s45, 15
    s_lshl_b32 s46, s3, 12
    s_add_u32 s45, s45, s46
    buffer_load_dwordx4 v[248:251], v10, s[20:23], s45 offen offset:2048 sc1
    s_add_u32 s45, s47, 1
    s_lshl_b32 s45, s45, 15
    s_lshl_b32 s46, s3, 12
    s_add_u32 s45, s45, s46
    buffer_load_dwordx4 v[252:255], v10, s[20:23], s45 offen offset:3072 sc1
    v_mul_f32 v20, v64, v64
    v_mul_f32 v22, v66, v66
    v_mul_f32 v21, v65, v65
    v_mul_f32 v23, v67, v67
    s_waitcnt vmcnt(17)
    s_waitcnt lgkmcnt(3)
    v_mfma_f32_32x32x16_bf16 v[128:143], v[164:167], v[192:195], v[128:143]
    ds_read_b128 v[208:211], v16 offset:7680
    v_fmamk_f32 v20, v20, 0xbdd2d3e8, v18
    v_fmamk_f32 v22, v22, 0xbdd2d3e8, v18
    v_fmamk_f32 v21, v21, 0xbdd2d3e8, v18
    v_fmamk_f32 v23, v23, 0xbdd2d3e8, v18
    v_mul_f32 v20, v20, v64
    v_mul_f32 v22, v22, v66
    s_waitcnt lgkmcnt(3)
    v_mfma_f32_32x32x16_bf16 v[144:159], v[164:167], v[196:199], v[144:159]
    ds_read_b128 v[212:215], v16 offset:8192
    s_add_u32 s44, s48, 44032
    buffer_load_dwordx4 v[164:167], v10, s[24:27], s44 offen sc1
    v_mul_f32 v21, v21, v65
    v_mul_f32 v23, v23, v67
    v_exp_f32 v20, v20
    v_exp_f32 v22, v22
    s_waitcnt vmcnt(17)
    s_waitcnt lgkmcnt(3)
    v_mfma_f32_32x32x16_bf16 v[128:143], v[168:171], v[200:203], v[128:143]
    ds_read_b128 v[192:195], v16 offset:10240
    v_exp_f32 v21, v21
    v_exp_f32 v23, v23
    v_add_f32 v20, 1.0, v20
    v_add_f32 v22, 1.0, v22
    s_waitcnt lgkmcnt(3)
    v_mfma_f32_32x32x16_bf16 v[144:159], v[168:171], v[204:207], v[144:159]
    ds_read_b128 v[196:199], v16 offset:10752
    s_add_u32 s44, s48, 45056
    buffer_load_dwordx4 v[168:171], v10, s[24:27], s44 offen sc1
    v_add_f32 v21, 1.0, v21
    v_add_f32 v23, 1.0, v23
    v_rcp_f32 v20, v20
    v_rcp_f32 v22, v22
    s_waitcnt vmcnt(17)
    s_waitcnt lgkmcnt(3)
    v_mfma_f32_32x32x16_bf16 v[128:143], v[172:175], v[208:211], v[128:143]
    ds_read_b128 v[200:203], v16 offset:12800
    v_rcp_f32 v21, v21
    v_rcp_f32 v23, v23
    v_mul_f32 v20, v20, v64
    v_mul_f32 v22, v22, v66
    s_waitcnt lgkmcnt(3)
    v_mfma_f32_32x32x16_bf16 v[144:159], v[172:175], v[212:215], v[144:159]
    ds_read_b128 v[204:207], v16 offset:13312
    s_add_u32 s44, s48, 46080
    buffer_load_dwordx4 v[172:175], v10, s[24:27], s44 offen sc1
    v_mul_f32 v21, v21, v65
    v_mul_f32 v23, v23, v67
    v_cvt_pk_bf16_f32 v32, v20, v21
    v_cvt_pk_bf16_f32 v33, v22, v23
    v_mul_f32 v20, v68, v68
    v_mul_f32 v22, v70, v70
    s_waitcnt vmcnt(17)
    s_waitcnt lgkmcnt(3)
    v_mfma_f32_32x32x16_bf16 v[128:143], v[176:179], v[192:195], v[128:143]
    ds_read_b128 v[208:211], v16 offset:15360
    v_mul_f32 v21, v69, v69
    v_mul_f32 v23, v71, v71
    v_fmamk_f32 v20, v20, 0xbdd2d3e8, v18
    v_fmamk_f32 v22, v22, 0xbdd2d3e8, v18
    v_fmamk_f32 v21, v21, 0xbdd2d3e8, v18
    v_fmamk_f32 v23, v23, 0xbdd2d3e8, v18
    s_waitcnt lgkmcnt(3)
    v_mfma_f32_32x32x16_bf16 v[144:159], v[176:179], v[196:199], v[144:159]
    ds_read_b128 v[212:215], v16 offset:15872
    s_add_u32 s44, s48, 47104
    buffer_load_dwordx4 v[176:179], v10, s[24:27], s44 offen sc1
    v_mul_f32 v20, v20, v68
    v_mul_f32 v22, v22, v70
    v_mul_f32 v21, v21, v69
    v_mul_f32 v23, v23, v71
    v_exp_f32 v20, v20
    s_waitcnt vmcnt(17)
    s_waitcnt lgkmcnt(3)
    v_mfma_f32_32x32x16_bf16 v[128:143], v[180:183], v[200:203], v[128:143]
    ds_read_b128 v[192:195], v16 offset:17920
    v_exp_f32 v22, v22
    v_exp_f32 v21, v21
    v_exp_f32 v23, v23
    s_waitcnt lgkmcnt(3)
    v_mfma_f32_32x32x16_bf16 v[144:159], v[180:183], v[204:207], v[144:159]
    ds_read_b128 v[196:199], v16 offset:18432
    s_add_u32 s44, s48, 48128
    buffer_load_dwordx4 v[180:183], v10, s[24:27], s44 offen sc1
    v_add_f32 v20, 1.0, v20
    v_add_f32 v22, 1.0, v22
    v_add_f32 v21, 1.0, v21
    v_add_f32 v23, 1.0, v23
    v_rcp_f32 v20, v20
    s_waitcnt vmcnt(17)
    s_waitcnt lgkmcnt(3)
    v_mfma_f32_32x32x16_bf16 v[128:143], v[184:187], v[208:211], v[128:143]
    ds_read_b128 v[200:203], v16 offset:20480
    v_rcp_f32 v22, v22
    v_rcp_f32 v21, v21
    v_rcp_f32 v23, v23
    s_waitcnt lgkmcnt(3)
    v_mfma_f32_32x32x16_bf16 v[144:159], v[184:187], v[212:215], v[144:159]
    ds_read_b128 v[204:207], v16 offset:20992
    s_add_u32 s44, s48, 49152
    buffer_load_dwordx4 v[184:187], v10, s[24:27], s44 offen sc1
    v_mul_f32 v20, v20, v68
    v_mul_f32 v22, v22, v70
    v_mul_f32 v21, v21, v69
    v_mul_f32 v23, v23, v71
    v_cvt_pk_bf16_f32 v34, v20, v21
    v_cvt_pk_bf16_f32 v35, v22, v23
    s_waitcnt vmcnt(17)
    s_waitcnt lgkmcnt(3)
    v_mfma_f32_32x32x16_bf16 v[128:143], v[188:191], v[192:195], v[128:143]
    ds_read_b128 v[208:211], v16 offset:23040
    v_mul_f32 v20, v72, v72
    v_mul_f32 v22, v74, v74
    v_mul_f32 v21, v73, v73
    v_mul_f32 v23, v75, v75
    v_fmamk_f32 v20, v20, 0xbdd2d3e8, v18
    v_fmamk_f32 v22, v22, 0xbdd2d3e8, v18
    s_waitcnt lgkmcnt(3)
    v_mfma_f32_32x32x16_bf16 v[144:159], v[188:191], v[196:199], v[144:159]
    ds_read_b128 v[212:215], v16 offset:23552
    s_add_u32 s44, s48, 50176
    buffer_load_dwordx4 v[188:191], v10, s[24:27], s44 offen sc1
    v_fmamk_f32 v21, v21, 0xbdd2d3e8, v18
    v_fmamk_f32 v23, v23, 0xbdd2d3e8, v18
    v_mul_f32 v20, v20, v72
    v_mul_f32 v22, v22, v74
    v_mul_f32 v21, v21, v73
    v_mul_f32 v23, v23, v75
    s_waitcnt vmcnt(17)
    s_waitcnt lgkmcnt(3)
    v_mfma_f32_32x32x16_bf16 v[128:143], v[216:219], v[200:203], v[128:143]
    ds_read_b128 v[192:195], v16 offset:25600
    v_exp_f32 v20, v20
    v_exp_f32 v22, v22
    v_exp_f32 v21, v21
    s_waitcnt lgkmcnt(3)
    v_mfma_f32_32x32x16_bf16 v[144:159], v[216:219], v[204:207], v[144:159]
    ds_read_b128 v[196:199], v16 offset:26112
    s_add_u32 s44, s48, 51200
    buffer_load_dwordx4 v[216:219], v10, s[24:27], s44 offen sc1
    v_exp_f32 v23, v23
    v_add_f32 v20, 1.0, v20
    v_add_f32 v22, 1.0, v22
    v_add_f32 v21, 1.0, v21
    v_add_f32 v23, 1.0, v23
    s_waitcnt vmcnt(17)
    s_waitcnt lgkmcnt(3)
    v_mfma_f32_32x32x16_bf16 v[128:143], v[220:223], v[208:211], v[128:143]
    ds_read_b128 v[200:203], v16 offset:28160
    v_rcp_f32 v20, v20
    v_rcp_f32 v22, v22
    v_rcp_f32 v21, v21
    s_waitcnt lgkmcnt(3)
    v_mfma_f32_32x32x16_bf16 v[144:159], v[220:223], v[212:215], v[144:159]
    ds_read_b128 v[204:207], v16 offset:28672
    s_add_u32 s44, s48, 52224
    buffer_load_dwordx4 v[220:223], v10, s[24:27], s44 offen sc1
    v_rcp_f32 v23, v23
    v_mul_f32 v20, v20, v72
    v_mul_f32 v22, v22, v74
    v_mul_f32 v21, v21, v73
    v_mul_f32 v23, v23, v75
    s_waitcnt vmcnt(11)
    s_waitcnt lgkmcnt(3)
    v_mfma_f32_32x32x16_bf16 v[128:143], v[160:163], v[192:195], v[128:143]
    ds_read_b128 v[208:211], v16 offset:30720
    v_cvt_pk_bf16_f32 v36, v20, v21
    v_cvt_pk_bf16_f32 v37, v22, v23
    v_mul_f32 v20, v76, v76
    v_mul_f32 v22, v78, v78
    v_mul_f32 v21, v77, v77
    v_mul_f32 v23, v79, v79
    s_waitcnt lgkmcnt(3)
    v_mfma_f32_32x32x16_bf16 v[144:159], v[160:163], v[196:199], v[144:159]
    ds_read_b128 v[212:215], v16 offset:31232
    s_add_u32 s44, s48, 53248
    buffer_load_dwordx4 v[160:163], v10, s[24:27], s44 offen sc1
    v_fmamk_f32 v20, v20, 0xbdd2d3e8, v18
    v_fmamk_f32 v22, v22, 0xbdd2d3e8, v18
    v_fmamk_f32 v21, v21, 0xbdd2d3e8, v18
    v_fmamk_f32 v23, v23, 0xbdd2d3e8, v18
    v_mul_f32 v20, v20, v76
    v_mul_f32 v22, v22, v78
    s_waitcnt vmcnt(9)
    s_waitcnt lgkmcnt(3)
    v_mfma_f32_32x32x16_bf16 v[128:143], v[164:167], v[200:203], v[128:143]
    ds_read_b128 v[192:195], v16 offset:33280
    v_mul_f32 v21, v21, v77
    v_mul_f32 v23, v23, v79
    v_exp_f32 v20, v20
    v_exp_f32 v22, v22
    s_waitcnt lgkmcnt(3)
    v_mfma_f32_32x32x16_bf16 v[144:159], v[164:167], v[204:207], v[144:159]
    ds_read_b128 v[196:199], v16 offset:33792
    s_add_u32 s44, s48, 54272
    buffer_load_dwordx4 v[164:167], v10, s[24:27], s44 offen sc1
    v_exp_f32 v21, v21
    v_exp_f32 v23, v23
    v_add_f32 v20, 1.0, v20
    v_add_f32 v22, 1.0, v22
    s_waitcnt vmcnt(9)
    s_waitcnt lgkmcnt(3)
    v_mfma_f32_32x32x16_bf16 v[128:143], v[168:171], v[208:211], v[128:143]
    ds_read_b128 v[200:203], v16 offset:35840
    v_add_f32 v21, 1.0, v21
    v_add_f32 v23, 1.0, v23
    v_rcp_f32 v20, v20
    v_rcp_f32 v22, v22
    s_waitcnt lgkmcnt(3)
    v_mfma_f32_32x32x16_bf16 v[144:159], v[168:171], v[212:215], v[144:159]
    ds_read_b128 v[204:207], v16 offset:36352
    s_add_u32 s44, s48, 55296
    buffer_load_dwordx4 v[168:171], v10, s[24:27], s44 offen sc1
    v_rcp_f32 v21, v21
    v_rcp_f32 v23, v23
    v_mul_f32 v20, v20, v76
    v_mul_f32 v22, v22, v78
    s_waitcnt vmcnt(9)
    s_waitcnt lgkmcnt(3)
    v_mfma_f32_32x32x16_bf16 v[128:143], v[172:175], v[192:195], v[128:143]
    ds_read_b128 v[208:211], v16 offset:38400
    v_mul_f32 v21, v21, v77
    v_mul_f32 v23, v23, v79
    v_cvt_pk_bf16_f32 v38, v20, v21
    v_cvt_pk_bf16_f32 v39, v22, v23
    v_mul_f32 v20, v80, v80
    v_mul_f32 v22, v82, v82
    s_waitcnt lgkmcnt(3)
    v_mfma_f32_32x32x16_bf16 v[144:159], v[172:175], v[196:199], v[144:159]
    ds_read_b128 v[212:215], v16 offset:38912
    s_add_u32 s44, s48, 56320
    buffer_load_dwordx4 v[172:175], v10, s[24:27], s44 offen sc1
    v_mul_f32 v21, v81, v81
    v_mul_f32 v23, v83, v83
    v_fmamk_f32 v20, v20, 0xbdd2d3e8, v18
    v_fmamk_f32 v22, v22, 0xbdd2d3e8, v18
    v_fmamk_f32 v21, v21, 0xbdd2d3e8, v18
    v_fmamk_f32 v23, v23, 0xbdd2d3e8, v18
    s_waitcnt vmcnt(9)
    s_waitcnt lgkmcnt(3)
    v_mfma_f32_32x32x16_bf16 v[128:143], v[176:179], v[200:203], v[128:143]
    ds_read_b128 v[192:195], v17 offset:0
    v_mul_f32 v20, v20, v80
    v_mul_f32 v22, v22, v82
    v_mul_f32 v21, v21, v81
    v_mul_f32 v23, v23, v83
    v_exp_f32 v20, v20
    s_waitcnt lgkmcnt(3)
    v_mfma_f32_32x32x16_bf16 v[144:159], v[176:179], v[204:207], v[144:159]
    ds_read_b128 v[196:199], v17 offset:512
    s_add_u32 s44, s48, 57344
    buffer_load_dwordx4 v[176:179], v10, s[24:27], s44 offen sc1
    v_exp_f32 v22, v22
    v_exp_f32 v21, v21
    v_exp_f32 v23, v23
    s_waitcnt vmcnt(9)
    s_waitcnt lgkmcnt(3)
    v_mfma_f32_32x32x16_bf16 v[128:143], v[180:183], v[208:211], v[128:143]
    ds_read_b128 v[200:203], v17 offset:2560
    v_add_f32 v20, 1.0, v20
    v_add_f32 v22, 1.0, v22
    v_add_f32 v21, 1.0, v21
    v_add_f32 v23, 1.0, v23
    v_rcp_f32 v20, v20
    s_waitcnt lgkmcnt(3)
    v_mfma_f32_32x32x16_bf16 v[144:159], v[180:183], v[212:215], v[144:159]
    ds_read_b128 v[204:207], v17 offset:3072
    s_add_u32 s44, s48, 58368
    buffer_load_dwordx4 v[180:183], v10, s[24:27], s44 offen sc1
    v_rcp_f32 v22, v22
    v_rcp_f32 v21, v21
    v_rcp_f32 v23, v23
    s_waitcnt vmcnt(9)
    s_waitcnt lgkmcnt(3)
    v_mfma_f32_32x32x16_bf16 v[128:143], v[184:187], v[192:195], v[128:143]
    ds_read_b128 v[208:211], v17 offset:5120
    v_mul_f32 v20, v20, v80
    v_mul_f32 v22, v22, v82
    v_mul_f32 v21, v21, v81
    v_mul_f32 v23, v23, v83
    v_cvt_pk_bf16_f32 v40, v20, v21
    v_cvt_pk_bf16_f32 v41, v22, v23
    s_waitcnt lgkmcnt(3)
    v_mfma_f32_32x32x16_bf16 v[144:159], v[184:187], v[196:199], v[144:159]
    ds_read_b128 v[212:215], v17 offset:5632
    s_add_u32 s44, s48, 59392
    buffer_load_dwordx4 v[184:187], v10, s[24:27], s44 offen sc1
    v_mul_f32 v20, v84, v84
    v_mul_f32 v22, v86, v86
    v_mul_f32 v21, v85, v85
    v_mul_f32 v23, v87, v87
    v_fmamk_f32 v20, v20, 0xbdd2d3e8, v18
    v_fmamk_f32 v22, v22, 0xbdd2d3e8, v18
    s_waitcnt vmcnt(9)
    s_waitcnt lgkmcnt(3)
    v_mfma_f32_32x32x16_bf16 v[128:143], v[188:191], v[200:203], v[128:143]
    ds_read_b128 v[192:195], v17 offset:7680
    v_fmamk_f32 v21, v21, 0xbdd2d3e8, v18
    v_fmamk_f32 v23, v23, 0xbdd2d3e8, v18
    v_mul_f32 v20, v20, v84
    v_mul_f32 v22, v22, v86
    v_mul_f32 v21, v21, v85
    v_mul_f32 v23, v23, v87
    s_waitcnt lgkmcnt(3)
    v_mfma_f32_32x32x16_bf16 v[144:159], v[188:191], v[204:207], v[144:159]
    ds_read_b128 v[196:199], v17 offset:8192
    s_add_u32 s44, s48, 60416
    buffer_load_dwordx4 v[188:191], v10, s[24:27], s44 offen sc1
    v_exp_f32 v20, v20
    v_exp_f32 v22, v22
    v_exp_f32 v21, v21
    s_waitcnt vmcnt(9)
    s_waitcnt lgkmcnt(3)
    v_mfma_f32_32x32x16_bf16 v[128:143], v[216:219], v[208:211], v[128:143]
    ds_read_b128 v[200:203], v17 offset:10240
    v_exp_f32 v23, v23
    v_add_f32 v20, 1.0, v20
    v_add_f32 v22, 1.0, v22
    v_add_f32 v21, 1.0, v21
    v_add_f32 v23, 1.0, v23
    s_waitcnt lgkmcnt(3)
    v_mfma_f32_32x32x16_bf16 v[144:159], v[216:219], v[212:215], v[144:159]
    ds_read_b128 v[204:207], v17 offset:10752
    s_add_u32 s44, s48, 61440
    buffer_load_dwordx4 v[216:219], v10, s[24:27], s44 offen sc1
    v_rcp_f32 v20, v20
    v_rcp_f32 v22, v22
    v_rcp_f32 v21, v21
    s_waitcnt vmcnt(9)
    s_waitcnt lgkmcnt(3)
    v_mfma_f32_32x32x16_bf16 v[128:143], v[220:223], v[192:195], v[128:143]
    ds_read_b128 v[208:211], v17 offset:12800
    v_rcp_f32 v23, v23
    v_mul_f32 v20, v20, v84
    v_mul_f32 v22, v22, v86
    v_mul_f32 v21, v21, v85
    v_mul_f32 v23, v23, v87
    s_waitcnt lgkmcnt(3)
    v_mfma_f32_32x32x16_bf16 v[144:159], v[220:223], v[196:199], v[144:159]
    ds_read_b128 v[212:215], v17 offset:13312
    s_add_u32 s44, s48, 62464
    buffer_load_dwordx4 v[220:223], v10, s[24:27], s44 offen sc1
    v_cvt_pk_bf16_f32 v42, v20, v21
    v_cvt_pk_bf16_f32 v43, v22, v23
    v_mul_f32 v20, v88, v88
    v_mul_f32 v22, v90, v90
    v_mul_f32 v21, v89, v89
    v_mul_f32 v23, v91, v91
    s_waitcnt vmcnt(9)
    s_waitcnt lgkmcnt(3)
    v_mfma_f32_32x32x16_bf16 v[128:143], v[160:163], v[200:203], v[128:143]
    ds_read_b128 v[192:195], v17 offset:15360
    v_fmamk_f32 v20, v20, 0xbdd2d3e8, v18
    v_fmamk_f32 v22, v22, 0xbdd2d3e8, v18
    v_fmamk_f32 v21, v21, 0xbdd2d3e8, v18
    v_fmamk_f32 v23, v23, 0xbdd2d3e8, v18
    v_mul_f32 v20, v20, v88
    v_mul_f32 v22, v22, v90
    s_waitcnt lgkmcnt(3)
    v_mfma_f32_32x32x16_bf16 v[144:159], v[160:163], v[204:207], v[144:159]
    ds_read_b128 v[196:199], v17 offset:15872
    s_add_u32 s44, s48, 63488
    buffer_load_dwordx4 v[160:163], v10, s[24:27], s44 offen sc1
    v_mul_f32 v21, v21, v89
    v_mul_f32 v23, v23, v91
    v_exp_f32 v20, v20
    v_exp_f32 v22, v22
    s_waitcnt vmcnt(9)
    s_waitcnt lgkmcnt(3)
    v_mfma_f32_32x32x16_bf16 v[128:143], v[164:167], v[208:211], v[128:143]
    ds_read_b128 v[200:203], v17 offset:17920
    v_exp_f32 v21, v21
    v_exp_f32 v23, v23
    v_add_f32 v20, 1.0, v20
    v_add_f32 v22, 1.0, v22
    s_waitcnt lgkmcnt(3)
    v_mfma_f32_32x32x16_bf16 v[144:159], v[164:167], v[212:215], v[144:159]
    ds_read_b128 v[204:207], v17 offset:18432
    s_add_u32 s44, s48, 64512
    buffer_load_dwordx4 v[164:167], v10, s[24:27], s44 offen sc1
    v_add_f32 v21, 1.0, v21
    v_add_f32 v23, 1.0, v23
    v_rcp_f32 v20, v20
    v_rcp_f32 v22, v22
    s_waitcnt vmcnt(9)
    s_waitcnt lgkmcnt(3)
    v_mfma_f32_32x32x16_bf16 v[128:143], v[168:171], v[192:195], v[128:143]
    ds_read_b128 v[208:211], v17 offset:20480
    v_rcp_f32 v21, v21
    v_rcp_f32 v23, v23
    v_mul_f32 v20, v20, v88
    v_mul_f32 v22, v22, v90
    s_waitcnt lgkmcnt(3)
    v_mfma_f32_32x32x16_bf16 v[144:159], v[168:171], v[196:199], v[144:159]
    ds_read_b128 v[212:215], v17 offset:20992
    s_add_u32 s44, s48, 524288
    buffer_load_dwordx4 v[168:171], v10, s[24:27], s44 offen sc1
    v_mul_f32 v21, v21, v89
    v_mul_f32 v23, v23, v91
    v_cvt_pk_bf16_f32 v44, v20, v21
    v_cvt_pk_bf16_f32 v45, v22, v23
    v_mul_f32 v20, v92, v92
    v_mul_f32 v22, v94, v94
    s_waitcnt vmcnt(9)
    s_waitcnt lgkmcnt(3)
    v_mfma_f32_32x32x16_bf16 v[128:143], v[172:175], v[200:203], v[128:143]
    ds_read_b128 v[192:195], v17 offset:23040
    v_mul_f32 v21, v93, v93
    v_mul_f32 v23, v95, v95
    v_fmamk_f32 v20, v20, 0xbdd2d3e8, v18
    v_fmamk_f32 v22, v22, 0xbdd2d3e8, v18
    v_fmamk_f32 v21, v21, 0xbdd2d3e8, v18
    v_fmamk_f32 v23, v23, 0xbdd2d3e8, v18
    s_waitcnt lgkmcnt(3)
    v_mfma_f32_32x32x16_bf16 v[144:159], v[172:175], v[204:207], v[144:159]
    ds_read_b128 v[196:199], v17 offset:23552
    s_add_u32 s44, s48, 557056
    buffer_load_dwordx4 v[172:175], v10, s[24:27], s44 offen sc1
    v_mul_f32 v20, v20, v92
    v_mul_f32 v22, v22, v94
    v_mul_f32 v21, v21, v93
    v_mul_f32 v23, v23, v95
    v_exp_f32 v20, v20
    s_waitcnt vmcnt(9)
    s_waitcnt lgkmcnt(3)
    v_mfma_f32_32x32x16_bf16 v[128:143], v[176:179], v[208:211], v[128:143]
    ds_read_b128 v[200:203], v17 offset:25600
    v_exp_f32 v22, v22
    v_exp_f32 v21, v21
    v_exp_f32 v23, v23
    s_waitcnt lgkmcnt(3)
    v_mfma_f32_32x32x16_bf16 v[144:159], v[176:179], v[212:215], v[144:159]
    ds_read_b128 v[204:207], v17 offset:26112
    s_add_u32 s44, s48, 525312
    buffer_load_dwordx4 v[176:179], v10, s[24:27], s44 offen sc1
    v_add_f32 v20, 1.0, v20
    v_add_f32 v22, 1.0, v22
    v_add_f32 v21, 1.0, v21
    v_add_f32 v23, 1.0, v23
    v_rcp_f32 v20, v20
    s_waitcnt vmcnt(9)
    s_waitcnt lgkmcnt(3)
    v_mfma_f32_32x32x16_bf16 v[128:143], v[180:183], v[192:195], v[128:143]
    ds_read_b128 v[208:211], v17 offset:28160
    v_rcp_f32 v22, v22
    v_rcp_f32 v21, v21
    v_rcp_f32 v23, v23
    s_waitcnt lgkmcnt(3)
    v_mfma_f32_32x32x16_bf16 v[144:159], v[180:183], v[196:199], v[144:159]
    ds_read_b128 v[212:215], v17 offset:28672
    s_add_u32 s44, s48, 558080
    buffer_load_dwordx4 v[180:183], v10, s[24:27], s44 offen sc1
    v_mul_f32 v20, v20, v92
    v_mul_f32 v22, v22, v94
    v_mul_f32 v21, v21, v93
    v_mul_f32 v23, v23, v95
    v_cvt_pk_bf16_f32 v46, v20, v21
    v_cvt_pk_bf16_f32 v47, v22, v23
    s_waitcnt vmcnt(9)
    s_waitcnt lgkmcnt(3)
    v_mfma_f32_32x32x16_bf16 v[128:143], v[184:187], v[200:203], v[128:143]
    ds_read_b128 v[192:195], v17 offset:30720
    ds_write_b128 v9, v[32:35] offset:0
    ds_write_b128 v9, v[36:39] offset:2048
    ds_write_b128 v9, v[40:43] offset:1024
    ds_write_b128 v9, v[44:47] offset:3072
    s_waitcnt lgkmcnt(7)
    v_mfma_f32_32x32x16_bf16 v[144:159], v[184:187], v[204:207], v[144:159]
    ds_read_b128 v[196:199], v17 offset:31232
    s_add_u32 s44, s48, 528384
    buffer_load_dwordx4 v[184:187], v10, s[24:27], s44 offen sc1
    s_waitcnt vmcnt(9)
    s_waitcnt lgkmcnt(7)
    v_mfma_f32_32x32x16_bf16 v[128:143], v[188:191], v[208:211], v[128:143]
    ds_read_b128 v[200:203], v17 offset:33280
    s_waitcnt lgkmcnt(7)
    v_mfma_f32_32x32x16_bf16 v[144:159], v[188:191], v[212:215], v[144:159]
    ds_read_b128 v[204:207], v17 offset:33792
    s_add_u32 s44, s48, 561152
    buffer_load_dwordx4 v[188:191], v10, s[24:27], s44 offen sc1
    s_waitcnt vmcnt(9)
    s_waitcnt lgkmcnt(7)
    v_mfma_f32_32x32x16_bf16 v[128:143], v[216:219], v[192:195], v[128:143]
    ds_read_b128 v[208:211], v17 offset:35840
    s_waitcnt lgkmcnt(3)
    v_mfma_f32_32x32x16_bf16 v[144:159], v[216:219], v[196:199], v[144:159]
    ds_read_b128 v[212:215], v17 offset:36352
    s_add_u32 s44, s48, 529408
    buffer_load_dwordx4 v[216:219], v10, s[24:27], s44 offen sc1
    s_waitcnt vmcnt(9)
    s_waitcnt lgkmcnt(3)
    v_mfma_f32_32x32x16_bf16 v[128:143], v[220:223], v[200:203], v[128:143]
    ds_read_b128 v[192:195], v17 offset:38400
    s_waitcnt lgkmcnt(3)
    v_mfma_f32_32x32x16_bf16 v[144:159], v[220:223], v[204:207], v[144:159]
    ds_read_b128 v[196:199], v17 offset:38912
    s_add_u32 s44, s48, 562176
    buffer_load_dwordx4 v[220:223], v10, s[24:27], s44 offen sc1
    s_waitcnt vmcnt(9)
    s_waitcnt lgkmcnt(3)
    v_mfma_f32_32x32x16_bf16 v[128:143], v[160:163], v[208:211], v[128:143]
    s_waitcnt lgkmcnt(2)
    v_mfma_f32_32x32x16_bf16 v[144:159], v[160:163], v[212:215], v[144:159]
    s_add_u32 s44, s48, 532480
    buffer_load_dwordx4 v[160:163], v10, s[24:27], s44 offen sc1
    s_waitcnt vmcnt(9)
    s_waitcnt lgkmcnt(1)
    v_mfma_f32_32x32x16_bf16 v[128:143], v[164:167], v[192:195], v[128:143]
    s_waitcnt lgkmcnt(0)
    v_mfma_f32_32x32x16_bf16 v[144:159], v[164:167], v[196:199], v[144:159]
    s_add_u32 s44, s48, 565248
    buffer_load_dwordx4 v[164:167], v10, s[24:27], s44 offen sc1
    s_waitcnt lgkmcnt(0)
    s_barrier
    ds_read_b128 v[192:195], v19 offset:0
    ds_read_b128 v[196:199], v19 offset:1024
    ds_read_b128 v[200:203], v19 offset:2048
    ds_read_b128 v[204:207], v19 offset:3072
    s_waitcnt vmcnt(31)
    v_mfma_f32_32x32x16_bf16 v[64:79], v[24:27], v[224:227], 0
    v_mfma_f32_32x32x16_bf16 v[64:79], v[28:31], v[228:231], v[64:79]
    v_mfma_f32_32x32x16_bf16 v[80:95], v[24:27], v[232:235], 0
    v_mfma_f32_32x32x16_bf16 v[80:95], v[28:31], v[236:239], v[80:95]
    v_mfma_f32_32x32x16_bf16 v[96:111], v[24:27], v[240:243], 0
    v_mfma_f32_32x32x16_bf16 v[96:111], v[28:31], v[244:247], v[96:111]
    v_mfma_f32_32x32x16_bf16 v[112:127], v[24:27], v[248:251], 0
    v_mfma_f32_32x32x16_bf16 v[112:127], v[28:31], v[252:255], v[112:127]
    s_waitcnt vmcnt(9)
    s_waitcnt lgkmcnt(3)
    v_mfma_f32_32x32x16_bf16 v[64:79], v[168:171], v[192:195], v[64:79]
    ds_read_b128 v[208:211], v19 offset:8192
    s_add_u32 s44, s48, 533504
    buffer_load_dwordx4 v[224:227], v10, s[24:27], s44 offen sc1
    s_add_u32 s44, s48, 566272
    buffer_load_dwordx4 v[228:231], v10, s[24:27], s44 offen sc1
    v_mul_f32 v20, v128, v128
    v_mul_f32 v22, v130, v130
    v_mul_f32 v21, v129, v129
    v_mul_f32 v23, v131, v131
    v_fmamk_f32 v20, v20, 0xbdd2d3e8, v18
    v_fmamk_f32 v22, v22, 0xbdd2d3e8, v18
    s_waitcnt lgkmcnt(3)
    v_mfma_f32_32x32x16_bf16 v[80:95], v[168:171], v[196:199], v[80:95]
    ds_read_b128 v[212:215], v19 offset:9216
    s_add_u32 s44, s48, 536576
    buffer_load_dwordx4 v[232:235], v10, s[24:27], s44 offen sc1
    s_add_u32 s44, s48, 569344
    buffer_load_dwordx4 v[236:239], v10, s[24:27], s44 offen sc1
    v_fmamk_f32 v21, v21, 0xbdd2d3e8, v18
    v_fmamk_f32 v23, v23, 0xbdd2d3e8, v18
    v_mul_f32 v20, v20, v128
    v_mul_f32 v22, v22, v130
    v_mul_f32 v21, v21, v129
    v_mul_f32 v23, v23, v131
    s_waitcnt vmcnt(12)
    v_mfma_f32_32x32x16_bf16 v[96:111], v[172:175], v[192:195], v[96:111]
    s_add_u32 s44, s48, 537600
    buffer_load_dwordx4 v[240:243], v10, s[24:27], s44 offen sc1
    s_add_u32 s44, s48, 570368
    buffer_load_dwordx4 v[244:247], v10, s[24:27], s44 offen sc1
    v_exp_f32 v20, v20
    v_exp_f32 v22, v22
    v_exp_f32 v21, v21
    v_mfma_f32_32x32x16_bf16 v[112:127], v[172:175], v[196:199], v[112:127]
    s_add_u32 s44, s48, 540672
    buffer_load_dwordx4 v[248:251], v10, s[24:27], s44 offen sc1
    s_add_u32 s44, s48, 573440
    buffer_load_dwordx4 v[252:255], v10, s[24:27], s44 offen sc1
    v_exp_f32 v23, v23
    v_add_f32 v20, 1.0, v20
    v_add_f32 v22, 1.0, v22
    v_add_f32 v21, 1.0, v21
    v_add_f32 v23, 1.0, v23
    s_waitcnt vmcnt(15)
    s_waitcnt lgkmcnt(3)
    v_mfma_f32_32x32x16_bf16 v[64:79], v[176:179], v[200:203], v[64:79]
    ds_read_b128 v[192:195], v19 offset:10240
    s_add_u32 s44, s48, 541696
    buffer_load_dwordx4 v[168:171], v10, s[24:27], s44 offen sc1
    s_add_u32 s44, s48, 574464
    buffer_load_dwordx4 v[172:175], v10, s[24:27], s44 offen sc1
    v_rcp_f32 v20, v20
    v_rcp_f32 v22, v22
    v_rcp_f32 v21, v21
    s_waitcnt lgkmcnt(3)
    v_mfma_f32_32x32x16_bf16 v[80:95], v[176:179], v[204:207], v[80:95]
    ds_read_b128 v[196:199], v19 offset:11264
    s_add_u32 s44, s48, 544768
    buffer_load_dwordx4 v[176:179], v10, s[24:27], s44 offen sc1
    v_rcp_f32 v23, v23
    v_mul_f32 v20, v20, v128
    v_mul_f32 v22, v22, v130
    v_mul_f32 v21, v21, v129
    v_mul_f32 v23, v23, v131
    s_waitcnt vmcnt(17)
    v_mfma_f32_32x32x16_bf16 v[96:111], v[180:183], v[200:203], v[96:111]
    v_cvt_pk_bf16_f32 v48, v20, v21
    v_cvt_pk_bf16_f32 v49, v22, v23
    v_mul_f32 v20, v132, v132
    v_mul_f32 v22, v134, v134
    v_mul_f32 v21, v133, v133
    v_mul_f32 v23, v135, v135
    v_mfma_f32_32x32x16_bf16 v[112:127], v[180:183], v[204:207], v[112:127]
    s_add_u32 s44, s48, 577536
    buffer_load_dwordx4 v[180:183], v10, s[24:27], s44 offen sc1
    v_fmamk_f32 v20, v20, 0xbdd2d3e8, v18
    v_fmamk_f32 v22, v22, 0xbdd2d3e8, v18
    v_fmamk_f32 v21, v21, 0xbdd2d3e8, v18
    v_fmamk_f32 v23, v23, 0xbdd2d3e8, v18
    v_mul_f32 v20, v20, v132
    v_mul_f32 v22, v22, v134
    s_waitcnt vmcnt(17)
    s_waitcnt lgkmcnt(3)
    v_mfma_f32_32x32x16_bf16 v[64:79], v[184:187], v[208:211], v[64:79]
    ds_read_b128 v[200:203], v19 offset:16384
    v_mul_f32 v21, v21, v133
    v_mul_f32 v23, v23, v135
    v_exp_f32 v20, v20
    v_exp_f32 v22, v22
    s_waitcnt lgkmcnt(3)
    v_mfma_f32_32x32x16_bf16 v[80:95], v[184:187], v[212:215], v[80:95]
    ds_read_b128 v[204:207], v19 offset:17408
    s_add_u32 s44, s48, 545792
    buffer_load_dwordx4 v[184:187], v10, s[24:27], s44 offen sc1
    v_exp_f32 v21, v21
    v_exp_f32 v23, v23
    v_add_f32 v20, 1.0, v20
    v_add_f32 v22, 1.0, v22
    s_waitcnt vmcnt(17)
    v_mfma_f32_32x32x16_bf16 v[96:111], v[188:191], v[208:211], v[96:111]
    v_add_f32 v21, 1.0, v21
    v_add_f32 v23, 1.0, v23
    v_rcp_f32 v20, v20
    v_rcp_f32 v22, v22
    v_mfma_f32_32x32x16_bf16 v[112:127], v[188:191], v[212:215], v[112:127]
    s_add_u32 s44, s48, 578560
    buffer_load_dwordx4 v[188:191], v10, s[24:27], s44 offen sc1
    v_rcp_f32 v21, v21
    v_rcp_f32 v23, v23
    v_mul_f32 v20, v20, v132
    v_mul_f32 v22, v22, v134
    s_waitcnt vmcnt(17)
    s_waitcnt lgkmcnt(3)
    v_mfma_f32_32x32x16_bf16 v[64:79], v[216:219], v[192:195], v[64:79]
    ds_read_b128 v[208:211], v19 offset:18432
    v_mul_f32 v21, v21, v133
    v_mul_f32 v23, v23, v135
    v_cvt_pk_bf16_f32 v50, v20, v21
    v_cvt_pk_bf16_f32 v51, v22, v23
    v_mul_f32 v20, v136, v136
    v_mul_f32 v22, v138, v138
    s_waitcnt lgkmcnt(3)
    v_mfma_f32_32x32x16_bf16 v[80:95], v[216:219], v[196:199], v[80:95]
    ds_read_b128 v[212:215], v19 offset:19456
    s_add_u32 s44, s48, 548864
    buffer_load_dwordx4 v[216:219], v10, s[24:27], s44 offen sc1
    v_mul_f32 v21, v137, v137
    v_mul_f32 v23, v139, v139
    v_fmamk_f32 v20, v20, 0xbdd2d3e8, v18
    v_fmamk_f32 v22, v22, 0xbdd2d3e8, v18
    v_fmamk_f32 v21, v21, 0xbdd2d3e8, v18
    v_fmamk_f32 v23, v23, 0xbdd2d3e8, v18
    s_waitcnt vmcnt(17)
    v_mfma_f32_32x32x16_bf16 v[96:111], v[220:223], v[192:195], v[96:111]
    v_mul_f32 v20, v20, v136
    v_mul_f32 v22, v22, v138
    v_mul_f32 v21, v21, v137
    v_mul_f32 v23, v23, v139
    v_exp_f32 v20, v20
    v_mfma_f32_32x32x16_bf16 v[112:127], v[220:223], v[196:199], v[112:127]
    s_add_u32 s44, s48, 581632
    buffer_load_dwordx4 v[220:223], v10, s[24:27], s44 offen sc1
    v_exp_f32 v22, v22
    v_exp_f32 v21, v21
    v_exp_f32 v23, v23
    s_waitcnt vmcnt(17)
    s_waitcnt lgkmcnt(3)
    v_mfma_f32_32x32x16_bf16 v[64:79], v[160:163], v[200:203], v[64:79]
    ds_read_b128 v[192:195], v19 offset:24576
    v_add_f32 v20, 1.0, v20
    v_add_f32 v22, 1.0, v22
    v_add_f32 v21, 1.0, v21
    v_add_f32 v23, 1.0, v23
    v_rcp_f32 v20, v20
    s_waitcnt lgkmcnt(3)
    v_mfma_f32_32x32x16_bf16 v[80:95], v[160:163], v[204:207], v[80:95]
    ds_read_b128 v[196:199], v19 offset:25600
    s_add_u32 s44, s48, 549888
    buffer_load_dwordx4 v[160:163], v10, s[24:27], s44 offen sc1
    v_rcp_f32 v22, v22
    v_rcp_f32 v21, v21
    v_rcp_f32 v23, v23
    s_waitcnt vmcnt(17)
    v_mfma_f32_32x32x16_bf16 v[96:111], v[164:167], v[200:203], v[96:111]
    v_mul_f32 v20, v20, v136
    v_mul_f32 v22, v22, v138
    v_mul_f32 v21, v21, v137
    v_mul_f32 v23, v23, v139
    v_cvt_pk_bf16_f32 v52, v20, v21
    v_cvt_pk_bf16_f32 v53, v22, v23
    v_mfma_f32_32x32x16_bf16 v[112:127], v[164:167], v[204:207], v[112:127]
    s_add_u32 s44, s48, 582656
    buffer_load_dwordx4 v[164:167], v10, s[24:27], s44 offen sc1
    v_mul_f32 v20, v140, v140
    v_mul_f32 v22, v142, v142
    v_mul_f32 v21, v141, v141
    v_mul_f32 v23, v143, v143
    v_fmamk_f32 v20, v20, 0xbdd2d3e8, v18
    v_fmamk_f32 v22, v22, 0xbdd2d3e8, v18
    s_waitcnt vmcnt(17)
    s_waitcnt lgkmcnt(3)
    v_mfma_f32_32x32x16_bf16 v[64:79], v[224:227], v[208:211], v[64:79]
    ds_read_b128 v[200:203], v19 offset:26624
    v_fmamk_f32 v21, v21, 0xbdd2d3e8, v18
    v_fmamk_f32 v23, v23, 0xbdd2d3e8, v18
    v_mul_f32 v20, v20, v140
    v_mul_f32 v22, v22, v142
    v_mul_f32 v21, v21, v141
    v_mul_f32 v23, v23, v143
    s_waitcnt lgkmcnt(3)
    v_mfma_f32_32x32x16_bf16 v[80:95], v[224:227], v[212:215], v[80:95]
    ds_read_b128 v[204:207], v19 offset:27648
    s_add_u32 s44, s48, 552960
    buffer_load_dwordx4 v[224:227], v10, s[24:27], s44 offen sc1
    v_exp_f32 v20, v20
    v_exp_f32 v22, v22
    v_exp_f32 v21, v21
    s_waitcnt vmcnt(17)
    v_mfma_f32_32x32x16_bf16 v[96:111], v[228:231], v[208:211], v[96:111]
    v_exp_f32 v23, v23
    v_add_f32 v20, 1.0, v20
    v_add_f32 v22, 1.0, v22
    v_add_f32 v21, 1.0, v21
    v_add_f32 v23, 1.0, v23
    v_mfma_f32_32x32x16_bf16 v[112:127], v[228:231], v[212:215], v[112:127]
    s_add_u32 s44, s48, 585728
    buffer_load_dwordx4 v[228:231], v10, s[24:27], s44 offen sc1
    v_rcp_f32 v20, v20
    v_rcp_f32 v22, v22
    v_rcp_f32 v21, v21
    s_waitcnt vmcnt(17)
    s_waitcnt lgkmcnt(3)
    v_mfma_f32_32x32x16_bf16 v[64:79], v[232:235], v[192:195], v[64:79]
    ds_read_b128 v[208:211], v19 offset:32768
    v_rcp_f32 v23, v23
    v_mul_f32 v20, v20, v140
    v_mul_f32 v22, v22, v142
    v_mul_f32 v21, v21, v141
    v_mul_f32 v23, v23, v143
    s_waitcnt lgkmcnt(3)
    v_mfma_f32_32x32x16_bf16 v[80:95], v[232:235], v[196:199], v[80:95]
    ds_read_b128 v[212:215], v19 offset:33792
    s_add_u32 s44, s48, 553984
    buffer_load_dwordx4 v[232:235], v10, s[24:27], s44 offen sc1
    v_cvt_pk_bf16_f32 v54, v20, v21
    v_cvt_pk_bf16_f32 v55, v22, v23
    v_mul_f32 v20, v144, v144
    v_mul_f32 v22, v146, v146
    v_mul_f32 v21, v145, v145
    v_mul_f32 v23, v147, v147
    s_waitcnt vmcnt(17)
    v_mfma_f32_32x32x16_bf16 v[96:111], v[236:239], v[192:195], v[96:111]
    v_fmamk_f32 v20, v20, 0xbdd2d3e8, v18
    v_fmamk_f32 v22, v22, 0xbdd2d3e8, v18
    v_fmamk_f32 v21, v21, 0xbdd2d3e8, v18
    v_fmamk_f32 v23, v23, 0xbdd2d3e8, v18
    v_mul_f32 v20, v20, v144
    v_mul_f32 v22, v22, v146
    v_mfma_f32_32x32x16_bf16 v[112:127], v[236:239], v[196:199], v[112:127]
    s_add_u32 s44, s48, 586752
    buffer_load_dwordx4 v[236:239], v10, s[24:27], s44 offen sc1
    v_mul_f32 v21, v21, v145
    v_mul_f32 v23, v23, v147
    v_exp_f32 v20, v20
    v_exp_f32 v22, v22
    s_waitcnt vmcnt(17)
    s_waitcnt lgkmcnt(3)
    v_mfma_f32_32x32x16_bf16 v[64:79], v[240:243], v[200:203], v[64:79]
    ds_read_b128 v[192:195], v19 offset:34816
    v_exp_f32 v21, v21
    v_exp_f32 v23, v23
    v_add_f32 v20, 1.0, v20
    v_add_f32 v22, 1.0, v22
    s_waitcnt lgkmcnt(3)
    v_mfma_f32_32x32x16_bf16 v[80:95], v[240:243], v[204:207], v[80:95]
    ds_read_b128 v[196:199], v19 offset:35840
    s_add_u32 s44, s48, 526336
    buffer_load_dwordx4 v[240:243], v10, s[24:27], s44 offen sc1
    v_add_f32 v21, 1.0, v21
    v_add_f32 v23, 1.0, v23
    v_rcp_f32 v20, v20
    v_rcp_f32 v22, v22
    s_waitcnt vmcnt(17)
    v_mfma_f32_32x32x16_bf16 v[96:111], v[244:247], v[200:203], v[96:111]
    v_rcp_f32 v21, v21
    v_rcp_f32 v23, v23
    v_mul_f32 v20, v20, v144
    v_mul_f32 v22, v22, v146
    v_mfma_f32_32x32x16_bf16 v[112:127], v[244:247], v[204:207], v[112:127]
    s_add_u32 s44, s48, 559104
    buffer_load_dwordx4 v[244:247], v10, s[24:27], s44 offen sc1
    v_mul_f32 v21, v21, v145
    v_mul_f32 v23, v23, v147
    v_cvt_pk_bf16_f32 v56, v20, v21
    v_cvt_pk_bf16_f32 v57, v22, v23
    v_mul_f32 v20, v148, v148
    v_mul_f32 v22, v150, v150
    s_waitcnt vmcnt(17)
    s_waitcnt lgkmcnt(3)
    v_mfma_f32_32x32x16_bf16 v[64:79], v[248:251], v[208:211], v[64:79]
    ds_read_b128 v[200:203], v19 offset:40960
    v_mul_f32 v21, v149, v149
    v_mul_f32 v23, v151, v151
    v_fmamk_f32 v20, v20, 0xbdd2d3e8, v18
    v_fmamk_f32 v22, v22, 0xbdd2d3e8, v18
    v_fmamk_f32 v21, v21, 0xbdd2d3e8, v18
    v_fmamk_f32 v23, v23, 0xbdd2d3e8, v18
    s_waitcnt lgkmcnt(3)
    v_mfma_f32_32x32x16_bf16 v[80:95], v[248:251], v[212:215], v[80:95]
    ds_read_b128 v[204:207], v19 offset:41984
    s_add_u32 s44, s48, 527360
    buffer_load_dwordx4 v[248:251], v10, s[24:27], s44 offen sc1
    v_mul_f32 v20, v20, v148
    v_mul_f32 v22, v22, v150
    v_mul_f32 v21, v21, v149
    v_mul_f32 v23, v23, v151
    v_exp_f32 v20, v20
    s_waitcnt vmcnt(17)
    v_mfma_f32_32x32x16_bf16 v[96:111], v[252:255], v[208:211], v[96:111]
    v_exp_f32 v22, v22
    v_exp_f32 v21, v21
    v_exp_f32 v23, v23
    v_mfma_f32_32x32x16_bf16 v[112:127], v[252:255], v[212:215], v[112:127]
    s_add_u32 s44, s48, 560128
    buffer_load_dwordx4 v[252:255], v10, s[24:27], s44 offen sc1
    v_add_f32 v20, 1.0, v20
    v_add_f32 v22, 1.0, v22
    v_add_f32 v21, 1.0, v21
    v_add_f32 v23, 1.0, v23
    v_rcp_f32 v20, v20
    s_waitcnt vmcnt(17)
    s_waitcnt lgkmcnt(3)
    v_mfma_f32_32x32x16_bf16 v[64:79], v[168:171], v[192:195], v[64:79]
    ds_read_b128 v[208:211], v19 offset:43008
    v_rcp_f32 v22, v22
    v_rcp_f32 v21, v21
    v_rcp_f32 v23, v23
    s_waitcnt lgkmcnt(3)
    v_mfma_f32_32x32x16_bf16 v[80:95], v[168:171], v[196:199], v[80:95]
    ds_read_b128 v[212:215], v19 offset:44032
    s_add_u32 s44, s48, 530432
    buffer_load_dwordx4 v[168:171], v10, s[24:27], s44 offen sc1
    v_mul_f32 v20, v20, v148
    v_mul_f32 v22, v22, v150
    v_mul_f32 v21, v21, v149
    v_mul_f32 v23, v23, v151
    v_cvt_pk_bf16_f32 v58, v20, v21
    v_cvt_pk_bf16_f32 v59, v22, v23
    s_waitcnt vmcnt(17)
    v_mfma_f32_32x32x16_bf16 v[96:111], v[172:175], v[192:195], v[96:111]
    v_mul_f32 v20, v152, v152
    v_mul_f32 v22, v154, v154
    v_mul_f32 v21, v153, v153
    v_mul_f32 v23, v155, v155
    v_fmamk_f32 v20, v20, 0xbdd2d3e8, v18
    v_fmamk_f32 v22, v22, 0xbdd2d3e8, v18
    v_mfma_f32_32x32x16_bf16 v[112:127], v[172:175], v[196:199], v[112:127]
    s_add_u32 s44, s48, 563200
    buffer_load_dwordx4 v[172:175], v10, s[24:27], s44 offen sc1
    v_fmamk_f32 v21, v21, 0xbdd2d3e8, v18
    v_fmamk_f32 v23, v23, 0xbdd2d3e8, v18
    v_mul_f32 v20, v20, v152
    v_mul_f32 v22, v22, v154
    v_mul_f32 v21, v21, v153
    v_mul_f32 v23, v23, v155
    s_waitcnt vmcnt(17)
    s_waitcnt lgkmcnt(3)
    v_mfma_f32_32x32x16_bf16 v[64:79], v[176:179], v[200:203], v[64:79]
    ds_read_b128 v[192:195], v19 offset:49152
    v_exp_f32 v20, v20
    v_exp_f32 v22, v22
    v_exp_f32 v21, v21
    s_waitcnt lgkmcnt(3)
    v_mfma_f32_32x32x16_bf16 v[80:95], v[176:179], v[204:207], v[80:95]
    ds_read_b128 v[196:199], v19 offset:50176
    s_add_u32 s44, s48, 531456
    buffer_load_dwordx4 v[176:179], v10, s[24:27], s44 offen sc1
    v_exp_f32 v23, v23
    v_add_f32 v20, 1.0, v20
    v_add_f32 v22, 1.0, v22
    v_add_f32 v21, 1.0, v21
    v_add_f32 v23, 1.0, v23
    s_waitcnt vmcnt(17)
    v_mfma_f32_32x32x16_bf16 v[96:111], v[180:183], v[200:203], v[96:111]
    v_rcp_f32 v20, v20
    v_rcp_f32 v22, v22
    v_rcp_f32 v21, v21
    v_mfma_f32_32x32x16_bf16 v[112:127], v[180:183], v[204:207], v[112:127]
    s_add_u32 s44, s48, 564224
    buffer_load_dwordx4 v[180:183], v10, s[24:27], s44 offen sc1
    v_rcp_f32 v23, v23
    v_mul_f32 v20, v20, v152
    v_mul_f32 v22, v22, v154
    v_mul_f32 v21, v21, v153
    v_mul_f32 v23, v23, v155
    s_waitcnt vmcnt(17)
    s_waitcnt lgkmcnt(3)
    v_mfma_f32_32x32x16_bf16 v[64:79], v[184:187], v[208:211], v[64:79]
    ds_read_b128 v[200:203], v19 offset:51200
    v_cvt_pk_bf16_f32 v60, v20, v21
    v_cvt_pk_bf16_f32 v61, v22, v23
    v_mul_f32 v20, v156, v156
    v_mul_f32 v22, v158, v158
    v_mul_f32 v21, v157, v157
    v_mul_f32 v23, v159, v159
    s_waitcnt lgkmcnt(3)
    v_mfma_f32_32x32x16_bf16 v[80:95], v[184:187], v[212:215], v[80:95]
    ds_read_b128 v[204:207], v19 offset:52224
    s_add_u32 s44, s48, 534528
    buffer_load_dwordx4 v[184:187], v10, s[24:27], s44 offen sc1
    v_fmamk_f32 v20, v20, 0xbdd2d3e8, v18
    v_fmamk_f32 v22, v22, 0xbdd2d3e8, v18
    v_fmamk_f32 v21, v21, 0xbdd2d3e8, v18
    v_fmamk_f32 v23, v23, 0xbdd2d3e8, v18
    v_mul_f32 v20, v20, v156
    v_mul_f32 v22, v22, v158
    s_waitcnt vmcnt(17)
    v_mfma_f32_32x32x16_bf16 v[96:111], v[188:191], v[208:211], v[96:111]
    v_mul_f32 v21, v21, v157
    v_mul_f32 v23, v23, v159
    v_exp_f32 v20, v20
    v_exp_f32 v22, v22
    v_mfma_f32_32x32x16_bf16 v[112:127], v[188:191], v[212:215], v[112:127]
    s_add_u32 s44, s48, 567296
    buffer_load_dwordx4 v[188:191], v10, s[24:27], s44 offen sc1
    v_exp_f32 v21, v21
    v_exp_f32 v23, v23
    v_add_f32 v20, 1.0, v20
    v_add_f32 v22, 1.0, v22
    s_waitcnt vmcnt(17)
    s_waitcnt lgkmcnt(3)
    v_mfma_f32_32x32x16_bf16 v[64:79], v[216:219], v[192:195], v[64:79]
    ds_read_b128 v[208:211], v19 offset:57344
    v_add_f32 v21, 1.0, v21
    v_add_f32 v23, 1.0, v23
    v_rcp_f32 v20, v20
    v_rcp_f32 v22, v22
    s_waitcnt lgkmcnt(3)
    v_mfma_f32_32x32x16_bf16 v[80:95], v[216:219], v[196:199], v[80:95]
    ds_read_b128 v[212:215], v19 offset:58368
    s_add_u32 s44, s48, 535552
    buffer_load_dwordx4 v[216:219], v10, s[24:27], s44 offen sc1
    v_rcp_f32 v21, v21
    v_rcp_f32 v23, v23
    v_mul_f32 v20, v20, v156
    v_mul_f32 v22, v22, v158
    s_waitcnt vmcnt(17)
    v_mfma_f32_32x32x16_bf16 v[96:111], v[220:223], v[192:195], v[96:111]
    v_mul_f32 v21, v21, v157
    v_mul_f32 v23, v23, v159
    v_cvt_pk_bf16_f32 v62, v20, v21
    v_cvt_pk_bf16_f32 v63, v22, v23
    ds_write_b128 v9, v[48:51] offset:4096
    ds_write_b128 v9, v[52:55] offset:6144
    v_mfma_f32_32x32x16_bf16 v[112:127], v[220:223], v[196:199], v[112:127]
    s_add_u32 s44, s48, 568320
    buffer_load_dwordx4 v[220:223], v10, s[24:27], s44 offen sc1
    ds_write_b128 v9, v[56:59] offset:5120
    ds_write_b128 v9, v[60:63] offset:7168
    s_waitcnt vmcnt(17)
    s_waitcnt lgkmcnt(7)
    v_mfma_f32_32x32x16_bf16 v[64:79], v[160:163], v[200:203], v[64:79]
    ds_read_b128 v[192:195], v19 offset:59392
    s_waitcnt lgkmcnt(7)
    v_mfma_f32_32x32x16_bf16 v[80:95], v[160:163], v[204:207], v[80:95]
    ds_read_b128 v[196:199], v19 offset:60416
    s_add_u32 s44, s48, 538624
    buffer_load_dwordx4 v[160:163], v10, s[24:27], s44 offen sc1
    s_waitcnt vmcnt(17)
    v_mfma_f32_32x32x16_bf16 v[96:111], v[164:167], v[200:203], v[96:111]
    v_mfma_f32_32x32x16_bf16 v[112:127], v[164:167], v[204:207], v[112:127]
    s_add_u32 s44, s48, 571392
    buffer_load_dwordx4 v[164:167], v10, s[24:27], s44 offen sc1
    s_waitcnt vmcnt(17)
    s_waitcnt lgkmcnt(7)
    v_mfma_f32_32x32x16_bf16 v[64:79], v[224:227], v[208:211], v[64:79]
    s_waitcnt lgkmcnt(6)
    v_mfma_f32_32x32x16_bf16 v[80:95], v[224:227], v[212:215], v[80:95]
    s_add_u32 s44, s48, 539648
    buffer_load_dwordx4 v[224:227], v10, s[24:27], s44 offen sc1
    s_waitcnt vmcnt(17)
    v_mfma_f32_32x32x16_bf16 v[96:111], v[228:231], v[208:211], v[96:111]
    v_mfma_f32_32x32x16_bf16 v[112:127], v[228:231], v[212:215], v[112:127]
    s_add_u32 s44, s48, 572416
    buffer_load_dwordx4 v[228:231], v10, s[24:27], s44 offen sc1
    s_waitcnt vmcnt(17)
    s_waitcnt lgkmcnt(1)
    v_mfma_f32_32x32x16_bf16 v[64:79], v[232:235], v[192:195], v[64:79]
    s_waitcnt lgkmcnt(0)
    v_mfma_f32_32x32x16_bf16 v[80:95], v[232:235], v[196:199], v[80:95]
    s_add_u32 s44, s48, 542720
    buffer_load_dwordx4 v[232:235], v10, s[24:27], s44 offen sc1
    s_waitcnt vmcnt(17)
    v_mfma_f32_32x32x16_bf16 v[96:111], v[236:239], v[192:195], v[96:111]
    v_mfma_f32_32x32x16_bf16 v[112:127], v[236:239], v[196:199], v[112:127]
    s_add_u32 s44, s48, 575488
    buffer_load_dwordx4 v[236:239], v10, s[24:27], s44 offen sc1
    s_waitcnt lgkmcnt(0)
    s_barrier
    ds_read_b128 v[200:203], v19 offset:4096
    ds_read_b128 v[204:207], v19 offset:5120
    ds_read_b128 v[208:211], v19 offset:6144
    ds_read_b128 v[212:215], v19 offset:7168
    s_waitcnt vmcnt(17)
    s_waitcnt lgkmcnt(3)
    v_mfma_f32_32x32x16_bf16 v[64:79], v[240:243], v[200:203], v[64:79]
    ds_read_b128 v[192:195], v19 offset:12288
    s_add_u32 s44, s48, 543744
    buffer_load_dwordx4 v[128:131], v10, s[24:27], s44 offen sc1
    s_add_u32 s44, s48, 576512
    buffer_load_dwordx4 v[132:135], v10, s[24:27], s44 offen sc1
    s_waitcnt lgkmcnt(3)
    v_mfma_f32_32x32x16_bf16 v[80:95], v[240:243], v[204:207], v[80:95]
    ds_read_b128 v[196:199], v19 offset:13312
    s_add_u32 s44, s48, 546816
    buffer_load_dwordx4 v[136:139], v10, s[24:27], s44 offen sc1
    s_add_u32 s44, s48, 579584
    buffer_load_dwordx4 v[140:143], v10, s[24:27], s44 offen sc1
    s_waitcnt vmcnt(20)
    v_mfma_f32_32x32x16_bf16 v[96:111], v[244:247], v[200:203], v[96:111]
    s_add_u32 s44, s48, 547840
    buffer_load_dwordx4 v[144:147], v10, s[24:27], s44 offen sc1
    s_add_u32 s44, s48, 580608
    buffer_load_dwordx4 v[148:151], v10, s[24:27], s44 offen sc1
    v_mfma_f32_32x32x16_bf16 v[112:127], v[244:247], v[204:207], v[112:127]
    s_add_u32 s44, s48, 550912
    buffer_load_dwordx4 v[152:155], v10, s[24:27], s44 offen sc1
    s_add_u32 s44, s48, 583680
    buffer_load_dwordx4 v[156:159], v10, s[24:27], s44 offen sc1
    s_waitcnt vmcnt(23)
    s_waitcnt lgkmcnt(3)
    v_mfma_f32_32x32x16_bf16 v[64:79], v[248:251], v[208:211], v[64:79]
    ds_read_b128 v[200:203], v19 offset:14336
    s_add_u32 s44, s48, 551936
    buffer_load_dwordx4 v[240:243], v10, s[24:27], s44 offen sc1
    s_add_u32 s44, s48, 584704
    buffer_load_dwordx4 v[244:247], v10, s[24:27], s44 offen sc1
    s_waitcnt lgkmcnt(3)
    v_mfma_f32_32x32x16_bf16 v[80:95], v[248:251], v[212:215], v[80:95]
    ds_read_b128 v[204:207], v19 offset:15360
    s_add_u32 s44, s48, 555008
    buffer_load_dwordx4 v[248:251], v10, s[24:27], s44 offen sc1
    s_waitcnt vmcnt(25)
    v_mfma_f32_32x32x16_bf16 v[96:111], v[252:255], v[208:211], v[96:111]
    v_mfma_f32_32x32x16_bf16 v[112:127], v[252:255], v[212:215], v[112:127]
    s_add_u32 s44, s48, 587776
    buffer_load_dwordx4 v[252:255], v10, s[24:27], s44 offen sc1
    s_waitcnt vmcnt(25)
    s_waitcnt lgkmcnt(3)
    v_mfma_f32_32x32x16_bf16 v[64:79], v[168:171], v[192:195], v[64:79]
    ds_read_b128 v[208:211], v19 offset:20480
    s_waitcnt lgkmcnt(3)
    v_mfma_f32_32x32x16_bf16 v[80:95], v[168:171], v[196:199], v[80:95]
    ds_read_b128 v[212:215], v19 offset:21504
    s_add_u32 s44, s48, 556032
    buffer_load_dwordx4 v[168:171], v10, s[24:27], s44 offen sc1
    s_waitcnt vmcnt(25)
    v_mfma_f32_32x32x16_bf16 v[96:111], v[172:175], v[192:195], v[96:111]
    v_mfma_f32_32x32x16_bf16 v[112:127], v[172:175], v[196:199], v[112:127]
    s_add_u32 s44, s48, 588800
    buffer_load_dwordx4 v[172:175], v10, s[24:27], s44 offen sc1
    s_waitcnt vmcnt(25)
    s_waitcnt lgkmcnt(3)
    v_mfma_f32_32x32x16_bf16 v[64:79], v[176:179], v[200:203], v[64:79]
    ds_read_b128 v[192:195], v19 offset:22528
    s_waitcnt lgkmcnt(3)
    v_mfma_f32_32x32x16_bf16 v[80:95], v[176:179], v[204:207], v[80:95]
    ds_read_b128 v[196:199], v19 offset:23552
    s_add_u32 s44, s49, 1048576
    buffer_load_dwordx4 v[176:179], v10, s[24:27], s44 offen sc1
    s_waitcnt vmcnt(25)
    v_mfma_f32_32x32x16_bf16 v[96:111], v[180:183], v[200:203], v[96:111]
    v_mfma_f32_32x32x16_bf16 v[112:127], v[180:183], v[204:207], v[112:127]
    s_add_u32 s44, s49, 1049600
    buffer_load_dwordx4 v[180:183], v10, s[24:27], s44 offen sc1
    s_waitcnt vmcnt(25)
    s_waitcnt lgkmcnt(3)
    v_mfma_f32_32x32x16_bf16 v[64:79], v[184:187], v[208:211], v[64:79]
    ds_read_b128 v[200:203], v19 offset:28672
    s_waitcnt lgkmcnt(3)
    v_mfma_f32_32x32x16_bf16 v[80:95], v[184:187], v[212:215], v[80:95]
    ds_read_b128 v[204:207], v19 offset:29696
    s_add_u32 s44, s49, 1050624
    buffer_load_dwordx4 v[184:187], v10, s[24:27], s44 offen sc1
    s_waitcnt vmcnt(25)
    v_mfma_f32_32x32x16_bf16 v[96:111], v[188:191], v[208:211], v[96:111]
    v_mfma_f32_32x32x16_bf16 v[112:127], v[188:191], v[212:215], v[112:127]
    s_add_u32 s44, s49, 1051648
    buffer_load_dwordx4 v[188:191], v10, s[24:27], s44 offen sc1
    s_waitcnt vmcnt(25)
    s_waitcnt lgkmcnt(3)
    v_mfma_f32_32x32x16_bf16 v[64:79], v[216:219], v[192:195], v[64:79]
    ds_read_b128 v[208:211], v19 offset:30720
    s_waitcnt lgkmcnt(3)
    v_mfma_f32_32x32x16_bf16 v[80:95], v[216:219], v[196:199], v[80:95]
    ds_read_b128 v[212:215], v19 offset:31744
    s_add_u32 s44, s49, 1052672
    buffer_load_dwordx4 v[216:219], v10, s[24:27], s44 offen sc1
    s_waitcnt vmcnt(25)
    v_mfma_f32_32x32x16_bf16 v[96:111], v[220:223], v[192:195], v[96:111]
    v_mfma_f32_32x32x16_bf16 v[112:127], v[220:223], v[196:199], v[112:127]
    s_add_u32 s44, s49, 1053696
    buffer_load_dwordx4 v[220:223], v10, s[24:27], s44 offen sc1
    s_waitcnt vmcnt(25)
    s_waitcnt lgkmcnt(3)
    v_mfma_f32_32x32x16_bf16 v[64:79], v[160:163], v[200:203], v[64:79]
    ds_read_b128 v[192:195], v19 offset:36864
    s_waitcnt lgkmcnt(3)
    v_mfma_f32_32x32x16_bf16 v[80:95], v[160:163], v[204:207], v[80:95]
    ds_read_b128 v[196:199], v19 offset:37888
    s_add_u32 s44, s49, 1054720
    buffer_load_dwordx4 v[160:163], v10, s[24:27], s44 offen sc1
    s_waitcnt vmcnt(25)
    v_mfma_f32_32x32x16_bf16 v[96:111], v[164:167], v[200:203], v[96:111]
    v_mfma_f32_32x32x16_bf16 v[112:127], v[164:167], v[204:207], v[112:127]
    s_add_u32 s44, s49, 1055744
    buffer_load_dwordx4 v[164:167], v10, s[24:27], s44 offen sc1
    s_waitcnt vmcnt(25)
    s_waitcnt lgkmcnt(3)
    v_mfma_f32_32x32x16_bf16 v[64:79], v[224:227], v[208:211], v[64:79]
    ds_read_b128 v[200:203], v19 offset:38912
    s_waitcnt lgkmcnt(3)
    v_mfma_f32_32x32x16_bf16 v[80:95], v[224:227], v[212:215], v[80:95]
    ds_read_b128 v[204:207], v19 offset:39936
    s_add_u32 s44, s49, 1056768
    buffer_load_dwordx4 v[224:227], v10, s[24:27], s44 offen sc1
    s_waitcnt vmcnt(25)
    v_mfma_f32_32x32x16_bf16 v[96:111], v[228:231], v[208:211], v[96:111]
    v_mfma_f32_32x32x16_bf16 v[112:127], v[228:231], v[212:215], v[112:127]
    s_add_u32 s44, s49, 1057792
    buffer_load_dwordx4 v[228:231], v10, s[24:27], s44 offen sc1
    s_waitcnt vmcnt(25)
    s_waitcnt lgkmcnt(3)
    v_mfma_f32_32x32x16_bf16 v[64:79], v[232:235], v[192:195], v[64:79]
    ds_read_b128 v[208:211], v19 offset:45056
    s_waitcnt lgkmcnt(3)
    v_mfma_f32_32x32x16_bf16 v[80:95], v[232:235], v[196:199], v[80:95]
    ds_read_b128 v[212:215], v19 offset:46080
    s_add_u32 s44, s49, 1058816
    buffer_load_dwordx4 v[232:235], v10, s[24:27], s44 offen sc1
    s_waitcnt vmcnt(25)
    v_mfma_f32_32x32x16_bf16 v[96:111], v[236:239], v[192:195], v[96:111]
    v_mfma_f32_32x32x16_bf16 v[112:127], v[236:239], v[196:199], v[112:127]
    s_add_u32 s44, s49, 1059840
    buffer_load_dwordx4 v[236:239], v10, s[24:27], s44 offen sc1
    s_waitcnt vmcnt(25)
    s_waitcnt lgkmcnt(3)
    v_mfma_f32_32x32x16_bf16 v[64:79], v[128:131], v[200:203], v[64:79]
    ds_read_b128 v[192:195], v19 offset:47104
    s_waitcnt lgkmcnt(3)
    v_mfma_f32_32x32x16_bf16 v[80:95], v[128:131], v[204:207], v[80:95]
    ds_read_b128 v[196:199], v19 offset:48128
    s_add_u32 s44, s49, 1060864
    buffer_load_dwordx4 v[128:131], v10, s[24:27], s44 offen sc1
    s_waitcnt vmcnt(25)
    v_mfma_f32_32x32x16_bf16 v[96:111], v[132:135], v[200:203], v[96:111]
    v_mfma_f32_32x32x16_bf16 v[112:127], v[132:135], v[204:207], v[112:127]
    s_add_u32 s44, s49, 1061888
    buffer_load_dwordx4 v[132:135], v10, s[24:27], s44 offen sc1
    s_waitcnt vmcnt(25)
    s_waitcnt lgkmcnt(3)
    v_mfma_f32_32x32x16_bf16 v[64:79], v[136:139], v[208:211], v[64:79]
    ds_read_b128 v[200:203], v19 offset:53248
    s_waitcnt lgkmcnt(3)
    v_mfma_f32_32x32x16_bf16 v[80:95], v[136:139], v[212:215], v[80:95]
    ds_read_b128 v[204:207], v19 offset:54272
    s_add_u32 s44, s49, 1062912
    buffer_load_dwordx4 v[136:139], v10, s[24:27], s44 offen sc1
    s_waitcnt vmcnt(25)
    v_mfma_f32_32x32x16_bf16 v[96:111], v[140:143], v[208:211], v[96:111]
    v_mfma_f32_32x32x16_bf16 v[112:127], v[140:143], v[212:215], v[112:127]
    s_add_u32 s44, s49, 1063936
    buffer_load_dwordx4 v[140:143], v10, s[24:27], s44 offen sc1
    s_waitcnt vmcnt(25)
    s_waitcnt lgkmcnt(3)
    v_mfma_f32_32x32x16_bf16 v[64:79], v[144:147], v[192:195], v[64:79]
    ds_read_b128 v[208:211], v19 offset:55296
    s_waitcnt lgkmcnt(3)
    v_mfma_f32_32x32x16_bf16 v[80:95], v[144:147], v[196:199], v[80:95]
    ds_read_b128 v[212:215], v19 offset:56320
    s_add_u32 s44, s49, 1064960
    buffer_load_dwordx4 v[144:147], v10, s[24:27], s44 offen sc1
    s_waitcnt vmcnt(25)
    v_mfma_f32_32x32x16_bf16 v[96:111], v[148:151], v[192:195], v[96:111]
    v_mfma_f32_32x32x16_bf16 v[112:127], v[148:151], v[196:199], v[112:127]
    s_add_u32 s44, s49, 1065984
    buffer_load_dwordx4 v[148:151], v10, s[24:27], s44 offen sc1
    s_waitcnt vmcnt(25)
    s_waitcnt lgkmcnt(3)
    v_mfma_f32_32x32x16_bf16 v[64:79], v[152:155], v[200:203], v[64:79]
    ds_read_b128 v[192:195], v19 offset:61440
    s_waitcnt lgkmcnt(3)
    v_mfma_f32_32x32x16_bf16 v[80:95], v[152:155], v[204:207], v[80:95]
    ds_read_b128 v[196:199], v19 offset:62464
    s_add_u32 s44, s49, 1067008
    buffer_load_dwordx4 v[152:155], v10, s[24:27], s44 offen sc1
    s_waitcnt vmcnt(25)
    v_mfma_f32_32x32x16_bf16 v[96:111], v[156:159], v[200:203], v[96:111]
    v_mfma_f32_32x32x16_bf16 v[112:127], v[156:159], v[204:207], v[112:127]
    s_add_u32 s44, s49, 1068032
    buffer_load_dwordx4 v[156:159], v10, s[24:27], s44 offen sc1
    s_waitcnt vmcnt(25)
    s_waitcnt lgkmcnt(3)
    v_mfma_f32_32x32x16_bf16 v[64:79], v[240:243], v[208:211], v[64:79]
    ds_read_b128 v[200:203], v19 offset:63488
    s_waitcnt lgkmcnt(3)
    v_mfma_f32_32x32x16_bf16 v[80:95], v[240:243], v[212:215], v[80:95]
    ds_read_b128 v[204:207], v19 offset:64512
    s_add_u32 s44, s49, 1069056
    buffer_load_dwordx4 v[240:243], v10, s[24:27], s44 offen sc1
    s_waitcnt vmcnt(25)
    v_mfma_f32_32x32x16_bf16 v[96:111], v[244:247], v[208:211], v[96:111]
    v_mfma_f32_32x32x16_bf16 v[112:127], v[244:247], v[212:215], v[112:127]
    s_add_u32 s44, s49, 1070080
    buffer_load_dwordx4 v[244:247], v10, s[24:27], s44 offen sc1
    s_waitcnt vmcnt(25)
    s_waitcnt lgkmcnt(3)
    v_mfma_f32_32x32x16_bf16 v[64:79], v[248:251], v[192:195], v[64:79]
    s_waitcnt lgkmcnt(2)
    v_mfma_f32_32x32x16_bf16 v[80:95], v[248:251], v[196:199], v[80:95]
    s_add_u32 s44, s49, 1071104
    buffer_load_dwordx4 v[248:251], v10, s[24:27], s44 offen sc1
    s_waitcnt vmcnt(25)
    v_mfma_f32_32x32x16_bf16 v[96:111], v[252:255], v[192:195], v[96:111]
    v_mfma_f32_32x32x16_bf16 v[112:127], v[252:255], v[196:199], v[112:127]
    s_add_u32 s44, s49, 1072128
    buffer_load_dwordx4 v[252:255], v10, s[24:27], s44 offen sc1
    s_waitcnt vmcnt(25)
    s_waitcnt lgkmcnt(1)
    v_mfma_f32_32x32x16_bf16 v[64:79], v[168:171], v[200:203], v[64:79]
    s_waitcnt lgkmcnt(0)
    v_mfma_f32_32x32x16_bf16 v[80:95], v[168:171], v[204:207], v[80:95]
    s_add_u32 s44, s49, 1073152
    buffer_load_dwordx4 v[168:171], v10, s[24:27], s44 offen sc1
    s_waitcnt vmcnt(25)
    v_mfma_f32_32x32x16_bf16 v[96:111], v[172:175], v[200:203], v[96:111]
    v_mfma_f32_32x32x16_bf16 v[112:127], v[172:175], v[204:207], v[112:127]
    s_add_u32 s44, s49, 1074176
    buffer_load_dwordx4 v[172:175], v10, s[24:27], s44 offen sc1
    s_nop 2
    v_pk_add_f32 v[20:21], v[64:65], v[66:67]
    v_pk_mul_f32 v[212:213], v[64:65], v[64:65]
    v_pk_fma_f32 v[212:213], v[66:67], v[66:67], v[212:213]
    v_pk_add_f32 v[20:21], v[20:21], v[68:69]
    v_pk_fma_f32 v[212:213], v[68:69], v[68:69], v[212:213]
    v_pk_add_f32 v[20:21], v[20:21], v[70:71]
    v_pk_fma_f32 v[212:213], v[70:71], v[70:71], v[212:213]
    v_pk_add_f32 v[20:21], v[20:21], v[72:73]
    v_pk_fma_f32 v[212:213], v[72:73], v[72:73], v[212:213]
    v_pk_add_f32 v[20:21], v[20:21], v[74:75]
    v_pk_fma_f32 v[212:213], v[74:75], v[74:75], v[212:213]
    v_pk_add_f32 v[20:21], v[20:21], v[76:77]
    v_pk_fma_f32 v[212:213], v[76:77], v[76:77], v[212:213]
    v_pk_add_f32 v[20:21], v[20:21], v[78:79]
    v_pk_fma_f32 v[212:213], v[78:79], v[78:79], v[212:213]
    v_pk_add_f32 v[20:21], v[20:21], v[96:97]
    v_pk_fma_f32 v[212:213], v[96:97], v[96:97], v[212:213]
    v_pk_add_f32 v[20:21], v[20:21], v[98:99]
    v_pk_fma_f32 v[212:213], v[98:99], v[98:99], v[212:213]
    v_pk_add_f32 v[20:21], v[20:21], v[100:101]
    v_pk_fma_f32 v[212:213], v[100:101], v[100:101], v[212:213]
    v_pk_add_f32 v[20:21], v[20:21], v[102:103]
    v_pk_fma_f32 v[212:213], v[102:103], v[102:103], v[212:213]
    v_pk_add_f32 v[20:21], v[20:21], v[104:105]
    v_pk_fma_f32 v[212:213], v[104:105], v[104:105], v[212:213]
    v_pk_add_f32 v[20:21], v[20:21], v[106:107]
    v_pk_fma_f32 v[212:213], v[106:107], v[106:107], v[212:213]
    v_pk_add_f32 v[20:21], v[20:21], v[108:109]
    v_pk_fma_f32 v[212:213], v[108:109], v[108:109], v[212:213]
    v_pk_add_f32 v[20:21], v[20:21], v[110:111]
    v_pk_fma_f32 v[212:213], v[110:111], v[110:111], v[212:213]
    v_pk_add_f32 v[22:23], v[80:81], v[82:83]
    v_pk_mul_f32 v[214:215], v[80:81], v[80:81]
    v_pk_fma_f32 v[214:215], v[82:83], v[82:83], v[214:215]
    v_pk_add_f32 v[22:23], v[22:23], v[84:85]
    v_pk_fma_f32 v[214:215], v[84:85], v[84:85], v[214:215]
    v_pk_add_f32 v[22:23], v[22:23], v[86:87]
    v_pk_fma_f32 v[214:215], v[86:87], v[86:87], v[214:215]
    v_pk_add_f32 v[22:23], v[22:23], v[88:89]
    v_pk_fma_f32 v[214:215], v[88:89], v[88:89], v[214:215]
    v_pk_add_f32 v[22:23], v[22:23], v[90:91]
    v_pk_fma_f32 v[214:215], v[90:91], v[90:91], v[214:215]
    v_pk_add_f32 v[22:23], v[22:23], v[92:93]
    v_pk_fma_f32 v[214:215], v[92:93], v[92:93], v[214:215]
    v_pk_add_f32 v[22:23], v[22:23], v[94:95]
    v_pk_fma_f32 v[214:215], v[94:95], v[94:95], v[214:215]
    v_pk_add_f32 v[22:23], v[22:23], v[112:113]
    v_pk_fma_f32 v[214:215], v[112:113], v[112:113], v[214:215]
    v_pk_add_f32 v[22:23], v[22:23], v[114:115]
    v_pk_fma_f32 v[214:215], v[114:115], v[114:115], v[214:215]
    v_pk_add_f32 v[22:23], v[22:23], v[116:117]
    v_pk_fma_f32 v[214:215], v[116:117], v[116:117], v[214:215]
    v_pk_add_f32 v[22:23], v[22:23], v[118:119]
    v_pk_fma_f32 v[214:215], v[118:119], v[118:119], v[214:215]
    v_pk_add_f32 v[22:23], v[22:23], v[120:121]
    v_pk_fma_f32 v[214:215], v[120:121], v[120:121], v[214:215]
    v_pk_add_f32 v[22:23], v[22:23], v[122:123]
    v_pk_fma_f32 v[214:215], v[122:123], v[122:123], v[214:215]
    v_pk_add_f32 v[22:23], v[22:23], v[124:125]
    v_pk_fma_f32 v[214:215], v[124:125], v[124:125], v[214:215]
    v_pk_add_f32 v[22:23], v[22:23], v[126:127]
    v_pk_fma_f32 v[214:215], v[126:127], v[126:127], v[214:215]
    v_add_f32 v20, v20, v21
    v_add_f32 v22, v22, v23
    v_add_f32 v212, v212, v213
    v_add_f32 v214, v214, v215
    v_permlane32_swap_b32 v20, v22
    s_nop 0
    v_permlane32_swap_b32 v212, v214
    v_add_f32 v20, v20, v22
    v_add_f32 v21, v212, v214
    v_lshlrev_b32 v2, 3, v1
    s_lshl_b32 s44, s3, 9
    s_add_u32 s44, s44, 147456
    v_add_u32 v3, s44, v2
    ds_write_b64 v3, v[20:21]
    v_add_u32 v3, 147456, v2
    s_add_u32 s45, s47, 0
    s_lshl_b32 s45, s45, 15
    s_lshl_b32 s46, s3, 12
    s_add_u32 s56, s45, s46
    v_cvt_pk_bf16_f32 v32, v64, v65
    v_cvt_pk_bf16_f32 v33, v66, v67
    v_cvt_pk_bf16_f32 v34, v68, v69
    v_cvt_pk_bf16_f32 v35, v70, v71
    buffer_store_dwordx4 v[32:35], v10, s[36:39], s56 offen offset:0 sc1
    v_cvt_pk_bf16_f32 v36, v72, v73
    v_cvt_pk_bf16_f32 v37, v74, v75
    v_cvt_pk_bf16_f32 v38, v76, v77
    v_cvt_pk_bf16_f32 v39, v78, v79
    buffer_store_dwordx4 v[36:39], v10, s[36:39], s56 offen offset:1024 sc1
    v_cvt_pk_bf16_f32 v40, v96, v97
    v_cvt_pk_bf16_f32 v41, v98, v99
    v_cvt_pk_bf16_f32 v42, v100, v101
    v_cvt_pk_bf16_f32 v43, v102, v103
    buffer_store_dwordx4 v[40:43], v10, s[36:39], s56 offen offset:2048 sc1
    v_cvt_pk_bf16_f32 v44, v104, v105
    v_cvt_pk_bf16_f32 v45, v106, v107
    v_cvt_pk_bf16_f32 v46, v108, v109
    v_cvt_pk_bf16_f32 v47, v110, v111
    buffer_store_dwordx4 v[44:47], v10, s[36:39], s56 offen offset:3072 sc1
    s_add_u32 s45, s47, 1
    s_lshl_b32 s45, s45, 15
    s_lshl_b32 s46, s3, 12
    s_add_u32 s56, s45, s46
    v_cvt_pk_bf16_f32 v48, v80, v81
    v_cvt_pk_bf16_f32 v49, v82, v83
    v_cvt_pk_bf16_f32 v50, v84, v85
    v_cvt_pk_bf16_f32 v51, v86, v87
    buffer_store_dwordx4 v[48:51], v10, s[36:39], s56 offen offset:0 sc1
    v_cvt_pk_bf16_f32 v52, v88, v89
    v_cvt_pk_bf16_f32 v53, v90, v91
    v_cvt_pk_bf16_f32 v54, v92, v93
    v_cvt_pk_bf16_f32 v55, v94, v95
    buffer_store_dwordx4 v[52:55], v10, s[36:39], s56 offen offset:1024 sc1
    v_cvt_pk_bf16_f32 v56, v112, v113
    v_cvt_pk_bf16_f32 v57, v114, v115
    v_cvt_pk_bf16_f32 v58, v116, v117
    v_cvt_pk_bf16_f32 v59, v118, v119
    buffer_store_dwordx4 v[56:59], v10, s[36:39], s56 offen offset:2048 sc1
    v_cvt_pk_bf16_f32 v60, v120, v121
    v_cvt_pk_bf16_f32 v61, v122, v123
    v_cvt_pk_bf16_f32 v62, v124, v125
    v_cvt_pk_bf16_f32 v63, v126, v127
    buffer_store_dwordx4 v[60:63], v10, s[36:39], s56 offen offset:3072 sc1
    s_waitcnt lgkmcnt(0)
    s_barrier
    ds_read_b64 v[192:193], v3 offset:0
    ds_read_b64 v[194:195], v3 offset:512
    ds_read_b64 v[196:197], v3 offset:1024
    ds_read_b64 v[198:199], v3 offset:1536
    ds_read_b64 v[200:201], v3 offset:2048
    ds_read_b64 v[202:203], v3 offset:2560
    ds_read_b64 v[204:205], v3 offset:3072
    ds_read_b64 v[206:207], v3 offset:3584
    v_subrev_u32 v9, 81920, v9
    s_waitcnt lgkmcnt(0)
    v_pk_add_f32 v[192:193], v[192:193], v[200:201]
    v_pk_add_f32 v[194:195], v[194:195], v[202:203]
    v_pk_add_f32 v[196:197], v[196:197], v[204:205]
    v_pk_add_f32 v[198:199], v[198:199], v[206:207]
    v_pk_add_f32 v[192:193], v[192:193], v[196:197]
    v_pk_add_f32 v[194:195], v[194:195], v[198:199]
    v_pk_add_f32 v[192:193], v[192:193], v[194:195]
    v_mul_f32 v192, s55, v192
    v_mul_f32 v193, s55, v193
    v_fma_f32 v193, -v192, v192, v193
    v_max_f32 v193, 0, v193
    v_add_f32 v193, s54, v193
    v_rsq_f32 v193, v193
    s_nop 0
    v_mul_f32 v192, v192, v193
    v_sub_f32 v192, 0, v192
    v_mov_b32 v194, v193
    v_mov_b32 v196, v193
    v_mov_b32 v198, v192
    v_mov_b32 v200, v192
    v_permlane32_swap_b32 v194, v196
    s_nop 0
    v_permlane32_swap_b32 v198, v200
    v_pk_fma_f32 v[202:203], v[64:65], v[194:195], v[198:199] op_sel_hi:[1,0,0]
    v_pk_fma_f32 v[204:205], v[66:67], v[194:195], v[198:199] op_sel_hi:[1,0,0]
    v_pk_fma_f32 v[206:207], v[68:69], v[194:195], v[198:199] op_sel_hi:[1,0,0]
    v_pk_fma_f32 v[208:209], v[70:71], v[194:195], v[198:199] op_sel_hi:[1,0,0]
    v_cvt_pk_bf16_f32 v64, v202, v203
    v_cvt_pk_bf16_f32 v65, v204, v205
    v_cvt_pk_bf16_f32 v66, v206, v207
    v_cvt_pk_bf16_f32 v67, v208, v209
    ds_write_b128 v9, v[64:67] offset:0
    v_pk_fma_f32 v[202:203], v[72:73], v[194:195], v[198:199] op_sel_hi:[1,0,0]
    v_pk_fma_f32 v[204:205], v[74:75], v[194:195], v[198:199] op_sel_hi:[1,0,0]
    v_pk_fma_f32 v[206:207], v[76:77], v[194:195], v[198:199] op_sel_hi:[1,0,0]
    v_pk_fma_f32 v[208:209], v[78:79], v[194:195], v[198:199] op_sel_hi:[1,0,0]
    v_cvt_pk_bf16_f32 v72, v202, v203
    v_cvt_pk_bf16_f32 v73, v204, v205
    v_cvt_pk_bf16_f32 v74, v206, v207
    v_cvt_pk_bf16_f32 v75, v208, v209
    ds_write_b128 v9, v[72:75] offset:2048
    v_pk_fma_f32 v[202:203], v[96:97], v[194:195], v[198:199] op_sel_hi:[1,0,0]
    v_pk_fma_f32 v[204:205], v[98:99], v[194:195], v[198:199] op_sel_hi:[1,0,0]
    v_pk_fma_f32 v[206:207], v[100:101], v[194:195], v[198:199] op_sel_hi:[1,0,0]
    v_pk_fma_f32 v[208:209], v[102:103], v[194:195], v[198:199] op_sel_hi:[1,0,0]
    v_cvt_pk_bf16_f32 v96, v202, v203
    v_cvt_pk_bf16_f32 v97, v204, v205
    v_cvt_pk_bf16_f32 v98, v206, v207
    v_cvt_pk_bf16_f32 v99, v208, v209
    ds_write_b128 v9, v[96:99] offset:4096
    v_pk_fma_f32 v[202:203], v[104:105], v[194:195], v[198:199] op_sel_hi:[1,0,0]
    v_pk_fma_f32 v[204:205], v[106:107], v[194:195], v[198:199] op_sel_hi:[1,0,0]
    v_pk_fma_f32 v[206:207], v[108:109], v[194:195], v[198:199] op_sel_hi:[1,0,0]
    v_pk_fma_f32 v[208:209], v[110:111], v[194:195], v[198:199] op_sel_hi:[1,0,0]
    v_cvt_pk_bf16_f32 v104, v202, v203
    v_cvt_pk_bf16_f32 v105, v204, v205
    v_cvt_pk_bf16_f32 v106, v206, v207
    v_cvt_pk_bf16_f32 v107, v208, v209
    ds_write_b128 v9, v[104:107] offset:6144
    v_pk_fma_f32 v[202:203], v[80:81], v[196:197], v[200:201] op_sel_hi:[1,0,0]
    v_pk_fma_f32 v[204:205], v[82:83], v[196:197], v[200:201] op_sel_hi:[1,0,0]
    v_pk_fma_f32 v[206:207], v[84:85], v[196:197], v[200:201] op_sel_hi:[1,0,0]
    v_pk_fma_f32 v[208:209], v[86:87], v[196:197], v[200:201] op_sel_hi:[1,0,0]
    v_cvt_pk_bf16_f32 v80, v202, v203
    v_cvt_pk_bf16_f32 v81, v204, v205
    v_cvt_pk_bf16_f32 v82, v206, v207
    v_cvt_pk_bf16_f32 v83, v208, v209
    ds_write_b128 v9, v[80:83] offset:1024
    v_pk_fma_f32 v[202:203], v[88:89], v[196:197], v[200:201] op_sel_hi:[1,0,0]
    v_pk_fma_f32 v[204:205], v[90:91], v[196:197], v[200:201] op_sel_hi:[1,0,0]
    v_pk_fma_f32 v[206:207], v[92:93], v[196:197], v[200:201] op_sel_hi:[1,0,0]
    v_pk_fma_f32 v[208:209], v[94:95], v[196:197], v[200:201] op_sel_hi:[1,0,0]
    v_cvt_pk_bf16_f32 v88, v202, v203
    v_cvt_pk_bf16_f32 v89, v204, v205
    v_cvt_pk_bf16_f32 v90, v206, v207
    v_cvt_pk_bf16_f32 v91, v208, v209
    ds_write_b128 v9, v[88:91] offset:3072
    v_pk_fma_f32 v[202:203], v[112:113], v[196:197], v[200:201] op_sel_hi:[1,0,0]
    v_pk_fma_f32 v[204:205], v[114:115], v[196:197], v[200:201] op_sel_hi:[1,0,0]
    v_pk_fma_f32 v[206:207], v[116:117], v[196:197], v[200:201] op_sel_hi:[1,0,0]
    v_pk_fma_f32 v[208:209], v[118:119], v[196:197], v[200:201] op_sel_hi:[1,0,0]
    v_cvt_pk_bf16_f32 v112, v202, v203
    v_cvt_pk_bf16_f32 v113, v204, v205
    v_cvt_pk_bf16_f32 v114, v206, v207
    v_cvt_pk_bf16_f32 v115, v208, v209
    ds_write_b128 v9, v[112:115] offset:5120
    v_pk_fma_f32 v[202:203], v[120:121], v[196:197], v[200:201] op_sel_hi:[1,0,0]
    v_pk_fma_f32 v[204:205], v[122:123], v[196:197], v[200:201] op_sel_hi:[1,0,0]
    v_pk_fma_f32 v[206:207], v[124:125], v[196:197], v[200:201] op_sel_hi:[1,0,0]
    v_pk_fma_f32 v[208:209], v[126:127], v[196:197], v[200:201] op_sel_hi:[1,0,0]
    v_cvt_pk_bf16_f32 v120, v202, v203
    v_cvt_pk_bf16_f32 v121, v204, v205
    v_cvt_pk_bf16_f32 v122, v206, v207
    v_cvt_pk_bf16_f32 v123, v208, v209
    ds_write_b128 v9, v[120:123] offset:7168
    s_add_u32 s45, s47, 0
    s_mul_i32 s45, s45, 88064
    s_lshl_b32 s46, s3, 11
    s_add_u32 s56, s45, s46
    s_add_u32 s45, s47, 1
    s_mul_i32 s45, s45, 88064
    s_lshl_b32 s46, s3, 11
    s_add_u32 s57, s45, s46
    s_waitcnt lgkmcnt(0)
    s_barrier
    ds_read_b128 v[192:195], v10 offset:0
    ds_read_b128 v[196:199], v10 offset:1024
    ds_read_b128 v[200:203], v10 offset:2048
    ds_read_b128 v[204:207], v10 offset:3072
    s_waitcnt vmcnt(33)
    s_waitcnt lgkmcnt(3)
    v_mfma_f32_32x32x16_bf16 v[64:79], v[176:179], v[192:195], 0
    ds_read_b128 v[208:211], v10 offset:4096
    s_waitcnt lgkmcnt(3)
    v_mfma_f32_32x32x16_bf16 v[80:95], v[176:179], v[196:199], 0
    ds_read_b128 v[212:215], v10 offset:5120
    s_add_u32 s44, s49, 1075200
    buffer_load_dwordx4 v[176:179], v10, s[24:27], s44 offen sc1
    s_waitcnt vmcnt(33)
    s_waitcnt lgkmcnt(3)
    v_mfma_f32_32x32x16_bf16 v[64:79], v[180:183], v[200:203], v[64:79]
    ds_read_b128 v[192:195], v10 offset:6144
    s_waitcnt lgkmcnt(3)
    v_mfma_f32_32x32x16_bf16 v[80:95], v[180:183], v[204:207], v[80:95]
    ds_read_b128 v[196:199], v10 offset:7168
    s_add_u32 s44, s49, 1076224
    buffer_load_dwordx4 v[180:183], v10, s[24:27], s44 offen sc1
    s_waitcnt vmcnt(33)
    s_waitcnt lgkmcnt(3)
    v_mfma_f32_32x32x16_bf16 v[64:79], v[184:187], v[208:211], v[64:79]
    ds_read_b128 v[200:203], v10 offset:8192
    s_waitcnt lgkmcnt(3)
    v_mfma_f32_32x32x16_bf16 v[80:95], v[184:187], v[212:215], v[80:95]
    ds_read_b128 v[204:207], v10 offset:9216
    s_add_u32 s44, s49, 1077248
    buffer_load_dwordx4 v[184:187], v10, s[24:27], s44 offen sc1
    s_waitcnt vmcnt(33)
    s_waitcnt lgkmcnt(3)
    v_mfma_f32_32x32x16_bf16 v[64:79], v[188:191], v[192:195], v[64:79]
    ds_read_b128 v[208:211], v10 offset:10240
    s_waitcnt lgkmcnt(3)
    v_mfma_f32_32x32x16_bf16 v[80:95], v[188:191], v[196:199], v[80:95]
    ds_read_b128 v[212:215], v10 offset:11264
    s_add_u32 s44, s49, 1078272
    buffer_load_dwordx4 v[188:191], v10, s[24:27], s44 offen sc1
    s_waitcnt vmcnt(33)
    s_waitcnt lgkmcnt(3)
    v_mfma_f32_32x32x16_bf16 v[64:79], v[216:219], v[200:203], v[64:79]
    ds_read_b128 v[192:195], v10 offset:12288
    s_waitcnt lgkmcnt(3)
    v_mfma_f32_32x32x16_bf16 v[80:95], v[216:219], v[204:207], v[80:95]
    ds_read_b128 v[196:199], v10 offset:13312
    s_add_u32 s44, s49, 1079296
    buffer_load_dwordx4 v[216:219], v10, s[24:27], s44 offen sc1
    s_waitcnt vmcnt(33)
    s_waitcnt lgkmcnt(3)
    v_mfma_f32_32x32x16_bf16 v[64:79], v[220:223], v[208:211], v[64:79]
    ds_read_b128 v[200:203], v10 offset:14336
    s_waitcnt lgkmcnt(3)
    v_mfma_f32_32x32x16_bf16 v[80:95], v[220:223], v[212:215], v[80:95]
    ds_read_b128 v[204:207], v10 offset:15360
    s_add_u32 s44, s49, 1080320
    buffer_load_dwordx4 v[220:223], v10, s[24:27], s44 offen sc1
    s_waitcnt vmcnt(33)
    s_waitcnt lgkmcnt(3)
    v_mfma_f32_32x32x16_bf16 v[64:79], v[160:163], v[192:195], v[64:79]
    ds_read_b128 v[208:211], v10 offset:16384
    s_waitcnt lgkmcnt(3)
    v_mfma_f32_32x32x16_bf16 v[80:95], v[160:163], v[196:199], v[80:95]
    ds_read_b128 v[212:215], v10 offset:17408
    s_add_u32 s44, s49, 1310720
    buffer_load_dwordx4 v[160:163], v10, s[24:27], s44 offen sc1
    s_waitcnt vmcnt(33)
    s_waitcnt lgkmcnt(3)
    v_mfma_f32_32x32x16_bf16 v[64:79], v[164:167], v[200:203], v[64:79]
    ds_read_b128 v[192:195], v10 offset:18432
    s_waitcnt lgkmcnt(3)
    v_mfma_f32_32x32x16_bf16 v[80:95], v[164:167], v[204:207], v[80:95]
    ds_read_b128 v[196:199], v10 offset:19456
    s_add_u32 s44, s49, 1311744
    buffer_load_dwordx4 v[164:167], v10, s[24:27], s44 offen sc1
    s_waitcnt vmcnt(33)
    s_waitcnt lgkmcnt(3)
    v_mfma_f32_32x32x16_bf16 v[64:79], v[224:227], v[208:211], v[64:79]
    ds_read_b128 v[200:203], v10 offset:20480
    s_waitcnt lgkmcnt(3)
    v_mfma_f32_32x32x16_bf16 v[80:95], v[224:227], v[212:215], v[80:95]
    ds_read_b128 v[204:207], v10 offset:21504
    s_add_u32 s44, s49, 1312768
    buffer_load_dwordx4 v[224:227], v10, s[24:27], s44 offen sc1
    s_waitcnt vmcnt(33)
    s_waitcnt lgkmcnt(3)
    v_mfma_f32_32x32x16_bf16 v[64:79], v[228:231], v[192:195], v[64:79]
    ds_read_b128 v[208:211], v10 offset:22528
    s_waitcnt lgkmcnt(3)
    v_mfma_f32_32x32x16_bf16 v[80:95], v[228:231], v[196:199], v[80:95]
    ds_read_b128 v[212:215], v10 offset:23552
    s_add_u32 s44, s49, 1313792
    buffer_load_dwordx4 v[228:231], v10, s[24:27], s44 offen sc1
    s_waitcnt vmcnt(33)
    s_waitcnt lgkmcnt(3)
    v_mfma_f32_32x32x16_bf16 v[64:79], v[232:235], v[200:203], v[64:79]
    ds_read_b128 v[192:195], v10 offset:24576
    s_waitcnt lgkmcnt(3)
    v_mfma_f32_32x32x16_bf16 v[80:95], v[232:235], v[204:207], v[80:95]
    ds_read_b128 v[196:199], v10 offset:25600
    s_add_u32 s44, s49, 1314816
    buffer_load_dwordx4 v[232:235], v10, s[24:27], s44 offen sc1
    s_waitcnt vmcnt(33)
    s_waitcnt lgkmcnt(3)
    v_mfma_f32_32x32x16_bf16 v[64:79], v[236:239], v[208:211], v[64:79]
    ds_read_b128 v[200:203], v10 offset:26624
    s_waitcnt lgkmcnt(3)
    v_mfma_f32_32x32x16_bf16 v[80:95], v[236:239], v[212:215], v[80:95]
    ds_read_b128 v[204:207], v10 offset:27648
    s_add_u32 s44, s49, 1315840
    buffer_load_dwordx4 v[236:239], v10, s[24:27], s44 offen sc1
    s_waitcnt vmcnt(33)
    s_waitcnt lgkmcnt(3)
    v_mfma_f32_32x32x16_bf16 v[64:79], v[128:131], v[192:195], v[64:79]
    ds_read_b128 v[208:211], v10 offset:28672
    s_waitcnt lgkmcnt(3)
    v_mfma_f32_32x32x16_bf16 v[80:95], v[128:131], v[196:199], v[80:95]
    ds_read_b128 v[212:215], v10 offset:29696
    s_add_u32 s44, s49, 1316864
    buffer_load_dwordx4 v[128:131], v10, s[24:27], s44 offen sc1
    s_waitcnt vmcnt(33)
    s_waitcnt lgkmcnt(3)
    v_mfma_f32_32x32x16_bf16 v[64:79], v[132:135], v[200:203], v[64:79]
    ds_read_b128 v[192:195], v10 offset:30720
    s_waitcnt lgkmcnt(3)
    v_mfma_f32_32x32x16_bf16 v[80:95], v[132:135], v[204:207], v[80:95]
    ds_read_b128 v[196:199], v10 offset:31744
    s_add_u32 s44, s49, 1317888
    buffer_load_dwordx4 v[132:135], v10, s[24:27], s44 offen sc1
    s_waitcnt vmcnt(33)
    s_waitcnt lgkmcnt(3)
    v_mfma_f32_32x32x16_bf16 v[64:79], v[136:139], v[208:211], v[64:79]
    ds_read_b128 v[200:203], v10 offset:32768
    s_waitcnt lgkmcnt(3)
    v_mfma_f32_32x32x16_bf16 v[80:95], v[136:139], v[212:215], v[80:95]
    ds_read_b128 v[204:207], v10 offset:33792
    s_add_u32 s44, s49, 1318912
    buffer_load_dwordx4 v[136:139], v10, s[24:27], s44 offen sc1
    s_waitcnt vmcnt(33)
    s_waitcnt lgkmcnt(3)
    v_mfma_f32_32x32x16_bf16 v[64:79], v[140:143], v[192:195], v[64:79]
    ds_read_b128 v[208:211], v10 offset:34816
    s_waitcnt lgkmcnt(3)
    v_mfma_f32_32x32x16_bf16 v[80:95], v[140:143], v[196:199], v[80:95]
    ds_read_b128 v[212:215], v10 offset:35840
    s_add_u32 s44, s49, 1319936
    buffer_load_dwordx4 v[140:143], v10, s[24:27], s44 offen sc1
    s_waitcnt vmcnt(33)
    s_waitcnt lgkmcnt(3)
    v_mfma_f32_32x32x16_bf16 v[64:79], v[144:147], v[200:203], v[64:79]
    ds_read_b128 v[192:195], v10 offset:36864
    s_waitcnt lgkmcnt(3)
    v_mfma_f32_32x32x16_bf16 v[80:95], v[144:147], v[204:207], v[80:95]
    ds_read_b128 v[196:199], v10 offset:37888
    s_add_u32 s44, s49, 1320960
    buffer_load_dwordx4 v[144:147], v10, s[24:27], s44 offen sc1
    s_waitcnt vmcnt(33)
    s_waitcnt lgkmcnt(3)
    v_mfma_f32_32x32x16_bf16 v[64:79], v[148:151], v[208:211], v[64:79]
    ds_read_b128 v[200:203], v10 offset:38912
    s_waitcnt lgkmcnt(3)
    v_mfma_f32_32x32x16_bf16 v[80:95], v[148:151], v[212:215], v[80:95]
    ds_read_b128 v[204:207], v10 offset:39936
    s_add_u32 s44, s49, 1321984
    buffer_load_dwordx4 v[148:151], v10, s[24:27], s44 offen sc1
    s_waitcnt vmcnt(33)
    s_waitcnt lgkmcnt(3)
    v_mfma_f32_32x32x16_bf16 v[64:79], v[152:155], v[192:195], v[64:79]
    ds_read_b128 v[208:211], v10 offset:40960
    s_waitcnt lgkmcnt(3)
    v_mfma_f32_32x32x16_bf16 v[80:95], v[152:155], v[196:199], v[80:95]
    ds_read_b128 v[212:215], v10 offset:41984
    s_add_u32 s44, s49, 1323008
    buffer_load_dwordx4 v[152:155], v10, s[24:27], s44 offen sc1
    s_waitcnt vmcnt(33)
    s_waitcnt lgkmcnt(3)
    v_mfma_f32_32x32x16_bf16 v[64:79], v[156:159], v[200:203], v[64:79]
    ds_read_b128 v[192:195], v10 offset:43008
    s_waitcnt lgkmcnt(3)
    v_mfma_f32_32x32x16_bf16 v[80:95], v[156:159], v[204:207], v[80:95]
    ds_read_b128 v[196:199], v10 offset:44032
    s_add_u32 s44, s49, 1324032
    buffer_load_dwordx4 v[156:159], v10, s[24:27], s44 offen sc1
    s_waitcnt vmcnt(33)
    s_waitcnt lgkmcnt(3)
    v_mfma_f32_32x32x16_bf16 v[64:79], v[240:243], v[208:211], v[64:79]
    ds_read_b128 v[200:203], v10 offset:45056
    s_waitcnt lgkmcnt(3)
    v_mfma_f32_32x32x16_bf16 v[80:95], v[240:243], v[212:215], v[80:95]
    ds_read_b128 v[204:207], v10 offset:46080
    s_add_u32 s44, s49, 1325056
    buffer_load_dwordx4 v[240:243], v10, s[24:27], s44 offen sc1
    s_waitcnt vmcnt(33)
    s_waitcnt lgkmcnt(3)
    v_mfma_f32_32x32x16_bf16 v[64:79], v[244:247], v[192:195], v[64:79]
    ds_read_b128 v[208:211], v10 offset:47104
    s_waitcnt lgkmcnt(3)
    v_mfma_f32_32x32x16_bf16 v[80:95], v[244:247], v[196:199], v[80:95]
    ds_read_b128 v[212:215], v10 offset:48128
    s_add_u32 s44, s49, 1326080
    buffer_load_dwordx4 v[244:247], v10, s[24:27], s44 offen sc1
    s_waitcnt vmcnt(33)
    s_waitcnt lgkmcnt(3)
    v_mfma_f32_32x32x16_bf16 v[64:79], v[248:251], v[200:203], v[64:79]
    ds_read_b128 v[192:195], v10 offset:49152
    s_waitcnt lgkmcnt(3)
    v_mfma_f32_32x32x16_bf16 v[80:95], v[248:251], v[204:207], v[80:95]
    ds_read_b128 v[196:199], v10 offset:50176
    s_add_u32 s44, s49, 1327104
    buffer_load_dwordx4 v[248:251], v10, s[24:27], s44 offen sc1
    s_waitcnt vmcnt(33)
    s_waitcnt lgkmcnt(3)
    v_mfma_f32_32x32x16_bf16 v[64:79], v[252:255], v[208:211], v[64:79]
    ds_read_b128 v[200:203], v10 offset:51200
    s_waitcnt lgkmcnt(3)
    v_mfma_f32_32x32x16_bf16 v[80:95], v[252:255], v[212:215], v[80:95]
    ds_read_b128 v[204:207], v10 offset:52224
    s_add_u32 s44, s49, 1328128
    buffer_load_dwordx4 v[252:255], v10, s[24:27], s44 offen sc1
    s_waitcnt vmcnt(33)
    s_waitcnt lgkmcnt(3)
    v_mfma_f32_32x32x16_bf16 v[64:79], v[168:171], v[192:195], v[64:79]
    ds_read_b128 v[208:211], v10 offset:53248
    s_waitcnt lgkmcnt(3)
    v_mfma_f32_32x32x16_bf16 v[80:95], v[168:171], v[196:199], v[80:95]
    ds_read_b128 v[212:215], v10 offset:54272
    s_add_u32 s44, s49, 1329152
    buffer_load_dwordx4 v[168:171], v10, s[24:27], s44 offen sc1
    s_waitcnt vmcnt(33)
    s_waitcnt lgkmcnt(3)
    v_mfma_f32_32x32x16_bf16 v[64:79], v[172:175], v[200:203], v[64:79]
    ds_read_b128 v[192:195], v10 offset:55296
    s_waitcnt lgkmcnt(3)
    v_mfma_f32_32x32x16_bf16 v[80:95], v[172:175], v[204:207], v[80:95]
    ds_read_b128 v[196:199], v10 offset:56320
    s_add_u32 s44, s49, 1330176
    buffer_load_dwordx4 v[172:175], v10, s[24:27], s44 offen sc1
    s_waitcnt vmcnt(25)
    s_waitcnt lgkmcnt(3)
    v_mfma_f32_32x32x16_bf16 v[64:79], v[176:179], v[208:211], v[64:79]
    ds_read_b128 v[200:203], v10 offset:57344
    s_waitcnt lgkmcnt(3)
    v_mfma_f32_32x32x16_bf16 v[80:95], v[176:179], v[212:215], v[80:95]
    ds_read_b128 v[204:207], v10 offset:58368
    s_add_u32 s44, s49, 1331200
    buffer_load_dwordx4 v[176:179], v10, s[24:27], s44 offen sc1
    s_waitcnt vmcnt(25)
    s_waitcnt lgkmcnt(3)
    v_mfma_f32_32x32x16_bf16 v[64:79], v[180:183], v[192:195], v[64:79]
    ds_read_b128 v[208:211], v10 offset:59392
    s_waitcnt lgkmcnt(3)
    v_mfma_f32_32x32x16_bf16 v[80:95], v[180:183], v[196:199], v[80:95]
    ds_read_b128 v[212:215], v10 offset:60416
    s_add_u32 s44, s49, 1332224
    buffer_load_dwordx4 v[180:183], v10, s[24:27], s44 offen sc1
    s_waitcnt vmcnt(25)
    s_waitcnt lgkmcnt(3)
    v_mfma_f32_32x32x16_bf16 v[64:79], v[184:187], v[200:203], v[64:79]
    ds_read_b128 v[192:195], v10 offset:61440
    s_waitcnt lgkmcnt(3)
    v_mfma_f32_32x32x16_bf16 v[80:95], v[184:187], v[204:207], v[80:95]
    ds_read_b128 v[196:199], v10 offset:62464
    s_add_u32 s44, s49, 1333248
    buffer_load_dwordx4 v[184:187], v10, s[24:27], s44 offen sc1
    s_waitcnt vmcnt(25)
    s_waitcnt lgkmcnt(3)
    v_mfma_f32_32x32x16_bf16 v[64:79], v[188:191], v[208:211], v[64:79]
    ds_read_b128 v[200:203], v10 offset:63488
    s_waitcnt lgkmcnt(3)
    v_mfma_f32_32x32x16_bf16 v[80:95], v[188:191], v[212:215], v[80:95]
    ds_read_b128 v[204:207], v10 offset:64512
    s_add_u32 s44, s49, 1334272
    buffer_load_dwordx4 v[188:191], v10, s[24:27], s44 offen sc1
    s_waitcnt vmcnt(25)
    s_waitcnt lgkmcnt(3)
    v_mfma_f32_32x32x16_bf16 v[64:79], v[216:219], v[192:195], v[64:79]
    ds_read_b128 v[208:211], v10 offset:0
    s_waitcnt lgkmcnt(3)
    v_mfma_f32_32x32x16_bf16 v[80:95], v[216:219], v[196:199], v[80:95]
    ds_read_b128 v[212:215], v10 offset:1024
    s_add_u32 s44, s49, 1335296
    buffer_load_dwordx4 v[216:219], v10, s[24:27], s44 offen sc1
    s_waitcnt vmcnt(25)
    s_waitcnt lgkmcnt(3)
    v_mfma_f32_32x32x16_bf16 v[64:79], v[220:223], v[200:203], v[64:79]
    ds_read_b128 v[192:195], v10 offset:2048
    s_waitcnt lgkmcnt(3)
    v_mfma_f32_32x32x16_bf16 v[80:95], v[220:223], v[204:207], v[80:95]
    ds_read_b128 v[196:199], v10 offset:3072
    s_add_u32 s44, s49, 1336320
    buffer_load_dwordx4 v[220:223], v10, s[24:27], s44 offen sc1
    s_waitcnt vmcnt(25)
    s_waitcnt lgkmcnt(3)
    v_mfma_f32_32x32x16_bf16 v[96:111], v[160:163], v[208:211], 0
    ds_read_b128 v[200:203], v10 offset:4096
    s_nop 1
    v_mul_f32 v20, v64, v64
    v_mul_f32 v22, v66, v66
    v_mul_f32 v21, v65, v65
    v_mul_f32 v23, v67, v67
    v_fmamk_f32 v20, v20, 0xbdd2d3e8, v18
    s_waitcnt lgkmcnt(3)
    v_mfma_f32_32x32x16_bf16 v[112:127], v[160:163], v[212:215], 0
    ds_read_b128 v[204:207], v10 offset:5120
    s_add_u32 s44, s49, 1337344
    buffer_load_dwordx4 v[160:163], v10, s[24:27], s44 offen sc1
    v_fmamk_f32 v22, v22, 0xbdd2d3e8, v18
    v_fmamk_f32 v21, v21, 0xbdd2d3e8, v18
    v_fmamk_f32 v23, v23, 0xbdd2d3e8, v18
    v_mul_f32 v20, v20, v64
    v_mul_f32 v22, v22, v66
    s_waitcnt vmcnt(25)
    s_waitcnt lgkmcnt(3)
    v_mfma_f32_32x32x16_bf16 v[96:111], v[164:167], v[192:195], v[96:111]
    ds_read_b128 v[208:211], v10 offset:6144
    v_mul_f32 v21, v21, v65
    v_mul_f32 v23, v23, v67
    v_exp_f32 v20, v20
    v_exp_f32 v22, v22
    s_waitcnt lgkmcnt(3)
    v_mfma_f32_32x32x16_bf16 v[112:127], v[164:167], v[196:199], v[112:127]
    ds_read_b128 v[212:215], v10 offset:7168
    s_add_u32 s44, s49, 1338368
    buffer_load_dwordx4 v[164:167], v10, s[24:27], s44 offen sc1
    v_exp_f32 v21, v21
    v_exp_f32 v23, v23
    v_add_f32 v20, 1.0, v20
    s_waitcnt vmcnt(25)
    s_waitcnt lgkmcnt(3)
    v_mfma_f32_32x32x16_bf16 v[96:111], v[224:227], v[200:203], v[96:111]
    ds_read_b128 v[192:195], v10 offset:8192
    v_add_f32 v22, 1.0, v22
    v_add_f32 v21, 1.0, v21
    v_add_f32 v23, 1.0, v23
    v_rcp_f32 v20, v20
    s_waitcnt lgkmcnt(3)
    v_mfma_f32_32x32x16_bf16 v[112:127], v[224:227], v[204:207], v[112:127]
    ds_read_b128 v[196:199], v10 offset:9216
    s_add_u32 s44, s49, 1339392
    buffer_load_dwordx4 v[224:227], v10, s[24:27], s44 offen sc1
    v_rcp_f32 v22, v22
    v_rcp_f32 v21, v21
    v_rcp_f32 v23, v23
    s_waitcnt vmcnt(25)
    s_waitcnt lgkmcnt(3)
    v_mfma_f32_32x32x16_bf16 v[96:111], v[228:231], v[208:211], v[96:111]
    ds_read_b128 v[200:203], v10 offset:10240
    v_mul_f32 v20, v20, v64
    v_mul_f32 v22, v22, v66
    v_mul_f32 v21, v21, v65
    v_mul_f32 v23, v23, v67
    v_cvt_pk_bf16_f32 v32, v20, v21
    s_waitcnt lgkmcnt(3)
    v_mfma_f32_32x32x16_bf16 v[112:127], v[228:231], v[212:215], v[112:127]
    ds_read_b128 v[204:207], v10 offset:11264
    s_add_u32 s44, s49, 1340416
    buffer_load_dwordx4 v[228:231], v10, s[24:27], s44 offen sc1
    v_cvt_pk_bf16_f32 v33, v22, v23
    v_mul_f32 v20, v68, v68
    v_mul_f32 v22, v70, v70
    v_mul_f32 v21, v69, v69
    v_mul_f32 v23, v71, v71
    s_waitcnt vmcnt(25)
    s_waitcnt lgkmcnt(3)
    v_mfma_f32_32x32x16_bf16 v[96:111], v[232:235], v[192:195], v[96:111]
    ds_read_b128 v[208:211], v10 offset:12288
    v_fmamk_f32 v20, v20, 0xbdd2d3e8, v18
    v_fmamk_f32 v22, v22, 0xbdd2d3e8, v18
    v_fmamk_f32 v21, v21, 0xbdd2d3e8, v18
    v_fmamk_f32 v23, v23, 0xbdd2d3e8, v18
    v_mul_f32 v20, v20, v68
    s_waitcnt lgkmcnt(3)
    v_mfma_f32_32x32x16_bf16 v[112:127], v[232:235], v[196:199], v[112:127]
    ds_read_b128 v[212:215], v10 offset:13312
    s_add_u32 s44, s49, 1341440
    buffer_load_dwordx4 v[232:235], v10, s[24:27], s44 offen sc1
    v_mul_f32 v22, v22, v70
    v_mul_f32 v21, v21, v69
    v_mul_f32 v23, v23, v71
    v_exp_f32 v20, v20
    s_waitcnt vmcnt(25)
    s_waitcnt lgkmcnt(3)
    v_mfma_f32_32x32x16_bf16 v[96:111], v[236:239], v[200:203], v[96:111]
    ds_read_b128 v[192:195], v10 offset:14336
    v_exp_f32 v22, v22
    v_exp_f32 v21, v21
    v_exp_f32 v23, v23
    s_waitcnt lgkmcnt(3)
    v_mfma_f32_32x32x16_bf16 v[112:127], v[236:239], v[204:207], v[112:127]
    ds_read_b128 v[196:199], v10 offset:15360
    s_add_u32 s44, s49, 1342464
    buffer_load_dwordx4 v[236:239], v10, s[24:27], s44 offen sc1
    v_add_f32 v20, 1.0, v20
    v_add_f32 v22, 1.0, v22
    v_add_f32 v21, 1.0, v21
    v_add_f32 v23, 1.0, v23
    v_rcp_f32 v20, v20
    s_waitcnt vmcnt(25)
    s_waitcnt lgkmcnt(3)
    v_mfma_f32_32x32x16_bf16 v[96:111], v[128:131], v[208:211], v[96:111]
    ds_read_b128 v[200:203], v10 offset:16384
    v_rcp_f32 v22, v22
    v_rcp_f32 v21, v21
    v_rcp_f32 v23, v23
    s_waitcnt lgkmcnt(3)
    v_mfma_f32_32x32x16_bf16 v[112:127], v[128:131], v[212:215], v[112:127]
    ds_read_b128 v[204:207], v10 offset:17408
    s_add_u32 s44, s49, 1572864
    buffer_load_dwordx4 v[128:131], v10, s[24:27], s44 offen sc1
    v_mul_f32 v20, v20, v68
    v_mul_f32 v22, v22, v70
    v_mul_f32 v21, v21, v69
    v_mul_f32 v23, v23, v71
    v_cvt_pk_bf16_f32 v34, v20, v21
    s_waitcnt vmcnt(25)
    s_waitcnt lgkmcnt(3)
    v_mfma_f32_32x32x16_bf16 v[96:111], v[132:135], v[192:195], v[96:111]
    ds_read_b128 v[208:211], v10 offset:18432
    v_cvt_pk_bf16_f32 v35, v22, v23
    v_mul_f32 v20, v72, v72
    v_mul_f32 v22, v74, v74
    v_mul_f32 v21, v73, v73
    v_mul_f32 v23, v75, v75
    s_waitcnt lgkmcnt(3)
    v_mfma_f32_32x32x16_bf16 v[112:127], v[132:135], v[196:199], v[112:127]
    ds_read_b128 v[212:215], v10 offset:19456
    s_add_u32 s44, s49, 1573888
    buffer_load_dwordx4 v[132:135], v10, s[24:27], s44 offen sc1
    v_fmamk_f32 v20, v20, 0xbdd2d3e8, v18
    v_fmamk_f32 v22, v22, 0xbdd2d3e8, v18
    v_fmamk_f32 v21, v21, 0xbdd2d3e8, v18
    v_fmamk_f32 v23, v23, 0xbdd2d3e8, v18
    v_mul_f32 v20, v20, v72
    s_waitcnt vmcnt(25)
    s_waitcnt lgkmcnt(3)
    v_mfma_f32_32x32x16_bf16 v[96:111], v[136:139], v[200:203], v[96:111]
    ds_read_b128 v[192:195], v10 offset:20480
    v_mul_f32 v22, v22, v74
    v_mul_f32 v21, v21, v73
    v_mul_f32 v23, v23, v75
    v_exp_f32 v20, v20
    s_waitcnt lgkmcnt(3)
    v_mfma_f32_32x32x16_bf16 v[112:127], v[136:139], v[204:207], v[112:127]
    ds_read_b128 v[196:199], v10 offset:21504
    s_add_u32 s44, s49, 1574912
    buffer_load_dwordx4 v[136:139], v10, s[24:27], s44 offen sc1
    v_exp_f32 v22, v22
    v_exp_f32 v21, v21
    v_exp_f32 v23, v23
    s_waitcnt vmcnt(25)
    s_waitcnt lgkmcnt(3)
    v_mfma_f32_32x32x16_bf16 v[96:111], v[140:143], v[208:211], v[96:111]
    ds_read_b128 v[200:203], v10 offset:22528
    v_add_f32 v20, 1.0, v20
    v_add_f32 v22, 1.0, v22
    v_add_f32 v21, 1.0, v21
    v_add_f32 v23, 1.0, v23
    v_rcp_f32 v20, v20
    s_waitcnt lgkmcnt(3)
    v_mfma_f32_32x32x16_bf16 v[112:127], v[140:143], v[212:215], v[112:127]
    ds_read_b128 v[204:207], v10 offset:23552
    s_add_u32 s44, s49, 1575936
    buffer_load_dwordx4 v[140:143], v10, s[24:27], s44 offen sc1
    v_rcp_f32 v22, v22
    v_rcp_f32 v21, v21
    v_rcp_f32 v23, v23
    s_waitcnt vmcnt(25)
    s_waitcnt lgkmcnt(3)
    v_mfma_f32_32x32x16_bf16 v[96:111], v[144:147], v[192:195], v[96:111]
    ds_read_b128 v[208:211], v10 offset:24576
    v_mul_f32 v20, v20, v72
    v_mul_f32 v22, v22, v74
    v_mul_f32 v21, v21, v73
    v_mul_f32 v23, v23, v75
    v_cvt_pk_bf16_f32 v36, v20, v21
    s_waitcnt lgkmcnt(3)
    v_mfma_f32_32x32x16_bf16 v[112:127], v[144:147], v[196:199], v[112:127]
    ds_read_b128 v[212:215], v10 offset:25600
    s_add_u32 s44, s49, 1576960
    buffer_load_dwordx4 v[144:147], v10, s[24:27], s44 offen sc1
    v_cvt_pk_bf16_f32 v37, v22, v23
    v_mul_f32 v20, v76, v76
    v_mul_f32 v22, v78, v78
    v_mul_f32 v21, v77, v77
    v_mul_f32 v23, v79, v79
    s_waitcnt vmcnt(25)
    s_waitcnt lgkmcnt(3)
    v_mfma_f32_32x32x16_bf16 v[96:111], v[148:151], v[200:203], v[96:111]
    ds_read_b128 v[192:195], v10 offset:26624
    v_fmamk_f32 v20, v20, 0xbdd2d3e8, v18
    v_fmamk_f32 v22, v22, 0xbdd2d3e8, v18
    v_fmamk_f32 v21, v21, 0xbdd2d3e8, v18
    v_fmamk_f32 v23, v23, 0xbdd2d3e8, v18
    v_mul_f32 v20, v20, v76
    s_waitcnt lgkmcnt(3)
    v_mfma_f32_32x32x16_bf16 v[112:127], v[148:151], v[204:207], v[112:127]
    ds_read_b128 v[196:199], v10 offset:27648
    s_add_u32 s44, s49, 1577984
    buffer_load_dwordx4 v[148:151], v10, s[24:27], s44 offen sc1
    v_mul_f32 v22, v22, v78
    v_mul_f32 v21, v21, v77
    v_mul_f32 v23, v23, v79
    v_exp_f32 v20, v20
    s_waitcnt vmcnt(25)
    s_waitcnt lgkmcnt(3)
    v_mfma_f32_32x32x16_bf16 v[96:111], v[152:155], v[208:211], v[96:111]
    ds_read_b128 v[200:203], v10 offset:28672
    v_exp_f32 v22, v22
    v_exp_f32 v21, v21
    v_exp_f32 v23, v23
    s_waitcnt lgkmcnt(3)
    v_mfma_f32_32x32x16_bf16 v[112:127], v[152:155], v[212:215], v[112:127]
    ds_read_b128 v[204:207], v10 offset:29696
    s_add_u32 s44, s49, 1579008
    buffer_load_dwordx4 v[152:155], v10, s[24:27], s44 offen sc1
    v_add_f32 v20, 1.0, v20
    v_add_f32 v22, 1.0, v22
    v_add_f32 v21, 1.0, v21
    v_add_f32 v23, 1.0, v23
    v_rcp_f32 v20, v20
    s_waitcnt vmcnt(25)
    s_waitcnt lgkmcnt(3)
    v_mfma_f32_32x32x16_bf16 v[96:111], v[156:159], v[192:195], v[96:111]
    ds_read_b128 v[208:211], v10 offset:30720
    v_rcp_f32 v22, v22
    v_rcp_f32 v21, v21
    v_rcp_f32 v23, v23
    s_waitcnt lgkmcnt(3)
    v_mfma_f32_32x32x16_bf16 v[112:127], v[156:159], v[196:199], v[112:127]
    ds_read_b128 v[212:215], v10 offset:31744
    s_add_u32 s44, s49, 1580032
    buffer_load_dwordx4 v[156:159], v10, s[24:27], s44 offen sc1
    v_mul_f32 v20, v20, v76
    v_mul_f32 v22, v22, v78
    v_mul_f32 v21, v21, v77
    v_mul_f32 v23, v23, v79
    v_cvt_pk_bf16_f32 v38, v20, v21
    s_waitcnt vmcnt(25)
    s_waitcnt lgkmcnt(3)
    v_mfma_f32_32x32x16_bf16 v[96:111], v[240:243], v[200:203], v[96:111]
    ds_read_b128 v[192:195], v10 offset:32768
    v_cvt_pk_bf16_f32 v39, v22, v23
    v_mul_f32 v20, v80, v80
    v_mul_f32 v22, v82, v82
    v_mul_f32 v21, v81, v81
    v_mul_f32 v23, v83, v83
    s_waitcnt lgkmcnt(3)
    v_mfma_f32_32x32x16_bf16 v[112:127], v[240:243], v[204:207], v[112:127]
    ds_read_b128 v[196:199], v10 offset:33792
    s_add_u32 s44, s49, 1581056
    buffer_load_dwordx4 v[240:243], v10, s[24:27], s44 offen sc1
    v_fmamk_f32 v20, v20, 0xbdd2d3e8, v18
    v_fmamk_f32 v22, v22, 0xbdd2d3e8, v18
    v_fmamk_f32 v21, v21, 0xbdd2d3e8, v18
    v_fmamk_f32 v23, v23, 0xbdd2d3e8, v18
    v_mul_f32 v20, v20, v80
    s_waitcnt vmcnt(25)
    s_waitcnt lgkmcnt(3)
    v_mfma_f32_32x32x16_bf16 v[96:111], v[244:247], v[208:211], v[96:111]
    ds_read_b128 v[200:203], v10 offset:34816
    v_mul_f32 v22, v22, v82
    v_mul_f32 v21, v21, v81
    v_mul_f32 v23, v23, v83
    v_exp_f32 v20, v20
    s_waitcnt lgkmcnt(3)
    v_mfma_f32_32x32x16_bf16 v[112:127], v[244:247], v[212:215], v[112:127]
    ds_read_b128 v[204:207], v10 offset:35840
    s_add_u32 s44, s49, 1582080
    buffer_load_dwordx4 v[244:247], v10, s[24:27], s44 offen sc1
    v_exp_f32 v22, v22
    v_exp_f32 v21, v21
    v_exp_f32 v23, v23
    s_waitcnt vmcnt(25)
    s_waitcnt lgkmcnt(3)
    v_mfma_f32_32x32x16_bf16 v[96:111], v[248:251], v[192:195], v[96:111]
    ds_read_b128 v[208:211], v10 offset:36864
    v_add_f32 v20, 1.0, v20
    v_add_f32 v22, 1.0, v22
    v_add_f32 v21, 1.0, v21
    v_add_f32 v23, 1.0, v23
    v_rcp_f32 v20, v20
    s_waitcnt lgkmcnt(3)
    v_mfma_f32_32x32x16_bf16 v[112:127], v[248:251], v[196:199], v[112:127]
    ds_read_b128 v[212:215], v10 offset:37888
    s_add_u32 s44, s49, 1583104
    buffer_load_dwordx4 v[248:251], v10, s[24:27], s44 offen sc1
    v_rcp_f32 v22, v22
    v_rcp_f32 v21, v21
    v_rcp_f32 v23, v23
    s_waitcnt vmcnt(25)
    s_waitcnt lgkmcnt(3)
    v_mfma_f32_32x32x16_bf16 v[96:111], v[252:255], v[200:203], v[96:111]
    ds_read_b128 v[192:195], v10 offset:38912
    v_mul_f32 v20, v20, v80
    v_mul_f32 v22, v22, v82
    v_mul_f32 v21, v21, v81
    v_mul_f32 v23, v23, v83
    v_cvt_pk_bf16_f32 v40, v20, v21
    s_waitcnt lgkmcnt(3)
    v_mfma_f32_32x32x16_bf16 v[112:127], v[252:255], v[204:207], v[112:127]
    ds_read_b128 v[196:199], v10 offset:39936
    s_add_u32 s44, s49, 1584128
    buffer_load_dwordx4 v[252:255], v10, s[24:27], s44 offen sc1
    v_cvt_pk_bf16_f32 v41, v22, v23
    v_mul_f32 v20, v84, v84
    v_mul_f32 v22, v86, v86
    v_mul_f32 v21, v85, v85
    v_mul_f32 v23, v87, v87
    s_waitcnt vmcnt(25)
    s_waitcnt lgkmcnt(3)
    v_mfma_f32_32x32x16_bf16 v[96:111], v[168:171], v[208:211], v[96:111]
    ds_read_b128 v[200:203], v10 offset:40960
    v_fmamk_f32 v20, v20, 0xbdd2d3e8, v18
    v_fmamk_f32 v22, v22, 0xbdd2d3e8, v18
    v_fmamk_f32 v21, v21, 0xbdd2d3e8, v18
    v_fmamk_f32 v23, v23, 0xbdd2d3e8, v18
    v_mul_f32 v20, v20, v84
    s_waitcnt lgkmcnt(3)
    v_mfma_f32_32x32x16_bf16 v[112:127], v[168:171], v[212:215], v[112:127]
    ds_read_b128 v[204:207], v10 offset:41984
    s_add_u32 s44, s49, 1585152
    buffer_load_dwordx4 v[168:171], v10, s[24:27], s44 offen sc1
    v_mul_f32 v22, v22, v86
    v_mul_f32 v21, v21, v85
    v_mul_f32 v23, v23, v87
    v_exp_f32 v20, v20
    s_waitcnt vmcnt(25)
    s_waitcnt lgkmcnt(3)
    v_mfma_f32_32x32x16_bf16 v[96:111], v[172:175], v[192:195], v[96:111]
    ds_read_b128 v[208:211], v10 offset:43008
    v_exp_f32 v22, v22
    v_exp_f32 v21, v21
    v_exp_f32 v23, v23
    s_waitcnt lgkmcnt(3)
    v_mfma_f32_32x32x16_bf16 v[112:127], v[172:175], v[196:199], v[112:127]
    ds_read_b128 v[212:215], v10 offset:44032
    s_add_u32 s44, s49, 1586176
    buffer_load_dwordx4 v[172:175], v10, s[24:27], s44 offen sc1
    v_add_f32 v20, 1.0, v20
    v_add_f32 v22, 1.0, v22
    v_add_f32 v21, 1.0, v21
    v_add_f32 v23, 1.0, v23
    v_rcp_f32 v20, v20
    s_waitcnt vmcnt(25)
    s_waitcnt lgkmcnt(3)
    v_mfma_f32_32x32x16_bf16 v[96:111], v[176:179], v[200:203], v[96:111]
    ds_read_b128 v[192:195], v10 offset:45056
    v_rcp_f32 v22, v22
    v_rcp_f32 v21, v21
    v_rcp_f32 v23, v23
    s_waitcnt lgkmcnt(3)
    v_mfma_f32_32x32x16_bf16 v[112:127], v[176:179], v[204:207], v[112:127]
    ds_read_b128 v[196:199], v10 offset:46080
    s_add_u32 s44, s49, 1587200
    buffer_load_dwordx4 v[176:179], v10, s[24:27], s44 offen sc1
    v_mul_f32 v20, v20, v84
    v_mul_f32 v22, v22, v86
    v_mul_f32 v21, v21, v85
    v_mul_f32 v23, v23, v87
    v_cvt_pk_bf16_f32 v42, v20, v21
    s_waitcnt vmcnt(25)
    s_waitcnt lgkmcnt(3)
    v_mfma_f32_32x32x16_bf16 v[96:111], v[180:183], v[208:211], v[96:111]
    ds_read_b128 v[200:203], v10 offset:47104
    v_cvt_pk_bf16_f32 v43, v22, v23
    v_mul_f32 v20, v88, v88
    v_mul_f32 v22, v90, v90
    v_mul_f32 v21, v89, v89
    v_mul_f32 v23, v91, v91
    s_waitcnt lgkmcnt(3)
    v_mfma_f32_32x32x16_bf16 v[112:127], v[180:183], v[212:215], v[112:127]
    ds_read_b128 v[204:207], v10 offset:48128
    s_add_u32 s44, s49, 1588224
    buffer_load_dwordx4 v[180:183], v10, s[24:27], s44 offen sc1
    v_fmamk_f32 v20, v20, 0xbdd2d3e8, v18
    v_fmamk_f32 v22, v22, 0xbdd2d3e8, v18
    v_fmamk_f32 v21, v21, 0xbdd2d3e8, v18
    v_fmamk_f32 v23, v23, 0xbdd2d3e8, v18
    v_mul_f32 v20, v20, v88
    s_waitcnt vmcnt(25)
    s_waitcnt lgkmcnt(3)
    v_mfma_f32_32x32x16_bf16 v[96:111], v[184:187], v[192:195], v[96:111]
    ds_read_b128 v[208:211], v10 offset:49152
    v_mul_f32 v22, v22, v90
    v_mul_f32 v21, v21, v89
    v_mul_f32 v23, v23, v91
    v_exp_f32 v20, v20
    s_waitcnt lgkmcnt(3)
    v_mfma_f32_32x32x16_bf16 v[112:127], v[184:187], v[196:199], v[112:127]
    ds_read_b128 v[212:215], v10 offset:50176
    s_add_u32 s44, s49, 1589248
    buffer_load_dwordx4 v[184:187], v10, s[24:27], s44 offen sc1
    v_exp_f32 v22, v22
    v_exp_f32 v21, v21
    v_exp_f32 v23, v23
    s_waitcnt vmcnt(25)
    s_waitcnt lgkmcnt(3)
    v_mfma_f32_32x32x16_bf16 v[96:111], v[188:191], v[200:203], v[96:111]
    ds_read_b128 v[192:195], v10 offset:51200
    v_add_f32 v20, 1.0, v20
    v_add_f32 v22, 1.0, v22
    v_add_f32 v21, 1.0, v21
    v_add_f32 v23, 1.0, v23
    v_rcp_f32 v20, v20
    s_waitcnt lgkmcnt(3)
    v_mfma_f32_32x32x16_bf16 v[112:127], v[188:191], v[204:207], v[112:127]
    ds_read_b128 v[196:199], v10 offset:52224
    s_add_u32 s44, s49, 1590272
    buffer_load_dwordx4 v[188:191], v10, s[24:27], s44 offen sc1
    v_rcp_f32 v22, v22
    v_rcp_f32 v21, v21
    v_rcp_f32 v23, v23
    s_waitcnt vmcnt(25)
    s_waitcnt lgkmcnt(3)
    v_mfma_f32_32x32x16_bf16 v[96:111], v[216:219], v[208:211], v[96:111]
    ds_read_b128 v[200:203], v10 offset:53248
    v_mul_f32 v20, v20, v88
    v_mul_f32 v22, v22, v90
    v_mul_f32 v21, v21, v89
    v_mul_f32 v23, v23, v91
    v_cvt_pk_bf16_f32 v44, v20, v21
    s_waitcnt lgkmcnt(3)
    v_mfma_f32_32x32x16_bf16 v[112:127], v[216:219], v[212:215], v[112:127]
    ds_read_b128 v[204:207], v10 offset:54272
    s_add_u32 s44, s49, 1591296
    buffer_load_dwordx4 v[216:219], v10, s[24:27], s44 offen sc1
    v_cvt_pk_bf16_f32 v45, v22, v23
    v_mul_f32 v20, v92, v92
    v_mul_f32 v22, v94, v94
    v_mul_f32 v21, v93, v93
    v_mul_f32 v23, v95, v95
    s_waitcnt vmcnt(25)
    s_waitcnt lgkmcnt(3)
    v_mfma_f32_32x32x16_bf16 v[96:111], v[220:223], v[192:195], v[96:111]
    ds_read_b128 v[208:211], v10 offset:55296
    v_fmamk_f32 v20, v20, 0xbdd2d3e8, v18
    v_fmamk_f32 v22, v22, 0xbdd2d3e8, v18
    v_fmamk_f32 v21, v21, 0xbdd2d3e8, v18
    v_fmamk_f32 v23, v23, 0xbdd2d3e8, v18
    v_mul_f32 v20, v20, v92
    s_waitcnt lgkmcnt(3)
    v_mfma_f32_32x32x16_bf16 v[112:127], v[220:223], v[196:199], v[112:127]
    ds_read_b128 v[212:215], v10 offset:56320
    s_add_u32 s44, s49, 1592320
    buffer_load_dwordx4 v[220:223], v10, s[24:27], s44 offen sc1
    v_mul_f32 v22, v22, v94
    v_mul_f32 v21, v21, v93
    v_mul_f32 v23, v23, v95
    v_exp_f32 v20, v20
    s_waitcnt vmcnt(25)
    s_waitcnt lgkmcnt(3)
    v_mfma_f32_32x32x16_bf16 v[96:111], v[160:163], v[200:203], v[96:111]
    ds_read_b128 v[192:195], v10 offset:57344
    v_exp_f32 v22, v22
    v_exp_f32 v21, v21
    v_exp_f32 v23, v23
    s_waitcnt lgkmcnt(3)
    v_mfma_f32_32x32x16_bf16 v[112:127], v[160:163], v[204:207], v[112:127]
    ds_read_b128 v[196:199], v10 offset:58368
    s_add_u32 s44, s49, 1593344
    buffer_load_dwordx4 v[160:163], v10, s[24:27], s44 offen sc1
    v_add_f32 v20, 1.0, v20
    v_add_f32 v22, 1.0, v22
    v_add_f32 v21, 1.0, v21
    v_add_f32 v23, 1.0, v23
    v_rcp_f32 v20, v20
    s_waitcnt vmcnt(25)
    s_waitcnt lgkmcnt(3)
    v_mfma_f32_32x32x16_bf16 v[96:111], v[164:167], v[208:211], v[96:111]
    ds_read_b128 v[200:203], v10 offset:59392
    v_rcp_f32 v22, v22
    v_rcp_f32 v21, v21
    v_rcp_f32 v23, v23
    s_waitcnt lgkmcnt(3)
    v_mfma_f32_32x32x16_bf16 v[112:127], v[164:167], v[212:215], v[112:127]
    ds_read_b128 v[204:207], v10 offset:60416
    s_add_u32 s44, s49, 1594368
    buffer_load_dwordx4 v[164:167], v10, s[24:27], s44 offen sc1
    v_mul_f32 v20, v20, v92
    v_mul_f32 v22, v22, v94
    v_mul_f32 v21, v21, v93
    v_mul_f32 v23, v23, v95
    v_cvt_pk_bf16_f32 v46, v20, v21
    s_waitcnt vmcnt(25)
    s_waitcnt lgkmcnt(3)
    v_mfma_f32_32x32x16_bf16 v[96:111], v[224:227], v[192:195], v[96:111]
    ds_read_b128 v[208:211], v10 offset:61440
    v_cvt_pk_bf16_f32 v47, v22, v23
    s_add_u32 s45, s56, 0
    buffer_store_dwordx4 v[32:35], v10, s[40:43], s45 offen offset:0 sc1
    buffer_store_dwordx4 v[36:39], v10, s[40:43], s45 offen offset:1024 sc1
    s_add_u32 s45, s57, 0
    s_waitcnt lgkmcnt(3)
    v_mfma_f32_32x32x16_bf16 v[112:127], v[224:227], v[196:199], v[112:127]
    ds_read_b128 v[212:215], v10 offset:62464
    s_add_u32 s44, s49, 1595392
    buffer_load_dwordx4 v[224:227], v10, s[24:27], s44 offen sc1
    buffer_store_dwordx4 v[40:43], v10, s[40:43], s45 offen offset:0 sc1
    buffer_store_dwordx4 v[44:47], v10, s[40:43], s45 offen offset:1024 sc1
    s_waitcnt vmcnt(29)
    s_waitcnt lgkmcnt(3)
    v_mfma_f32_32x32x16_bf16 v[96:111], v[228:231], v[200:203], v[96:111]
    ds_read_b128 v[192:195], v10 offset:63488
    s_waitcnt lgkmcnt(3)
    v_mfma_f32_32x32x16_bf16 v[112:127], v[228:231], v[204:207], v[112:127]
    ds_read_b128 v[196:199], v10 offset:64512
    s_add_u32 s44, s49, 1596416
    buffer_load_dwordx4 v[228:231], v10, s[24:27], s44 offen sc1
    s_waitcnt vmcnt(29)
    s_waitcnt lgkmcnt(3)
    v_mfma_f32_32x32x16_bf16 v[96:111], v[232:235], v[208:211], v[96:111]
    ds_read_b128 v[200:203], v10 offset:0
    s_waitcnt lgkmcnt(3)
    v_mfma_f32_32x32x16_bf16 v[112:127], v[232:235], v[212:215], v[112:127]
    ds_read_b128 v[204:207], v10 offset:1024
    s_add_u32 s44, s49, 1597440
    buffer_load_dwordx4 v[232:235], v10, s[24:27], s44 offen sc1
    s_waitcnt vmcnt(29)
    s_waitcnt lgkmcnt(3)
    v_mfma_f32_32x32x16_bf16 v[96:111], v[236:239], v[192:195], v[96:111]
    ds_read_b128 v[208:211], v10 offset:2048
    s_waitcnt lgkmcnt(3)
    v_mfma_f32_32x32x16_bf16 v[112:127], v[236:239], v[196:199], v[112:127]
    ds_read_b128 v[212:215], v10 offset:3072
    s_add_u32 s44, s49, 1598464
    buffer_load_dwordx4 v[236:239], v10, s[24:27], s44 offen sc1
    s_waitcnt vmcnt(29)
    s_waitcnt lgkmcnt(3)
    v_mfma_f32_32x32x16_bf16 v[64:79], v[128:131], v[200:203], 0
    ds_read_b128 v[192:195], v10 offset:4096
    s_nop 1
    v_mul_f32 v20, v96, v96
    v_mul_f32 v22, v98, v98
    v_mul_f32 v21, v97, v97
    v_mul_f32 v23, v99, v99
    v_fmamk_f32 v20, v20, 0xbdd2d3e8, v18
    s_waitcnt lgkmcnt(3)
    v_mfma_f32_32x32x16_bf16 v[80:95], v[128:131], v[204:207], 0
    ds_read_b128 v[196:199], v10 offset:5120
    s_add_u32 s44, s49, 1599488
    buffer_load_dwordx4 v[128:131], v10, s[24:27], s44 offen sc1
    v_fmamk_f32 v22, v22, 0xbdd2d3e8, v18
    v_fmamk_f32 v21, v21, 0xbdd2d3e8, v18
    v_fmamk_f32 v23, v23, 0xbdd2d3e8, v18
    v_mul_f32 v20, v20, v96
    v_mul_f32 v22, v22, v98
    s_waitcnt vmcnt(29)
    s_waitcnt lgkmcnt(3)
    v_mfma_f32_32x32x16_bf16 v[64:79], v[132:135], v[208:211], v[64:79]
    ds_read_b128 v[200:203], v10 offset:6144
    v_mul_f32 v21, v21, v97
    v_mul_f32 v23, v23, v99
    v_exp_f32 v20, v20
    v_exp_f32 v22, v22
    s_waitcnt lgkmcnt(3)
    v_mfma_f32_32x32x16_bf16 v[80:95], v[132:135], v[212:215], v[80:95]
    ds_read_b128 v[204:207], v10 offset:7168
    s_add_u32 s44, s49, 1600512
    buffer_load_dwordx4 v[132:135], v10, s[24:27], s44 offen sc1
    v_exp_f32 v21, v21
    v_exp_f32 v23, v23
    v_add_f32 v20, 1.0, v20
    s_waitcnt vmcnt(29)
    s_waitcnt lgkmcnt(3)
    v_mfma_f32_32x32x16_bf16 v[64:79], v[136:139], v[192:195], v[64:79]
    ds_read_b128 v[208:211], v10 offset:8192
    v_add_f32 v22, 1.0, v22
    v_add_f32 v21, 1.0, v21
    v_add_f32 v23, 1.0, v23
    v_rcp_f32 v20, v20
    s_waitcnt lgkmcnt(3)
    v_mfma_f32_32x32x16_bf16 v[80:95], v[136:139], v[196:199], v[80:95]
    ds_read_b128 v[212:215], v10 offset:9216
    s_add_u32 s44, s49, 1601536
    buffer_load_dwordx4 v[136:139], v10, s[24:27], s44 offen sc1
    v_rcp_f32 v22, v22
    v_rcp_f32 v21, v21
    v_rcp_f32 v23, v23
    s_waitcnt vmcnt(29)
    s_waitcnt lgkmcnt(3)
    v_mfma_f32_32x32x16_bf16 v[64:79], v[140:143], v[200:203], v[64:79]
    ds_read_b128 v[192:195], v10 offset:10240
    v_mul_f32 v20, v20, v96
    v_mul_f32 v22, v22, v98
    v_mul_f32 v21, v21, v97
    v_mul_f32 v23, v23, v99
    v_cvt_pk_bf16_f32 v48, v20, v21
    s_waitcnt lgkmcnt(3)
    v_mfma_f32_32x32x16_bf16 v[80:95], v[140:143], v[204:207], v[80:95]
    ds_read_b128 v[196:199], v10 offset:11264
    s_add_u32 s44, s49, 1602560
    buffer_load_dwordx4 v[140:143], v10, s[24:27], s44 offen sc1
    v_cvt_pk_bf16_f32 v49, v22, v23
    v_mul_f32 v20, v100, v100
    v_mul_f32 v22, v102, v102
    v_mul_f32 v21, v101, v101
    v_mul_f32 v23, v103, v103
    s_waitcnt vmcnt(29)
    s_waitcnt lgkmcnt(3)
    v_mfma_f32_32x32x16_bf16 v[64:79], v[144:147], v[208:211], v[64:79]
    ds_read_b128 v[200:203], v10 offset:12288
    v_fmamk_f32 v20, v20, 0xbdd2d3e8, v18
    v_fmamk_f32 v22, v22, 0xbdd2d3e8, v18
    v_fmamk_f32 v21, v21, 0xbdd2d3e8, v18
    v_fmamk_f32 v23, v23, 0xbdd2d3e8, v18
    v_mul_f32 v20, v20, v100
    s_waitcnt lgkmcnt(3)
    v_mfma_f32_32x32x16_bf16 v[80:95], v[144:147], v[212:215], v[80:95]
    ds_read_b128 v[204:207], v10 offset:13312
    s_add_u32 s44, s49, 1603584
    buffer_load_dwordx4 v[144:147], v10, s[24:27], s44 offen sc1
    v_mul_f32 v22, v22, v102
    v_mul_f32 v21, v21, v101
    v_mul_f32 v23, v23, v103
    v_exp_f32 v20, v20
    s_waitcnt vmcnt(29)
    s_waitcnt lgkmcnt(3)
    v_mfma_f32_32x32x16_bf16 v[64:79], v[148:151], v[192:195], v[64:79]
    ds_read_b128 v[208:211], v10 offset:14336
    v_exp_f32 v22, v22
    v_exp_f32 v21, v21
    v_exp_f32 v23, v23
    s_waitcnt lgkmcnt(3)
    v_mfma_f32_32x32x16_bf16 v[80:95], v[148:151], v[196:199], v[80:95]
    ds_read_b128 v[212:215], v10 offset:15360
    s_add_u32 s44, s49, 1604608
    buffer_load_dwordx4 v[148:151], v10, s[24:27], s44 offen sc1
    v_add_f32 v20, 1.0, v20
    v_add_f32 v22, 1.0, v22
    v_add_f32 v21, 1.0, v21
    v_add_f32 v23, 1.0, v23
    v_rcp_f32 v20, v20
    s_waitcnt vmcnt(29)
    s_waitcnt lgkmcnt(3)
    v_mfma_f32_32x32x16_bf16 v[64:79], v[152:155], v[200:203], v[64:79]
    ds_read_b128 v[192:195], v10 offset:16384
    v_rcp_f32 v22, v22
    v_rcp_f32 v21, v21
    v_rcp_f32 v23, v23
    s_waitcnt lgkmcnt(3)
    v_mfma_f32_32x32x16_bf16 v[80:95], v[152:155], v[204:207], v[80:95]
    ds_read_b128 v[196:199], v10 offset:17408
    s_add_u32 s44, s49, 1835008
    buffer_load_dwordx4 v[152:155], v10, s[24:27], s44 offen sc1
    v_mul_f32 v20, v20, v100
    v_mul_f32 v22, v22, v102
    v_mul_f32 v21, v21, v101
    v_mul_f32 v23, v23, v103
    v_cvt_pk_bf16_f32 v50, v20, v21
    s_waitcnt vmcnt(29)
    s_waitcnt lgkmcnt(3)
    v_mfma_f32_32x32x16_bf16 v[64:79], v[156:159], v[208:211], v[64:79]
    ds_read_b128 v[200:203], v10 offset:18432
    v_cvt_pk_bf16_f32 v51, v22, v23
    v_mul_f32 v20, v104, v104
    v_mul_f32 v22, v106, v106
    v_mul_f32 v21, v105, v105
    v_mul_f32 v23, v107, v107
    s_waitcnt lgkmcnt(3)
    v_mfma_f32_32x32x16_bf16 v[80:95], v[156:159], v[212:215], v[80:95]
    ds_read_b128 v[204:207], v10 offset:19456
    s_add_u32 s44, s49, 1836032
    buffer_load_dwordx4 v[156:159], v10, s[24:27], s44 offen sc1
    v_fmamk_f32 v20, v20, 0xbdd2d3e8, v18
    v_fmamk_f32 v22, v22, 0xbdd2d3e8, v18
    v_fmamk_f32 v21, v21, 0xbdd2d3e8, v18
    v_fmamk_f32 v23, v23, 0xbdd2d3e8, v18
    v_mul_f32 v20, v20, v104
    s_waitcnt vmcnt(29)
    s_waitcnt lgkmcnt(3)
    v_mfma_f32_32x32x16_bf16 v[64:79], v[240:243], v[192:195], v[64:79]
    ds_read_b128 v[208:211], v10 offset:20480
    v_mul_f32 v22, v22, v106
    v_mul_f32 v21, v21, v105
    v_mul_f32 v23, v23, v107
    v_exp_f32 v20, v20
    s_waitcnt lgkmcnt(3)
    v_mfma_f32_32x32x16_bf16 v[80:95], v[240:243], v[196:199], v[80:95]
    ds_read_b128 v[212:215], v10 offset:21504
    s_add_u32 s44, s49, 1837056
    buffer_load_dwordx4 v[240:243], v10, s[24:27], s44 offen sc1
    v_exp_f32 v22, v22
    v_exp_f32 v21, v21
    v_exp_f32 v23, v23
    s_waitcnt vmcnt(29)
    s_waitcnt lgkmcnt(3)
    v_mfma_f32_32x32x16_bf16 v[64:79], v[244:247], v[200:203], v[64:79]
    ds_read_b128 v[192:195], v10 offset:22528
    v_add_f32 v20, 1.0, v20
    v_add_f32 v22, 1.0, v22
    v_add_f32 v21, 1.0, v21
    v_add_f32 v23, 1.0, v23
    v_rcp_f32 v20, v20
    s_waitcnt lgkmcnt(3)
    v_mfma_f32_32x32x16_bf16 v[80:95], v[244:247], v[204:207], v[80:95]
    ds_read_b128 v[196:199], v10 offset:23552
    s_add_u32 s44, s49, 1838080
    buffer_load_dwordx4 v[244:247], v10, s[24:27], s44 offen sc1
    v_rcp_f32 v22, v22
    v_rcp_f32 v21, v21
    v_rcp_f32 v23, v23
    s_waitcnt vmcnt(29)
    s_waitcnt lgkmcnt(3)
    v_mfma_f32_32x32x16_bf16 v[64:79], v[248:251], v[208:211], v[64:79]
    ds_read_b128 v[200:203], v10 offset:24576
    v_mul_f32 v20, v20, v104
    v_mul_f32 v22, v22, v106
    v_mul_f32 v21, v21, v105
    v_mul_f32 v23, v23, v107
    v_cvt_pk_bf16_f32 v52, v20, v21
    s_waitcnt lgkmcnt(3)
    v_mfma_f32_32x32x16_bf16 v[80:95], v[248:251], v[212:215], v[80:95]
    ds_read_b128 v[204:207], v10 offset:25600
    s_add_u32 s44, s49, 1839104
    buffer_load_dwordx4 v[248:251], v10, s[24:27], s44 offen sc1
    v_cvt_pk_bf16_f32 v53, v22, v23
    v_mul_f32 v20, v108, v108
    v_mul_f32 v22, v110, v110
    v_mul_f32 v21, v109, v109
    v_mul_f32 v23, v111, v111
    s_waitcnt vmcnt(29)
    s_waitcnt lgkmcnt(3)
    v_mfma_f32_32x32x16_bf16 v[64:79], v[252:255], v[192:195], v[64:79]
    ds_read_b128 v[208:211], v10 offset:26624
    v_fmamk_f32 v20, v20, 0xbdd2d3e8, v18
    v_fmamk_f32 v22, v22, 0xbdd2d3e8, v18
    v_fmamk_f32 v21, v21, 0xbdd2d3e8, v18
    v_fmamk_f32 v23, v23, 0xbdd2d3e8, v18
    v_mul_f32 v20, v20, v108
    s_waitcnt lgkmcnt(3)
    v_mfma_f32_32x32x16_bf16 v[80:95], v[252:255], v[196:199], v[80:95]
    ds_read_b128 v[212:215], v10 offset:27648
    s_add_u32 s44, s49, 1840128
    buffer_load_dwordx4 v[252:255], v10, s[24:27], s44 offen sc1
    v_mul_f32 v22, v22, v110
    v_mul_f32 v21, v21, v109
    v_mul_f32 v23, v23, v111
    v_exp_f32 v20, v20
    s_waitcnt vmcnt(29)
    s_waitcnt lgkmcnt(3)
    v_mfma_f32_32x32x16_bf16 v[64:79], v[168:171], v[200:203], v[64:79]
    ds_read_b128 v[192:195], v10 offset:28672
    v_exp_f32 v22, v22
    v_exp_f32 v21, v21
    v_exp_f32 v23, v23
    s_waitcnt lgkmcnt(3)
    v_mfma_f32_32x32x16_bf16 v[80:95], v[168:171], v[204:207], v[80:95]
    ds_read_b128 v[196:199], v10 offset:29696
    s_add_u32 s44, s49, 1841152
    buffer_load_dwordx4 v[168:171], v10, s[24:27], s44 offen sc1
    v_add_f32 v20, 1.0, v20
    v_add_f32 v22, 1.0, v22
    v_add_f32 v21, 1.0, v21
    v_add_f32 v23, 1.0, v23
    v_rcp_f32 v20, v20
    s_waitcnt vmcnt(29)
    s_waitcnt lgkmcnt(3)
    v_mfma_f32_32x32x16_bf16 v[64:79], v[172:175], v[208:211], v[64:79]
    ds_read_b128 v[200:203], v10 offset:30720
    v_rcp_f32 v22, v22
    v_rcp_f32 v21, v21
    v_rcp_f32 v23, v23
    s_waitcnt lgkmcnt(3)
    v_mfma_f32_32x32x16_bf16 v[80:95], v[172:175], v[212:215], v[80:95]
    ds_read_b128 v[204:207], v10 offset:31744
    s_add_u32 s44, s49, 1842176
    buffer_load_dwordx4 v[172:175], v10, s[24:27], s44 offen sc1
    v_mul_f32 v20, v20, v108
    v_mul_f32 v22, v22, v110
    v_mul_f32 v21, v21, v109
    v_mul_f32 v23, v23, v111
    v_cvt_pk_bf16_f32 v54, v20, v21
    s_waitcnt vmcnt(29)
    s_waitcnt lgkmcnt(3)
    v_mfma_f32_32x32x16_bf16 v[64:79], v[176:179], v[192:195], v[64:79]
    ds_read_b128 v[208:211], v10 offset:32768
    v_cvt_pk_bf16_f32 v55, v22, v23
    v_mul_f32 v20, v112, v112
    v_mul_f32 v22, v114, v114
    v_mul_f32 v21, v113, v113
    v_mul_f32 v23, v115, v115
    s_waitcnt lgkmcnt(3)
    v_mfma_f32_32x32x16_bf16 v[80:95], v[176:179], v[196:199], v[80:95]
    ds_read_b128 v[212:215], v10 offset:33792
    s_add_u32 s44, s49, 1843200
    buffer_load_dwordx4 v[176:179], v10, s[24:27], s44 offen sc1
    v_fmamk_f32 v20, v20, 0xbdd2d3e8, v18
    v_fmamk_f32 v22, v22, 0xbdd2d3e8, v18
    v_fmamk_f32 v21, v21, 0xbdd2d3e8, v18
    v_fmamk_f32 v23, v23, 0xbdd2d3e8, v18
    v_mul_f32 v20, v20, v112
    s_waitcnt vmcnt(29)
    s_waitcnt lgkmcnt(3)
    v_mfma_f32_32x32x16_bf16 v[64:79], v[180:183], v[200:203], v[64:79]
    ds_read_b128 v[192:195], v10 offset:34816
    v_mul_f32 v22, v22, v114
    v_mul_f32 v21, v21, v113
    v_mul_f32 v23, v23, v115
    v_exp_f32 v20, v20
    s_waitcnt lgkmcnt(3)
    v_mfma_f32_32x32x16_bf16 v[80:95], v[180:183], v[204:207], v[80:95]
    ds_read_b128 v[196:199], v10 offset:35840
    s_add_u32 s44, s49, 1844224
    buffer_load_dwordx4 v[180:183], v10, s[24:27], s44 offen sc1
    v_exp_f32 v22, v22
    v_exp_f32 v21, v21
    v_exp_f32 v23, v23
    s_waitcnt vmcnt(29)
    s_waitcnt lgkmcnt(3)
    v_mfma_f32_32x32x16_bf16 v[64:79], v[184:187], v[208:211], v[64:79]
    ds_read_b128 v[200:203], v10 offset:36864
    v_add_f32 v20, 1.0, v20
    v_add_f32 v22, 1.0, v22
    v_add_f32 v21, 1.0, v21
    v_add_f32 v23, 1.0, v23
    v_rcp_f32 v20, v20
    s_waitcnt lgkmcnt(3)
    v_mfma_f32_32x32x16_bf16 v[80:95], v[184:187], v[212:215], v[80:95]
    ds_read_b128 v[204:207], v10 offset:37888
    s_add_u32 s44, s49, 1845248
    buffer_load_dwordx4 v[184:187], v10, s[24:27], s44 offen sc1
    v_rcp_f32 v22, v22
    v_rcp_f32 v21, v21
    v_rcp_f32 v23, v23
    s_waitcnt vmcnt(29)
    s_waitcnt lgkmcnt(3)
    v_mfma_f32_32x32x16_bf16 v[64:79], v[188:191], v[192:195], v[64:79]
    ds_read_b128 v[208:211], v10 offset:38912
    v_mul_f32 v20, v20, v112
    v_mul_f32 v22, v22, v114
    v_mul_f32 v21, v21, v113
    v_mul_f32 v23, v23, v115
    v_cvt_pk_bf16_f32 v56, v20, v21
    s_waitcnt lgkmcnt(3)
    v_mfma_f32_32x32x16_bf16 v[80:95], v[188:191], v[196:199], v[80:95]
    ds_read_b128 v[212:215], v10 offset:39936
    s_add_u32 s44, s49, 1846272
    buffer_load_dwordx4 v[188:191], v10, s[24:27], s44 offen sc1
    v_cvt_pk_bf16_f32 v57, v22, v23
    v_mul_f32 v20, v116, v116
    v_mul_f32 v22, v118, v118
    v_mul_f32 v21, v117, v117
    v_mul_f32 v23, v119, v119
    s_waitcnt vmcnt(29)
    s_waitcnt lgkmcnt(3)
    v_mfma_f32_32x32x16_bf16 v[64:79], v[216:219], v[200:203], v[64:79]
    ds_read_b128 v[192:195], v10 offset:40960
    v_fmamk_f32 v20, v20, 0xbdd2d3e8, v18
    v_fmamk_f32 v22, v22, 0xbdd2d3e8, v18
    v_fmamk_f32 v21, v21, 0xbdd2d3e8, v18
    v_fmamk_f32 v23, v23, 0xbdd2d3e8, v18
    v_mul_f32 v20, v20, v116
    s_waitcnt lgkmcnt(3)
    v_mfma_f32_32x32x16_bf16 v[80:95], v[216:219], v[204:207], v[80:95]
    ds_read_b128 v[196:199], v10 offset:41984
    s_add_u32 s44, s49, 1847296
    buffer_load_dwordx4 v[216:219], v10, s[24:27], s44 offen sc1
    v_mul_f32 v22, v22, v118
    v_mul_f32 v21, v21, v117
    v_mul_f32 v23, v23, v119
    v_exp_f32 v20, v20
    s_waitcnt vmcnt(29)
    s_waitcnt lgkmcnt(3)
    v_mfma_f32_32x32x16_bf16 v[64:79], v[220:223], v[208:211], v[64:79]
    ds_read_b128 v[200:203], v10 offset:43008
    v_exp_f32 v22, v22
    v_exp_f32 v21, v21
    v_exp_f32 v23, v23
    s_waitcnt lgkmcnt(3)
    v_mfma_f32_32x32x16_bf16 v[80:95], v[220:223], v[212:215], v[80:95]
    ds_read_b128 v[204:207], v10 offset:44032
    s_add_u32 s44, s49, 1848320
    buffer_load_dwordx4 v[220:223], v10, s[24:27], s44 offen sc1
    v_add_f32 v20, 1.0, v20
    v_add_f32 v22, 1.0, v22
    v_add_f32 v21, 1.0, v21
    v_add_f32 v23, 1.0, v23
    v_rcp_f32 v20, v20
    s_waitcnt vmcnt(29)
    s_waitcnt lgkmcnt(3)
    v_mfma_f32_32x32x16_bf16 v[64:79], v[160:163], v[192:195], v[64:79]
    ds_read_b128 v[208:211], v10 offset:45056
    v_rcp_f32 v22, v22
    v_rcp_f32 v21, v21
    v_rcp_f32 v23, v23
    s_waitcnt lgkmcnt(3)
    v_mfma_f32_32x32x16_bf16 v[80:95], v[160:163], v[196:199], v[80:95]
    ds_read_b128 v[212:215], v10 offset:46080
    s_add_u32 s44, s49, 1849344
    buffer_load_dwordx4 v[160:163], v10, s[24:27], s44 offen sc1
    v_mul_f32 v20, v20, v116
    v_mul_f32 v22, v22, v118
    v_mul_f32 v21, v21, v117
    v_mul_f32 v23, v23, v119
    v_cvt_pk_bf16_f32 v58, v20, v21
    s_waitcnt vmcnt(29)
    s_waitcnt lgkmcnt(3)
    v_mfma_f32_32x32x16_bf16 v[64:79], v[164:167], v[200:203], v[64:79]
    ds_read_b128 v[192:195], v10 offset:47104
    v_cvt_pk_bf16_f32 v59, v22, v23
    v_mul_f32 v20, v120, v120
    v_mul_f32 v22, v122, v122
    v_mul_f32 v21, v121, v121
    v_mul_f32 v23, v123, v123
    s_waitcnt lgkmcnt(3)
    v_mfma_f32_32x32x16_bf16 v[80:95], v[164:167], v[204:207], v[80:95]
    ds_read_b128 v[196:199], v10 offset:48128
    s_add_u32 s44, s49, 1850368
    buffer_load_dwordx4 v[164:167], v10, s[24:27], s44 offen sc1
    v_fmamk_f32 v20, v20, 0xbdd2d3e8, v18
    v_fmamk_f32 v22, v22, 0xbdd2d3e8, v18
    v_fmamk_f32 v21, v21, 0xbdd2d3e8, v18
    v_fmamk_f32 v23, v23, 0xbdd2d3e8, v18
    v_mul_f32 v20, v20, v120
    s_waitcnt vmcnt(27)
    s_waitcnt lgkmcnt(3)
    v_mfma_f32_32x32x16_bf16 v[64:79], v[224:227], v[208:211], v[64:79]
    ds_read_b128 v[200:203], v10 offset:49152
    v_mul_f32 v22, v22, v122
    v_mul_f32 v21, v21, v121
    v_mul_f32 v23, v23, v123
    v_exp_f32 v20, v20
    s_waitcnt lgkmcnt(3)
    v_mfma_f32_32x32x16_bf16 v[80:95], v[224:227], v[212:215], v[80:95]
    ds_read_b128 v[204:207], v10 offset:50176
    s_add_u32 s44, s49, 1851392
    buffer_load_dwordx4 v[224:227], v10, s[24:27], s44 offen sc1
    v_exp_f32 v22, v22
    v_exp_f32 v21, v21
    v_exp_f32 v23, v23
    s_waitcnt vmcnt(25)
    s_waitcnt lgkmcnt(3)
    v_mfma_f32_32x32x16_bf16 v[64:79], v[228:231], v[192:195], v[64:79]
    ds_read_b128 v[208:211], v10 offset:51200
    v_add_f32 v20, 1.0, v20
    v_add_f32 v22, 1.0, v22
    v_add_f32 v21, 1.0, v21
    v_add_f32 v23, 1.0, v23
    v_rcp_f32 v20, v20
    s_waitcnt lgkmcnt(3)
    v_mfma_f32_32x32x16_bf16 v[80:95], v[228:231], v[196:199], v[80:95]
    ds_read_b128 v[212:215], v10 offset:52224
    s_add_u32 s44, s49, 1852416
    buffer_load_dwordx4 v[228:231], v10, s[24:27], s44 offen sc1
    v_rcp_f32 v22, v22
    v_rcp_f32 v21, v21
    v_rcp_f32 v23, v23
    s_waitcnt vmcnt(25)
    s_waitcnt lgkmcnt(3)
    v_mfma_f32_32x32x16_bf16 v[64:79], v[232:235], v[200:203], v[64:79]
    ds_read_b128 v[192:195], v10 offset:53248
    v_mul_f32 v20, v20, v120
    v_mul_f32 v22, v22, v122
    v_mul_f32 v21, v21, v121
    v_mul_f32 v23, v23, v123
    v_cvt_pk_bf16_f32 v60, v20, v21
    s_waitcnt lgkmcnt(3)
    v_mfma_f32_32x32x16_bf16 v[80:95], v[232:235], v[204:207], v[80:95]
    ds_read_b128 v[196:199], v10 offset:54272
    s_add_u32 s44, s49, 1853440
    buffer_load_dwordx4 v[232:235], v10, s[24:27], s44 offen sc1
    v_cvt_pk_bf16_f32 v61, v22, v23
    v_mul_f32 v20, v124, v124
    v_mul_f32 v22, v126, v126
    v_mul_f32 v21, v125, v125
    v_mul_f32 v23, v127, v127
    s_waitcnt vmcnt(25)
    s_waitcnt lgkmcnt(3)
    v_mfma_f32_32x32x16_bf16 v[64:79], v[236:239], v[208:211], v[64:79]
    ds_read_b128 v[200:203], v10 offset:55296
    v_fmamk_f32 v20, v20, 0xbdd2d3e8, v18
    v_fmamk_f32 v22, v22, 0xbdd2d3e8, v18
    v_fmamk_f32 v21, v21, 0xbdd2d3e8, v18
    v_fmamk_f32 v23, v23, 0xbdd2d3e8, v18
    v_mul_f32 v20, v20, v124
    s_waitcnt lgkmcnt(3)
    v_mfma_f32_32x32x16_bf16 v[80:95], v[236:239], v[212:215], v[80:95]
    ds_read_b128 v[204:207], v10 offset:56320
    s_add_u32 s44, s49, 1854464
    buffer_load_dwordx4 v[236:239], v10, s[24:27], s44 offen sc1
    v_mul_f32 v22, v22, v126
    v_mul_f32 v21, v21, v125
    v_mul_f32 v23, v23, v127
    v_exp_f32 v20, v20
    s_waitcnt vmcnt(25)
    s_waitcnt lgkmcnt(3)
    v_mfma_f32_32x32x16_bf16 v[64:79], v[128:131], v[192:195], v[64:79]
    ds_read_b128 v[208:211], v10 offset:57344
    v_exp_f32 v22, v22
    v_exp_f32 v21, v21
    v_exp_f32 v23, v23
    s_waitcnt lgkmcnt(3)
    v_mfma_f32_32x32x16_bf16 v[80:95], v[128:131], v[196:199], v[80:95]
    ds_read_b128 v[212:215], v10 offset:58368
    s_add_u32 s44, s49, 1855488
    buffer_load_dwordx4 v[128:131], v10, s[24:27], s44 offen sc1
    v_add_f32 v20, 1.0, v20
    v_add_f32 v22, 1.0, v22
    v_add_f32 v21, 1.0, v21
    v_add_f32 v23, 1.0, v23
    v_rcp_f32 v20, v20
    s_waitcnt vmcnt(25)
    s_waitcnt lgkmcnt(3)
    v_mfma_f32_32x32x16_bf16 v[64:79], v[132:135], v[200:203], v[64:79]
    ds_read_b128 v[192:195], v10 offset:59392
    v_rcp_f32 v22, v22
    v_rcp_f32 v21, v21
    v_rcp_f32 v23, v23
    s_waitcnt lgkmcnt(3)
    v_mfma_f32_32x32x16_bf16 v[80:95], v[132:135], v[204:207], v[80:95]
    ds_read_b128 v[196:199], v10 offset:60416
    s_add_u32 s44, s49, 1856512
    buffer_load_dwordx4 v[132:135], v10, s[24:27], s44 offen sc1
    v_mul_f32 v20, v20, v124
    v_mul_f32 v22, v22, v126
    v_mul_f32 v21, v21, v125
    v_mul_f32 v23, v23, v127
    v_cvt_pk_bf16_f32 v62, v20, v21
    s_waitcnt vmcnt(25)
    s_waitcnt lgkmcnt(3)
    v_mfma_f32_32x32x16_bf16 v[64:79], v[136:139], v[208:211], v[64:79]
    ds_read_b128 v[200:203], v10 offset:61440
    v_cvt_pk_bf16_f32 v63, v22, v23
    s_add_u32 s45, s56, 16384
    buffer_store_dwordx4 v[48:51], v10, s[40:43], s45 offen offset:0 sc1
    buffer_store_dwordx4 v[52:55], v10, s[40:43], s45 offen offset:1024 sc1
    s_add_u32 s45, s57, 16384
    s_waitcnt lgkmcnt(3)
    v_mfma_f32_32x32x16_bf16 v[80:95], v[136:139], v[212:215], v[80:95]
    ds_read_b128 v[204:207], v10 offset:62464
    s_add_u32 s44, s49, 1857536
    buffer_load_dwordx4 v[136:139], v10, s[24:27], s44 offen sc1
    buffer_store_dwordx4 v[56:59], v10, s[40:43], s45 offen offset:0 sc1
    buffer_store_dwordx4 v[60:63], v10, s[40:43], s45 offen offset:1024 sc1
    s_waitcnt vmcnt(29)
    s_waitcnt lgkmcnt(3)
    v_mfma_f32_32x32x16_bf16 v[64:79], v[140:143], v[192:195], v[64:79]
    ds_read_b128 v[208:211], v10 offset:63488
    s_waitcnt lgkmcnt(3)
    v_mfma_f32_32x32x16_bf16 v[80:95], v[140:143], v[196:199], v[80:95]
    ds_read_b128 v[212:215], v10 offset:64512
    s_add_u32 s44, s49, 1858560
    buffer_load_dwordx4 v[140:143], v10, s[24:27], s44 offen sc1
    s_waitcnt vmcnt(29)
    s_waitcnt lgkmcnt(3)
    v_mfma_f32_32x32x16_bf16 v[64:79], v[144:147], v[200:203], v[64:79]
    ds_read_b128 v[192:195], v10 offset:0
    s_waitcnt lgkmcnt(3)
    v_mfma_f32_32x32x16_bf16 v[80:95], v[144:147], v[204:207], v[80:95]
    ds_read_b128 v[196:199], v10 offset:1024
    s_add_u32 s44, s49, 1859584
    buffer_load_dwordx4 v[144:147], v10, s[24:27], s44 offen sc1
    s_waitcnt vmcnt(29)
    s_waitcnt lgkmcnt(3)
    v_mfma_f32_32x32x16_bf16 v[64:79], v[148:151], v[208:211], v[64:79]
    ds_read_b128 v[200:203], v10 offset:2048
    s_waitcnt lgkmcnt(3)
    v_mfma_f32_32x32x16_bf16 v[80:95], v[148:151], v[212:215], v[80:95]
    ds_read_b128 v[204:207], v10 offset:3072
    s_add_u32 s44, s49, 1860608
    buffer_load_dwordx4 v[148:151], v10, s[24:27], s44 offen sc1
    s_waitcnt vmcnt(29)
    s_waitcnt lgkmcnt(3)
    v_mfma_f32_32x32x16_bf16 v[96:111], v[152:155], v[192:195], 0
    ds_read_b128 v[208:211], v10 offset:4096
    s_nop 1
    v_mul_f32 v20, v64, v64
    v_mul_f32 v22, v66, v66
    v_mul_f32 v21, v65, v65
    v_mul_f32 v23, v67, v67
    v_fmamk_f32 v20, v20, 0xbdd2d3e8, v18
    s_waitcnt lgkmcnt(3)
    v_mfma_f32_32x32x16_bf16 v[112:127], v[152:155], v[196:199], 0
    ds_read_b128 v[212:215], v10 offset:5120
    s_add_u32 s44, s49, 1861632
    buffer_load_dwordx4 v[152:155], v10, s[24:27], s44 offen sc1
    v_fmamk_f32 v22, v22, 0xbdd2d3e8, v18
    v_fmamk_f32 v21, v21, 0xbdd2d3e8, v18
    v_fmamk_f32 v23, v23, 0xbdd2d3e8, v18
    v_mul_f32 v20, v20, v64
    v_mul_f32 v22, v22, v66
    s_waitcnt vmcnt(29)
    s_waitcnt lgkmcnt(3)
    v_mfma_f32_32x32x16_bf16 v[96:111], v[156:159], v[200:203], v[96:111]
    ds_read_b128 v[192:195], v10 offset:6144
    v_mul_f32 v21, v21, v65
    v_mul_f32 v23, v23, v67
    v_exp_f32 v20, v20
    v_exp_f32 v22, v22
    s_waitcnt lgkmcnt(3)
    v_mfma_f32_32x32x16_bf16 v[112:127], v[156:159], v[204:207], v[112:127]
    ds_read_b128 v[196:199], v10 offset:7168
    s_add_u32 s44, s49, 1862656
    buffer_load_dwordx4 v[156:159], v10, s[24:27], s44 offen sc1
    v_exp_f32 v21, v21
    v_exp_f32 v23, v23
    v_add_f32 v20, 1.0, v20
    s_waitcnt vmcnt(29)
    s_waitcnt lgkmcnt(3)
    v_mfma_f32_32x32x16_bf16 v[96:111], v[240:243], v[208:211], v[96:111]
    ds_read_b128 v[200:203], v10 offset:8192
    v_add_f32 v22, 1.0, v22
    v_add_f32 v21, 1.0, v21
    v_add_f32 v23, 1.0, v23
    v_rcp_f32 v20, v20
    s_waitcnt lgkmcnt(3)
    v_mfma_f32_32x32x16_bf16 v[112:127], v[240:243], v[212:215], v[112:127]
    ds_read_b128 v[204:207], v10 offset:9216
    s_add_u32 s44, s49, 1863680
    buffer_load_dwordx4 v[240:243], v10, s[24:27], s44 offen sc1
    v_rcp_f32 v22, v22
    v_rcp_f32 v21, v21
    v_rcp_f32 v23, v23
    s_waitcnt vmcnt(29)
    s_waitcnt lgkmcnt(3)
    v_mfma_f32_32x32x16_bf16 v[96:111], v[244:247], v[192:195], v[96:111]
    ds_read_b128 v[208:211], v10 offset:10240
    v_mul_f32 v20, v20, v64
    v_mul_f32 v22, v22, v66
    v_mul_f32 v21, v21, v65
    v_mul_f32 v23, v23, v67
    v_cvt_pk_bf16_f32 v32, v20, v21
    s_waitcnt lgkmcnt(3)
    v_mfma_f32_32x32x16_bf16 v[112:127], v[244:247], v[196:199], v[112:127]
    ds_read_b128 v[212:215], v10 offset:11264
    s_add_u32 s44, s49, 1864704
    buffer_load_dwordx4 v[244:247], v10, s[24:27], s44 offen sc1
    v_cvt_pk_bf16_f32 v33, v22, v23
    v_mul_f32 v20, v68, v68
    v_mul_f32 v22, v70, v70
    v_mul_f32 v21, v69, v69
    v_mul_f32 v23, v71, v71
    s_waitcnt vmcnt(29)
    s_waitcnt lgkmcnt(3)
    v_mfma_f32_32x32x16_bf16 v[96:111], v[248:251], v[200:203], v[96:111]
    ds_read_b128 v[192:195], v10 offset:12288
    v_fmamk_f32 v20, v20, 0xbdd2d3e8, v18
    v_fmamk_f32 v22, v22, 0xbdd2d3e8, v18
    v_fmamk_f32 v21, v21, 0xbdd2d3e8, v18
    v_fmamk_f32 v23, v23, 0xbdd2d3e8, v18
    v_mul_f32 v20, v20, v68
    s_waitcnt lgkmcnt(3)
    v_mfma_f32_32x32x16_bf16 v[112:127], v[248:251], v[204:207], v[112:127]
    ds_read_b128 v[196:199], v10 offset:13312
    s_add_u32 s44, s49, 1865728
    buffer_load_dwordx4 v[248:251], v10, s[24:27], s44 offen sc1
    v_mul_f32 v22, v22, v70
    v_mul_f32 v21, v21, v69
    v_mul_f32 v23, v23, v71
    v_exp_f32 v20, v20
    s_waitcnt vmcnt(29)
    s_waitcnt lgkmcnt(3)
    v_mfma_f32_32x32x16_bf16 v[96:111], v[252:255], v[208:211], v[96:111]
    ds_read_b128 v[200:203], v10 offset:14336
    v_exp_f32 v22, v22
    v_exp_f32 v21, v21
    v_exp_f32 v23, v23
    s_waitcnt lgkmcnt(3)
    v_mfma_f32_32x32x16_bf16 v[112:127], v[252:255], v[212:215], v[112:127]
    ds_read_b128 v[204:207], v10 offset:15360
    s_add_u32 s44, s49, 1866752
    buffer_load_dwordx4 v[252:255], v10, s[24:27], s44 offen sc1
    v_add_f32 v20, 1.0, v20
    v_add_f32 v22, 1.0, v22
    v_add_f32 v21, 1.0, v21
    v_add_f32 v23, 1.0, v23
    v_rcp_f32 v20, v20
    s_waitcnt vmcnt(29)
    s_waitcnt lgkmcnt(3)
    v_mfma_f32_32x32x16_bf16 v[96:111], v[168:171], v[192:195], v[96:111]
    ds_read_b128 v[208:211], v10 offset:16384
    v_rcp_f32 v22, v22
    v_rcp_f32 v21, v21
    v_rcp_f32 v23, v23
    s_waitcnt lgkmcnt(3)
    v_mfma_f32_32x32x16_bf16 v[112:127], v[168:171], v[196:199], v[112:127]
    ds_read_b128 v[212:215], v10 offset:17408
    s_add_u32 s44, s49, 2097152
    buffer_load_dwordx4 v[168:171], v10, s[24:27], s44 offen sc1
    v_mul_f32 v20, v20, v68
    v_mul_f32 v22, v22, v70
    v_mul_f32 v21, v21, v69
    v_mul_f32 v23, v23, v71
    v_cvt_pk_bf16_f32 v34, v20, v21
    s_waitcnt vmcnt(29)
    s_waitcnt lgkmcnt(3)
    v_mfma_f32_32x32x16_bf16 v[96:111], v[172:175], v[200:203], v[96:111]
    ds_read_b128 v[192:195], v10 offset:18432
    v_cvt_pk_bf16_f32 v35, v22, v23
    v_mul_f32 v20, v72, v72
    v_mul_f32 v22, v74, v74
    v_mul_f32 v21, v73, v73
    v_mul_f32 v23, v75, v75
    s_waitcnt lgkmcnt(3)
    v_mfma_f32_32x32x16_bf16 v[112:127], v[172:175], v[204:207], v[112:127]
    ds_read_b128 v[196:199], v10 offset:19456
    s_add_u32 s44, s49, 2098176
    buffer_load_dwordx4 v[172:175], v10, s[24:27], s44 offen sc1
    v_fmamk_f32 v20, v20, 0xbdd2d3e8, v18
    v_fmamk_f32 v22, v22, 0xbdd2d3e8, v18
    v_fmamk_f32 v21, v21, 0xbdd2d3e8, v18
    v_fmamk_f32 v23, v23, 0xbdd2d3e8, v18
    v_mul_f32 v20, v20, v72
    s_waitcnt vmcnt(29)
    s_waitcnt lgkmcnt(3)
    v_mfma_f32_32x32x16_bf16 v[96:111], v[176:179], v[208:211], v[96:111]
    ds_read_b128 v[200:203], v10 offset:20480
    v_mul_f32 v22, v22, v74
    v_mul_f32 v21, v21, v73
    v_mul_f32 v23, v23, v75
    v_exp_f32 v20, v20
    s_waitcnt lgkmcnt(3)
    v_mfma_f32_32x32x16_bf16 v[112:127], v[176:179], v[212:215], v[112:127]
    ds_read_b128 v[204:207], v10 offset:21504
    s_add_u32 s44, s49, 2099200
    buffer_load_dwordx4 v[176:179], v10, s[24:27], s44 offen sc1
    v_exp_f32 v22, v22
    v_exp_f32 v21, v21
    v_exp_f32 v23, v23
    s_waitcnt vmcnt(29)
    s_waitcnt lgkmcnt(3)
    v_mfma_f32_32x32x16_bf16 v[96:111], v[180:183], v[192:195], v[96:111]
    ds_read_b128 v[208:211], v10 offset:22528
    v_add_f32 v20, 1.0, v20
    v_add_f32 v22, 1.0, v22
    v_add_f32 v21, 1.0, v21
    v_add_f32 v23, 1.0, v23
    v_rcp_f32 v20, v20
    s_waitcnt lgkmcnt(3)
    v_mfma_f32_32x32x16_bf16 v[112:127], v[180:183], v[196:199], v[112:127]
    ds_read_b128 v[212:215], v10 offset:23552
    s_add_u32 s44, s49, 2100224
    buffer_load_dwordx4 v[180:183], v10, s[24:27], s44 offen sc1
    v_rcp_f32 v22, v22
    v_rcp_f32 v21, v21
    v_rcp_f32 v23, v23
    s_waitcnt vmcnt(29)
    s_waitcnt lgkmcnt(3)
    v_mfma_f32_32x32x16_bf16 v[96:111], v[184:187], v[200:203], v[96:111]
    ds_read_b128 v[192:195], v10 offset:24576
    v_mul_f32 v20, v20, v72
    v_mul_f32 v22, v22, v74
    v_mul_f32 v21, v21, v73
    v_mul_f32 v23, v23, v75
    v_cvt_pk_bf16_f32 v36, v20, v21
    s_waitcnt lgkmcnt(3)
    v_mfma_f32_32x32x16_bf16 v[112:127], v[184:187], v[204:207], v[112:127]
    ds_read_b128 v[196:199], v10 offset:25600
    s_add_u32 s44, s49, 2101248
    buffer_load_dwordx4 v[184:187], v10, s[24:27], s44 offen sc1
    v_cvt_pk_bf16_f32 v37, v22, v23
    v_mul_f32 v20, v76, v76
    v_mul_f32 v22, v78, v78
    v_mul_f32 v21, v77, v77
    v_mul_f32 v23, v79, v79
    s_waitcnt vmcnt(29)
    s_waitcnt lgkmcnt(3)
    v_mfma_f32_32x32x16_bf16 v[96:111], v[188:191], v[208:211], v[96:111]
    ds_read_b128 v[200:203], v10 offset:26624
    v_fmamk_f32 v20, v20, 0xbdd2d3e8, v18
    v_fmamk_f32 v22, v22, 0xbdd2d3e8, v18
    v_fmamk_f32 v21, v21, 0xbdd2d3e8, v18
    v_fmamk_f32 v23, v23, 0xbdd2d3e8, v18
    v_mul_f32 v20, v20, v76
    s_waitcnt lgkmcnt(3)
    v_mfma_f32_32x32x16_bf16 v[112:127], v[188:191], v[212:215], v[112:127]
    ds_read_b128 v[204:207], v10 offset:27648
    s_add_u32 s44, s49, 2102272
    buffer_load_dwordx4 v[188:191], v10, s[24:27], s44 offen sc1
    v_mul_f32 v22, v22, v78
    v_mul_f32 v21, v21, v77
    v_mul_f32 v23, v23, v79
    v_exp_f32 v20, v20
    s_waitcnt vmcnt(29)
    s_waitcnt lgkmcnt(3)
    v_mfma_f32_32x32x16_bf16 v[96:111], v[216:219], v[192:195], v[96:111]
    ds_read_b128 v[208:211], v10 offset:28672
    v_exp_f32 v22, v22
    v_exp_f32 v21, v21
    v_exp_f32 v23, v23
    s_waitcnt lgkmcnt(3)
    v_mfma_f32_32x32x16_bf16 v[112:127], v[216:219], v[196:199], v[112:127]
    ds_read_b128 v[212:215], v10 offset:29696
    s_add_u32 s44, s49, 2103296
    buffer_load_dwordx4 v[216:219], v10, s[24:27], s44 offen sc1
    v_add_f32 v20, 1.0, v20
    v_add_f32 v22, 1.0, v22
    v_add_f32 v21, 1.0, v21
    v_add_f32 v23, 1.0, v23
    v_rcp_f32 v20, v20
    s_waitcnt vmcnt(29)
    s_waitcnt lgkmcnt(3)
    v_mfma_f32_32x32x16_bf16 v[96:111], v[220:223], v[200:203], v[96:111]
    ds_read_b128 v[192:195], v10 offset:30720
    v_rcp_f32 v22, v22
    v_rcp_f32 v21, v21
    v_rcp_f32 v23, v23
    s_waitcnt lgkmcnt(3)
    v_mfma_f32_32x32x16_bf16 v[112:127], v[220:223], v[204:207], v[112:127]
    ds_read_b128 v[196:199], v10 offset:31744
    s_add_u32 s44, s49, 2104320
    buffer_load_dwordx4 v[220:223], v10, s[24:27], s44 offen sc1
    v_mul_f32 v20, v20, v76
    v_mul_f32 v22, v22, v78
    v_mul_f32 v21, v21, v77
    v_mul_f32 v23, v23, v79
    v_cvt_pk_bf16_f32 v38, v20, v21
    s_waitcnt vmcnt(29)
    s_waitcnt lgkmcnt(3)
    v_mfma_f32_32x32x16_bf16 v[96:111], v[160:163], v[208:211], v[96:111]
    ds_read_b128 v[200:203], v10 offset:32768
    v_cvt_pk_bf16_f32 v39, v22, v23
    v_mul_f32 v20, v80, v80
    v_mul_f32 v22, v82, v82
    v_mul_f32 v21, v81, v81
    v_mul_f32 v23, v83, v83
    s_waitcnt lgkmcnt(3)
    v_mfma_f32_32x32x16_bf16 v[112:127], v[160:163], v[212:215], v[112:127]
    ds_read_b128 v[204:207], v10 offset:33792
    s_add_u32 s44, s49, 2105344
    buffer_load_dwordx4 v[160:163], v10, s[24:27], s44 offen sc1
    v_fmamk_f32 v20, v20, 0xbdd2d3e8, v18
    v_fmamk_f32 v22, v22, 0xbdd2d3e8, v18
    v_fmamk_f32 v21, v21, 0xbdd2d3e8, v18
    v_fmamk_f32 v23, v23, 0xbdd2d3e8, v18
    v_mul_f32 v20, v20, v80
    s_waitcnt vmcnt(29)
    s_waitcnt lgkmcnt(3)
    v_mfma_f32_32x32x16_bf16 v[96:111], v[164:167], v[192:195], v[96:111]
    ds_read_b128 v[208:211], v10 offset:34816
    v_mul_f32 v22, v22, v82
    v_mul_f32 v21, v21, v81
    v_mul_f32 v23, v23, v83
    v_exp_f32 v20, v20
    s_waitcnt lgkmcnt(3)
    v_mfma_f32_32x32x16_bf16 v[112:127], v[164:167], v[196:199], v[112:127]
    ds_read_b128 v[212:215], v10 offset:35840
    s_add_u32 s44, s49, 2106368
    buffer_load_dwordx4 v[164:167], v10, s[24:27], s44 offen sc1
    v_exp_f32 v22, v22
    v_exp_f32 v21, v21
    v_exp_f32 v23, v23
    s_waitcnt vmcnt(29)
    s_waitcnt lgkmcnt(3)
    v_mfma_f32_32x32x16_bf16 v[96:111], v[224:227], v[200:203], v[96:111]
    ds_read_b128 v[192:195], v10 offset:36864
    v_add_f32 v20, 1.0, v20
    v_add_f32 v22, 1.0, v22
    v_add_f32 v21, 1.0, v21
    v_add_f32 v23, 1.0, v23
    v_rcp_f32 v20, v20
    s_waitcnt lgkmcnt(3)
    v_mfma_f32_32x32x16_bf16 v[112:127], v[224:227], v[204:207], v[112:127]
    ds_read_b128 v[196:199], v10 offset:37888
    s_add_u32 s44, s49, 2107392
    buffer_load_dwordx4 v[224:227], v10, s[24:27], s44 offen sc1
    v_rcp_f32 v22, v22
    v_rcp_f32 v21, v21
    v_rcp_f32 v23, v23
    s_waitcnt vmcnt(29)
    s_waitcnt lgkmcnt(3)
    v_mfma_f32_32x32x16_bf16 v[96:111], v[228:231], v[208:211], v[96:111]
    ds_read_b128 v[200:203], v10 offset:38912
    v_mul_f32 v20, v20, v80
    v_mul_f32 v22, v22, v82
    v_mul_f32 v21, v21, v81
    v_mul_f32 v23, v23, v83
    v_cvt_pk_bf16_f32 v40, v20, v21
    s_waitcnt lgkmcnt(3)
    v_mfma_f32_32x32x16_bf16 v[112:127], v[228:231], v[212:215], v[112:127]
    ds_read_b128 v[204:207], v10 offset:39936
    s_add_u32 s44, s49, 2108416
    buffer_load_dwordx4 v[228:231], v10, s[24:27], s44 offen sc1
    v_cvt_pk_bf16_f32 v41, v22, v23
    v_mul_f32 v20, v84, v84
    v_mul_f32 v22, v86, v86
    v_mul_f32 v21, v85, v85
    v_mul_f32 v23, v87, v87
    s_waitcnt vmcnt(29)
    s_waitcnt lgkmcnt(3)
    v_mfma_f32_32x32x16_bf16 v[96:111], v[232:235], v[192:195], v[96:111]
    ds_read_b128 v[208:211], v10 offset:40960
    v_fmamk_f32 v20, v20, 0xbdd2d3e8, v18
    v_fmamk_f32 v22, v22, 0xbdd2d3e8, v18
    v_fmamk_f32 v21, v21, 0xbdd2d3e8, v18
    v_fmamk_f32 v23, v23, 0xbdd2d3e8, v18
    v_mul_f32 v20, v20, v84
    s_waitcnt lgkmcnt(3)
    v_mfma_f32_32x32x16_bf16 v[112:127], v[232:235], v[196:199], v[112:127]
    ds_read_b128 v[212:215], v10 offset:41984
    s_add_u32 s44, s49, 2109440
    buffer_load_dwordx4 v[232:235], v10, s[24:27], s44 offen sc1
    v_mul_f32 v22, v22, v86
    v_mul_f32 v21, v21, v85
    v_mul_f32 v23, v23, v87
    v_exp_f32 v20, v20
    s_waitcnt vmcnt(29)
    s_waitcnt lgkmcnt(3)
    v_mfma_f32_32x32x16_bf16 v[96:111], v[236:239], v[200:203], v[96:111]
    ds_read_b128 v[192:195], v10 offset:43008
    v_exp_f32 v22, v22
    v_exp_f32 v21, v21
    v_exp_f32 v23, v23
    s_waitcnt lgkmcnt(3)
    v_mfma_f32_32x32x16_bf16 v[112:127], v[236:239], v[204:207], v[112:127]
    ds_read_b128 v[196:199], v10 offset:44032
    s_add_u32 s44, s49, 2110464
    buffer_load_dwordx4 v[236:239], v10, s[24:27], s44 offen sc1
    v_add_f32 v20, 1.0, v20
    v_add_f32 v22, 1.0, v22
    v_add_f32 v21, 1.0, v21
    v_add_f32 v23, 1.0, v23
    v_rcp_f32 v20, v20
    s_waitcnt vmcnt(29)
    s_waitcnt lgkmcnt(3)
    v_mfma_f32_32x32x16_bf16 v[96:111], v[128:131], v[208:211], v[96:111]
    ds_read_b128 v[200:203], v10 offset:45056
    v_rcp_f32 v22, v22
    v_rcp_f32 v21, v21
    v_rcp_f32 v23, v23
    s_waitcnt lgkmcnt(3)
    v_mfma_f32_32x32x16_bf16 v[112:127], v[128:131], v[212:215], v[112:127]
    ds_read_b128 v[204:207], v10 offset:46080
    s_add_u32 s44, s49, 2111488
    buffer_load_dwordx4 v[128:131], v10, s[24:27], s44 offen sc1
    v_mul_f32 v20, v20, v84
    v_mul_f32 v22, v22, v86
    v_mul_f32 v21, v21, v85
    v_mul_f32 v23, v23, v87
    v_cvt_pk_bf16_f32 v42, v20, v21
    s_waitcnt vmcnt(29)
    s_waitcnt lgkmcnt(3)
    v_mfma_f32_32x32x16_bf16 v[96:111], v[132:135], v[192:195], v[96:111]
    ds_read_b128 v[208:211], v10 offset:47104
    v_cvt_pk_bf16_f32 v43, v22, v23
    v_mul_f32 v20, v88, v88
    v_mul_f32 v22, v90, v90
    v_mul_f32 v21, v89, v89
    v_mul_f32 v23, v91, v91
    s_waitcnt lgkmcnt(3)
    v_mfma_f32_32x32x16_bf16 v[112:127], v[132:135], v[196:199], v[112:127]
    ds_read_b128 v[212:215], v10 offset:48128
    s_add_u32 s44, s49, 2112512
    buffer_load_dwordx4 v[132:135], v10, s[24:27], s44 offen sc1
    v_fmamk_f32 v20, v20, 0xbdd2d3e8, v18
    v_fmamk_f32 v22, v22, 0xbdd2d3e8, v18
    v_fmamk_f32 v21, v21, 0xbdd2d3e8, v18
    v_fmamk_f32 v23, v23, 0xbdd2d3e8, v18
    v_mul_f32 v20, v20, v88
    s_waitcnt vmcnt(27)
    s_waitcnt lgkmcnt(3)
    v_mfma_f32_32x32x16_bf16 v[96:111], v[136:139], v[200:203], v[96:111]
    ds_read_b128 v[192:195], v10 offset:49152
    v_mul_f32 v22, v22, v90
    v_mul_f32 v21, v21, v89
    v_mul_f32 v23, v23, v91
    v_exp_f32 v20, v20
    s_waitcnt lgkmcnt(3)
    v_mfma_f32_32x32x16_bf16 v[112:127], v[136:139], v[204:207], v[112:127]
    ds_read_b128 v[196:199], v10 offset:50176
    s_add_u32 s44, s49, 2113536
    buffer_load_dwordx4 v[136:139], v10, s[24:27], s44 offen sc1
    v_exp_f32 v22, v22
    v_exp_f32 v21, v21
    v_exp_f32 v23, v23
    s_waitcnt vmcnt(25)
    s_waitcnt lgkmcnt(3)
    v_mfma_f32_32x32x16_bf16 v[96:111], v[140:143], v[208:211], v[96:111]
    ds_read_b128 v[200:203], v10 offset:51200
    v_add_f32 v20, 1.0, v20
    v_add_f32 v22, 1.0, v22
    v_add_f32 v21, 1.0, v21
    v_add_f32 v23, 1.0, v23
    v_rcp_f32 v20, v20
    s_waitcnt lgkmcnt(3)
    v_mfma_f32_32x32x16_bf16 v[112:127], v[140:143], v[212:215], v[112:127]
    ds_read_b128 v[204:207], v10 offset:52224
    s_add_u32 s44, s49, 2114560
    buffer_load_dwordx4 v[140:143], v10, s[24:27], s44 offen sc1
    v_rcp_f32 v22, v22
    v_rcp_f32 v21, v21
    v_rcp_f32 v23, v23
    s_waitcnt vmcnt(25)
    s_waitcnt lgkmcnt(3)
    v_mfma_f32_32x32x16_bf16 v[96:111], v[144:147], v[192:195], v[96:111]
    ds_read_b128 v[208:211], v10 offset:53248
    v_mul_f32 v20, v20, v88
    v_mul_f32 v22, v22, v90
    v_mul_f32 v21, v21, v89
    v_mul_f32 v23, v23, v91
    v_cvt_pk_bf16_f32 v44, v20, v21
    s_waitcnt lgkmcnt(3)
    v_mfma_f32_32x32x16_bf16 v[112:127], v[144:147], v[196:199], v[112:127]
    ds_read_b128 v[212:215], v10 offset:54272
    s_add_u32 s44, s49, 2115584
    buffer_load_dwordx4 v[144:147], v10, s[24:27], s44 offen sc1
    v_cvt_pk_bf16_f32 v45, v22, v23
    v_mul_f32 v20, v92, v92
    v_mul_f32 v22, v94, v94
    v_mul_f32 v21, v93, v93
    v_mul_f32 v23, v95, v95
    s_waitcnt vmcnt(25)
    s_waitcnt lgkmcnt(3)
    v_mfma_f32_32x32x16_bf16 v[96:111], v[148:151], v[200:203], v[96:111]
    ds_read_b128 v[192:195], v10 offset:55296
    v_fmamk_f32 v20, v20, 0xbdd2d3e8, v18
    v_fmamk_f32 v22, v22, 0xbdd2d3e8, v18
    v_fmamk_f32 v21, v21, 0xbdd2d3e8, v18
    v_fmamk_f32 v23, v23, 0xbdd2d3e8, v18
    v_mul_f32 v20, v20, v92
    s_waitcnt lgkmcnt(3)
    v_mfma_f32_32x32x16_bf16 v[112:127], v[148:151], v[204:207], v[112:127]
    ds_read_b128 v[196:199], v10 offset:56320
    s_add_u32 s44, s49, 2116608
    buffer_load_dwordx4 v[148:151], v10, s[24:27], s44 offen sc1
    v_mul_f32 v22, v22, v94
    v_mul_f32 v21, v21, v93
    v_mul_f32 v23, v23, v95
    v_exp_f32 v20, v20
    s_waitcnt vmcnt(25)
    s_waitcnt lgkmcnt(3)
    v_mfma_f32_32x32x16_bf16 v[96:111], v[152:155], v[208:211], v[96:111]
    ds_read_b128 v[200:203], v10 offset:57344
    v_exp_f32 v22, v22
    v_exp_f32 v21, v21
    v_exp_f32 v23, v23
    s_waitcnt lgkmcnt(3)
    v_mfma_f32_32x32x16_bf16 v[112:127], v[152:155], v[212:215], v[112:127]
    ds_read_b128 v[204:207], v10 offset:58368
    s_add_u32 s44, s49, 2117632
    buffer_load_dwordx4 v[152:155], v10, s[24:27], s44 offen sc1
    v_add_f32 v20, 1.0, v20
    v_add_f32 v22, 1.0, v22
    v_add_f32 v21, 1.0, v21
    v_add_f32 v23, 1.0, v23
    v_rcp_f32 v20, v20
    s_waitcnt vmcnt(25)
    s_waitcnt lgkmcnt(3)
    v_mfma_f32_32x32x16_bf16 v[96:111], v[156:159], v[192:195], v[96:111]
    ds_read_b128 v[208:211], v10 offset:59392
    v_rcp_f32 v22, v22
    v_rcp_f32 v21, v21
    v_rcp_f32 v23, v23
    s_waitcnt lgkmcnt(3)
    v_mfma_f32_32x32x16_bf16 v[112:127], v[156:159], v[196:199], v[112:127]
    ds_read_b128 v[212:215], v10 offset:60416
    s_add_u32 s44, s49, 2118656
    buffer_load_dwordx4 v[156:159], v10, s[24:27], s44 offen sc1
    v_mul_f32 v20, v20, v92
    v_mul_f32 v22, v22, v94
    v_mul_f32 v21, v21, v93
    v_mul_f32 v23, v23, v95
    v_cvt_pk_bf16_f32 v46, v20, v21
    s_waitcnt vmcnt(25)
    s_waitcnt lgkmcnt(3)
    v_mfma_f32_32x32x16_bf16 v[96:111], v[240:243], v[200:203], v[96:111]
    ds_read_b128 v[192:195], v10 offset:61440
    v_cvt_pk_bf16_f32 v47, v22, v23
    s_add_u32 s45, s56, 32768
    buffer_store_dwordx4 v[32:35], v10, s[40:43], s45 offen offset:0 sc1
    buffer_store_dwordx4 v[36:39], v10, s[40:43], s45 offen offset:1024 sc1
    s_add_u32 s45, s57, 32768
    s_waitcnt lgkmcnt(3)
    v_mfma_f32_32x32x16_bf16 v[112:127], v[240:243], v[204:207], v[112:127]
    ds_read_b128 v[196:199], v10 offset:62464
    s_add_u32 s44, s49, 2119680
    buffer_load_dwordx4 v[240:243], v10, s[24:27], s44 offen sc1
    buffer_store_dwordx4 v[40:43], v10, s[40:43], s45 offen offset:0 sc1
    buffer_store_dwordx4 v[44:47], v10, s[40:43], s45 offen offset:1024 sc1
    s_waitcnt vmcnt(29)
    s_waitcnt lgkmcnt(3)
    v_mfma_f32_32x32x16_bf16 v[96:111], v[244:247], v[208:211], v[96:111]
    ds_read_b128 v[200:203], v10 offset:63488
    s_waitcnt lgkmcnt(3)
    v_mfma_f32_32x32x16_bf16 v[112:127], v[244:247], v[212:215], v[112:127]
    ds_read_b128 v[204:207], v10 offset:64512
    s_add_u32 s44, s49, 2120704
    buffer_load_dwordx4 v[244:247], v10, s[24:27], s44 offen sc1
    s_waitcnt vmcnt(29)
    s_waitcnt lgkmcnt(3)
    v_mfma_f32_32x32x16_bf16 v[96:111], v[248:251], v[192:195], v[96:111]
    ds_read_b128 v[208:211], v10 offset:0
    s_waitcnt lgkmcnt(3)
    v_mfma_f32_32x32x16_bf16 v[112:127], v[248:251], v[196:199], v[112:127]
    ds_read_b128 v[212:215], v10 offset:1024
    s_add_u32 s44, s49, 2121728
    buffer_load_dwordx4 v[248:251], v10, s[24:27], s44 offen sc1
    s_waitcnt vmcnt(29)
    s_waitcnt lgkmcnt(3)
    v_mfma_f32_32x32x16_bf16 v[96:111], v[252:255], v[200:203], v[96:111]
    ds_read_b128 v[192:195], v10 offset:2048
    s_waitcnt lgkmcnt(3)
    v_mfma_f32_32x32x16_bf16 v[112:127], v[252:255], v[204:207], v[112:127]
    ds_read_b128 v[196:199], v10 offset:3072
    s_add_u32 s44, s49, 2122752
    buffer_load_dwordx4 v[252:255], v10, s[24:27], s44 offen sc1
    s_waitcnt vmcnt(29)
    s_waitcnt lgkmcnt(3)
    v_mfma_f32_32x32x16_bf16 v[64:79], v[168:171], v[208:211], 0
    ds_read_b128 v[200:203], v10 offset:4096
    s_nop 1
    v_mul_f32 v20, v96, v96
    v_mul_f32 v22, v98, v98
    v_mul_f32 v21, v97, v97
    v_mul_f32 v23, v99, v99
    v_fmamk_f32 v20, v20, 0xbdd2d3e8, v18
    s_waitcnt lgkmcnt(3)
    v_mfma_f32_32x32x16_bf16 v[80:95], v[168:171], v[212:215], 0
    ds_read_b128 v[204:207], v10 offset:5120
    s_add_u32 s44, s49, 2123776
    buffer_load_dwordx4 v[168:171], v10, s[24:27], s44 offen sc1
    v_fmamk_f32 v22, v22, 0xbdd2d3e8, v18
    v_fmamk_f32 v21, v21, 0xbdd2d3e8, v18
    v_fmamk_f32 v23, v23, 0xbdd2d3e8, v18
    v_mul_f32 v20, v20, v96
    v_mul_f32 v22, v22, v98
    s_waitcnt vmcnt(29)
    s_waitcnt lgkmcnt(3)
    v_mfma_f32_32x32x16_bf16 v[64:79], v[172:175], v[192:195], v[64:79]
    ds_read_b128 v[208:211], v10 offset:6144
    v_mul_f32 v21, v21, v97
    v_mul_f32 v23, v23, v99
    v_exp_f32 v20, v20
    v_exp_f32 v22, v22
    s_waitcnt lgkmcnt(3)
    v_mfma_f32_32x32x16_bf16 v[80:95], v[172:175], v[196:199], v[80:95]
    ds_read_b128 v[212:215], v10 offset:7168
    s_add_u32 s44, s49, 2124800
    buffer_load_dwordx4 v[172:175], v10, s[24:27], s44 offen sc1
    v_exp_f32 v21, v21
    v_exp_f32 v23, v23
    v_add_f32 v20, 1.0, v20
    s_waitcnt vmcnt(29)
    s_waitcnt lgkmcnt(3)
    v_mfma_f32_32x32x16_bf16 v[64:79], v[176:179], v[200:203], v[64:79]
    ds_read_b128 v[192:195], v10 offset:8192
    v_add_f32 v22, 1.0, v22
    v_add_f32 v21, 1.0, v21
    v_add_f32 v23, 1.0, v23
    v_rcp_f32 v20, v20
    s_waitcnt lgkmcnt(3)
    v_mfma_f32_32x32x16_bf16 v[80:95], v[176:179], v[204:207], v[80:95]
    ds_read_b128 v[196:199], v10 offset:9216
    s_add_u32 s44, s49, 2125824
    buffer_load_dwordx4 v[176:179], v10, s[24:27], s44 offen sc1
    v_rcp_f32 v22, v22
    v_rcp_f32 v21, v21
    v_rcp_f32 v23, v23
    s_waitcnt vmcnt(29)
    s_waitcnt lgkmcnt(3)
    v_mfma_f32_32x32x16_bf16 v[64:79], v[180:183], v[208:211], v[64:79]
    ds_read_b128 v[200:203], v10 offset:10240
    v_mul_f32 v20, v20, v96
    v_mul_f32 v22, v22, v98
    v_mul_f32 v21, v21, v97
    v_mul_f32 v23, v23, v99
    v_cvt_pk_bf16_f32 v48, v20, v21
    s_waitcnt lgkmcnt(3)
    v_mfma_f32_32x32x16_bf16 v[80:95], v[180:183], v[212:215], v[80:95]
    ds_read_b128 v[204:207], v10 offset:11264
    s_add_u32 s44, s49, 2126848
    buffer_load_dwordx4 v[180:183], v10, s[24:27], s44 offen sc1
    v_cvt_pk_bf16_f32 v49, v22, v23
    v_mul_f32 v20, v100, v100
    v_mul_f32 v22, v102, v102
    v_mul_f32 v21, v101, v101
    v_mul_f32 v23, v103, v103
    s_waitcnt vmcnt(29)
    s_waitcnt lgkmcnt(3)
    v_mfma_f32_32x32x16_bf16 v[64:79], v[184:187], v[192:195], v[64:79]
    ds_read_b128 v[208:211], v10 offset:12288
    v_fmamk_f32 v20, v20, 0xbdd2d3e8, v18
    v_fmamk_f32 v22, v22, 0xbdd2d3e8, v18
    v_fmamk_f32 v21, v21, 0xbdd2d3e8, v18
    v_fmamk_f32 v23, v23, 0xbdd2d3e8, v18
    v_mul_f32 v20, v20, v100
    s_waitcnt lgkmcnt(3)
    v_mfma_f32_32x32x16_bf16 v[80:95], v[184:187], v[196:199], v[80:95]
    ds_read_b128 v[212:215], v10 offset:13312
    s_add_u32 s44, s49, 2127872
    buffer_load_dwordx4 v[184:187], v10, s[24:27], s44 offen sc1
    v_mul_f32 v22, v22, v102
    v_mul_f32 v21, v21, v101
    v_mul_f32 v23, v23, v103
    v_exp_f32 v20, v20
    s_waitcnt vmcnt(29)
    s_waitcnt lgkmcnt(3)
    v_mfma_f32_32x32x16_bf16 v[64:79], v[188:191], v[200:203], v[64:79]
    ds_read_b128 v[192:195], v10 offset:14336
    v_exp_f32 v22, v22
    v_exp_f32 v21, v21
    v_exp_f32 v23, v23
    s_waitcnt lgkmcnt(3)
    v_mfma_f32_32x32x16_bf16 v[80:95], v[188:191], v[204:207], v[80:95]
    ds_read_b128 v[196:199], v10 offset:15360
    s_add_u32 s44, s49, 2128896
    buffer_load_dwordx4 v[188:191], v10, s[24:27], s44 offen sc1
    v_add_f32 v20, 1.0, v20
    v_add_f32 v22, 1.0, v22
    v_add_f32 v21, 1.0, v21
    v_add_f32 v23, 1.0, v23
    v_rcp_f32 v20, v20
    s_waitcnt vmcnt(29)
    s_waitcnt lgkmcnt(3)
    v_mfma_f32_32x32x16_bf16 v[64:79], v[216:219], v[208:211], v[64:79]
    ds_read_b128 v[200:203], v10 offset:16384
    v_rcp_f32 v22, v22
    v_rcp_f32 v21, v21
    v_rcp_f32 v23, v23
    s_waitcnt lgkmcnt(3)
    v_mfma_f32_32x32x16_bf16 v[80:95], v[216:219], v[212:215], v[80:95]
    ds_read_b128 v[204:207], v10 offset:17408
    s_add_u32 s44, s49, 2359296
    buffer_load_dwordx4 v[216:219], v10, s[24:27], s44 offen sc1
    v_mul_f32 v20, v20, v100
    v_mul_f32 v22, v22, v102
    v_mul_f32 v21, v21, v101
    v_mul_f32 v23, v23, v103
    v_cvt_pk_bf16_f32 v50, v20, v21
    s_waitcnt vmcnt(29)
    s_waitcnt lgkmcnt(3)
    v_mfma_f32_32x32x16_bf16 v[64:79], v[220:223], v[192:195], v[64:79]
    ds_read_b128 v[208:211], v10 offset:18432
    v_cvt_pk_bf16_f32 v51, v22, v23
    v_mul_f32 v20, v104, v104
    v_mul_f32 v22, v106, v106
    v_mul_f32 v21, v105, v105
    v_mul_f32 v23, v107, v107
    s_waitcnt lgkmcnt(3)
    v_mfma_f32_32x32x16_bf16 v[80:95], v[220:223], v[196:199], v[80:95]
    ds_read_b128 v[212:215], v10 offset:19456
    s_add_u32 s44, s49, 2360320
    buffer_load_dwordx4 v[220:223], v10, s[24:27], s44 offen sc1
    v_fmamk_f32 v20, v20, 0xbdd2d3e8, v18
    v_fmamk_f32 v22, v22, 0xbdd2d3e8, v18
    v_fmamk_f32 v21, v21, 0xbdd2d3e8, v18
    v_fmamk_f32 v23, v23, 0xbdd2d3e8, v18
    v_mul_f32 v20, v20, v104
    s_waitcnt vmcnt(29)
    s_waitcnt lgkmcnt(3)
    v_mfma_f32_32x32x16_bf16 v[64:79], v[160:163], v[200:203], v[64:79]
    ds_read_b128 v[192:195], v10 offset:20480
    v_mul_f32 v22, v22, v106
    v_mul_f32 v21, v21, v105
    v_mul_f32 v23, v23, v107
    v_exp_f32 v20, v20
    s_waitcnt lgkmcnt(3)
    v_mfma_f32_32x32x16_bf16 v[80:95], v[160:163], v[204:207], v[80:95]
    ds_read_b128 v[196:199], v10 offset:21504
    s_add_u32 s44, s49, 2361344
    buffer_load_dwordx4 v[160:163], v10, s[24:27], s44 offen sc1
    v_exp_f32 v22, v22
    v_exp_f32 v21, v21
    v_exp_f32 v23, v23
    s_waitcnt vmcnt(29)
    s_waitcnt lgkmcnt(3)
    v_mfma_f32_32x32x16_bf16 v[64:79], v[164:167], v[208:211], v[64:79]
    ds_read_b128 v[200:203], v10 offset:22528
    v_add_f32 v20, 1.0, v20
    v_add_f32 v22, 1.0, v22
    v_add_f32 v21, 1.0, v21
    v_add_f32 v23, 1.0, v23
    v_rcp_f32 v20, v20
    s_waitcnt lgkmcnt(3)
    v_mfma_f32_32x32x16_bf16 v[80:95], v[164:167], v[212:215], v[80:95]
    ds_read_b128 v[204:207], v10 offset:23552
    s_add_u32 s44, s49, 2362368
    buffer_load_dwordx4 v[164:167], v10, s[24:27], s44 offen sc1
    v_rcp_f32 v22, v22
    v_rcp_f32 v21, v21
    v_rcp_f32 v23, v23
    s_waitcnt vmcnt(29)
    s_waitcnt lgkmcnt(3)
    v_mfma_f32_32x32x16_bf16 v[64:79], v[224:227], v[192:195], v[64:79]
    ds_read_b128 v[208:211], v10 offset:24576
    v_mul_f32 v20, v20, v104
    v_mul_f32 v22, v22, v106
    v_mul_f32 v21, v21, v105
    v_mul_f32 v23, v23, v107
    v_cvt_pk_bf16_f32 v52, v20, v21
    s_waitcnt lgkmcnt(3)
    v_mfma_f32_32x32x16_bf16 v[80:95], v[224:227], v[196:199], v[80:95]
    ds_read_b128 v[212:215], v10 offset:25600
    s_add_u32 s44, s49, 2363392
    buffer_load_dwordx4 v[224:227], v10, s[24:27], s44 offen sc1
    v_cvt_pk_bf16_f32 v53, v22, v23
    v_mul_f32 v20, v108, v108
    v_mul_f32 v22, v110, v110
    v_mul_f32 v21, v109, v109
    v_mul_f32 v23, v111, v111
    s_waitcnt vmcnt(29)
    s_waitcnt lgkmcnt(3)
    v_mfma_f32_32x32x16_bf16 v[64:79], v[228:231], v[200:203], v[64:79]
    ds_read_b128 v[192:195], v10 offset:26624
    v_fmamk_f32 v20, v20, 0xbdd2d3e8, v18
    v_fmamk_f32 v22, v22, 0xbdd2d3e8, v18
    v_fmamk_f32 v21, v21, 0xbdd2d3e8, v18
    v_fmamk_f32 v23, v23, 0xbdd2d3e8, v18
    v_mul_f32 v20, v20, v108
    s_waitcnt lgkmcnt(3)
    v_mfma_f32_32x32x16_bf16 v[80:95], v[228:231], v[204:207], v[80:95]
    ds_read_b128 v[196:199], v10 offset:27648
    s_add_u32 s44, s49, 2364416
    buffer_load_dwordx4 v[228:231], v10, s[24:27], s44 offen sc1
    v_mul_f32 v22, v22, v110
    v_mul_f32 v21, v21, v109
    v_mul_f32 v23, v23, v111
    v_exp_f32 v20, v20
    s_waitcnt vmcnt(29)
    s_waitcnt lgkmcnt(3)
    v_mfma_f32_32x32x16_bf16 v[64:79], v[232:235], v[208:211], v[64:79]
    ds_read_b128 v[200:203], v10 offset:28672
    v_exp_f32 v22, v22
    v_exp_f32 v21, v21
    v_exp_f32 v23, v23
    s_waitcnt lgkmcnt(3)
    v_mfma_f32_32x32x16_bf16 v[80:95], v[232:235], v[212:215], v[80:95]
    ds_read_b128 v[204:207], v10 offset:29696
    s_add_u32 s44, s49, 2365440
    buffer_load_dwordx4 v[232:235], v10, s[24:27], s44 offen sc1
    v_add_f32 v20, 1.0, v20
    v_add_f32 v22, 1.0, v22
    v_add_f32 v21, 1.0, v21
    v_add_f32 v23, 1.0, v23
    v_rcp_f32 v20, v20
    s_waitcnt vmcnt(29)
    s_waitcnt lgkmcnt(3)
    v_mfma_f32_32x32x16_bf16 v[64:79], v[236:239], v[192:195], v[64:79]
    ds_read_b128 v[208:211], v10 offset:30720
    v_rcp_f32 v22, v22
    v_rcp_f32 v21, v21
    v_rcp_f32 v23, v23
    s_waitcnt lgkmcnt(3)
    v_mfma_f32_32x32x16_bf16 v[80:95], v[236:239], v[196:199], v[80:95]
    ds_read_b128 v[212:215], v10 offset:31744
    s_add_u32 s44, s49, 2366464
    buffer_load_dwordx4 v[236:239], v10, s[24:27], s44 offen sc1
    v_mul_f32 v20, v20, v108
    v_mul_f32 v22, v22, v110
    v_mul_f32 v21, v21, v109
    v_mul_f32 v23, v23, v111
    v_cvt_pk_bf16_f32 v54, v20, v21
    s_waitcnt vmcnt(29)
    s_waitcnt lgkmcnt(3)
    v_mfma_f32_32x32x16_bf16 v[64:79], v[128:131], v[200:203], v[64:79]
    ds_read_b128 v[192:195], v10 offset:32768
    v_cvt_pk_bf16_f32 v55, v22, v23
    v_mul_f32 v20, v112, v112
    v_mul_f32 v22, v114, v114
    v_mul_f32 v21, v113, v113
    v_mul_f32 v23, v115, v115
    s_waitcnt lgkmcnt(3)
    v_mfma_f32_32x32x16_bf16 v[80:95], v[128:131], v[204:207], v[80:95]
    ds_read_b128 v[196:199], v10 offset:33792
    s_add_u32 s44, s49, 2367488
    buffer_load_dwordx4 v[128:131], v10, s[24:27], s44 offen sc1
    v_fmamk_f32 v20, v20, 0xbdd2d3e8, v18
    v_fmamk_f32 v22, v22, 0xbdd2d3e8, v18
    v_fmamk_f32 v21, v21, 0xbdd2d3e8, v18
    v_fmamk_f32 v23, v23, 0xbdd2d3e8, v18
    v_mul_f32 v20, v20, v112
    s_waitcnt vmcnt(29)
    s_waitcnt lgkmcnt(3)
    v_mfma_f32_32x32x16_bf16 v[64:79], v[132:135], v[208:211], v[64:79]
    ds_read_b128 v[200:203], v10 offset:34816
    v_mul_f32 v22, v22, v114
    v_mul_f32 v21, v21, v113
    v_mul_f32 v23, v23, v115
    v_exp_f32 v20, v20
    s_waitcnt lgkmcnt(3)
    v_mfma_f32_32x32x16_bf16 v[80:95], v[132:135], v[212:215], v[80:95]
    ds_read_b128 v[204:207], v10 offset:35840
    s_add_u32 s44, s49, 2368512
    buffer_load_dwordx4 v[132:135], v10, s[24:27], s44 offen sc1
    v_exp_f32 v22, v22
    v_exp_f32 v21, v21
    v_exp_f32 v23, v23
    s_waitcnt vmcnt(29)
    s_waitcnt lgkmcnt(3)
    v_mfma_f32_32x32x16_bf16 v[64:79], v[136:139], v[192:195], v[64:79]
    ds_read_b128 v[208:211], v10 offset:36864
    v_add_f32 v20, 1.0, v20
    v_add_f32 v22, 1.0, v22
    v_add_f32 v21, 1.0, v21
    v_add_f32 v23, 1.0, v23
    v_rcp_f32 v20, v20
    s_waitcnt lgkmcnt(3)
    v_mfma_f32_32x32x16_bf16 v[80:95], v[136:139], v[196:199], v[80:95]
    ds_read_b128 v[212:215], v10 offset:37888
    s_add_u32 s44, s49, 2369536
    buffer_load_dwordx4 v[136:139], v10, s[24:27], s44 offen sc1
    v_rcp_f32 v22, v22
    v_rcp_f32 v21, v21
    v_rcp_f32 v23, v23
    s_waitcnt vmcnt(29)
    s_waitcnt lgkmcnt(3)
    v_mfma_f32_32x32x16_bf16 v[64:79], v[140:143], v[200:203], v[64:79]
    ds_read_b128 v[192:195], v10 offset:38912
    v_mul_f32 v20, v20, v112
    v_mul_f32 v22, v22, v114
    v_mul_f32 v21, v21, v113
    v_mul_f32 v23, v23, v115
    v_cvt_pk_bf16_f32 v56, v20, v21
    s_waitcnt lgkmcnt(3)
    v_mfma_f32_32x32x16_bf16 v[80:95], v[140:143], v[204:207], v[80:95]
    ds_read_b128 v[196:199], v10 offset:39936
    s_add_u32 s44, s49, 2370560
    buffer_load_dwordx4 v[140:143], v10, s[24:27], s44 offen sc1
    v_cvt_pk_bf16_f32 v57, v22, v23
    v_mul_f32 v20, v116, v116
    v_mul_f32 v22, v118, v118
    v_mul_f32 v21, v117, v117
    v_mul_f32 v23, v119, v119
    s_waitcnt vmcnt(29)
    s_waitcnt lgkmcnt(3)
    v_mfma_f32_32x32x16_bf16 v[64:79], v[144:147], v[208:211], v[64:79]
    ds_read_b128 v[200:203], v10 offset:40960
    v_fmamk_f32 v20, v20, 0xbdd2d3e8, v18
    v_fmamk_f32 v22, v22, 0xbdd2d3e8, v18
    v_fmamk_f32 v21, v21, 0xbdd2d3e8, v18
    v_fmamk_f32 v23, v23, 0xbdd2d3e8, v18
    v_mul_f32 v20, v20, v116
    s_waitcnt lgkmcnt(3)
    v_mfma_f32_32x32x16_bf16 v[80:95], v[144:147], v[212:215], v[80:95]
    ds_read_b128 v[204:207], v10 offset:41984
    s_add_u32 s44, s49, 2371584
    buffer_load_dwordx4 v[144:147], v10, s[24:27], s44 offen sc1
    v_mul_f32 v22, v22, v118
    v_mul_f32 v21, v21, v117
    v_mul_f32 v23, v23, v119
    v_exp_f32 v20, v20
    s_waitcnt vmcnt(29)
    s_waitcnt lgkmcnt(3)
    v_mfma_f32_32x32x16_bf16 v[64:79], v[148:151], v[192:195], v[64:79]
    ds_read_b128 v[208:211], v10 offset:43008
    v_exp_f32 v22, v22
    v_exp_f32 v21, v21
    v_exp_f32 v23, v23
    s_waitcnt lgkmcnt(3)
    v_mfma_f32_32x32x16_bf16 v[80:95], v[148:151], v[196:199], v[80:95]
    ds_read_b128 v[212:215], v10 offset:44032
    s_add_u32 s44, s49, 2372608
    buffer_load_dwordx4 v[148:151], v10, s[24:27], s44 offen sc1
    v_add_f32 v20, 1.0, v20
    v_add_f32 v22, 1.0, v22
    v_add_f32 v21, 1.0, v21
    v_add_f32 v23, 1.0, v23
    v_rcp_f32 v20, v20
    s_waitcnt vmcnt(29)
    s_waitcnt lgkmcnt(3)
    v_mfma_f32_32x32x16_bf16 v[64:79], v[152:155], v[200:203], v[64:79]
    ds_read_b128 v[192:195], v10 offset:45056
    v_rcp_f32 v22, v22
    v_rcp_f32 v21, v21
    v_rcp_f32 v23, v23
    s_waitcnt lgkmcnt(3)
    v_mfma_f32_32x32x16_bf16 v[80:95], v[152:155], v[204:207], v[80:95]
    ds_read_b128 v[196:199], v10 offset:46080
    s_add_u32 s44, s49, 2373632
    buffer_load_dwordx4 v[152:155], v10, s[24:27], s44 offen sc1
    v_mul_f32 v20, v20, v116
    v_mul_f32 v22, v22, v118
    v_mul_f32 v21, v21, v117
    v_mul_f32 v23, v23, v119
    v_cvt_pk_bf16_f32 v58, v20, v21
    s_waitcnt vmcnt(29)
    s_waitcnt lgkmcnt(3)
    v_mfma_f32_32x32x16_bf16 v[64:79], v[156:159], v[208:211], v[64:79]
    ds_read_b128 v[200:203], v10 offset:47104
    v_cvt_pk_bf16_f32 v59, v22, v23
    v_mul_f32 v20, v120, v120
    v_mul_f32 v22, v122, v122
    v_mul_f32 v21, v121, v121
    v_mul_f32 v23, v123, v123
    s_waitcnt lgkmcnt(3)
    v_mfma_f32_32x32x16_bf16 v[80:95], v[156:159], v[212:215], v[80:95]
    ds_read_b128 v[204:207], v10 offset:48128
    s_add_u32 s44, s49, 2374656
    buffer_load_dwordx4 v[156:159], v10, s[24:27], s44 offen sc1
    v_fmamk_f32 v20, v20, 0xbdd2d3e8, v18
    v_fmamk_f32 v22, v22, 0xbdd2d3e8, v18
    v_fmamk_f32 v21, v21, 0xbdd2d3e8, v18
    v_fmamk_f32 v23, v23, 0xbdd2d3e8, v18
    v_mul_f32 v20, v20, v120
    s_waitcnt vmcnt(27)
    s_waitcnt lgkmcnt(3)
    v_mfma_f32_32x32x16_bf16 v[64:79], v[240:243], v[192:195], v[64:79]
    ds_read_b128 v[208:211], v10 offset:49152
    v_mul_f32 v22, v22, v122
    v_mul_f32 v21, v21, v121
    v_mul_f32 v23, v23, v123
    v_exp_f32 v20, v20
    s_waitcnt lgkmcnt(3)
    v_mfma_f32_32x32x16_bf16 v[80:95], v[240:243], v[196:199], v[80:95]
    ds_read_b128 v[212:215], v10 offset:50176
    s_add_u32 s44, s49, 2375680
    buffer_load_dwordx4 v[240:243], v10, s[24:27], s44 offen sc1
    v_exp_f32 v22, v22
    v_exp_f32 v21, v21
    v_exp_f32 v23, v23
    s_waitcnt vmcnt(25)
    s_waitcnt lgkmcnt(3)
    v_mfma_f32_32x32x16_bf16 v[64:79], v[244:247], v[200:203], v[64:79]
    ds_read_b128 v[192:195], v10 offset:51200
    v_add_f32 v20, 1.0, v20
    v_add_f32 v22, 1.0, v22
    v_add_f32 v21, 1.0, v21
    v_add_f32 v23, 1.0, v23
    v_rcp_f32 v20, v20
    s_waitcnt lgkmcnt(3)
    v_mfma_f32_32x32x16_bf16 v[80:95], v[244:247], v[204:207], v[80:95]
    ds_read_b128 v[196:199], v10 offset:52224
    s_add_u32 s44, s49, 2376704
    buffer_load_dwordx4 v[244:247], v10, s[24:27], s44 offen sc1
    v_rcp_f32 v22, v22
    v_rcp_f32 v21, v21
    v_rcp_f32 v23, v23
    s_waitcnt vmcnt(25)
    s_waitcnt lgkmcnt(3)
    v_mfma_f32_32x32x16_bf16 v[64:79], v[248:251], v[208:211], v[64:79]
    ds_read_b128 v[200:203], v10 offset:53248
    v_mul_f32 v20, v20, v120
    v_mul_f32 v22, v22, v122
    v_mul_f32 v21, v21, v121
    v_mul_f32 v23, v23, v123
    v_cvt_pk_bf16_f32 v60, v20, v21
    s_waitcnt lgkmcnt(3)
    v_mfma_f32_32x32x16_bf16 v[80:95], v[248:251], v[212:215], v[80:95]
    ds_read_b128 v[204:207], v10 offset:54272
    s_add_u32 s44, s49, 2377728
    buffer_load_dwordx4 v[248:251], v10, s[24:27], s44 offen sc1
    v_cvt_pk_bf16_f32 v61, v22, v23
    v_mul_f32 v20, v124, v124
    v_mul_f32 v22, v126, v126
    v_mul_f32 v21, v125, v125
    v_mul_f32 v23, v127, v127
    s_waitcnt vmcnt(25)
    s_waitcnt lgkmcnt(3)
    v_mfma_f32_32x32x16_bf16 v[64:79], v[252:255], v[192:195], v[64:79]
    ds_read_b128 v[208:211], v10 offset:55296
    v_fmamk_f32 v20, v20, 0xbdd2d3e8, v18
    v_fmamk_f32 v22, v22, 0xbdd2d3e8, v18
    v_fmamk_f32 v21, v21, 0xbdd2d3e8, v18
    v_fmamk_f32 v23, v23, 0xbdd2d3e8, v18
    v_mul_f32 v20, v20, v124
    s_waitcnt lgkmcnt(3)
    v_mfma_f32_32x32x16_bf16 v[80:95], v[252:255], v[196:199], v[80:95]
    ds_read_b128 v[212:215], v10 offset:56320
    s_add_u32 s44, s49, 2378752
    buffer_load_dwordx4 v[252:255], v10, s[24:27], s44 offen sc1
    v_mul_f32 v22, v22, v126
    v_mul_f32 v21, v21, v125
    v_mul_f32 v23, v23, v127
    v_exp_f32 v20, v20
    s_waitcnt vmcnt(25)
    s_waitcnt lgkmcnt(3)
    v_mfma_f32_32x32x16_bf16 v[64:79], v[168:171], v[200:203], v[64:79]
    ds_read_b128 v[192:195], v10 offset:57344
    v_exp_f32 v22, v22
    v_exp_f32 v21, v21
    v_exp_f32 v23, v23
    s_waitcnt lgkmcnt(3)
    v_mfma_f32_32x32x16_bf16 v[80:95], v[168:171], v[204:207], v[80:95]
    ds_read_b128 v[196:199], v10 offset:58368
    s_add_u32 s44, s49, 2379776
    buffer_load_dwordx4 v[168:171], v10, s[24:27], s44 offen sc1
    v_add_f32 v20, 1.0, v20
    v_add_f32 v22, 1.0, v22
    v_add_f32 v21, 1.0, v21
    v_add_f32 v23, 1.0, v23
    v_rcp_f32 v20, v20
    s_waitcnt vmcnt(25)
    s_waitcnt lgkmcnt(3)
    v_mfma_f32_32x32x16_bf16 v[64:79], v[172:175], v[208:211], v[64:79]
    ds_read_b128 v[200:203], v10 offset:59392
    v_rcp_f32 v22, v22
    v_rcp_f32 v21, v21
    v_rcp_f32 v23, v23
    s_waitcnt lgkmcnt(3)
    v_mfma_f32_32x32x16_bf16 v[80:95], v[172:175], v[212:215], v[80:95]
    ds_read_b128 v[204:207], v10 offset:60416
    s_add_u32 s44, s49, 2380800
    buffer_load_dwordx4 v[172:175], v10, s[24:27], s44 offen sc1
    v_mul_f32 v20, v20, v124
    v_mul_f32 v22, v22, v126
    v_mul_f32 v21, v21, v125
    v_mul_f32 v23, v23, v127
    v_cvt_pk_bf16_f32 v62, v20, v21
    s_waitcnt vmcnt(25)
    s_waitcnt lgkmcnt(3)
    v_mfma_f32_32x32x16_bf16 v[64:79], v[176:179], v[192:195], v[64:79]
    ds_read_b128 v[208:211], v10 offset:61440
    v_cvt_pk_bf16_f32 v63, v22, v23
    s_add_u32 s45, s56, 49152
    buffer_store_dwordx4 v[48:51], v10, s[40:43], s45 offen offset:0 sc1
    buffer_store_dwordx4 v[52:55], v10, s[40:43], s45 offen offset:1024 sc1
    s_add_u32 s45, s57, 49152
    s_waitcnt lgkmcnt(3)
    v_mfma_f32_32x32x16_bf16 v[80:95], v[176:179], v[196:199], v[80:95]
    ds_read_b128 v[212:215], v10 offset:62464
    s_add_u32 s44, s49, 2381824
    buffer_load_dwordx4 v[176:179], v10, s[24:27], s44 offen sc1
    buffer_store_dwordx4 v[56:59], v10, s[40:43], s45 offen offset:0 sc1
    buffer_store_dwordx4 v[60:63], v10, s[40:43], s45 offen offset:1024 sc1
    s_waitcnt vmcnt(29)
    s_waitcnt lgkmcnt(3)
    v_mfma_f32_32x32x16_bf16 v[64:79], v[180:183], v[200:203], v[64:79]
    ds_read_b128 v[192:195], v10 offset:63488
    s_waitcnt lgkmcnt(3)
    v_mfma_f32_32x32x16_bf16 v[80:95], v[180:183], v[204:207], v[80:95]
    ds_read_b128 v[196:199], v10 offset:64512
    s_add_u32 s44, s49, 2382848
    buffer_load_dwordx4 v[180:183], v10, s[24:27], s44 offen sc1
    s_waitcnt vmcnt(29)
    s_waitcnt lgkmcnt(3)
    v_mfma_f32_32x32x16_bf16 v[64:79], v[184:187], v[208:211], v[64:79]
    ds_read_b128 v[200:203], v10 offset:0
    s_waitcnt lgkmcnt(3)
    v_mfma_f32_32x32x16_bf16 v[80:95], v[184:187], v[212:215], v[80:95]
    ds_read_b128 v[204:207], v10 offset:1024
    s_add_u32 s44, s49, 2383872
    buffer_load_dwordx4 v[184:187], v10, s[24:27], s44 offen sc1
    s_waitcnt vmcnt(29)
    s_waitcnt lgkmcnt(3)
    v_mfma_f32_32x32x16_bf16 v[64:79], v[188:191], v[192:195], v[64:79]
    ds_read_b128 v[208:211], v10 offset:2048
    s_waitcnt lgkmcnt(3)
    v_mfma_f32_32x32x16_bf16 v[80:95], v[188:191], v[196:199], v[80:95]
    ds_read_b128 v[212:215], v10 offset:3072
    s_add_u32 s44, s49, 2384896
    buffer_load_dwordx4 v[188:191], v10, s[24:27], s44 offen sc1
    s_cmp_ge_u32 s3, 3
    s_cbranch_scc1 B_SHORT
    s_waitcnt vmcnt(29)
    s_waitcnt lgkmcnt(3)
    v_mfma_f32_32x32x16_bf16 v[96:111], v[216:219], v[200:203], 0
    ds_read_b128 v[192:195], v10 offset:4096
    v_mul_f32 v20, v64, v64
    v_mul_f32 v22, v66, v66
    v_mul_f32 v21, v65, v65
    v_mul_f32 v23, v67, v67
    v_fmamk_f32 v20, v20, 0xbdd2d3e8, v18
    s_waitcnt lgkmcnt(3)
    v_mfma_f32_32x32x16_bf16 v[112:127], v[216:219], v[204:207], 0
    ds_read_b128 v[196:199], v10 offset:5120
    s_add_u32 s44, s49, 2385920
    buffer_load_dwordx4 v[216:219], v10, s[24:27], s44 offen sc1
    v_fmamk_f32 v22, v22, 0xbdd2d3e8, v18
    v_fmamk_f32 v21, v21, 0xbdd2d3e8, v18
    v_fmamk_f32 v23, v23, 0xbdd2d3e8, v18
    v_mul_f32 v20, v20, v64
    v_mul_f32 v22, v22, v66
    s_waitcnt vmcnt(29)
    s_waitcnt lgkmcnt(3)
    v_mfma_f32_32x32x16_bf16 v[96:111], v[220:223], v[208:211], v[96:111]
    ds_read_b128 v[200:203], v10 offset:6144
    v_mul_f32 v21, v21, v65
    v_mul_f32 v23, v23, v67
    v_exp_f32 v20, v20
    v_exp_f32 v22, v22
    s_waitcnt lgkmcnt(3)
    v_mfma_f32_32x32x16_bf16 v[112:127], v[220:223], v[212:215], v[112:127]
    ds_read_b128 v[204:207], v10 offset:7168
    s_add_u32 s44, s49, 2386944
    buffer_load_dwordx4 v[220:223], v10, s[24:27], s44 offen sc1
    v_exp_f32 v21, v21
    v_exp_f32 v23, v23
    v_add_f32 v20, 1.0, v20
    s_waitcnt vmcnt(29)
    s_waitcnt lgkmcnt(3)
    v_mfma_f32_32x32x16_bf16 v[96:111], v[160:163], v[192:195], v[96:111]
    ds_read_b128 v[208:211], v10 offset:8192
    v_add_f32 v22, 1.0, v22
    v_add_f32 v21, 1.0, v21
    v_add_f32 v23, 1.0, v23
    v_rcp_f32 v20, v20
    s_waitcnt lgkmcnt(3)
    v_mfma_f32_32x32x16_bf16 v[112:127], v[160:163], v[196:199], v[112:127]
    ds_read_b128 v[212:215], v10 offset:9216
    s_add_u32 s44, s49, 2387968
    buffer_load_dwordx4 v[160:163], v10, s[24:27], s44 offen sc1
    v_rcp_f32 v22, v22
    v_rcp_f32 v21, v21
    v_rcp_f32 v23, v23
    s_waitcnt vmcnt(29)
    s_waitcnt lgkmcnt(3)
    v_mfma_f32_32x32x16_bf16 v[96:111], v[164:167], v[200:203], v[96:111]
    ds_read_b128 v[192:195], v10 offset:10240
    v_mul_f32 v20, v20, v64
    v_mul_f32 v22, v22, v66
    v_mul_f32 v21, v21, v65
    v_mul_f32 v23, v23, v67
    v_cvt_pk_bf16_f32 v32, v20, v21
    s_waitcnt lgkmcnt(3)
    v_mfma_f32_32x32x16_bf16 v[112:127], v[164:167], v[204:207], v[112:127]
    ds_read_b128 v[196:199], v10 offset:11264
    s_add_u32 s44, s49, 2388992
    buffer_load_dwordx4 v[164:167], v10, s[24:27], s44 offen sc1
    v_cvt_pk_bf16_f32 v33, v22, v23
    v_mul_f32 v20, v68, v68
    v_mul_f32 v22, v70, v70
    v_mul_f32 v21, v69, v69
    v_mul_f32 v23, v71, v71
    s_waitcnt vmcnt(29)
    s_waitcnt lgkmcnt(3)
    v_mfma_f32_32x32x16_bf16 v[96:111], v[224:227], v[208:211], v[96:111]
    ds_read_b128 v[200:203], v10 offset:12288
    v_fmamk_f32 v20, v20, 0xbdd2d3e8, v18
    v_fmamk_f32 v22, v22, 0xbdd2d3e8, v18
    v_fmamk_f32 v21, v21, 0xbdd2d3e8, v18
    v_fmamk_f32 v23, v23, 0xbdd2d3e8, v18
    v_mul_f32 v20, v20, v68
    s_waitcnt lgkmcnt(3)
    v_mfma_f32_32x32x16_bf16 v[112:127], v[224:227], v[212:215], v[112:127]
    ds_read_b128 v[204:207], v10 offset:13312
    s_add_u32 s44, s49, 2390016
    buffer_load_dwordx4 v[224:227], v10, s[24:27], s44 offen sc1
    v_mul_f32 v22, v22, v70
    v_mul_f32 v21, v21, v69
    v_mul_f32 v23, v23, v71
    v_exp_f32 v20, v20
    s_waitcnt vmcnt(29)
    s_waitcnt lgkmcnt(3)
    v_mfma_f32_32x32x16_bf16 v[96:111], v[228:231], v[192:195], v[96:111]
    ds_read_b128 v[208:211], v10 offset:14336
    v_exp_f32 v22, v22
    v_exp_f32 v21, v21
    v_exp_f32 v23, v23
    s_waitcnt lgkmcnt(3)
    v_mfma_f32_32x32x16_bf16 v[112:127], v[228:231], v[196:199], v[112:127]
    ds_read_b128 v[212:215], v10 offset:15360
    s_add_u32 s44, s49, 2391040
    buffer_load_dwordx4 v[228:231], v10, s[24:27], s44 offen sc1
    v_add_f32 v20, 1.0, v20
    v_add_f32 v22, 1.0, v22
    v_add_f32 v21, 1.0, v21
    v_add_f32 v23, 1.0, v23
    v_rcp_f32 v20, v20
    s_waitcnt vmcnt(29)
    s_waitcnt lgkmcnt(3)
    v_mfma_f32_32x32x16_bf16 v[96:111], v[232:235], v[200:203], v[96:111]
    ds_read_b128 v[192:195], v10 offset:16384
    v_rcp_f32 v22, v22
    v_rcp_f32 v21, v21
    v_rcp_f32 v23, v23
    s_waitcnt lgkmcnt(3)
    v_mfma_f32_32x32x16_bf16 v[112:127], v[232:235], v[204:207], v[112:127]
    ds_read_b128 v[196:199], v10 offset:17408
    v_mul_f32 v20, v20, v68
    v_mul_f32 v22, v22, v70
    v_mul_f32 v21, v21, v69
    v_mul_f32 v23, v23, v71
    v_cvt_pk_bf16_f32 v34, v20, v21
    s_waitcnt vmcnt(28)
    s_waitcnt lgkmcnt(3)
    v_mfma_f32_32x32x16_bf16 v[96:111], v[236:239], v[208:211], v[96:111]
    ds_read_b128 v[200:203], v10 offset:18432
    v_cvt_pk_bf16_f32 v35, v22, v23
    v_mul_f32 v20, v72, v72
    v_mul_f32 v22, v74, v74
    v_mul_f32 v21, v73, v73
    v_mul_f32 v23, v75, v75
    s_waitcnt lgkmcnt(3)
    v_mfma_f32_32x32x16_bf16 v[112:127], v[236:239], v[212:215], v[112:127]
    ds_read_b128 v[204:207], v10 offset:19456
    v_fmamk_f32 v20, v20, 0xbdd2d3e8, v18
    v_fmamk_f32 v22, v22, 0xbdd2d3e8, v18
    v_fmamk_f32 v21, v21, 0xbdd2d3e8, v18
    v_fmamk_f32 v23, v23, 0xbdd2d3e8, v18
    v_mul_f32 v20, v20, v72
    s_waitcnt vmcnt(27)
    s_waitcnt lgkmcnt(3)
    v_mfma_f32_32x32x16_bf16 v[96:111], v[128:131], v[192:195], v[96:111]
    ds_read_b128 v[208:211], v10 offset:20480
    v_mul_f32 v22, v22, v74
    v_mul_f32 v21, v21, v73
    v_mul_f32 v23, v23, v75
    v_exp_f32 v20, v20
    s_waitcnt lgkmcnt(3)
    v_mfma_f32_32x32x16_bf16 v[112:127], v[128:131], v[196:199], v[112:127]
    ds_read_b128 v[212:215], v10 offset:21504
    v_exp_f32 v22, v22
    v_exp_f32 v21, v21
    v_exp_f32 v23, v23
    s_waitcnt vmcnt(26)
    s_waitcnt lgkmcnt(3)
    v_mfma_f32_32x32x16_bf16 v[96:111], v[132:135], v[200:203], v[96:111]
    ds_read_b128 v[192:195], v10 offset:22528
    v_add_f32 v20, 1.0, v20
    v_add_f32 v22, 1.0, v22
    v_add_f32 v21, 1.0, v21
    v_add_f32 v23, 1.0, v23
    v_rcp_f32 v20, v20
    s_waitcnt lgkmcnt(3)
    v_mfma_f32_32x32x16_bf16 v[112:127], v[132:135], v[204:207], v[112:127]
    ds_read_b128 v[196:199], v10 offset:23552
    v_rcp_f32 v22, v22
    v_rcp_f32 v21, v21
    v_rcp_f32 v23, v23
    s_waitcnt vmcnt(25)
    s_waitcnt lgkmcnt(3)
    v_mfma_f32_32x32x16_bf16 v[96:111], v[136:139], v[208:211], v[96:111]
    ds_read_b128 v[200:203], v10 offset:24576
    v_mul_f32 v20, v20, v72
    v_mul_f32 v22, v22, v74
    v_mul_f32 v21, v21, v73
    v_mul_f32 v23, v23, v75
    v_cvt_pk_bf16_f32 v36, v20, v21
    s_waitcnt lgkmcnt(3)
    v_mfma_f32_32x32x16_bf16 v[112:127], v[136:139], v[212:215], v[112:127]
    ds_read_b128 v[204:207], v10 offset:25600
    v_cvt_pk_bf16_f32 v37, v22, v23
    v_mul_f32 v20, v76, v76
    v_mul_f32 v22, v78, v78
    v_mul_f32 v21, v77, v77
    v_mul_f32 v23, v79, v79
    s_waitcnt vmcnt(24)
    s_waitcnt lgkmcnt(3)
    v_mfma_f32_32x32x16_bf16 v[96:111], v[140:143], v[192:195], v[96:111]
    ds_read_b128 v[208:211], v10 offset:26624
    v_fmamk_f32 v20, v20, 0xbdd2d3e8, v18
    v_fmamk_f32 v22, v22, 0xbdd2d3e8, v18
    v_fmamk_f32 v21, v21, 0xbdd2d3e8, v18
    v_fmamk_f32 v23, v23, 0xbdd2d3e8, v18
    v_mul_f32 v20, v20, v76
    s_waitcnt lgkmcnt(3)
    v_mfma_f32_32x32x16_bf16 v[112:127], v[140:143], v[196:199], v[112:127]
    ds_read_b128 v[212:215], v10 offset:27648
    v_mul_f32 v22, v22, v78
    v_mul_f32 v21, v21, v77
    v_mul_f32 v23, v23, v79
    v_exp_f32 v20, v20
    s_waitcnt vmcnt(23)
    s_waitcnt lgkmcnt(3)
    v_mfma_f32_32x32x16_bf16 v[96:111], v[144:147], v[200:203], v[96:111]
    ds_read_b128 v[192:195], v10 offset:28672
    v_exp_f32 v22, v22
    v_exp_f32 v21, v21
    v_exp_f32 v23, v23
    s_waitcnt lgkmcnt(3)
    v_mfma_f32_32x32x16_bf16 v[112:127], v[144:147], v[204:207], v[112:127]
    ds_read_b128 v[196:199], v10 offset:29696
    v_add_f32 v20, 1.0, v20
    v_add_f32 v22, 1.0, v22
    v_add_f32 v21, 1.0, v21
    v_add_f32 v23, 1.0, v23
    v_rcp_f32 v20, v20
    s_waitcnt vmcnt(22)
    s_waitcnt lgkmcnt(3)
    v_mfma_f32_32x32x16_bf16 v[96:111], v[148:151], v[208:211], v[96:111]
    ds_read_b128 v[200:203], v10 offset:30720
    v_rcp_f32 v22, v22
    v_rcp_f32 v21, v21
    v_rcp_f32 v23, v23
    s_waitcnt lgkmcnt(3)
    v_mfma_f32_32x32x16_bf16 v[112:127], v[148:151], v[212:215], v[112:127]
    ds_read_b128 v[204:207], v10 offset:31744
    v_mul_f32 v20, v20, v76
    v_mul_f32 v22, v22, v78
    v_mul_f32 v21, v21, v77
    v_mul_f32 v23, v23, v79
    v_cvt_pk_bf16_f32 v38, v20, v21
    s_waitcnt vmcnt(21)
    s_waitcnt lgkmcnt(3)
    v_mfma_f32_32x32x16_bf16 v[96:111], v[152:155], v[192:195], v[96:111]
    ds_read_b128 v[208:211], v10 offset:32768
    v_cvt_pk_bf16_f32 v39, v22, v23
    v_mul_f32 v20, v80, v80
    v_mul_f32 v22, v82, v82
    v_mul_f32 v21, v81, v81
    v_mul_f32 v23, v83, v83
    s_waitcnt lgkmcnt(3)
    v_mfma_f32_32x32x16_bf16 v[112:127], v[152:155], v[196:199], v[112:127]
    ds_read_b128 v[212:215], v10 offset:33792
    v_fmamk_f32 v20, v20, 0xbdd2d3e8, v18
    v_fmamk_f32 v22, v22, 0xbdd2d3e8, v18
    v_fmamk_f32 v21, v21, 0xbdd2d3e8, v18
    v_fmamk_f32 v23, v23, 0xbdd2d3e8, v18
    v_mul_f32 v20, v20, v80
    s_waitcnt vmcnt(20)
    s_waitcnt lgkmcnt(3)
    v_mfma_f32_32x32x16_bf16 v[96:111], v[156:159], v[200:203], v[96:111]
    ds_read_b128 v[192:195], v10 offset:34816
    v_mul_f32 v22, v22, v82
    v_mul_f32 v21, v21, v81
    v_mul_f32 v23, v23, v83
    v_exp_f32 v20, v20
    s_waitcnt lgkmcnt(3)
    v_mfma_f32_32x32x16_bf16 v[112:127], v[156:159], v[204:207], v[112:127]
    ds_read_b128 v[196:199], v10 offset:35840
    v_exp_f32 v22, v22
    v_exp_f32 v21, v21
    v_exp_f32 v23, v23
    s_waitcnt vmcnt(19)
    s_waitcnt lgkmcnt(3)
    v_mfma_f32_32x32x16_bf16 v[96:111], v[240:243], v[208:211], v[96:111]
    ds_read_b128 v[200:203], v10 offset:36864
    v_add_f32 v20, 1.0, v20
    v_add_f32 v22, 1.0, v22
    v_add_f32 v21, 1.0, v21
    v_add_f32 v23, 1.0, v23
    v_rcp_f32 v20, v20
    s_waitcnt lgkmcnt(3)
    v_mfma_f32_32x32x16_bf16 v[112:127], v[240:243], v[212:215], v[112:127]
    ds_read_b128 v[204:207], v10 offset:37888
    v_rcp_f32 v22, v22
    v_rcp_f32 v21, v21
    v_rcp_f32 v23, v23
    s_waitcnt vmcnt(18)
    s_waitcnt lgkmcnt(3)
    v_mfma_f32_32x32x16_bf16 v[96:111], v[244:247], v[192:195], v[96:111]
    ds_read_b128 v[208:211], v10 offset:38912
    v_mul_f32 v20, v20, v80
    v_mul_f32 v22, v22, v82
    v_mul_f32 v21, v21, v81
    v_mul_f32 v23, v23, v83
    v_cvt_pk_bf16_f32 v40, v20, v21
    s_waitcnt lgkmcnt(3)
    v_mfma_f32_32x32x16_bf16 v[112:127], v[244:247], v[196:199], v[112:127]
    ds_read_b128 v[212:215], v10 offset:39936
    v_cvt_pk_bf16_f32 v41, v22, v23
    v_mul_f32 v20, v84, v84
    v_mul_f32 v22, v86, v86
    v_mul_f32 v21, v85, v85
    v_mul_f32 v23, v87, v87
    s_waitcnt vmcnt(17)
    s_waitcnt lgkmcnt(3)
    v_mfma_f32_32x32x16_bf16 v[96:111], v[248:251], v[200:203], v[96:111]
    ds_read_b128 v[192:195], v10 offset:40960
    v_fmamk_f32 v20, v20, 0xbdd2d3e8, v18
    v_fmamk_f32 v22, v22, 0xbdd2d3e8, v18
    v_fmamk_f32 v21, v21, 0xbdd2d3e8, v18
    v_fmamk_f32 v23, v23, 0xbdd2d3e8, v18
    v_mul_f32 v20, v20, v84
    s_waitcnt lgkmcnt(3)
    v_mfma_f32_32x32x16_bf16 v[112:127], v[248:251], v[204:207], v[112:127]
    ds_read_b128 v[196:199], v10 offset:41984
    v_mul_f32 v22, v22, v86
    v_mul_f32 v21, v21, v85
    v_mul_f32 v23, v23, v87
    v_exp_f32 v20, v20
    s_waitcnt vmcnt(16)
    s_waitcnt lgkmcnt(3)
    v_mfma_f32_32x32x16_bf16 v[96:111], v[252:255], v[208:211], v[96:111]
    ds_read_b128 v[200:203], v10 offset:43008
    v_exp_f32 v22, v22
    v_exp_f32 v21, v21
    v_exp_f32 v23, v23
    s_waitcnt lgkmcnt(3)
    v_mfma_f32_32x32x16_bf16 v[112:127], v[252:255], v[212:215], v[112:127]
    ds_read_b128 v[204:207], v10 offset:44032
    v_add_f32 v20, 1.0, v20
    v_add_f32 v22, 1.0, v22
    v_add_f32 v21, 1.0, v21
    v_add_f32 v23, 1.0, v23
    v_rcp_f32 v20, v20
    s_waitcnt vmcnt(15)
    s_waitcnt lgkmcnt(3)
    v_mfma_f32_32x32x16_bf16 v[96:111], v[168:171], v[192:195], v[96:111]
    ds_read_b128 v[208:211], v10 offset:45056
    v_rcp_f32 v22, v22
    v_rcp_f32 v21, v21
    v_rcp_f32 v23, v23
    s_waitcnt lgkmcnt(3)
    v_mfma_f32_32x32x16_bf16 v[112:127], v[168:171], v[196:199], v[112:127]
    ds_read_b128 v[212:215], v10 offset:46080
    v_mul_f32 v20, v20, v84
    v_mul_f32 v22, v22, v86
    v_mul_f32 v21, v21, v85
    v_mul_f32 v23, v23, v87
    v_cvt_pk_bf16_f32 v42, v20, v21
    s_waitcnt vmcnt(14)
    s_waitcnt lgkmcnt(3)
    v_mfma_f32_32x32x16_bf16 v[96:111], v[172:175], v[200:203], v[96:111]
    ds_read_b128 v[192:195], v10 offset:47104
    v_cvt_pk_bf16_f32 v43, v22, v23
    v_mul_f32 v20, v88, v88
    v_mul_f32 v22, v90, v90
    v_mul_f32 v21, v89, v89
    v_mul_f32 v23, v91, v91
    s_waitcnt lgkmcnt(3)
    v_mfma_f32_32x32x16_bf16 v[112:127], v[172:175], v[204:207], v[112:127]
    ds_read_b128 v[196:199], v10 offset:48128
    v_fmamk_f32 v20, v20, 0xbdd2d3e8, v18
    v_fmamk_f32 v22, v22, 0xbdd2d3e8, v18
    v_fmamk_f32 v21, v21, 0xbdd2d3e8, v18
    v_fmamk_f32 v23, v23, 0xbdd2d3e8, v18
    v_mul_f32 v20, v20, v88
    s_waitcnt vmcnt(11)
    s_waitcnt lgkmcnt(3)
    v_mfma_f32_32x32x16_bf16 v[96:111], v[176:179], v[208:211], v[96:111]
    ds_read_b128 v[200:203], v10 offset:49152
    v_mul_f32 v22, v22, v90
    v_mul_f32 v21, v21, v89
    v_mul_f32 v23, v23, v91
    v_exp_f32 v20, v20
    s_waitcnt lgkmcnt(3)
    v_mfma_f32_32x32x16_bf16 v[112:127], v[176:179], v[212:215], v[112:127]
    ds_read_b128 v[204:207], v10 offset:50176
    v_exp_f32 v22, v22
    v_exp_f32 v21, v21
    v_exp_f32 v23, v23
    s_waitcnt vmcnt(8)
    s_waitcnt lgkmcnt(3)
    v_mfma_f32_32x32x16_bf16 v[96:111], v[180:183], v[192:195], v[96:111]
    ds_read_b128 v[208:211], v10 offset:51200
    v_add_f32 v20, 1.0, v20
    v_add_f32 v22, 1.0, v22
    v_add_f32 v21, 1.0, v21
    v_add_f32 v23, 1.0, v23
    v_rcp_f32 v20, v20
    s_waitcnt lgkmcnt(3)
    v_mfma_f32_32x32x16_bf16 v[112:127], v[180:183], v[196:199], v[112:127]
    ds_read_b128 v[212:215], v10 offset:52224
    v_rcp_f32 v22, v22
    v_rcp_f32 v21, v21
    v_rcp_f32 v23, v23
    s_waitcnt vmcnt(7)
    s_waitcnt lgkmcnt(3)
    v_mfma_f32_32x32x16_bf16 v[96:111], v[184:187], v[200:203], v[96:111]
    ds_read_b128 v[192:195], v10 offset:53248
    v_mul_f32 v20, v20, v88
    v_mul_f32 v22, v22, v90
    v_mul_f32 v21, v21, v89
    v_mul_f32 v23, v23, v91
    v_cvt_pk_bf16_f32 v44, v20, v21
    s_waitcnt lgkmcnt(3)
    v_mfma_f32_32x32x16_bf16 v[112:127], v[184:187], v[204:207], v[112:127]
    ds_read_b128 v[196:199], v10 offset:54272
    v_cvt_pk_bf16_f32 v45, v22, v23
    v_mul_f32 v20, v92, v92
    v_mul_f32 v22, v94, v94
    v_mul_f32 v21, v93, v93
    v_mul_f32 v23, v95, v95
    s_waitcnt vmcnt(6)
    s_waitcnt lgkmcnt(3)
    v_mfma_f32_32x32x16_bf16 v[96:111], v[188:191], v[208:211], v[96:111]
    ds_read_b128 v[200:203], v10 offset:55296
    v_fmamk_f32 v20, v20, 0xbdd2d3e8, v18
    v_fmamk_f32 v22, v22, 0xbdd2d3e8, v18
    v_fmamk_f32 v21, v21, 0xbdd2d3e8, v18
    v_fmamk_f32 v23, v23, 0xbdd2d3e8, v18
    v_mul_f32 v20, v20, v92
    s_waitcnt lgkmcnt(3)
    v_mfma_f32_32x32x16_bf16 v[112:127], v[188:191], v[212:215], v[112:127]
    ds_read_b128 v[204:207], v10 offset:56320
    v_mul_f32 v22, v22, v94
    v_mul_f32 v21, v21, v93
    v_mul_f32 v23, v23, v95
    v_exp_f32 v20, v20
    s_waitcnt vmcnt(5)
    s_waitcnt lgkmcnt(3)
    v_mfma_f32_32x32x16_bf16 v[96:111], v[216:219], v[192:195], v[96:111]
    ds_read_b128 v[208:211], v10 offset:57344
    v_exp_f32 v22, v22
    v_exp_f32 v21, v21
    v_exp_f32 v23, v23
    s_waitcnt lgkmcnt(3)
    v_mfma_f32_32x32x16_bf16 v[112:127], v[216:219], v[196:199], v[112:127]
    ds_read_b128 v[212:215], v10 offset:58368
    v_add_f32 v20, 1.0, v20
    v_add_f32 v22, 1.0, v22
    v_add_f32 v21, 1.0, v21
    v_add_f32 v23, 1.0, v23
    v_rcp_f32 v20, v20
    s_waitcnt vmcnt(4)
    s_waitcnt lgkmcnt(3)
    v_mfma_f32_32x32x16_bf16 v[96:111], v[220:223], v[200:203], v[96:111]
    ds_read_b128 v[192:195], v10 offset:59392
    v_rcp_f32 v22, v22
    v_rcp_f32 v21, v21
    v_rcp_f32 v23, v23
    s_waitcnt lgkmcnt(3)
    v_mfma_f32_32x32x16_bf16 v[112:127], v[220:223], v[204:207], v[112:127]
    ds_read_b128 v[196:199], v10 offset:60416
    v_mul_f32 v20, v20, v92
    v_mul_f32 v22, v22, v94
    v_mul_f32 v21, v21, v93
    v_mul_f32 v23, v23, v95
    v_cvt_pk_bf16_f32 v46, v20, v21
    s_waitcnt vmcnt(3)
    s_waitcnt lgkmcnt(3)
    v_mfma_f32_32x32x16_bf16 v[96:111], v[160:163], v[208:211], v[96:111]
    ds_read_b128 v[200:203], v10 offset:61440
    v_cvt_pk_bf16_f32 v47, v22, v23
    s_add_u32 s45, s56, 65536
    buffer_store_dwordx4 v[32:35], v10, s[40:43], s45 offen offset:0 sc1
    buffer_store_dwordx4 v[36:39], v10, s[40:43], s45 offen offset:1024 sc1
    s_add_u32 s45, s57, 65536
    s_waitcnt lgkmcnt(3)
    v_mfma_f32_32x32x16_bf16 v[112:127], v[160:163], v[212:215], v[112:127]
    ds_read_b128 v[204:207], v10 offset:62464
    buffer_store_dwordx4 v[40:43], v10, s[40:43], s45 offen offset:0 sc1
    buffer_store_dwordx4 v[44:47], v10, s[40:43], s45 offen offset:1024 sc1
    s_waitcnt vmcnt(6)
    s_waitcnt lgkmcnt(3)
    v_mfma_f32_32x32x16_bf16 v[96:111], v[164:167], v[192:195], v[96:111]
    ds_read_b128 v[208:211], v10 offset:63488
    s_waitcnt lgkmcnt(3)
    v_mfma_f32_32x32x16_bf16 v[112:127], v[164:167], v[196:199], v[112:127]
    ds_read_b128 v[212:215], v10 offset:64512
    s_waitcnt vmcnt(5)
    s_waitcnt lgkmcnt(3)
    v_mfma_f32_32x32x16_bf16 v[96:111], v[224:227], v[200:203], v[96:111]
    s_waitcnt lgkmcnt(2)
    v_mfma_f32_32x32x16_bf16 v[112:127], v[224:227], v[204:207], v[112:127]
    s_waitcnt vmcnt(4)
    s_waitcnt lgkmcnt(1)
    v_mfma_f32_32x32x16_bf16 v[96:111], v[228:231], v[208:211], v[96:111]
    s_waitcnt lgkmcnt(0)
    v_mfma_f32_32x32x16_bf16 v[112:127], v[228:231], v[212:215], v[112:127]
    s_nop 9
    v_mul_f32 v20, v96, v96
    v_mul_f32 v22, v98, v98
    v_mul_f32 v21, v97, v97
    v_mul_f32 v23, v99, v99
    v_fmamk_f32 v20, v20, 0xbdd2d3e8, v18
    v_fmamk_f32 v22, v22, 0xbdd2d3e8, v18
    v_fmamk_f32 v21, v21, 0xbdd2d3e8, v18
    v_fmamk_f32 v23, v23, 0xbdd2d3e8, v18
    v_mul_f32 v20, v20, v96
    v_mul_f32 v22, v22, v98
    v_mul_f32 v21, v21, v97
    v_mul_f32 v23, v23, v99
    v_exp_f32 v20, v20
    v_exp_f32 v22, v22
    v_exp_f32 v21, v21
    v_exp_f32 v23, v23
    v_add_f32 v20, 1.0, v20
    v_add_f32 v22, 1.0, v22
    v_add_f32 v21, 1.0, v21
    v_add_f32 v23, 1.0, v23
    v_rcp_f32 v20, v20
    v_rcp_f32 v22, v22
    v_rcp_f32 v21, v21
    v_rcp_f32 v23, v23
    v_mul_f32 v20, v20, v96
    v_mul_f32 v22, v22, v98
    v_mul_f32 v21, v21, v97
    v_mul_f32 v23, v23, v99
    v_cvt_pk_bf16_f32 v48, v20, v21
    v_cvt_pk_bf16_f32 v49, v22, v23
    v_mul_f32 v20, v100, v100
    v_mul_f32 v22, v102, v102
    v_mul_f32 v21, v101, v101
    v_mul_f32 v23, v103, v103
    v_fmamk_f32 v20, v20, 0xbdd2d3e8, v18
    v_fmamk_f32 v22, v22, 0xbdd2d3e8, v18
    v_fmamk_f32 v21, v21, 0xbdd2d3e8, v18
    v_fmamk_f32 v23, v23, 0xbdd2d3e8, v18
    v_mul_f32 v20, v20, v100
    v_mul_f32 v22, v22, v102
    v_mul_f32 v21, v21, v101
    v_mul_f32 v23, v23, v103
    v_exp_f32 v20, v20
    v_exp_f32 v22, v22
    v_exp_f32 v21, v21
    v_exp_f32 v23, v23
    v_add_f32 v20, 1.0, v20
    v_add_f32 v22, 1.0, v22
    v_add_f32 v21, 1.0, v21
    v_add_f32 v23, 1.0, v23
    v_rcp_f32 v20, v20
    v_rcp_f32 v22, v22
    v_rcp_f32 v21, v21
    v_rcp_f32 v23, v23
    v_mul_f32 v20, v20, v100
    v_mul_f32 v22, v22, v102
    v_mul_f32 v21, v21, v101
    v_mul_f32 v23, v23, v103
    v_cvt_pk_bf16_f32 v50, v20, v21
    v_cvt_pk_bf16_f32 v51, v22, v23
    v_mul_f32 v20, v104, v104
    v_mul_f32 v22, v106, v106
    v_mul_f32 v21, v105, v105
    v_mul_f32 v23, v107, v107
    v_fmamk_f32 v20, v20, 0xbdd2d3e8, v18
    v_fmamk_f32 v22, v22, 0xbdd2d3e8, v18
    v_fmamk_f32 v21, v21, 0xbdd2d3e8, v18
    v_fmamk_f32 v23, v23, 0xbdd2d3e8, v18
    v_mul_f32 v20, v20, v104
    v_mul_f32 v22, v22, v106
    v_mul_f32 v21, v21, v105
    v_mul_f32 v23, v23, v107
    v_exp_f32 v20, v20
    v_exp_f32 v22, v22
    v_exp_f32 v21, v21
    v_exp_f32 v23, v23
    v_add_f32 v20, 1.0, v20
    v_add_f32 v22, 1.0, v22
    v_add_f32 v21, 1.0, v21
    v_add_f32 v23, 1.0, v23
    v_rcp_f32 v20, v20
    v_rcp_f32 v22, v22
    v_rcp_f32 v21, v21
    v_rcp_f32 v23, v23
    v_mul_f32 v20, v20, v104
    v_mul_f32 v22, v22, v106
    v_mul_f32 v21, v21, v105
    v_mul_f32 v23, v23, v107
    v_cvt_pk_bf16_f32 v52, v20, v21
    v_cvt_pk_bf16_f32 v53, v22, v23
    v_mul_f32 v20, v108, v108
    v_mul_f32 v22, v110, v110
    v_mul_f32 v21, v109, v109
    v_mul_f32 v23, v111, v111
    v_fmamk_f32 v20, v20, 0xbdd2d3e8, v18
    v_fmamk_f32 v22, v22, 0xbdd2d3e8, v18
    v_fmamk_f32 v21, v21, 0xbdd2d3e8, v18
    v_fmamk_f32 v23, v23, 0xbdd2d3e8, v18
    v_mul_f32 v20, v20, v108
    v_mul_f32 v22, v22, v110
    v_mul_f32 v21, v21, v109
    v_mul_f32 v23, v23, v111
    v_exp_f32 v20, v20
    v_exp_f32 v22, v22
    v_exp_f32 v21, v21
    v_exp_f32 v23, v23
    v_add_f32 v20, 1.0, v20
    v_add_f32 v22, 1.0, v22
    v_add_f32 v21, 1.0, v21
    v_add_f32 v23, 1.0, v23
    v_rcp_f32 v20, v20
    v_rcp_f32 v22, v22
    v_rcp_f32 v21, v21
    v_rcp_f32 v23, v23
    v_mul_f32 v20, v20, v108
    v_mul_f32 v22, v22, v110
    v_mul_f32 v21, v21, v109
    v_mul_f32 v23, v23, v111
    v_cvt_pk_bf16_f32 v54, v20, v21
    v_cvt_pk_bf16_f32 v55, v22, v23
    v_mul_f32 v20, v112, v112
    v_mul_f32 v22, v114, v114
    v_mul_f32 v21, v113, v113
    v_mul_f32 v23, v115, v115
    v_fmamk_f32 v20, v20, 0xbdd2d3e8, v18
    v_fmamk_f32 v22, v22, 0xbdd2d3e8, v18
    v_fmamk_f32 v21, v21, 0xbdd2d3e8, v18
    v_fmamk_f32 v23, v23, 0xbdd2d3e8, v18
    v_mul_f32 v20, v20, v112
    v_mul_f32 v22, v22, v114
    v_mul_f32 v21, v21, v113
    v_mul_f32 v23, v23, v115
    v_exp_f32 v20, v20
    v_exp_f32 v22, v22
    v_exp_f32 v21, v21
    v_exp_f32 v23, v23
    v_add_f32 v20, 1.0, v20
    v_add_f32 v22, 1.0, v22
    v_add_f32 v21, 1.0, v21
    v_add_f32 v23, 1.0, v23
    v_rcp_f32 v20, v20
    v_rcp_f32 v22, v22
    v_rcp_f32 v21, v21
    v_rcp_f32 v23, v23
    v_mul_f32 v20, v20, v112
    v_mul_f32 v22, v22, v114
    v_mul_f32 v21, v21, v113
    v_mul_f32 v23, v23, v115
    v_cvt_pk_bf16_f32 v56, v20, v21
    v_cvt_pk_bf16_f32 v57, v22, v23
    v_mul_f32 v20, v116, v116
    v_mul_f32 v22, v118, v118
    v_mul_f32 v21, v117, v117
    v_mul_f32 v23, v119, v119
    v_fmamk_f32 v20, v20, 0xbdd2d3e8, v18
    v_fmamk_f32 v22, v22, 0xbdd2d3e8, v18
    v_fmamk_f32 v21, v21, 0xbdd2d3e8, v18
    v_fmamk_f32 v23, v23, 0xbdd2d3e8, v18
    v_mul_f32 v20, v20, v116
    v_mul_f32 v22, v22, v118
    v_mul_f32 v21, v21, v117
    v_mul_f32 v23, v23, v119
    v_exp_f32 v20, v20
    v_exp_f32 v22, v22
    v_exp_f32 v21, v21
    v_exp_f32 v23, v23
    v_add_f32 v20, 1.0, v20
    v_add_f32 v22, 1.0, v22
    v_add_f32 v21, 1.0, v21
    v_add_f32 v23, 1.0, v23
    v_rcp_f32 v20, v20
    v_rcp_f32 v22, v22
    v_rcp_f32 v21, v21
    v_rcp_f32 v23, v23
    v_mul_f32 v20, v20, v116
    v_mul_f32 v22, v22, v118
    v_mul_f32 v21, v21, v117
    v_mul_f32 v23, v23, v119
    v_cvt_pk_bf16_f32 v58, v20, v21
    v_cvt_pk_bf16_f32 v59, v22, v23
    v_mul_f32 v20, v120, v120
    v_mul_f32 v22, v122, v122
    v_mul_f32 v21, v121, v121
    v_mul_f32 v23, v123, v123
    v_fmamk_f32 v20, v20, 0xbdd2d3e8, v18
    v_fmamk_f32 v22, v22, 0xbdd2d3e8, v18
    v_fmamk_f32 v21, v21, 0xbdd2d3e8, v18
    v_fmamk_f32 v23, v23, 0xbdd2d3e8, v18
    v_mul_f32 v20, v20, v120
    v_mul_f32 v22, v22, v122
    v_mul_f32 v21, v21, v121
    v_mul_f32 v23, v23, v123
    v_exp_f32 v20, v20
    v_exp_f32 v22, v22
    v_exp_f32 v21, v21
    v_exp_f32 v23, v23
    v_add_f32 v20, 1.0, v20
    v_add_f32 v22, 1.0, v22
    v_add_f32 v21, 1.0, v21
    v_add_f32 v23, 1.0, v23
    v_rcp_f32 v20, v20
    v_rcp_f32 v22, v22
    v_rcp_f32 v21, v21
    v_rcp_f32 v23, v23
    v_mul_f32 v20, v20, v120
    v_mul_f32 v22, v22, v122
    v_mul_f32 v21, v21, v121
    v_mul_f32 v23, v23, v123
    v_cvt_pk_bf16_f32 v60, v20, v21
    v_cvt_pk_bf16_f32 v61, v22, v23
    v_mul_f32 v20, v124, v124
    v_mul_f32 v22, v126, v126
    v_mul_f32 v21, v125, v125
    v_mul_f32 v23, v127, v127
    v_fmamk_f32 v20, v20, 0xbdd2d3e8, v18
    v_fmamk_f32 v22, v22, 0xbdd2d3e8, v18
    v_fmamk_f32 v21, v21, 0xbdd2d3e8, v18
    v_fmamk_f32 v23, v23, 0xbdd2d3e8, v18
    v_mul_f32 v20, v20, v124
    v_mul_f32 v22, v22, v126
    v_mul_f32 v21, v21, v125
    v_mul_f32 v23, v23, v127
    v_exp_f32 v20, v20
    v_exp_f32 v22, v22
    v_exp_f32 v21, v21
    v_exp_f32 v23, v23
    v_add_f32 v20, 1.0, v20
    v_add_f32 v22, 1.0, v22
    v_add_f32 v21, 1.0, v21
    v_add_f32 v23, 1.0, v23
    v_rcp_f32 v20, v20
    v_rcp_f32 v22, v22
    v_rcp_f32 v21, v21
    v_rcp_f32 v23, v23
    v_mul_f32 v20, v20, v124
    v_mul_f32 v22, v22, v126
    v_mul_f32 v21, v21, v125
    v_mul_f32 v23, v23, v127
    v_cvt_pk_bf16_f32 v62, v20, v21
    v_cvt_pk_bf16_f32 v63, v22, v23
    s_add_u32 s45, s56, 81920
    buffer_store_dwordx4 v[48:51], v10, s[40:43], s45 offen offset:0 sc1
    buffer_store_dwordx4 v[52:55], v10, s[40:43], s45 offen offset:1024 sc1
    s_add_u32 s45, s57, 81920
    buffer_store_dwordx4 v[56:59], v10, s[40:43], s45 offen offset:0 sc1
    buffer_store_dwordx4 v[60:63], v10, s[40:43], s45 offen offset:1024 sc1
    s_branch B_END
B_SHORT:
    s_nop 11
    v_mul_f32 v20, v64, v64
    v_mul_f32 v22, v66, v66
    v_mul_f32 v21, v65, v65
    v_mul_f32 v23, v67, v67
    v_fmamk_f32 v20, v20, 0xbdd2d3e8, v18
    v_fmamk_f32 v22, v22, 0xbdd2d3e8, v18
    v_fmamk_f32 v21, v21, 0xbdd2d3e8, v18
    v_fmamk_f32 v23, v23, 0xbdd2d3e8, v18
    v_mul_f32 v20, v20, v64
    v_mul_f32 v22, v22, v66
    v_mul_f32 v21, v21, v65
    v_mul_f32 v23, v23, v67
    v_exp_f32 v20, v20
    v_exp_f32 v22, v22
    v_exp_f32 v21, v21
    v_exp_f32 v23, v23
    v_add_f32 v20, 1.0, v20
    v_add_f32 v22, 1.0, v22
    v_add_f32 v21, 1.0, v21
    v_add_f32 v23, 1.0, v23
    v_rcp_f32 v20, v20
    v_rcp_f32 v22, v22
    v_rcp_f32 v21, v21
    v_rcp_f32 v23, v23
    v_mul_f32 v20, v20, v64
    v_mul_f32 v22, v22, v66
    v_mul_f32 v21, v21, v65
    v_mul_f32 v23, v23, v67
    v_cvt_pk_bf16_f32 v32, v20, v21
    v_cvt_pk_bf16_f32 v33, v22, v23
    v_mul_f32 v20, v68, v68
    v_mul_f32 v22, v70, v70
    v_mul_f32 v21, v69, v69
    v_mul_f32 v23, v71, v71
    v_fmamk_f32 v20, v20, 0xbdd2d3e8, v18
    v_fmamk_f32 v22, v22, 0xbdd2d3e8, v18
    v_fmamk_f32 v21, v21, 0xbdd2d3e8, v18
    v_fmamk_f32 v23, v23, 0xbdd2d3e8, v18
    v_mul_f32 v20, v20, v68
    v_mul_f32 v22, v22, v70
    v_mul_f32 v21, v21, v69
    v_mul_f32 v23, v23, v71
    v_exp_f32 v20, v20
    v_exp_f32 v22, v22
    v_exp_f32 v21, v21
    v_exp_f32 v23, v23
    v_add_f32 v20, 1.0, v20
    v_add_f32 v22, 1.0, v22
    v_add_f32 v21, 1.0, v21
    v_add_f32 v23, 1.0, v23
    v_rcp_f32 v20, v20
    v_rcp_f32 v22, v22
    v_rcp_f32 v21, v21
    v_rcp_f32 v23, v23
    v_mul_f32 v20, v20, v68
    v_mul_f32 v22, v22, v70
    v_mul_f32 v21, v21, v69
    v_mul_f32 v23, v23, v71
    v_cvt_pk_bf16_f32 v34, v20, v21
    v_cvt_pk_bf16_f32 v35, v22, v23
    v_mul_f32 v20, v72, v72
    v_mul_f32 v22, v74, v74
    v_mul_f32 v21, v73, v73
    v_mul_f32 v23, v75, v75
    v_fmamk_f32 v20, v20, 0xbdd2d3e8, v18
    v_fmamk_f32 v22, v22, 0xbdd2d3e8, v18
    v_fmamk_f32 v21, v21, 0xbdd2d3e8, v18
    v_fmamk_f32 v23, v23, 0xbdd2d3e8, v18
    v_mul_f32 v20, v20, v72
    v_mul_f32 v22, v22, v74
    v_mul_f32 v21, v21, v73
    v_mul_f32 v23, v23, v75
    v_exp_f32 v20, v20
    v_exp_f32 v22, v22
    v_exp_f32 v21, v21
    v_exp_f32 v23, v23
    v_add_f32 v20, 1.0, v20
    v_add_f32 v22, 1.0, v22
    v_add_f32 v21, 1.0, v21
    v_add_f32 v23, 1.0, v23
    v_rcp_f32 v20, v20
    v_rcp_f32 v22, v22
    v_rcp_f32 v21, v21
    v_rcp_f32 v23, v23
    v_mul_f32 v20, v20, v72
    v_mul_f32 v22, v22, v74
    v_mul_f32 v21, v21, v73
    v_mul_f32 v23, v23, v75
    v_cvt_pk_bf16_f32 v36, v20, v21
    v_cvt_pk_bf16_f32 v37, v22, v23
    v_mul_f32 v20, v76, v76
    v_mul_f32 v22, v78, v78
    v_mul_f32 v21, v77, v77
    v_mul_f32 v23, v79, v79
    v_fmamk_f32 v20, v20, 0xbdd2d3e8, v18
    v_fmamk_f32 v22, v22, 0xbdd2d3e8, v18
    v_fmamk_f32 v21, v21, 0xbdd2d3e8, v18
    v_fmamk_f32 v23, v23, 0xbdd2d3e8, v18
    v_mul_f32 v20, v20, v76
    v_mul_f32 v22, v22, v78
    v_mul_f32 v21, v21, v77
    v_mul_f32 v23, v23, v79
    v_exp_f32 v20, v20
    v_exp_f32 v22, v22
    v_exp_f32 v21, v21
    v_exp_f32 v23, v23
    v_add_f32 v20, 1.0, v20
    v_add_f32 v22, 1.0, v22
    v_add_f32 v21, 1.0, v21
    v_add_f32 v23, 1.0, v23
    v_rcp_f32 v20, v20
    v_rcp_f32 v22, v22
    v_rcp_f32 v21, v21
    v_rcp_f32 v23, v23
    v_mul_f32 v20, v20, v76
    v_mul_f32 v22, v22, v78
    v_mul_f32 v21, v21, v77
    v_mul_f32 v23, v23, v79
    v_cvt_pk_bf16_f32 v38, v20, v21
    v_cvt_pk_bf16_f32 v39, v22, v23
    v_mul_f32 v20, v80, v80
    v_mul_f32 v22, v82, v82
    v_mul_f32 v21, v81, v81
    v_mul_f32 v23, v83, v83
    v_fmamk_f32 v20, v20, 0xbdd2d3e8, v18
    v_fmamk_f32 v22, v22, 0xbdd2d3e8, v18
    v_fmamk_f32 v21, v21, 0xbdd2d3e8, v18
    v_fmamk_f32 v23, v23, 0xbdd2d3e8, v18
    v_mul_f32 v20, v20, v80
    v_mul_f32 v22, v22, v82
    v_mul_f32 v21, v21, v81
    v_mul_f32 v23, v23, v83
    v_exp_f32 v20, v20
    v_exp_f32 v22, v22
    v_exp_f32 v21, v21
    v_exp_f32 v23, v23
    v_add_f32 v20, 1.0, v20
    v_add_f32 v22, 1.0, v22
    v_add_f32 v21, 1.0, v21
    v_add_f32 v23, 1.0, v23
    v_rcp_f32 v20, v20
    v_rcp_f32 v22, v22
    v_rcp_f32 v21, v21
    v_rcp_f32 v23, v23
    v_mul_f32 v20, v20, v80
    v_mul_f32 v22, v22, v82
    v_mul_f32 v21, v21, v81
    v_mul_f32 v23, v23, v83
    v_cvt_pk_bf16_f32 v40, v20, v21
    v_cvt_pk_bf16_f32 v41, v22, v23
    v_mul_f32 v20, v84, v84
    v_mul_f32 v22, v86, v86
    v_mul_f32 v21, v85, v85
    v_mul_f32 v23, v87, v87
    v_fmamk_f32 v20, v20, 0xbdd2d3e8, v18
    v_fmamk_f32 v22, v22, 0xbdd2d3e8, v18
    v_fmamk_f32 v21, v21, 0xbdd2d3e8, v18
    v_fmamk_f32 v23, v23, 0xbdd2d3e8, v18
    v_mul_f32 v20, v20, v84
    v_mul_f32 v22, v22, v86
    v_mul_f32 v21, v21, v85
    v_mul_f32 v23, v23, v87
    v_exp_f32 v20, v20
    v_exp_f32 v22, v22
    v_exp_f32 v21, v21
    v_exp_f32 v23, v23
    v_add_f32 v20, 1.0, v20
    v_add_f32 v22, 1.0, v22
    v_add_f32 v21, 1.0, v21
    v_add_f32 v23, 1.0, v23
    v_rcp_f32 v20, v20
    v_rcp_f32 v22, v22
    v_rcp_f32 v21, v21
    v_rcp_f32 v23, v23
    v_mul_f32 v20, v20, v84
    v_mul_f32 v22, v22, v86
    v_mul_f32 v21, v21, v85
    v_mul_f32 v23, v23, v87
    v_cvt_pk_bf16_f32 v42, v20, v21
    v_cvt_pk_bf16_f32 v43, v22, v23
    v_mul_f32 v20, v88, v88
    v_mul_f32 v22, v90, v90
    v_mul_f32 v21, v89, v89
    v_mul_f32 v23, v91, v91
    v_fmamk_f32 v20, v20, 0xbdd2d3e8, v18
    v_fmamk_f32 v22, v22, 0xbdd2d3e8, v18
    v_fmamk_f32 v21, v21, 0xbdd2d3e8, v18
    v_fmamk_f32 v23, v23, 0xbdd2d3e8, v18
    v_mul_f32 v20, v20, v88
    v_mul_f32 v22, v22, v90
    v_mul_f32 v21, v21, v89
    v_mul_f32 v23, v23, v91
    v_exp_f32 v20, v20
    v_exp_f32 v22, v22
    v_exp_f32 v21, v21
    v_exp_f32 v23, v23
    v_add_f32 v20, 1.0, v20
    v_add_f32 v22, 1.0, v22
    v_add_f32 v21, 1.0, v21
    v_add_f32 v23, 1.0, v23
    v_rcp_f32 v20, v20
    v_rcp_f32 v22, v22
    v_rcp_f32 v21, v21
    v_rcp_f32 v23, v23
    v_mul_f32 v20, v20, v88
    v_mul_f32 v22, v22, v90
    v_mul_f32 v21, v21, v89
    v_mul_f32 v23, v23, v91
    v_cvt_pk_bf16_f32 v44, v20, v21
    v_cvt_pk_bf16_f32 v45, v22, v23
    v_mul_f32 v20, v92, v92
    v_mul_f32 v22, v94, v94
    v_mul_f32 v21, v93, v93
    v_mul_f32 v23, v95, v95
    v_fmamk_f32 v20, v20, 0xbdd2d3e8, v18
    v_fmamk_f32 v22, v22, 0xbdd2d3e8, v18
    v_fmamk_f32 v21, v21, 0xbdd2d3e8, v18
    v_fmamk_f32 v23, v23, 0xbdd2d3e8, v18
    v_mul_f32 v20, v20, v92
    v_mul_f32 v22, v22, v94
    v_mul_f32 v21, v21, v93
    v_mul_f32 v23, v23, v95
    v_exp_f32 v20, v20
    v_exp_f32 v22, v22
    v_exp_f32 v21, v21
    v_exp_f32 v23, v23
    v_add_f32 v20, 1.0, v20
    v_add_f32 v22, 1.0, v22
    v_add_f32 v21, 1.0, v21
    v_add_f32 v23, 1.0, v23
    v_rcp_f32 v20, v20
    v_rcp_f32 v22, v22
    v_rcp_f32 v21, v21
    v_rcp_f32 v23, v23
    v_mul_f32 v20, v20, v92
    v_mul_f32 v22, v22, v94
    v_mul_f32 v21, v21, v93
    v_mul_f32 v23, v23, v95
    v_cvt_pk_bf16_f32 v46, v20, v21
    v_cvt_pk_bf16_f32 v47, v22, v23
    s_add_u32 s45, s56, 65536
    buffer_store_dwordx4 v[32:35], v10, s[40:43], s45 offen offset:0 sc1
    buffer_store_dwordx4 v[36:39], v10, s[40:43], s45 offen offset:1024 sc1
    s_add_u32 s45, s57, 65536
    buffer_store_dwordx4 v[40:43], v10, s[40:43], s45 offen offset:0 sc1
    buffer_store_dwordx4 v[44:47], v10, s[40:43], s45 offen offset:1024 sc1
B_END:
    s_lshl_b32 s44, s47, 1
    s_add_u32 s44, s44, 10240
    v_mov_b32 v8, s44
    s_waitcnt vmcnt(0)
    s_barrier
    s_cmp_lg_u32 s3, 0
    s_cbranch_scc1 B_FL
    v_mov_b32 v9, s77
    s_mov_b64 exec, 3
    global_store_dword v8, v9, s[100:101] sc1
    s_mov_b64 exec, -1
B_FL:
    s_mov_b32 s72, 0
    s_lshr_b32 s44, s2, 3
    s_load_dwordx2 s[60:61], s[0:1], 40
    s_load_dwordx2 s[62:63], s[0:1], 80
    s_lshl_b32 s68, s44, 3
    s_add_u32 s68, s68, s3
    s_mul_i32 s68, s68, 6144
    s_and_b32 s69, s2, 3
    v_and_b32 v26, 63, v1
    v_lshlrev_b32 v26, 7, v26
    s_waitcnt lgkmcnt(0)
    s_mov_b32 s64, s60
    s_mov_b32 s65, s61
    s_mov_b32 s66, 0x400000
    s_mov_b32 s67, 0x00020000
    s_cmp_eq_u32 s69, 2
    s_cselect_b32 s64, s62, s64
    s_cselect_b32 s65, s63, s65
    s_cselect_b32 s66, 0x158000, s66
    s_cselect_b32 s69, 0, s69
    s_cmp_eq_u32 s69, 3
    s_mul_i32 s69, s69, 1572864
    s_cselect_b32 s69, 2883584, s69
    s_add_u32 s68, s68, s69
    s_mov_b32 exec_hi, 65535
    buffer_load_dword v27, v26, s[64:67], s68 offen
    s_mov_b32 exec_hi, -1
    s_branch L3C_ENTRY
L3C_ENTRY:
    s_load_dwordx2 s[4:5], s[0:1], 40
    s_load_dwordx2 s[6:7], s[0:1], 80
    s_load_dwordx2 s[8:9], s[0:1], 104
    s_load_dwordx2 s[10:11], s[0:1], 0
    s_load_dwordx2 s[12:13], s[0:1], 88
    s_and_b32 s44, s2, 7
    s_and_b32 s53, s44, 3
    s_lshr_b32 s45, s53, 1
    s_xor_b32 s53, s53, s45
    s_lshr_b32 s44, s44, 2
    s_lshr_b32 s45, s2, 3
    s_sub_u32 s46, s45, 4
    s_mul_i32 s58, s46, 37
    s_lshr_b32 s58, s58, 8
    s_mul_i32 s59, s58, 7
    s_sub_u32 s59, s46, s59
    s_mul_i32 s60, s58, 6
    s_add_u32 s60, s60, s59
    s_mul_i32 s52, s44, 24
    s_add_u32 s60, s60, s52
    s_add_u32 s60, s60, 16
    s_lshl_b32 s44, s44, 3
    s_add_u32 s58, s58, 4
    s_add_u32 s58, s58, s44
    s_cmp_eq_u32 s59, 6
    s_cselect_b32 s60, s58, s60
    s_add_u32 s58, s45, s44
    s_cmp_lt_u32 s45, 4
    s_cselect_b32 s60, s58, s60
    s_lshr_b32 s51, s60, 2
    s_and_b32 s52, s60, 3
    v_lshlrev_b32 v10, 4, v1
    v_lshrrev_b32 v3, 4, v1
    v_and_b32 v4, 15, v1
    v_lshlrev_b32 v2, 10, v3
    v_lshlrev_b32 v3, 2, v3
    v_xor_b32 v4, v4, v3
    v_lshlrev_b32 v4, 4, v4
    v_or_b32 v11, v2, v4
    v_add_u32 v12, 3072, v11
    s_mov_b32 s54, 262144
    s_mul_i32 s44, s53, 80
    s_add_u32 s44, s44, 16
    s_cmp_eq_u32 s53, 0
    s_cselect_b32 s44, 0, s44
    s_cmp_eq_u32 s53, 3
    s_cselect_b32 s54, 88064, s54
    s_cselect_b32 s44, 0, s44
    s_lshl_b32 s45, s51, 2
    s_lshr_b32 s46, s3, 1
    s_add_u32 s45, s45, s46
    s_mul_i32 s47, s45, s54
    s_and_b32 s45, s3, 1
    s_lshl_b32 s45, s45, 1
    s_add_u32 s45, s45, s44
    s_lshl_b32 s45, s45, 10
    s_add_u32 s47, s47, s45
    s_lshl_b32 s48, s44, 14
    s_lshl_b32 s45, s3, 13
    s_add_u32 s48, s48, s45
    s_lshl_b32 s45, s52, 8
    s_add_u32 s48, s48, s45
    s_lshl_b32 s49, s3, 11
    s_add_u32 s50, s49, 16384
    s_waitcnt lgkmcnt(0)
    s_cmp_eq_u32 s53, 3
    s_cbranch_scc1 L3C_MLP
    s_mov_b32 s20, s4
    s_mov_b32 s21, s5
    s_mov_b32 s22, 0x400000
    s_mov_b32 s23, 0x00020000
    s_add_u32 s16, s8, 0x3000000
    s_addc_u32 s17, s9, 0
    s_mov_b32 s18, 0x1000000
    s_mov_b32 s19, 0x00020000
    s_branch L3C_GO
L3C_MLP:
    s_mov_b32 s20, s6
    s_mov_b32 s21, s7
    s_mov_b32 s22, 0x158000
    s_mov_b32 s23, 0x00020000
    s_add_u32 s16, s8, 0x600000
    s_addc_u32 s17, s9, 0
    s_mov_b32 s18, 0x560000
    s_mov_b32 s19, 0x00020000
L3C_GO:
    s_mov_b32 s61, s48
    s_mov_b32 s62, s47
    s_and_b32 s44, s3, 1
    s_cmp_eq_u32 s53, 3
    s_cselect_b32 s44, s44, 0
    s_mul_i32 s63, s44, 0x7f000000
    s_mul_i32 s64, s53, 10
    s_add_u32 s64, s64, 2
    s_mov_b32 s65, 0x3ff
    s_cmp_eq_u32 s53, 0
    s_cselect_b32 s65, 0xfff, s65
    s_cselect_b32 s64, 0, s64
    s_mov_b32 s66, 0x8000
    s_cmp_eq_u32 s53, 3
    s_cselect_b32 s65, 0x7ff, s65
    s_cselect_b32 s66, 0x87ff, s66
    s_cselect_b32 s64, 0, s64
    s_or_b32 s67, s65, 0x8000
    s_lshl_b32 s44, s51, 7
    s_add_u32 s44, s44, 8192
    v_lshlrev_b32 v2, 2, v1
    v_add_u32 v24, s44, v2
    s_lshl_b32 s44, s51, 3
    s_add_u32 s44, s44, 10240
    v_and_b32 v2, 4, v2
    v_add_u32 v2, s44, v2
    v_cmp_lt_u32 vcc, 31, v1
    s_nop 1
    v_cndmask_b32 v24, v24, v2, vcc
    s_cmp_lg_u32 s3, 0
    s_cbranch_scc1 L3C_NP
    global_load_dword v25, v24, s[100:101] sc1
L3C_NP:
    s_waitcnt vmcnt(0)
    s_barrier
    s_cmp_eq_u32 s72, 0
    s_cbranch_scc1 L3C_NF
    s_cmp_lg_u32 s3, 0
    s_cbranch_scc1 L3C_CF
    v_mov_b32 v9, s77
    s_mov_b64 exec, 3
    global_store_dword v8, v9, s[100:101] sc1
    s_mov_b64 exec, -1
L3C_CF:
L3C_NF:
    s_cmp_lg_u32 s3, 0
    s_cbranch_scc1 L3C_ORD
    s_mov_b32 s45, 100000
    s_branch L3C_SP0
L3C_SP:
    global_load_dword v25, v24, s[100:101] sc1
    s_waitcnt vmcnt(0)
L3C_SP0:
    v_cmp_eq_u32 vcc, s77, v25
    s_lshr_b32 s68, vcc_lo, s64
    s_and_b32 s68, s68, s65
    s_or_b32 s68, s68, s66
    s_and_b32 s44, vcc_hi, 3
    s_bcnt1_i32_b32 s46, s68
    s_cmp_eq_u32 s44, 3
    s_cselect_b32 s46, s46, 0
    s_cmp_gt_u32 s46, 3
    s_cbranch_scc1 L3C_SD
    s_sleep 4
    s_sub_u32 s45, s45, 1
    s_cmp_lg_u32 s45, 0
    s_cbranch_scc1 L3C_SP
L3C_SD:
    s_and_b32 s58, s68, s65
    s_andn2_b32 s59, 0xfff, s58
    s_bcnt1_i32_b32 s44, s58
    v_mbcnt_lo_u32_b32 v2, s58, 0
    v_mov_b32 v3, s44
    v_mbcnt_lo_u32_b32 v3, s59, v3
    s_mov_b32 vcc_lo, s58
    s_mov_b32 vcc_hi, 0
    s_nop 1
    v_cndmask_b32 v2, v3, v2, vcc
    s_mov_b32 vcc_lo, s65
    s_nop 1
    v_cndmask_b32 v4, 15, v1, vcc
    v_add_u32 v2, 163824, v2
    s_mov_b64 exec, 0xfff
    ds_write_b8 v2, v4
    s_mov_b64 exec, -1
    s_waitcnt lgkmcnt(0)
L3C_ORD:
    s_barrier
    v_mov_b32 v2, 163824
    ds_read_b128 v[4:7], v2
    s_waitcnt lgkmcnt(0)
    v_readfirstlane_b32 s70, v4
    v_readfirstlane_b32 s71, v5
    v_readfirstlane_b32 s72, v6
    s_bfe_u32 s44, s70, 0x80000
    s_lshl_b32 s48, s44, 17
    s_add_u32 s48, s48, s61
    s_lshl_b32 s47, s44, 13
    s_add_u32 s47, s47, s62
    s_cmp_eq_u32 s44, 15
    s_cselect_b32 s48, 0x7f000000, s48
    s_cselect_b32 s47, 0x7f000000, s47
    s_add_u32 m0, s50, 0
    s_nop 0
    buffer_load_dwordx4 v11, s[20:23], s48 offen lds
    buffer_load_dwordx4 v12, s[20:23], s48 offen offset:1024 lds
    s_add_u32 s48, s48, 65536
    s_add_u32 m0, s49, 0
    s_nop 0
    buffer_load_dwordx4 v10, s[16:19], s47 offen sc1 lds
    buffer_load_dwordx4 v10, s[16:19], s47 offen offset:1024 sc1 lds
    s_add_u32 s47, s47, 4096
    s_add_u32 m0, s50, 32768
    s_nop 0
    buffer_load_dwordx4 v11, s[20:23], s48 offen lds
    buffer_load_dwordx4 v12, s[20:23], s48 offen offset:1024 lds
    s_add_u32 s48, s48, 65536
    s_add_u32 m0, s49, 32768
    s_nop 0
    buffer_load_dwordx4 v10, s[16:19], s47 offen sc1 lds
    buffer_load_dwordx4 v10, s[16:19], s47 offen offset:1024 sc1 lds
    s_add_u32 s47, s47, 4096
    s_bfe_u32 s44, s70, 0x80008
    s_lshl_b32 s48, s44, 17
    s_add_u32 s48, s48, s61
    s_lshl_b32 s47, s44, 13
    s_add_u32 s47, s47, s62
    s_cmp_eq_u32 s44, 15
    s_cselect_b32 s48, 0x7f000000, s48
    s_cselect_b32 s47, 0x7f000000, s47
    s_add_u32 m0, s50, 65536
    s_nop 0
    buffer_load_dwordx4 v11, s[20:23], s48 offen lds
    buffer_load_dwordx4 v12, s[20:23], s48 offen offset:1024 lds
    s_add_u32 s48, s48, 65536
    s_add_u32 m0, s49, 65536
    s_nop 0
    buffer_load_dwordx4 v10, s[16:19], s47 offen sc1 lds
    buffer_load_dwordx4 v10, s[16:19], s47 offen offset:1024 sc1 lds
    s_add_u32 s47, s47, 4096
    s_add_u32 m0, s50, 98304
    s_nop 0
    buffer_load_dwordx4 v11, s[20:23], s48 offen lds
    buffer_load_dwordx4 v12, s[20:23], s48 offen offset:1024 lds
    s_add_u32 s48, s48, 65536
    s_add_u32 m0, s49, 98304
    s_nop 0
    buffer_load_dwordx4 v10, s[16:19], s47 offen sc1 lds
    buffer_load_dwordx4 v10, s[16:19], s47 offen offset:1024 sc1 lds
    s_add_u32 s47, s47, 4096
    s_add_u32 s24, s8, 0x4000000
    s_addc_u32 s25, s9, 0
    s_mov_b32 s26, 0x800000
    s_mov_b32 s27, 0x00020000
    s_add_u32 s32, s8, 0x400000
    s_addc_u32 s33, s9, 0
    s_mov_b32 s34, 0x200000
    s_mov_b32 s35, 0x00020000
    s_mov_b32 s28, s10
    s_mov_b32 s29, s11
    s_mov_b32 s30, 0x200000
    s_mov_b32 s31, 0x00020000
    s_mov_b32 s36, s12
    s_mov_b32 s37, s13
    s_mov_b32 s38, 0x200000
    s_mov_b32 s39, 0x00020000
    v_and_b32 v2, 31, v1
    v_lshrrev_b32 v3, 5, v1
    s_lshl_b32 s44, s51, 2
    s_add_u32 s44, s44, s53
    s_lshl_b32 s45, s44, 15
    s_lshl_b32 s46, s52, 8
    s_add_u32 s45, s45, s46
    s_lshl_b32 s46, s3, 5
    s_add_u32 s45, s45, s46
    v_lshlrev_b32 v4, 10, v2
    v_lshlrev_b32 v5, 3, v3
    v_add_u32 v4, v4, v5
    v_add_u32 v120, s45, v4
    buffer_load_dwordx2 v[112:113], v120, s[28:31], 0 offen
    buffer_load_dwordx2 v[114:115], v120, s[28:31], 0 offen offset:16
    s_lshl_b32 s45, s44, 15
    s_lshl_b32 s46, s52, 13
    s_add_u32 s45, s45, s46
    s_lshl_b32 s46, s3, 10
    s_add_u32 s45, s45, s46
    buffer_load_dwordx4 v[116:119], v10, s[32:35], s45 offen sc1
    s_and_b32 s44, s3, 3
    s_lshl_b32 s44, s44, 12
    v_add_u32 v14, s44, v10
    v_lshrrev_b32 v3, 5, v1
    v_lshrrev_b32 v2, 2, v1
    v_and_b32 v2, 3, v2
    v_lshlrev_b32 v4, 2, v3
    v_add_u32 v4, v4, v2
    v_lshlrev_b32 v4, 8, v4
    v_lshrrev_b32 v5, 4, v1
    v_and_b32 v5, 1, v5
    v_lshlrev_b32 v5, 5, v5
    v_and_b32 v6, 3, v1
    v_lshlrev_b32 v6, 3, v6
    v_or_b32 v4, v4, v5
    v_or_b32 v4, v4, v6
    v_lshlrev_b32 v5, 6, v2
    v_or_b32 v4, v4, v5
    s_lshr_b32 s44, s3, 2
    s_lshl_b32 s44, s44, 7
    v_xor_b32 v4, s44, v4
    v_add_u32 v17, 16384, v4
    v_xor_b32 v4, 64, v4
    v_add_u32 v20, 16384, v4
    v_add_u32 v15, 0x10000, v14
    v_add_u32 v16, 0x20000, v14
    v_add_u32 v18, 0x10000, v17
    v_add_u32 v19, 0x20000, v17
    v_add_u32 v21, 0x10000, v20
    v_add_u32 v22, 0x20000, v20
    s_lshl_b32 s56, s51, 2
    s_add_u32 s56, s56, s52
    s_mul_i32 s57, s56, 98304
    s_and_b32 s45, s3, 3
    s_mul_i32 s46, s45, 24576
    s_add_u32 s55, s57, s46
    s_cmp_gt_u32 s53, s45
    s_cselect_b32 s45, 1, 0
    s_sub_u32 s45, s53, s45
    s_lshl_b32 s45, s45, 13
    s_add_u32 s55, s55, s45
    s_lshr_b32 s45, s3, 2
    s_lshl_b32 s45, s45, 12
    s_add_u32 s55, s55, s45
    s_mul_i32 s45, s53, 24576
    s_add_u32 s57, s57, s45
    s_lshl_b32 s45, s3, 10
    s_add_u32 s58, s57, s45
    s_add_u32 s59, s58, 8192
    s_add_u32 s60, s58, 16384
    s_waitcnt vmcnt(15)
    s_barrier
    ds_read_b128 v[64:67], v14 offset:0
    ds_read_b64_tr_b16 v[68:69], v17 offset:0
    ds_read_b64_tr_b16 v[70:71], v17 offset:2048
    ds_read_b64_tr_b16 v[72:73], v20 offset:0
    ds_read_b64_tr_b16 v[74:75], v20 offset:2048
    ds_read_b128 v[76:79], v14 offset:1024
    ds_read_b64_tr_b16 v[80:81], v17 offset:4096
    ds_read_b64_tr_b16 v[82:83], v17 offset:6144
    ds_read_b64_tr_b16 v[84:85], v20 offset:4096
    ds_read_b64_tr_b16 v[86:87], v20 offset:6144
    s_waitcnt lgkmcnt(7)
    v_mfma_f32_32x32x16_bf16 v[32:47], v[68:71], v[64:67], 0
    ds_read_b128 v[88:91], v14 offset:2048
    ds_read_b64_tr_b16 v[92:93], v17 offset:8192
    ds_read_b64_tr_b16 v[94:95], v17 offset:10240
    ds_read_b64_tr_b16 v[96:97], v20 offset:8192
    ds_read_b64_tr_b16 v[98:99], v20 offset:10240
    s_waitcnt lgkmcnt(10)
    v_mfma_f32_32x32x16_bf16 v[48:63], v[72:75], v[64:67], 0
    s_waitcnt lgkmcnt(7)
    v_mfma_f32_32x32x16_bf16 v[32:47], v[80:83], v[76:79], v[32:47]
    ds_read_b128 v[100:103], v14 offset:3072
    ds_read_b64_tr_b16 v[104:105], v17 offset:12288
    ds_read_b64_tr_b16 v[106:107], v17 offset:14336
    ds_read_b64_tr_b16 v[108:109], v20 offset:12288
    ds_read_b64_tr_b16 v[110:111], v20 offset:14336
    s_waitcnt lgkmcnt(10)
    v_mfma_f32_32x32x16_bf16 v[48:63], v[84:87], v[76:79], v[48:63]
    s_waitcnt vmcnt(11)
    s_cmp_lg_u32 s3, 0
    s_cbranch_scc1 L3C_K2
    s_cmp_eq_u32 s68, s67
    s_cbranch_scc1 L3C_K2
    s_bfe_u32 s44, s70, 0x80010
    s_bitcmp1_b32 s68, s44
    s_cbranch_scc0 L3C_S2
L3C_K2:
    s_barrier
    s_waitcnt lgkmcnt(7)
    v_mfma_f32_32x32x16_bf16 v[32:47], v[92:95], v[88:91], v[32:47]
    ds_read_b128 v[64:67], v14 offset:32768
    ds_read_b64_tr_b16 v[68:69], v17 offset:32768
    ds_read_b64_tr_b16 v[70:71], v17 offset:34816
    ds_read_b64_tr_b16 v[72:73], v20 offset:32768
    ds_read_b64_tr_b16 v[74:75], v20 offset:34816
    s_waitcnt lgkmcnt(10)
    v_mfma_f32_32x32x16_bf16 v[48:63], v[96:99], v[88:91], v[48:63]
    s_bfe_u32 s44, s70, 0x80010
    s_lshl_b32 s48, s44, 17
    s_add_u32 s48, s48, s61
    s_lshl_b32 s47, s44, 13
    s_add_u32 s47, s47, s62
    s_cmp_eq_u32 s44, 15
    s_cselect_b32 s48, 0x7f000000, s48
    s_cselect_b32 s47, 0x7f000000, s47
    s_add_u32 m0, s50, 131072
    s_nop 0
    buffer_load_dwordx4 v11, s[20:23], s48 offen lds
    s_waitcnt lgkmcnt(7)
    v_mfma_f32_32x32x16_bf16 v[32:47], v[104:107], v[100:103], v[32:47]
    ds_read_b128 v[76:79], v14 offset:33792
    ds_read_b64_tr_b16 v[80:81], v17 offset:36864
    ds_read_b64_tr_b16 v[82:83], v17 offset:38912
    ds_read_b64_tr_b16 v[84:85], v20 offset:36864
    ds_read_b64_tr_b16 v[86:87], v20 offset:38912
    s_waitcnt lgkmcnt(10)
    v_mfma_f32_32x32x16_bf16 v[48:63], v[108:111], v[100:103], v[48:63]
    buffer_load_dwordx4 v12, s[20:23], s48 offen offset:1024 lds
    s_add_u32 s48, s48, 65536
    s_waitcnt lgkmcnt(7)
    v_mfma_f32_32x32x16_bf16 v[32:47], v[68:71], v[64:67], v[32:47]
    ds_read_b128 v[88:91], v14 offset:34816
    ds_read_b64_tr_b16 v[92:93], v17 offset:40960
    ds_read_b64_tr_b16 v[94:95], v17 offset:43008
    ds_read_b64_tr_b16 v[96:97], v20 offset:40960
    ds_read_b64_tr_b16 v[98:99], v20 offset:43008
    s_waitcnt lgkmcnt(10)
    v_mfma_f32_32x32x16_bf16 v[48:63], v[72:75], v[64:67], v[48:63]
    s_add_u32 m0, s49, 131072
    s_nop 0
    buffer_load_dwordx4 v10, s[16:19], s47 offen sc1 lds
    s_waitcnt lgkmcnt(7)
    v_mfma_f32_32x32x16_bf16 v[32:47], v[80:83], v[76:79], v[32:47]
    ds_read_b128 v[100:103], v14 offset:35840
    ds_read_b64_tr_b16 v[104:105], v17 offset:45056
    ds_read_b64_tr_b16 v[106:107], v17 offset:47104
    ds_read_b64_tr_b16 v[108:109], v20 offset:45056
    ds_read_b64_tr_b16 v[110:111], v20 offset:47104
    s_waitcnt lgkmcnt(10)
    v_mfma_f32_32x32x16_bf16 v[48:63], v[84:87], v[76:79], v[48:63]
    buffer_load_dwordx4 v10, s[16:19], s47 offen offset:1024 sc1 lds
    s_add_u32 s47, s47, 4096
    s_waitcnt vmcnt(11)
    s_barrier
    s_cmp_lg_u32 s3, 0
    s_cbranch_scc1 L3C_P2
    s_cmp_eq_u32 s68, s67
    s_cbranch_scc1 L3C_P2
    global_load_dword v25, v24, s[100:101] sc1
L3C_P2:
    s_waitcnt lgkmcnt(7)
    v_mfma_f32_32x32x16_bf16 v[32:47], v[92:95], v[88:91], v[32:47]
    ds_read_b128 v[64:67], v15 offset:0
    ds_read_b64_tr_b16 v[68:69], v18 offset:0
    ds_read_b64_tr_b16 v[70:71], v18 offset:2048
    ds_read_b64_tr_b16 v[72:73], v21 offset:0
    ds_read_b64_tr_b16 v[74:75], v21 offset:2048
    s_waitcnt lgkmcnt(10)
    v_mfma_f32_32x32x16_bf16 v[48:63], v[96:99], v[88:91], v[48:63]
    s_add_u32 m0, s50, 0
    s_nop 0
    buffer_load_dwordx4 v11, s[20:23], s48 offen lds
    s_waitcnt lgkmcnt(7)
    v_mfma_f32_32x32x16_bf16 v[32:47], v[104:107], v[100:103], v[32:47]
    ds_read_b128 v[76:79], v15 offset:1024
    ds_read_b64_tr_b16 v[80:81], v18 offset:4096
    ds_read_b64_tr_b16 v[82:83], v18 offset:6144
    ds_read_b64_tr_b16 v[84:85], v21 offset:4096
    ds_read_b64_tr_b16 v[86:87], v21 offset:6144
    s_waitcnt lgkmcnt(10)
    v_mfma_f32_32x32x16_bf16 v[48:63], v[108:111], v[100:103], v[48:63]
    buffer_load_dwordx4 v12, s[20:23], s48 offen offset:1024 lds
    s_add_u32 s48, s48, 65536
    s_waitcnt lgkmcnt(7)
    v_mfma_f32_32x32x16_bf16 v[32:47], v[68:71], v[64:67], v[32:47]
    ds_read_b128 v[88:91], v15 offset:2048
    ds_read_b64_tr_b16 v[92:93], v18 offset:8192
    ds_read_b64_tr_b16 v[94:95], v18 offset:10240
    ds_read_b64_tr_b16 v[96:97], v21 offset:8192
    ds_read_b64_tr_b16 v[98:99], v21 offset:10240
    s_waitcnt lgkmcnt(10)
    v_mfma_f32_32x32x16_bf16 v[48:63], v[72:75], v[64:67], v[48:63]
    s_add_u32 m0, s49, 0
    s_nop 0
    buffer_load_dwordx4 v10, s[16:19], s47 offen sc1 lds
    s_waitcnt lgkmcnt(7)
    v_mfma_f32_32x32x16_bf16 v[32:47], v[80:83], v[76:79], v[32:47]
    ds_read_b128 v[100:103], v15 offset:3072
    ds_read_b64_tr_b16 v[104:105], v18 offset:12288
    ds_read_b64_tr_b16 v[106:107], v18 offset:14336
    ds_read_b64_tr_b16 v[108:109], v21 offset:12288
    ds_read_b64_tr_b16 v[110:111], v21 offset:14336
    s_waitcnt lgkmcnt(10)
    v_mfma_f32_32x32x16_bf16 v[48:63], v[84:87], v[76:79], v[48:63]
    buffer_load_dwordx4 v10, s[16:19], s47 offen offset:1024 sc1 lds
    s_add_u32 s47, s47, 4096
    s_waitcnt vmcnt(11)
    s_cmp_lg_u32 s3, 0
    s_cbranch_scc1 L3C_K3
    s_cmp_eq_u32 s68, s67
    s_cbranch_scc1 L3C_K3
    s_waitcnt vmcnt(4)
    v_cmp_eq_u32 vcc, s77, v25
    s_lshr_b32 s68, vcc_lo, s64
    s_and_b32 s68, s68, s65
    s_or_b32 s68, s68, s66
    s_bfe_u32 s44, s70, 0x80018
    s_bitcmp1_b32 s68, s44
    s_cbranch_scc0 L3C_S3
L3C_K3:
    s_barrier
    s_waitcnt lgkmcnt(7)
    v_mfma_f32_32x32x16_bf16 v[32:47], v[92:95], v[88:91], v[32:47]
    ds_read_b128 v[64:67], v15 offset:32768
    ds_read_b64_tr_b16 v[68:69], v18 offset:32768
    ds_read_b64_tr_b16 v[70:71], v18 offset:34816
    ds_read_b64_tr_b16 v[72:73], v21 offset:32768
    ds_read_b64_tr_b16 v[74:75], v21 offset:34816
    s_waitcnt lgkmcnt(10)
    v_mfma_f32_32x32x16_bf16 v[48:63], v[96:99], v[88:91], v[48:63]
    s_bfe_u32 s44, s70, 0x80018
    s_lshl_b32 s48, s44, 17
    s_add_u32 s48, s48, s61
    s_lshl_b32 s47, s44, 13
    s_add_u32 s47, s47, s62
    s_cmp_eq_u32 s44, 15
    s_cselect_b32 s48, 0x7f000000, s48
    s_cselect_b32 s47, 0x7f000000, s47
    s_add_u32 m0, s50, 32768
    s_nop 0
    buffer_load_dwordx4 v11, s[20:23], s48 offen lds
    s_waitcnt lgkmcnt(7)
    v_mfma_f32_32x32x16_bf16 v[32:47], v[104:107], v[100:103], v[32:47]
    ds_read_b128 v[76:79], v15 offset:33792
    ds_read_b64_tr_b16 v[80:81], v18 offset:36864
    ds_read_b64_tr_b16 v[82:83], v18 offset:38912
    ds_read_b64_tr_b16 v[84:85], v21 offset:36864
    ds_read_b64_tr_b16 v[86:87], v21 offset:38912
    s_waitcnt lgkmcnt(10)
    v_mfma_f32_32x32x16_bf16 v[48:63], v[108:111], v[100:103], v[48:63]
    buffer_load_dwordx4 v12, s[20:23], s48 offen offset:1024 lds
    s_add_u32 s48, s48, 65536
    s_waitcnt lgkmcnt(7)
    v_mfma_f32_32x32x16_bf16 v[32:47], v[68:71], v[64:67], v[32:47]
    ds_read_b128 v[88:91], v15 offset:34816
    ds_read_b64_tr_b16 v[92:93], v18 offset:40960
    ds_read_b64_tr_b16 v[94:95], v18 offset:43008
    ds_read_b64_tr_b16 v[96:97], v21 offset:40960
    ds_read_b64_tr_b16 v[98:99], v21 offset:43008
    s_waitcnt lgkmcnt(10)
    v_mfma_f32_32x32x16_bf16 v[48:63], v[72:75], v[64:67], v[48:63]
    s_add_u32 m0, s49, 32768
    s_nop 0
    buffer_load_dwordx4 v10, s[16:19], s47 offen sc1 lds
    s_waitcnt lgkmcnt(7)
    v_mfma_f32_32x32x16_bf16 v[32:47], v[80:83], v[76:79], v[32:47]
    ds_read_b128 v[100:103], v15 offset:35840
    ds_read_b64_tr_b16 v[104:105], v18 offset:45056
    ds_read_b64_tr_b16 v[106:107], v18 offset:47104
    ds_read_b64_tr_b16 v[108:109], v21 offset:45056
    ds_read_b64_tr_b16 v[110:111], v21 offset:47104
    s_waitcnt lgkmcnt(10)
    v_mfma_f32_32x32x16_bf16 v[48:63], v[84:87], v[76:79], v[48:63]
    buffer_load_dwordx4 v10, s[16:19], s47 offen offset:1024 sc1 lds
    s_add_u32 s47, s47, 4096
    s_waitcnt vmcnt(8)
    s_barrier
    s_cmp_lg_u32 s3, 0
    s_cbranch_scc1 L3C_P3
    s_cmp_eq_u32 s68, s67
    s_cbranch_scc1 L3C_P3
    global_load_dword v25, v24, s[100:101] sc1
L3C_P3:
    s_waitcnt lgkmcnt(7)
    v_mfma_f32_32x32x16_bf16 v[32:47], v[92:95], v[88:91], v[32:47]
    ds_read_b128 v[64:67], v16 offset:0
    ds_read_b64_tr_b16 v[68:69], v19 offset:0
    ds_read_b64_tr_b16 v[70:71], v19 offset:2048
    ds_read_b64_tr_b16 v[72:73], v22 offset:0
    ds_read_b64_tr_b16 v[74:75], v22 offset:2048
    s_waitcnt lgkmcnt(10)
    v_mfma_f32_32x32x16_bf16 v[48:63], v[96:99], v[88:91], v[48:63]
    s_add_u32 m0, s50, 65536
    s_nop 0
    buffer_load_dwordx4 v11, s[20:23], s48 offen lds
    s_waitcnt lgkmcnt(7)
    v_mfma_f32_32x32x16_bf16 v[32:47], v[104:107], v[100:103], v[32:47]
    ds_read_b128 v[76:79], v16 offset:1024
    ds_read_b64_tr_b16 v[80:81], v19 offset:4096
    ds_read_b64_tr_b16 v[82:83], v19 offset:6144
    ds_read_b64_tr_b16 v[84:85], v22 offset:4096
    ds_read_b64_tr_b16 v[86:87], v22 offset:6144
    s_waitcnt lgkmcnt(10)
    v_mfma_f32_32x32x16_bf16 v[48:63], v[108:111], v[100:103], v[48:63]
    buffer_load_dwordx4 v12, s[20:23], s48 offen offset:1024 lds
    s_add_u32 s48, s48, 65536
    s_waitcnt lgkmcnt(7)
    v_mfma_f32_32x32x16_bf16 v[32:47], v[68:71], v[64:67], v[32:47]
    ds_read_b128 v[88:91], v16 offset:2048
    ds_read_b64_tr_b16 v[92:93], v19 offset:8192
    ds_read_b64_tr_b16 v[94:95], v19 offset:10240
    ds_read_b64_tr_b16 v[96:97], v22 offset:8192
    ds_read_b64_tr_b16 v[98:99], v22 offset:10240
    s_waitcnt lgkmcnt(10)
    v_mfma_f32_32x32x16_bf16 v[48:63], v[72:75], v[64:67], v[48:63]
    s_add_u32 m0, s49, 65536
    s_nop 0
    buffer_load_dwordx4 v10, s[16:19], s47 offen sc1 lds
    s_waitcnt lgkmcnt(7)
    v_mfma_f32_32x32x16_bf16 v[32:47], v[80:83], v[76:79], v[32:47]
    ds_read_b128 v[100:103], v16 offset:3072
    ds_read_b64_tr_b16 v[104:105], v19 offset:12288
    ds_read_b64_tr_b16 v[106:107], v19 offset:14336
    ds_read_b64_tr_b16 v[108:109], v22 offset:12288
    ds_read_b64_tr_b16 v[110:111], v22 offset:14336
    s_waitcnt lgkmcnt(10)
    v_mfma_f32_32x32x16_bf16 v[48:63], v[84:87], v[76:79], v[48:63]
    buffer_load_dwordx4 v10, s[16:19], s47 offen offset:1024 sc1 lds
    s_add_u32 s47, s47, 4096
    s_waitcnt vmcnt(8)
    s_cmp_lg_u32 s3, 0
    s_cbranch_scc1 L3C_K4
    s_cmp_eq_u32 s68, s67
    s_cbranch_scc1 L3C_K4
    s_waitcnt vmcnt(4)
    v_cmp_eq_u32 vcc, s77, v25
    s_lshr_b32 s68, vcc_lo, s64
    s_and_b32 s68, s68, s65
    s_or_b32 s68, s68, s66
    s_bfe_u32 s44, s71, 0x80000
    s_bitcmp1_b32 s68, s44
    s_cbranch_scc0 L3C_S4
L3C_K4:
    s_barrier
    s_waitcnt lgkmcnt(7)
    v_mfma_f32_32x32x16_bf16 v[32:47], v[92:95], v[88:91], v[32:47]
    ds_read_b128 v[64:67], v14 offset:0
    ds_read_b64_tr_b16 v[68:69], v17 offset:0
    ds_read_b64_tr_b16 v[70:71], v17 offset:2048
    ds_read_b64_tr_b16 v[72:73], v20 offset:0
    ds_read_b64_tr_b16 v[74:75], v20 offset:2048
    s_waitcnt lgkmcnt(10)
    v_mfma_f32_32x32x16_bf16 v[48:63], v[96:99], v[88:91], v[48:63]
    s_bfe_u32 s44, s71, 0x80000
    s_lshl_b32 s48, s44, 17
    s_add_u32 s48, s48, s61
    s_lshl_b32 s47, s44, 13
    s_add_u32 s47, s47, s62
    s_cmp_eq_u32 s44, 15
    s_cselect_b32 s48, 0x7f000000, s48
    s_cselect_b32 s47, 0x7f000000, s47
    s_add_u32 m0, s50, 98304
    s_nop 0
    buffer_load_dwordx4 v11, s[20:23], s48 offen lds
    s_waitcnt lgkmcnt(7)
    v_mfma_f32_32x32x16_bf16 v[32:47], v[104:107], v[100:103], v[32:47]
    ds_read_b128 v[76:79], v14 offset:1024
    ds_read_b64_tr_b16 v[80:81], v17 offset:4096
    ds_read_b64_tr_b16 v[82:83], v17 offset:6144
    ds_read_b64_tr_b16 v[84:85], v20 offset:4096
    ds_read_b64_tr_b16 v[86:87], v20 offset:6144
    s_waitcnt lgkmcnt(10)
    v_mfma_f32_32x32x16_bf16 v[48:63], v[108:111], v[100:103], v[48:63]
    buffer_load_dwordx4 v12, s[20:23], s48 offen offset:1024 lds
    s_add_u32 s48, s48, 65536
    s_waitcnt lgkmcnt(7)
    v_mfma_f32_32x32x16_bf16 v[32:47], v[68:71], v[64:67], v[32:47]
    ds_read_b128 v[88:91], v14 offset:2048
    ds_read_b64_tr_b16 v[92:93], v17 offset:8192
    ds_read_b64_tr_b16 v[94:95], v17 offset:10240
    ds_read_b64_tr_b16 v[96:97], v20 offset:8192
    ds_read_b64_tr_b16 v[98:99], v20 offset:10240
    s_waitcnt lgkmcnt(10)
    v_mfma_f32_32x32x16_bf16 v[48:63], v[72:75], v[64:67], v[48:63]
    s_add_u32 m0, s49, 98304
    s_nop 0
    buffer_load_dwordx4 v10, s[16:19], s47 offen sc1 lds
    s_waitcnt lgkmcnt(7)
    v_mfma_f32_32x32x16_bf16 v[32:47], v[80:83], v[76:79], v[32:47]
    ds_read_b128 v[100:103], v14 offset:3072
    ds_read_b64_tr_b16 v[104:105], v17 offset:12288
    ds_read_b64_tr_b16 v[106:107], v17 offset:14336
    ds_read_b64_tr_b16 v[108:109], v20 offset:12288
    ds_read_b64_tr_b16 v[110:111], v20 offset:14336
    s_waitcnt lgkmcnt(10)
    v_mfma_f32_32x32x16_bf16 v[48:63], v[84:87], v[76:79], v[48:63]
    buffer_load_dwordx4 v10, s[16:19], s47 offen offset:1024 sc1 lds
    s_add_u32 s47, s47, 4096
    s_waitcnt vmcnt(8)
    s_barrier
    s_cmp_lg_u32 s3, 0
    s_cbranch_scc1 L3C_P4
    s_cmp_eq_u32 s68, s67
    s_cbranch_scc1 L3C_P4
    global_load_dword v25, v24, s[100:101] sc1
L3C_P4:
    s_waitcnt lgkmcnt(7)
    v_mfma_f32_32x32x16_bf16 v[32:47], v[92:95], v[88:91], v[32:47]
    ds_read_b128 v[64:67], v14 offset:32768
    ds_read_b64_tr_b16 v[68:69], v17 offset:32768
    ds_read_b64_tr_b16 v[70:71], v17 offset:34816
    ds_read_b64_tr_b16 v[72:73], v20 offset:32768
    ds_read_b64_tr_b16 v[74:75], v20 offset:34816
    s_waitcnt lgkmcnt(10)
    v_mfma_f32_32x32x16_bf16 v[48:63], v[96:99], v[88:91], v[48:63]
    s_add_u32 m0, s50, 131072
    s_nop 0
    buffer_load_dwordx4 v11, s[20:23], s48 offen lds
    s_waitcnt lgkmcnt(7)
    v_mfma_f32_32x32x16_bf16 v[32:47], v[104:107], v[100:103], v[32:47]
    ds_read_b128 v[76:79], v14 offset:33792
    ds_read_b64_tr_b16 v[80:81], v17 offset:36864
    ds_read_b64_tr_b16 v[82:83], v17 offset:38912
    ds_read_b64_tr_b16 v[84:85], v20 offset:36864
    ds_read_b64_tr_b16 v[86:87], v20 offset:38912
    s_waitcnt lgkmcnt(10)
    v_mfma_f32_32x32x16_bf16 v[48:63], v[108:111], v[100:103], v[48:63]
    buffer_load_dwordx4 v12, s[20:23], s48 offen offset:1024 lds
    s_add_u32 s48, s48, 65536
    s_waitcnt lgkmcnt(7)
    v_mfma_f32_32x32x16_bf16 v[32:47], v[68:71], v[64:67], v[32:47]
    ds_read_b128 v[88:91], v14 offset:34816
    ds_read_b64_tr_b16 v[92:93], v17 offset:40960
    ds_read_b64_tr_b16 v[94:95], v17 offset:43008
    ds_read_b64_tr_b16 v[96:97], v20 offset:40960
    ds_read_b64_tr_b16 v[98:99], v20 offset:43008
    s_waitcnt lgkmcnt(10)
    v_mfma_f32_32x32x16_bf16 v[48:63], v[72:75], v[64:67], v[48:63]
    s_add_u32 m0, s49, 131072
    s_nop 0
    buffer_load_dwordx4 v10, s[16:19], s47 offen sc1 lds
    s_waitcnt lgkmcnt(7)
    v_mfma_f32_32x32x16_bf16 v[32:47], v[80:83], v[76:79], v[32:47]
    ds_read_b128 v[100:103], v14 offset:35840
    ds_read_b64_tr_b16 v[104:105], v17 offset:45056
    ds_read_b64_tr_b16 v[106:107], v17 offset:47104
    ds_read_b64_tr_b16 v[108:109], v20 offset:45056
    ds_read_b64_tr_b16 v[110:111], v20 offset:47104
    s_waitcnt lgkmcnt(10)
    v_mfma_f32_32x32x16_bf16 v[48:63], v[84:87], v[76:79], v[48:63]
    buffer_load_dwordx4 v10, s[16:19], s47 offen offset:1024 sc1 lds
    s_add_u32 s47, s47, 4096
    s_waitcnt vmcnt(8)
    s_cmp_lg_u32 s3, 0
    s_cbranch_scc1 L3C_K5
    s_cmp_eq_u32 s68, s67
    s_cbranch_scc1 L3C_K5
    s_waitcnt vmcnt(4)
    v_cmp_eq_u32 vcc, s77, v25
    s_lshr_b32 s68, vcc_lo, s64
    s_and_b32 s68, s68, s65
    s_or_b32 s68, s68, s66
    s_bfe_u32 s44, s71, 0x80008
    s_bitcmp1_b32 s68, s44
    s_cbranch_scc0 L3C_S5
L3C_K5:
    s_barrier
    s_waitcnt lgkmcnt(7)
    v_mfma_f32_32x32x16_bf16 v[32:47], v[92:95], v[88:91], v[32:47]
    ds_read_b128 v[64:67], v15 offset:0
    ds_read_b64_tr_b16 v[68:69], v18 offset:0
    ds_read_b64_tr_b16 v[70:71], v18 offset:2048
    ds_read_b64_tr_b16 v[72:73], v21 offset:0
    ds_read_b64_tr_b16 v[74:75], v21 offset:2048
    s_waitcnt lgkmcnt(10)
    v_mfma_f32_32x32x16_bf16 v[48:63], v[96:99], v[88:91], v[48:63]
    s_bfe_u32 s44, s71, 0x80008
    s_lshl_b32 s48, s44, 17
    s_add_u32 s48, s48, s61
    s_lshl_b32 s47, s44, 13
    s_add_u32 s47, s47, s62
    s_cmp_eq_u32 s44, 15
    s_cselect_b32 s48, 0x7f000000, s48
    s_cselect_b32 s47, 0x7f000000, s47
    s_add_u32 m0, s50, 0
    s_nop 0
    buffer_load_dwordx4 v11, s[20:23], s48 offen lds
    s_waitcnt lgkmcnt(7)
    v_mfma_f32_32x32x16_bf16 v[32:47], v[104:107], v[100:103], v[32:47]
    ds_read_b128 v[76:79], v15 offset:1024
    ds_read_b64_tr_b16 v[80:81], v18 offset:4096
    ds_read_b64_tr_b16 v[82:83], v18 offset:6144
    ds_read_b64_tr_b16 v[84:85], v21 offset:4096
    ds_read_b64_tr_b16 v[86:87], v21 offset:6144
    s_waitcnt lgkmcnt(10)
    v_mfma_f32_32x32x16_bf16 v[48:63], v[108:111], v[100:103], v[48:63]
    buffer_load_dwordx4 v12, s[20:23], s48 offen offset:1024 lds
    s_add_u32 s48, s48, 65536
    s_waitcnt lgkmcnt(7)
    v_mfma_f32_32x32x16_bf16 v[32:47], v[68:71], v[64:67], v[32:47]
    ds_read_b128 v[88:91], v15 offset:2048
    ds_read_b64_tr_b16 v[92:93], v18 offset:8192
    ds_read_b64_tr_b16 v[94:95], v18 offset:10240
    ds_read_b64_tr_b16 v[96:97], v21 offset:8192
    ds_read_b64_tr_b16 v[98:99], v21 offset:10240
    s_waitcnt lgkmcnt(10)
    v_mfma_f32_32x32x16_bf16 v[48:63], v[72:75], v[64:67], v[48:63]
    s_add_u32 m0, s49, 0
    s_nop 0
    buffer_load_dwordx4 v10, s[16:19], s47 offen sc1 lds
    s_waitcnt lgkmcnt(7)
    v_mfma_f32_32x32x16_bf16 v[32:47], v[80:83], v[76:79], v[32:47]
    ds_read_b128 v[100:103], v15 offset:3072
    ds_read_b64_tr_b16 v[104:105], v18 offset:12288
    ds_read_b64_tr_b16 v[106:107], v18 offset:14336
    ds_read_b64_tr_b16 v[108:109], v21 offset:12288
    ds_read_b64_tr_b16 v[110:111], v21 offset:14336
    s_waitcnt lgkmcnt(10)
    v_mfma_f32_32x32x16_bf16 v[48:63], v[84:87], v[76:79], v[48:63]
    buffer_load_dwordx4 v10, s[16:19], s47 offen offset:1024 sc1 lds
    s_add_u32 s47, s47, 4096
    s_waitcnt vmcnt(8)
    s_barrier
    s_cmp_lg_u32 s3, 0
    s_cbranch_scc1 L3C_P5
    s_cmp_eq_u32 s68, s67
    s_cbranch_scc1 L3C_P5
    global_load_dword v25, v24, s[100:101] sc1
L3C_P5:
    s_waitcnt lgkmcnt(7)
    v_mfma_f32_32x32x16_bf16 v[32:47], v[92:95], v[88:91], v[32:47]
    ds_read_b128 v[64:67], v15 offset:32768
    ds_read_b64_tr_b16 v[68:69], v18 offset:32768
    ds_read_b64_tr_b16 v[70:71], v18 offset:34816
    ds_read_b64_tr_b16 v[72:73], v21 offset:32768
    ds_read_b64_tr_b16 v[74:75], v21 offset:34816
    s_waitcnt lgkmcnt(10)
    v_mfma_f32_32x32x16_bf16 v[48:63], v[96:99], v[88:91], v[48:63]
    s_add_u32 m0, s50, 32768
    s_nop 0
    buffer_load_dwordx4 v11, s[20:23], s48 offen lds
    s_waitcnt lgkmcnt(7)
    v_mfma_f32_32x32x16_bf16 v[32:47], v[104:107], v[100:103], v[32:47]
    ds_read_b128 v[76:79], v15 offset:33792
    ds_read_b64_tr_b16 v[80:81], v18 offset:36864
    ds_read_b64_tr_b16 v[82:83], v18 offset:38912
    ds_read_b64_tr_b16 v[84:85], v21 offset:36864
    ds_read_b64_tr_b16 v[86:87], v21 offset:38912
    s_waitcnt lgkmcnt(10)
    v_mfma_f32_32x32x16_bf16 v[48:63], v[108:111], v[100:103], v[48:63]
    buffer_load_dwordx4 v12, s[20:23], s48 offen offset:1024 lds
    s_add_u32 s48, s48, 65536
    s_waitcnt lgkmcnt(7)
    v_mfma_f32_32x32x16_bf16 v[32:47], v[68:71], v[64:67], v[32:47]
    ds_read_b128 v[88:91], v15 offset:34816
    ds_read_b64_tr_b16 v[92:93], v18 offset:40960
    ds_read_b64_tr_b16 v[94:95], v18 offset:43008
    ds_read_b64_tr_b16 v[96:97], v21 offset:40960
    ds_read_b64_tr_b16 v[98:99], v21 offset:43008
    s_waitcnt lgkmcnt(10)
    v_mfma_f32_32x32x16_bf16 v[48:63], v[72:75], v[64:67], v[48:63]
    s_add_u32 m0, s49, 32768
    s_nop 0
    buffer_load_dwordx4 v10, s[16:19], s47 offen sc1 lds
    s_waitcnt lgkmcnt(7)
    v_mfma_f32_32x32x16_bf16 v[32:47], v[80:83], v[76:79], v[32:47]
    ds_read_b128 v[100:103], v15 offset:35840
    ds_read_b64_tr_b16 v[104:105], v18 offset:45056
    ds_read_b64_tr_b16 v[106:107], v18 offset:47104
    ds_read_b64_tr_b16 v[108:109], v21 offset:45056
    ds_read_b64_tr_b16 v[110:111], v21 offset:47104
    s_waitcnt lgkmcnt(10)
    v_mfma_f32_32x32x16_bf16 v[48:63], v[84:87], v[76:79], v[48:63]
    buffer_load_dwordx4 v10, s[16:19], s47 offen offset:1024 sc1 lds
    s_add_u32 s47, s47, 4096
    s_waitcnt vmcnt(8)
    s_cmp_lg_u32 s3, 0
    s_cbranch_scc1 L3C_K6
    s_cmp_eq_u32 s68, s67
    s_cbranch_scc1 L3C_K6
    s_waitcnt vmcnt(4)
    v_cmp_eq_u32 vcc, s77, v25
    s_lshr_b32 s68, vcc_lo, s64
    s_and_b32 s68, s68, s65
    s_or_b32 s68, s68, s66
    s_bfe_u32 s44, s71, 0x80010
    s_bitcmp1_b32 s68, s44
    s_cbranch_scc0 L3C_S6
L3C_K6:
    s_barrier
    s_waitcnt lgkmcnt(7)
    v_mfma_f32_32x32x16_bf16 v[32:47], v[92:95], v[88:91], v[32:47]
    ds_read_b128 v[64:67], v16 offset:0
    ds_read_b64_tr_b16 v[68:69], v19 offset:0
    ds_read_b64_tr_b16 v[70:71], v19 offset:2048
    ds_read_b64_tr_b16 v[72:73], v22 offset:0
    ds_read_b64_tr_b16 v[74:75], v22 offset:2048
    s_waitcnt lgkmcnt(10)
    v_mfma_f32_32x32x16_bf16 v[48:63], v[96:99], v[88:91], v[48:63]
    s_bfe_u32 s44, s71, 0x80010
    s_lshl_b32 s48, s44, 17
    s_add_u32 s48, s48, s61
    s_lshl_b32 s47, s44, 13
    s_add_u32 s47, s47, s62
    s_cmp_eq_u32 s44, 15
    s_cselect_b32 s48, 0x7f000000, s48
    s_cselect_b32 s47, 0x7f000000, s47
    s_add_u32 m0, s50, 65536
    s_nop 0
    buffer_load_dwordx4 v11, s[20:23], s48 offen lds
    s_waitcnt lgkmcnt(7)
    v_mfma_f32_32x32x16_bf16 v[32:47], v[104:107], v[100:103], v[32:47]
    ds_read_b128 v[76:79], v16 offset:1024
    ds_read_b64_tr_b16 v[80:81], v19 offset:4096
    ds_read_b64_tr_b16 v[82:83], v19 offset:6144
    ds_read_b64_tr_b16 v[84:85], v22 offset:4096
    ds_read_b64_tr_b16 v[86:87], v22 offset:6144
    s_waitcnt lgkmcnt(10)
    v_mfma_f32_32x32x16_bf16 v[48:63], v[108:111], v[100:103], v[48:63]
    buffer_load_dwordx4 v12, s[20:23], s48 offen offset:1024 lds
    s_add_u32 s48, s48, 65536
    s_waitcnt lgkmcnt(7)
    v_mfma_f32_32x32x16_bf16 v[32:47], v[68:71], v[64:67], v[32:47]
    ds_read_b128 v[88:91], v16 offset:2048
    ds_read_b64_tr_b16 v[92:93], v19 offset:8192
    ds_read_b64_tr_b16 v[94:95], v19 offset:10240
    ds_read_b64_tr_b16 v[96:97], v22 offset:8192
    ds_read_b64_tr_b16 v[98:99], v22 offset:10240
    s_waitcnt lgkmcnt(10)
    v_mfma_f32_32x32x16_bf16 v[48:63], v[72:75], v[64:67], v[48:63]
    s_add_u32 m0, s49, 65536
    s_nop 0
    buffer_load_dwordx4 v10, s[16:19], s47 offen sc1 lds
    s_waitcnt lgkmcnt(7)
    v_mfma_f32_32x32x16_bf16 v[32:47], v[80:83], v[76:79], v[32:47]
    ds_read_b128 v[100:103], v16 offset:3072
    ds_read_b64_tr_b16 v[104:105], v19 offset:12288
    ds_read_b64_tr_b16 v[106:107], v19 offset:14336
    ds_read_b64_tr_b16 v[108:109], v22 offset:12288
    ds_read_b64_tr_b16 v[110:111], v22 offset:14336
    s_waitcnt lgkmcnt(10)
    v_mfma_f32_32x32x16_bf16 v[48:63], v[84:87], v[76:79], v[48:63]
    buffer_load_dwordx4 v10, s[16:19], s47 offen offset:1024 sc1 lds
    s_add_u32 s47, s47, 4096
    s_waitcnt vmcnt(8)
    s_barrier
    s_cmp_lg_u32 s3, 0
    s_cbranch_scc1 L3C_P6
    s_cmp_eq_u32 s68, s67
    s_cbranch_scc1 L3C_P6
    global_load_dword v25, v24, s[100:101] sc1
L3C_P6:
    s_waitcnt lgkmcnt(7)
    v_mfma_f32_32x32x16_bf16 v[32:47], v[92:95], v[88:91], v[32:47]
    ds_read_b128 v[64:67], v14 offset:0
    ds_read_b64_tr_b16 v[68:69], v17 offset:0
    ds_read_b64_tr_b16 v[70:71], v17 offset:2048
    ds_read_b64_tr_b16 v[72:73], v20 offset:0
    ds_read_b64_tr_b16 v[74:75], v20 offset:2048
    s_waitcnt lgkmcnt(10)
    v_mfma_f32_32x32x16_bf16 v[48:63], v[96:99], v[88:91], v[48:63]
    s_add_u32 m0, s50, 98304
    s_nop 0
    buffer_load_dwordx4 v11, s[20:23], s48 offen lds
    s_waitcnt lgkmcnt(7)
    v_mfma_f32_32x32x16_bf16 v[32:47], v[104:107], v[100:103], v[32:47]
    ds_read_b128 v[76:79], v14 offset:1024
    ds_read_b64_tr_b16 v[80:81], v17 offset:4096
    ds_read_b64_tr_b16 v[82:83], v17 offset:6144
    ds_read_b64_tr_b16 v[84:85], v20 offset:4096
    ds_read_b64_tr_b16 v[86:87], v20 offset:6144
    s_waitcnt lgkmcnt(10)
    v_mfma_f32_32x32x16_bf16 v[48:63], v[108:111], v[100:103], v[48:63]
    buffer_load_dwordx4 v12, s[20:23], s48 offen offset:1024 lds
    s_add_u32 s48, s48, 65536
    s_waitcnt lgkmcnt(7)
    v_mfma_f32_32x32x16_bf16 v[32:47], v[68:71], v[64:67], v[32:47]
    ds_read_b128 v[88:91], v14 offset:2048
    ds_read_b64_tr_b16 v[92:93], v17 offset:8192
    ds_read_b64_tr_b16 v[94:95], v17 offset:10240
    ds_read_b64_tr_b16 v[96:97], v20 offset:8192
    ds_read_b64_tr_b16 v[98:99], v20 offset:10240
    s_waitcnt lgkmcnt(10)
    v_mfma_f32_32x32x16_bf16 v[48:63], v[72:75], v[64:67], v[48:63]
    s_add_u32 m0, s49, 98304
    s_nop 0
    buffer_load_dwordx4 v10, s[16:19], s47 offen sc1 lds
    s_waitcnt lgkmcnt(7)
    v_mfma_f32_32x32x16_bf16 v[32:47], v[80:83], v[76:79], v[32:47]
    ds_read_b128 v[100:103], v14 offset:3072
    ds_read_b64_tr_b16 v[104:105], v17 offset:12288
    ds_read_b64_tr_b16 v[106:107], v17 offset:14336
    ds_read_b64_tr_b16 v[108:109], v20 offset:12288
    ds_read_b64_tr_b16 v[110:111], v20 offset:14336
    s_waitcnt lgkmcnt(10)
    v_mfma_f32_32x32x16_bf16 v[48:63], v[84:87], v[76:79], v[48:63]
    buffer_load_dwordx4 v10, s[16:19], s47 offen offset:1024 sc1 lds
    s_add_u32 s47, s47, 4096
    s_waitcnt vmcnt(8)
    s_cmp_lg_u32 s3, 0
    s_cbranch_scc1 L3C_K7
    s_cmp_eq_u32 s68, s67
    s_cbranch_scc1 L3C_K7
    s_waitcnt vmcnt(4)
    v_cmp_eq_u32 vcc, s77, v25
    s_lshr_b32 s68, vcc_lo, s64
    s_and_b32 s68, s68, s65
    s_or_b32 s68, s68, s66
    s_bfe_u32 s44, s71, 0x80018
    s_bitcmp1_b32 s68, s44
    s_cbranch_scc0 L3C_S7
L3C_K7:
    s_barrier
    s_waitcnt lgkmcnt(7)
    v_mfma_f32_32x32x16_bf16 v[32:47], v[92:95], v[88:91], v[32:47]
    ds_read_b128 v[64:67], v14 offset:32768
    ds_read_b64_tr_b16 v[68:69], v17 offset:32768
    ds_read_b64_tr_b16 v[70:71], v17 offset:34816
    ds_read_b64_tr_b16 v[72:73], v20 offset:32768
    ds_read_b64_tr_b16 v[74:75], v20 offset:34816
    s_waitcnt lgkmcnt(10)
    v_mfma_f32_32x32x16_bf16 v[48:63], v[96:99], v[88:91], v[48:63]
    s_bfe_u32 s44, s71, 0x80018
    s_lshl_b32 s48, s44, 17
    s_add_u32 s48, s48, s61
    s_lshl_b32 s47, s44, 13
    s_add_u32 s47, s47, s62
    s_cmp_eq_u32 s44, 15
    s_cselect_b32 s48, 0x7f000000, s48
    s_cselect_b32 s47, 0x7f000000, s47
    s_add_u32 m0, s50, 131072
    s_nop 0
    buffer_load_dwordx4 v11, s[20:23], s48 offen lds
    s_waitcnt lgkmcnt(7)
    v_mfma_f32_32x32x16_bf16 v[32:47], v[104:107], v[100:103], v[32:47]
    ds_read_b128 v[76:79], v14 offset:33792
    ds_read_b64_tr_b16 v[80:81], v17 offset:36864
    ds_read_b64_tr_b16 v[82:83], v17 offset:38912
    ds_read_b64_tr_b16 v[84:85], v20 offset:36864
    ds_read_b64_tr_b16 v[86:87], v20 offset:38912
    s_waitcnt lgkmcnt(10)
    v_mfma_f32_32x32x16_bf16 v[48:63], v[108:111], v[100:103], v[48:63]
    buffer_load_dwordx4 v12, s[20:23], s48 offen offset:1024 lds
    s_add_u32 s48, s48, 65536
    s_waitcnt lgkmcnt(7)
    v_mfma_f32_32x32x16_bf16 v[32:47], v[68:71], v[64:67], v[32:47]
    ds_read_b128 v[88:91], v14 offset:34816
    ds_read_b64_tr_b16 v[92:93], v17 offset:40960
    ds_read_b64_tr_b16 v[94:95], v17 offset:43008
    ds_read_b64_tr_b16 v[96:97], v20 offset:40960
    ds_read_b64_tr_b16 v[98:99], v20 offset:43008
    s_waitcnt lgkmcnt(10)
    v_mfma_f32_32x32x16_bf16 v[48:63], v[72:75], v[64:67], v[48:63]
    s_add_u32 m0, s49, 131072
    s_nop 0
    buffer_load_dwordx4 v10, s[16:19], s47 offen sc1 lds
    s_waitcnt lgkmcnt(7)
    v_mfma_f32_32x32x16_bf16 v[32:47], v[80:83], v[76:79], v[32:47]
    ds_read_b128 v[100:103], v14 offset:35840
    ds_read_b64_tr_b16 v[104:105], v17 offset:45056
    ds_read_b64_tr_b16 v[106:107], v17 offset:47104
    ds_read_b64_tr_b16 v[108:109], v20 offset:45056
    ds_read_b64_tr_b16 v[110:111], v20 offset:47104
    s_waitcnt lgkmcnt(10)
    v_mfma_f32_32x32x16_bf16 v[48:63], v[84:87], v[76:79], v[48:63]
    buffer_load_dwordx4 v10, s[16:19], s47 offen offset:1024 sc1 lds
    s_add_u32 s47, s47, 4096
    s_waitcnt vmcnt(8)
    s_barrier
    s_cmp_lg_u32 s3, 0
    s_cbranch_scc1 L3C_P7
    s_cmp_eq_u32 s68, s67
    s_cbranch_scc1 L3C_P7
    global_load_dword v25, v24, s[100:101] sc1
L3C_P7:
    s_waitcnt lgkmcnt(7)
    v_mfma_f32_32x32x16_bf16 v[32:47], v[92:95], v[88:91], v[32:47]
    ds_read_b128 v[64:67], v15 offset:0
    ds_read_b64_tr_b16 v[68:69], v18 offset:0
    ds_read_b64_tr_b16 v[70:71], v18 offset:2048
    ds_read_b64_tr_b16 v[72:73], v21 offset:0
    ds_read_b64_tr_b16 v[74:75], v21 offset:2048
    s_waitcnt lgkmcnt(10)
    v_mfma_f32_32x32x16_bf16 v[48:63], v[96:99], v[88:91], v[48:63]
    s_add_u32 m0, s50, 0
    s_nop 0
    buffer_load_dwordx4 v11, s[20:23], s48 offen lds
    s_waitcnt lgkmcnt(7)
    v_mfma_f32_32x32x16_bf16 v[32:47], v[104:107], v[100:103], v[32:47]
    ds_read_b128 v[76:79], v15 offset:1024
    ds_read_b64_tr_b16 v[80:81], v18 offset:4096
    ds_read_b64_tr_b16 v[82:83], v18 offset:6144
    ds_read_b64_tr_b16 v[84:85], v21 offset:4096
    ds_read_b64_tr_b16 v[86:87], v21 offset:6144
    s_waitcnt lgkmcnt(10)
    v_mfma_f32_32x32x16_bf16 v[48:63], v[108:111], v[100:103], v[48:63]
    buffer_load_dwordx4 v12, s[20:23], s48 offen offset:1024 lds
    s_add_u32 s48, s48, 65536
    s_waitcnt lgkmcnt(7)
    v_mfma_f32_32x32x16_bf16 v[32:47], v[68:71], v[64:67], v[32:47]
    ds_read_b128 v[88:91], v15 offset:2048
    ds_read_b64_tr_b16 v[92:93], v18 offset:8192
    ds_read_b64_tr_b16 v[94:95], v18 offset:10240
    ds_read_b64_tr_b16 v[96:97], v21 offset:8192
    ds_read_b64_tr_b16 v[98:99], v21 offset:10240
    s_waitcnt lgkmcnt(10)
    v_mfma_f32_32x32x16_bf16 v[48:63], v[72:75], v[64:67], v[48:63]
    s_add_u32 m0, s49, 0
    s_nop 0
    buffer_load_dwordx4 v10, s[16:19], s47 offen sc1 lds
    s_waitcnt lgkmcnt(7)
    v_mfma_f32_32x32x16_bf16 v[32:47], v[80:83], v[76:79], v[32:47]
    ds_read_b128 v[100:103], v15 offset:3072
    ds_read_b64_tr_b16 v[104:105], v18 offset:12288
    ds_read_b64_tr_b16 v[106:107], v18 offset:14336
    ds_read_b64_tr_b16 v[108:109], v21 offset:12288
    ds_read_b64_tr_b16 v[110:111], v21 offset:14336
    s_waitcnt lgkmcnt(10)
    v_mfma_f32_32x32x16_bf16 v[48:63], v[84:87], v[76:79], v[48:63]
    buffer_load_dwordx4 v10, s[16:19], s47 offen offset:1024 sc1 lds
    s_add_u32 s47, s47, 4096
    s_waitcnt vmcnt(8)
    s_cmp_lg_u32 s3, 0
    s_cbranch_scc1 L3C_K8
    s_cmp_eq_u32 s68, s67
    s_cbranch_scc1 L3C_K8
    s_waitcnt vmcnt(4)
    v_cmp_eq_u32 vcc, s77, v25
    s_lshr_b32 s68, vcc_lo, s64
    s_and_b32 s68, s68, s65
    s_or_b32 s68, s68, s66
    s_bfe_u32 s44, s72, 0x80000
    s_bitcmp1_b32 s68, s44
    s_cbranch_scc0 L3C_S8
L3C_K8:
    s_barrier
    s_waitcnt lgkmcnt(7)
    v_mfma_f32_32x32x16_bf16 v[32:47], v[92:95], v[88:91], v[32:47]
    ds_read_b128 v[64:67], v15 offset:32768
    ds_read_b64_tr_b16 v[68:69], v18 offset:32768
    ds_read_b64_tr_b16 v[70:71], v18 offset:34816
    ds_read_b64_tr_b16 v[72:73], v21 offset:32768
    ds_read_b64_tr_b16 v[74:75], v21 offset:34816
    s_waitcnt lgkmcnt(10)
    v_mfma_f32_32x32x16_bf16 v[48:63], v[96:99], v[88:91], v[48:63]
    s_bfe_u32 s44, s72, 0x80000
    s_lshl_b32 s48, s44, 17
    s_add_u32 s48, s48, s61
    s_lshl_b32 s47, s44, 13
    s_add_u32 s47, s47, s62
    s_cmp_eq_u32 s44, 15
    s_cselect_b32 s48, 0x7f000000, s48
    s_cselect_b32 s47, 0x7f000000, s47
    s_add_u32 m0, s50, 32768
    s_nop 0
    buffer_load_dwordx4 v11, s[20:23], s48 offen lds
    s_waitcnt lgkmcnt(7)
    v_mfma_f32_32x32x16_bf16 v[32:47], v[104:107], v[100:103], v[32:47]
    ds_read_b128 v[76:79], v15 offset:33792
    ds_read_b64_tr_b16 v[80:81], v18 offset:36864
    ds_read_b64_tr_b16 v[82:83], v18 offset:38912
    ds_read_b64_tr_b16 v[84:85], v21 offset:36864
    ds_read_b64_tr_b16 v[86:87], v21 offset:38912
    s_waitcnt lgkmcnt(10)
    v_mfma_f32_32x32x16_bf16 v[48:63], v[108:111], v[100:103], v[48:63]
    buffer_load_dwordx4 v12, s[20:23], s48 offen offset:1024 lds
    s_add_u32 s48, s48, 65536
    s_waitcnt lgkmcnt(7)
    v_mfma_f32_32x32x16_bf16 v[32:47], v[68:71], v[64:67], v[32:47]
    ds_read_b128 v[88:91], v15 offset:34816
    ds_read_b64_tr_b16 v[92:93], v18 offset:40960
    ds_read_b64_tr_b16 v[94:95], v18 offset:43008
    ds_read_b64_tr_b16 v[96:97], v21 offset:40960
    ds_read_b64_tr_b16 v[98:99], v21 offset:43008
    s_waitcnt lgkmcnt(10)
    v_mfma_f32_32x32x16_bf16 v[48:63], v[72:75], v[64:67], v[48:63]
    s_add_u32 m0, s49, 32768
    s_nop 0
    buffer_load_dwordx4 v10, s[16:19], s47 offen sc1 lds
    s_waitcnt lgkmcnt(7)
    v_mfma_f32_32x32x16_bf16 v[32:47], v[80:83], v[76:79], v[32:47]
    ds_read_b128 v[100:103], v15 offset:35840
    ds_read_b64_tr_b16 v[104:105], v18 offset:45056
    ds_read_b64_tr_b16 v[106:107], v18 offset:47104
    ds_read_b64_tr_b16 v[108:109], v21 offset:45056
    ds_read_b64_tr_b16 v[110:111], v21 offset:47104
    s_waitcnt lgkmcnt(10)
    v_mfma_f32_32x32x16_bf16 v[48:63], v[84:87], v[76:79], v[48:63]
    buffer_load_dwordx4 v10, s[16:19], s47 offen offset:1024 sc1 lds
    s_add_u32 s47, s47, 4096
    s_waitcnt vmcnt(8)
    s_barrier
    s_cmp_lg_u32 s3, 0
    s_cbranch_scc1 L3C_P8
    s_cmp_eq_u32 s68, s67
    s_cbranch_scc1 L3C_P8
    global_load_dword v25, v24, s[100:101] sc1
L3C_P8:
    s_waitcnt lgkmcnt(7)
    v_mfma_f32_32x32x16_bf16 v[32:47], v[92:95], v[88:91], v[32:47]
    ds_read_b128 v[64:67], v16 offset:0
    ds_read_b64_tr_b16 v[68:69], v19 offset:0
    ds_read_b64_tr_b16 v[70:71], v19 offset:2048
    ds_read_b64_tr_b16 v[72:73], v22 offset:0
    ds_read_b64_tr_b16 v[74:75], v22 offset:2048
    s_waitcnt lgkmcnt(10)
    v_mfma_f32_32x32x16_bf16 v[48:63], v[96:99], v[88:91], v[48:63]
    s_add_u32 m0, s50, 65536
    s_nop 0
    buffer_load_dwordx4 v11, s[20:23], s48 offen lds
    s_waitcnt lgkmcnt(7)
    v_mfma_f32_32x32x16_bf16 v[32:47], v[104:107], v[100:103], v[32:47]
    ds_read_b128 v[76:79], v16 offset:1024
    ds_read_b64_tr_b16 v[80:81], v19 offset:4096
    ds_read_b64_tr_b16 v[82:83], v19 offset:6144
    ds_read_b64_tr_b16 v[84:85], v22 offset:4096
    ds_read_b64_tr_b16 v[86:87], v22 offset:6144
    s_waitcnt lgkmcnt(10)
    v_mfma_f32_32x32x16_bf16 v[48:63], v[108:111], v[100:103], v[48:63]
    buffer_load_dwordx4 v12, s[20:23], s48 offen offset:1024 lds
    s_add_u32 s48, s48, 65536
    s_waitcnt lgkmcnt(7)
    v_mfma_f32_32x32x16_bf16 v[32:47], v[68:71], v[64:67], v[32:47]
    ds_read_b128 v[88:91], v16 offset:2048
    ds_read_b64_tr_b16 v[92:93], v19 offset:8192
    ds_read_b64_tr_b16 v[94:95], v19 offset:10240
    ds_read_b64_tr_b16 v[96:97], v22 offset:8192
    ds_read_b64_tr_b16 v[98:99], v22 offset:10240
    s_waitcnt lgkmcnt(10)
    v_mfma_f32_32x32x16_bf16 v[48:63], v[72:75], v[64:67], v[48:63]
    s_add_u32 m0, s49, 65536
    s_nop 0
    buffer_load_dwordx4 v10, s[16:19], s47 offen sc1 lds
    s_waitcnt lgkmcnt(7)
    v_mfma_f32_32x32x16_bf16 v[32:47], v[80:83], v[76:79], v[32:47]
    ds_read_b128 v[100:103], v16 offset:3072
    ds_read_b64_tr_b16 v[104:105], v19 offset:12288
    ds_read_b64_tr_b16 v[106:107], v19 offset:14336
    ds_read_b64_tr_b16 v[108:109], v22 offset:12288
    ds_read_b64_tr_b16 v[110:111], v22 offset:14336
    s_waitcnt lgkmcnt(10)
    v_mfma_f32_32x32x16_bf16 v[48:63], v[84:87], v[76:79], v[48:63]
    buffer_load_dwordx4 v10, s[16:19], s47 offen offset:1024 sc1 lds
    s_add_u32 s47, s47, 4096
    s_waitcnt vmcnt(8)
    s_cmp_lg_u32 s3, 0
    s_cbranch_scc1 L3C_K9
    s_cmp_eq_u32 s68, s67
    s_cbranch_scc1 L3C_K9
    s_waitcnt vmcnt(4)
    v_cmp_eq_u32 vcc, s77, v25
    s_lshr_b32 s68, vcc_lo, s64
    s_and_b32 s68, s68, s65
    s_or_b32 s68, s68, s66
    s_bfe_u32 s44, s72, 0x80008
    s_bitcmp1_b32 s68, s44
    s_cbranch_scc0 L3C_S9
L3C_K9:
    s_barrier
    s_waitcnt lgkmcnt(7)
    v_mfma_f32_32x32x16_bf16 v[32:47], v[92:95], v[88:91], v[32:47]
    ds_read_b128 v[64:67], v14 offset:0
    ds_read_b64_tr_b16 v[68:69], v17 offset:0
    ds_read_b64_tr_b16 v[70:71], v17 offset:2048
    ds_read_b64_tr_b16 v[72:73], v20 offset:0
    ds_read_b64_tr_b16 v[74:75], v20 offset:2048
    s_waitcnt lgkmcnt(10)
    v_mfma_f32_32x32x16_bf16 v[48:63], v[96:99], v[88:91], v[48:63]
    s_bfe_u32 s44, s72, 0x80008
    s_lshl_b32 s48, s44, 17
    s_add_u32 s48, s48, s61
    s_lshl_b32 s47, s44, 13
    s_add_u32 s47, s47, s62
    s_cmp_eq_u32 s44, 15
    s_cselect_b32 s48, 0x7f000000, s48
    s_cselect_b32 s47, 0x7f000000, s47
    s_add_u32 m0, s50, 98304
    s_nop 0
    buffer_load_dwordx4 v11, s[20:23], s48 offen lds
    s_waitcnt lgkmcnt(7)
    v_mfma_f32_32x32x16_bf16 v[32:47], v[104:107], v[100:103], v[32:47]
    ds_read_b128 v[76:79], v14 offset:1024
    ds_read_b64_tr_b16 v[80:81], v17 offset:4096
    ds_read_b64_tr_b16 v[82:83], v17 offset:6144
    ds_read_b64_tr_b16 v[84:85], v20 offset:4096
    ds_read_b64_tr_b16 v[86:87], v20 offset:6144
    s_waitcnt lgkmcnt(10)
    v_mfma_f32_32x32x16_bf16 v[48:63], v[108:111], v[100:103], v[48:63]
    buffer_load_dwordx4 v12, s[20:23], s48 offen offset:1024 lds
    s_add_u32 s48, s48, 65536
    s_waitcnt lgkmcnt(7)
    v_mfma_f32_32x32x16_bf16 v[32:47], v[68:71], v[64:67], v[32:47]
    ds_read_b128 v[88:91], v14 offset:2048
    ds_read_b64_tr_b16 v[92:93], v17 offset:8192
    ds_read_b64_tr_b16 v[94:95], v17 offset:10240
    ds_read_b64_tr_b16 v[96:97], v20 offset:8192
    ds_read_b64_tr_b16 v[98:99], v20 offset:10240
    s_waitcnt lgkmcnt(10)
    v_mfma_f32_32x32x16_bf16 v[48:63], v[72:75], v[64:67], v[48:63]
    s_add_u32 m0, s49, 98304
    s_nop 0
    buffer_load_dwordx4 v10, s[16:19], s47 offen sc1 lds
    s_waitcnt lgkmcnt(7)
    v_mfma_f32_32x32x16_bf16 v[32:47], v[80:83], v[76:79], v[32:47]
    ds_read_b128 v[100:103], v14 offset:3072
    ds_read_b64_tr_b16 v[104:105], v17 offset:12288
    ds_read_b64_tr_b16 v[106:107], v17 offset:14336
    ds_read_b64_tr_b16 v[108:109], v20 offset:12288
    ds_read_b64_tr_b16 v[110:111], v20 offset:14336
    s_waitcnt lgkmcnt(10)
    v_mfma_f32_32x32x16_bf16 v[48:63], v[84:87], v[76:79], v[48:63]
    buffer_load_dwordx4 v10, s[16:19], s47 offen offset:1024 sc1 lds
    s_add_u32 s47, s47, 4096
    s_waitcnt vmcnt(8)
    s_barrier
    s_cmp_lg_u32 s3, 0
    s_cbranch_scc1 L3C_P9
    s_cmp_eq_u32 s68, s67
    s_cbranch_scc1 L3C_P9
    global_load_dword v25, v24, s[100:101] sc1
L3C_P9:
    s_waitcnt lgkmcnt(7)
    v_mfma_f32_32x32x16_bf16 v[32:47], v[92:95], v[88:91], v[32:47]
    ds_read_b128 v[64:67], v14 offset:32768
    ds_read_b64_tr_b16 v[68:69], v17 offset:32768
    ds_read_b64_tr_b16 v[70:71], v17 offset:34816
    ds_read_b64_tr_b16 v[72:73], v20 offset:32768
    ds_read_b64_tr_b16 v[74:75], v20 offset:34816
    s_waitcnt lgkmcnt(10)
    v_mfma_f32_32x32x16_bf16 v[48:63], v[96:99], v[88:91], v[48:63]
    s_add_u32 m0, s50, 131072
    s_nop 0
    buffer_load_dwordx4 v11, s[20:23], s48 offen lds
    s_waitcnt lgkmcnt(7)
    v_mfma_f32_32x32x16_bf16 v[32:47], v[104:107], v[100:103], v[32:47]
    ds_read_b128 v[76:79], v14 offset:33792
    ds_read_b64_tr_b16 v[80:81], v17 offset:36864
    ds_read_b64_tr_b16 v[82:83], v17 offset:38912
    ds_read_b64_tr_b16 v[84:85], v20 offset:36864
    ds_read_b64_tr_b16 v[86:87], v20 offset:38912
    s_waitcnt lgkmcnt(10)
    v_mfma_f32_32x32x16_bf16 v[48:63], v[108:111], v[100:103], v[48:63]
    buffer_load_dwordx4 v12, s[20:23], s48 offen offset:1024 lds
    s_add_u32 s48, s48, 65536
    s_waitcnt lgkmcnt(7)
    v_mfma_f32_32x32x16_bf16 v[32:47], v[68:71], v[64:67], v[32:47]
    ds_read_b128 v[88:91], v14 offset:34816
    ds_read_b64_tr_b16 v[92:93], v17 offset:40960
    ds_read_b64_tr_b16 v[94:95], v17 offset:43008
    ds_read_b64_tr_b16 v[96:97], v20 offset:40960
    ds_read_b64_tr_b16 v[98:99], v20 offset:43008
    s_waitcnt lgkmcnt(10)
    v_mfma_f32_32x32x16_bf16 v[48:63], v[72:75], v[64:67], v[48:63]
    s_add_u32 m0, s49, 131072
    s_nop 0
    buffer_load_dwordx4 v10, s[16:19], s47 offen sc1 lds
    s_waitcnt lgkmcnt(7)
    v_mfma_f32_32x32x16_bf16 v[32:47], v[80:83], v[76:79], v[32:47]
    ds_read_b128 v[100:103], v14 offset:35840
    ds_read_b64_tr_b16 v[104:105], v17 offset:45056
    ds_read_b64_tr_b16 v[106:107], v17 offset:47104
    ds_read_b64_tr_b16 v[108:109], v20 offset:45056
    ds_read_b64_tr_b16 v[110:111], v20 offset:47104
    s_waitcnt lgkmcnt(10)
    v_mfma_f32_32x32x16_bf16 v[48:63], v[84:87], v[76:79], v[48:63]
    buffer_load_dwordx4 v10, s[16:19], s47 offen offset:1024 sc1 lds
    s_add_u32 s47, s47, 4096
    s_waitcnt vmcnt(8)
    s_cmp_lg_u32 s3, 0
    s_cbranch_scc1 L3C_K10
    s_cmp_eq_u32 s68, s67
    s_cbranch_scc1 L3C_K10
    s_waitcnt vmcnt(4)
    v_cmp_eq_u32 vcc, s77, v25
    s_lshr_b32 s68, vcc_lo, s64
    s_and_b32 s68, s68, s65
    s_or_b32 s68, s68, s66
    s_bfe_u32 s44, s72, 0x80010
    s_bitcmp1_b32 s68, s44
    s_cbranch_scc0 L3C_S10
L3C_K10:
    s_barrier
    s_cmp_lg_u32 s65, 0x3ff
    s_cbranch_scc1 L3C_PA16
    s_cmp_lg_u32 s3, 0
    s_cbranch_scc1 L3C_PA16
    global_load_dword v25, v24, s[100:101] sc1
L3C_PA16:
    s_waitcnt lgkmcnt(7)
    v_mfma_f32_32x32x16_bf16 v[32:47], v[92:95], v[88:91], v[32:47]
    ds_read_b128 v[64:67], v15 offset:0
    ds_read_b64_tr_b16 v[68:69], v18 offset:0
    ds_read_b64_tr_b16 v[70:71], v18 offset:2048
    ds_read_b64_tr_b16 v[72:73], v21 offset:0
    ds_read_b64_tr_b16 v[74:75], v21 offset:2048
    s_waitcnt lgkmcnt(10)
    v_mfma_f32_32x32x16_bf16 v[48:63], v[96:99], v[88:91], v[48:63]
    s_bfe_u32 s44, s72, 0x80010
    s_lshl_b32 s48, s44, 17
    s_add_u32 s48, s48, s61
    s_lshl_b32 s47, s44, 13
    s_add_u32 s47, s47, s62
    s_cmp_eq_u32 s44, 15
    s_cselect_b32 s48, 0x7f000000, s48
    s_cselect_b32 s47, 0x7f000000, s47
    s_add_u32 m0, s50, 0
    s_nop 0
    buffer_load_dwordx4 v11, s[20:23], s48 offen lds
    s_waitcnt lgkmcnt(7)
    v_mfma_f32_32x32x16_bf16 v[32:47], v[104:107], v[100:103], v[32:47]
    ds_read_b128 v[76:79], v15 offset:1024
    ds_read_b64_tr_b16 v[80:81], v18 offset:4096
    ds_read_b64_tr_b16 v[82:83], v18 offset:6144
    ds_read_b64_tr_b16 v[84:85], v21 offset:4096
    ds_read_b64_tr_b16 v[86:87], v21 offset:6144
    s_waitcnt lgkmcnt(10)
    v_mfma_f32_32x32x16_bf16 v[48:63], v[108:111], v[100:103], v[48:63]
    buffer_load_dwordx4 v12, s[20:23], s48 offen offset:1024 lds
    s_add_u32 s48, s48, 65536
    s_waitcnt lgkmcnt(7)
    v_mfma_f32_32x32x16_bf16 v[32:47], v[68:71], v[64:67], v[32:47]
    ds_read_b128 v[88:91], v15 offset:2048
    ds_read_b64_tr_b16 v[92:93], v18 offset:8192
    ds_read_b64_tr_b16 v[94:95], v18 offset:10240
    ds_read_b64_tr_b16 v[96:97], v21 offset:8192
    ds_read_b64_tr_b16 v[98:99], v21 offset:10240
    s_waitcnt lgkmcnt(10)
    v_mfma_f32_32x32x16_bf16 v[48:63], v[72:75], v[64:67], v[48:63]
    s_add_u32 m0, s49, 0
    s_nop 0
    buffer_load_dwordx4 v10, s[16:19], s47 offen sc1 lds
    s_waitcnt lgkmcnt(7)
    v_mfma_f32_32x32x16_bf16 v[32:47], v[80:83], v[76:79], v[32:47]
    ds_read_b128 v[100:103], v15 offset:3072
    ds_read_b64_tr_b16 v[104:105], v18 offset:12288
    ds_read_b64_tr_b16 v[106:107], v18 offset:14336
    ds_read_b64_tr_b16 v[108:109], v21 offset:12288
    ds_read_b64_tr_b16 v[110:111], v21 offset:14336
    s_waitcnt lgkmcnt(10)
    v_mfma_f32_32x32x16_bf16 v[48:63], v[84:87], v[76:79], v[48:63]
    buffer_load_dwordx4 v10, s[16:19], s47 offen offset:1024 sc1 lds
    s_add_u32 s47, s47, 4096
    s_waitcnt vmcnt(8)
    s_barrier
    s_cmp_lg_u32 s3, 0
    s_cbranch_scc1 L3C_P10
    s_cmp_eq_u32 s68, s67
    s_cbranch_scc1 L3C_P10
    global_load_dword v25, v24, s[100:101] sc1
L3C_P10:
    s_waitcnt lgkmcnt(7)
    v_mfma_f32_32x32x16_bf16 v[32:47], v[92:95], v[88:91], v[32:47]
    ds_read_b128 v[64:67], v15 offset:32768
    ds_read_b64_tr_b16 v[68:69], v18 offset:32768
    ds_read_b64_tr_b16 v[70:71], v18 offset:34816
    ds_read_b64_tr_b16 v[72:73], v21 offset:32768
    ds_read_b64_tr_b16 v[74:75], v21 offset:34816
    s_waitcnt lgkmcnt(10)
    v_mfma_f32_32x32x16_bf16 v[48:63], v[96:99], v[88:91], v[48:63]
    s_add_u32 s47, s47, s63
    s_add_u32 m0, s50, 32768
    s_nop 0
    buffer_load_dwordx4 v11, s[20:23], s48 offen lds
    s_waitcnt lgkmcnt(7)
    v_mfma_f32_32x32x16_bf16 v[32:47], v[104:107], v[100:103], v[32:47]
    ds_read_b128 v[76:79], v15 offset:33792
    ds_read_b64_tr_b16 v[80:81], v18 offset:36864
    ds_read_b64_tr_b16 v[82:83], v18 offset:38912
    ds_read_b64_tr_b16 v[84:85], v21 offset:36864
    ds_read_b64_tr_b16 v[86:87], v21 offset:38912
    s_waitcnt lgkmcnt(10)
    v_mfma_f32_32x32x16_bf16 v[48:63], v[108:111], v[100:103], v[48:63]
    buffer_load_dwordx4 v12, s[20:23], s48 offen offset:1024 lds
    s_add_u32 s48, s48, 65536
    s_waitcnt lgkmcnt(7)
    v_mfma_f32_32x32x16_bf16 v[32:47], v[68:71], v[64:67], v[32:47]
    ds_read_b128 v[88:91], v15 offset:34816
    ds_read_b64_tr_b16 v[92:93], v18 offset:40960
    ds_read_b64_tr_b16 v[94:95], v18 offset:43008
    ds_read_b64_tr_b16 v[96:97], v21 offset:40960
    ds_read_b64_tr_b16 v[98:99], v21 offset:43008
    s_waitcnt lgkmcnt(10)
    v_mfma_f32_32x32x16_bf16 v[48:63], v[72:75], v[64:67], v[48:63]
    s_add_u32 m0, s49, 32768
    s_nop 0
    buffer_load_dwordx4 v10, s[16:19], s47 offen sc1 lds
    s_waitcnt lgkmcnt(7)
    v_mfma_f32_32x32x16_bf16 v[32:47], v[80:83], v[76:79], v[32:47]
    ds_read_b128 v[100:103], v15 offset:35840
    ds_read_b64_tr_b16 v[104:105], v18 offset:45056
    ds_read_b64_tr_b16 v[106:107], v18 offset:47104
    ds_read_b64_tr_b16 v[108:109], v21 offset:45056
    ds_read_b64_tr_b16 v[110:111], v21 offset:47104
    s_waitcnt lgkmcnt(10)
    v_mfma_f32_32x32x16_bf16 v[48:63], v[84:87], v[76:79], v[48:63]
    buffer_load_dwordx4 v10, s[16:19], s47 offen offset:1024 sc1 lds
    s_add_u32 s47, s47, 4096
    s_waitcnt vmcnt(8)
    s_cmp_lg_u32 s3, 0
    s_cbranch_scc1 L3C_K11
    s_cmp_eq_u32 s68, s67
    s_cbranch_scc1 L3C_K11
    s_waitcnt vmcnt(4)
    v_cmp_eq_u32 vcc, s77, v25
    s_lshr_b32 s68, vcc_lo, s64
    s_and_b32 s68, s68, s65
    s_or_b32 s68, s68, s66
    s_bfe_u32 s44, s72, 0x80018
    s_bitcmp1_b32 s68, s44
    s_cbranch_scc0 L3C_S11
L3C_K11:
    s_cmp_lg_u32 s65, 0x3ff
    s_cbranch_scc1 L3C_AOK18
    s_cmp_lg_u32 s3, 0
    s_cbranch_scc1 L3C_AOK18
    s_waitcnt vmcnt(4)
    v_cmp_eq_u32 vcc, s77, v25
    s_cmp_lg_u32 vcc_lo, -1
    s_cbranch_scc1 L3C_ASLOW18
L3C_AOK18:
    s_barrier
    s_waitcnt lgkmcnt(7)
    v_mfma_f32_32x32x16_bf16 v[32:47], v[92:95], v[88:91], v[32:47]
    ds_read_b128 v[64:67], v16 offset:0
    ds_read_b64_tr_b16 v[68:69], v19 offset:0
    ds_read_b64_tr_b16 v[70:71], v19 offset:2048
    ds_read_b64_tr_b16 v[72:73], v22 offset:0
    ds_read_b64_tr_b16 v[74:75], v22 offset:2048
    s_waitcnt lgkmcnt(10)
    v_mfma_f32_32x32x16_bf16 v[48:63], v[96:99], v[88:91], v[48:63]
    s_bfe_u32 s44, s72, 0x80018
    s_lshl_b32 s48, s44, 17
    s_add_u32 s48, s48, s61
    s_lshl_b32 s47, s44, 13
    s_add_u32 s47, s47, s62
    s_cmp_eq_u32 s44, 15
    s_cselect_b32 s48, 0x7f000000, s48
    s_cselect_b32 s47, 0x7f000000, s47
    s_add_u32 m0, s50, 65536
    s_nop 0
    buffer_load_dwordx4 v11, s[20:23], s48 offen lds
    s_waitcnt lgkmcnt(7)
    v_mfma_f32_32x32x16_bf16 v[32:47], v[104:107], v[100:103], v[32:47]
    ds_read_b128 v[76:79], v16 offset:1024
    ds_read_b64_tr_b16 v[80:81], v19 offset:4096
    ds_read_b64_tr_b16 v[82:83], v19 offset:6144
    ds_read_b64_tr_b16 v[84:85], v22 offset:4096
    ds_read_b64_tr_b16 v[86:87], v22 offset:6144
    s_waitcnt lgkmcnt(10)
    v_mfma_f32_32x32x16_bf16 v[48:63], v[108:111], v[100:103], v[48:63]
    buffer_load_dwordx4 v12, s[20:23], s48 offen offset:1024 lds
    s_add_u32 s48, s48, 65536
    s_waitcnt lgkmcnt(7)
    v_mfma_f32_32x32x16_bf16 v[32:47], v[68:71], v[64:67], v[32:47]
    ds_read_b128 v[88:91], v16 offset:2048
    ds_read_b64_tr_b16 v[92:93], v19 offset:8192
    ds_read_b64_tr_b16 v[94:95], v19 offset:10240
    ds_read_b64_tr_b16 v[96:97], v22 offset:8192
    ds_read_b64_tr_b16 v[98:99], v22 offset:10240
    s_waitcnt lgkmcnt(10)
    v_mfma_f32_32x32x16_bf16 v[48:63], v[72:75], v[64:67], v[48:63]
    s_add_u32 m0, s49, 65536
    s_nop 0
    buffer_load_dwordx4 v10, s[16:19], s47 offen sc1 lds
    s_waitcnt lgkmcnt(7)
    v_mfma_f32_32x32x16_bf16 v[32:47], v[80:83], v[76:79], v[32:47]
    ds_read_b128 v[100:103], v16 offset:3072
    ds_read_b64_tr_b16 v[104:105], v19 offset:12288
    ds_read_b64_tr_b16 v[106:107], v19 offset:14336
    ds_read_b64_tr_b16 v[108:109], v22 offset:12288
    ds_read_b64_tr_b16 v[110:111], v22 offset:14336
    s_waitcnt lgkmcnt(10)
    v_mfma_f32_32x32x16_bf16 v[48:63], v[84:87], v[76:79], v[48:63]
    buffer_load_dwordx4 v10, s[16:19], s47 offen offset:1024 sc1 lds
    s_add_u32 s47, s47, 4096
    s_waitcnt vmcnt(8)
    s_barrier
    s_waitcnt lgkmcnt(7)
    v_mfma_f32_32x32x16_bf16 v[32:47], v[92:95], v[88:91], v[32:47]
    ds_read_b128 v[64:67], v14 offset:0
    ds_read_b64_tr_b16 v[68:69], v17 offset:0
    ds_read_b64_tr_b16 v[70:71], v17 offset:2048
    ds_read_b64_tr_b16 v[72:73], v20 offset:0
    ds_read_b64_tr_b16 v[74:75], v20 offset:2048
    s_waitcnt lgkmcnt(10)
    v_mfma_f32_32x32x16_bf16 v[48:63], v[96:99], v[88:91], v[48:63]
    s_add_u32 m0, s50, 98304
    s_nop 0
    buffer_load_dwordx4 v11, s[20:23], s48 offen lds
    s_waitcnt lgkmcnt(7)
    v_mfma_f32_32x32x16_bf16 v[32:47], v[104:107], v[100:103], v[32:47]
    ds_read_b128 v[76:79], v14 offset:1024
    ds_read_b64_tr_b16 v[80:81], v17 offset:4096
    ds_read_b64_tr_b16 v[82:83], v17 offset:6144
    ds_read_b64_tr_b16 v[84:85], v20 offset:4096
    ds_read_b64_tr_b16 v[86:87], v20 offset:6144
    s_waitcnt lgkmcnt(10)
    v_mfma_f32_32x32x16_bf16 v[48:63], v[108:111], v[100:103], v[48:63]
    buffer_load_dwordx4 v12, s[20:23], s48 offen offset:1024 lds
    s_add_u32 s48, s48, 65536
    s_cmp_eq_u32 s65, 0x3ff
    s_cbranch_scc1 L3C_XS
    s_waitcnt lgkmcnt(7)
    v_mfma_f32_32x32x16_bf16 v[32:47], v[68:71], v[64:67], v[32:47]
    ds_read_b128 v[88:91], v14 offset:2048
    ds_read_b64_tr_b16 v[92:93], v17 offset:8192
    ds_read_b64_tr_b16 v[94:95], v17 offset:10240
    ds_read_b64_tr_b16 v[96:97], v20 offset:8192
    ds_read_b64_tr_b16 v[98:99], v20 offset:10240
    s_waitcnt lgkmcnt(10)
    v_mfma_f32_32x32x16_bf16 v[48:63], v[72:75], v[64:67], v[48:63]
    s_add_u32 m0, s49, 98304
    s_nop 0
    buffer_load_dwordx4 v10, s[16:19], s47 offen sc1 lds
    s_waitcnt lgkmcnt(7)
    v_mfma_f32_32x32x16_bf16 v[32:47], v[80:83], v[76:79], v[32:47]
    ds_read_b128 v[100:103], v14 offset:3072
    ds_read_b64_tr_b16 v[104:105], v17 offset:12288
    ds_read_b64_tr_b16 v[106:107], v17 offset:14336
    ds_read_b64_tr_b16 v[108:109], v20 offset:12288
    ds_read_b64_tr_b16 v[110:111], v20 offset:14336
    s_waitcnt lgkmcnt(10)
    v_mfma_f32_32x32x16_bf16 v[48:63], v[84:87], v[76:79], v[48:63]
    buffer_load_dwordx4 v10, s[16:19], s47 offen offset:1024 sc1 lds
    s_add_u32 s47, s47, 4096
    s_waitcnt vmcnt(8)
    s_barrier
    s_cmp_lg_u32 s3, 0
    s_cbranch_scc1 L3C_PA20
    global_load_dword v25, v24, s[100:101] sc1
L3C_PA20:
    s_waitcnt lgkmcnt(7)
    v_mfma_f32_32x32x16_bf16 v[32:47], v[92:95], v[88:91], v[32:47]
    ds_read_b128 v[64:67], v14 offset:32768
    ds_read_b64_tr_b16 v[68:69], v17 offset:32768
    ds_read_b64_tr_b16 v[70:71], v17 offset:34816
    ds_read_b64_tr_b16 v[72:73], v20 offset:32768
    ds_read_b64_tr_b16 v[74:75], v20 offset:34816
    s_waitcnt lgkmcnt(10)
    v_mfma_f32_32x32x16_bf16 v[48:63], v[96:99], v[88:91], v[48:63]
    s_waitcnt lgkmcnt(7)
    v_mfma_f32_32x32x16_bf16 v[32:47], v[104:107], v[100:103], v[32:47]
    ds_read_b128 v[76:79], v14 offset:33792
    ds_read_b64_tr_b16 v[80:81], v17 offset:36864
    ds_read_b64_tr_b16 v[82:83], v17 offset:38912
    ds_read_b64_tr_b16 v[84:85], v20 offset:36864
    ds_read_b64_tr_b16 v[86:87], v20 offset:38912
    s_waitcnt lgkmcnt(10)
    v_mfma_f32_32x32x16_bf16 v[48:63], v[108:111], v[100:103], v[48:63]
    s_waitcnt lgkmcnt(7)
    v_mfma_f32_32x32x16_bf16 v[32:47], v[68:71], v[64:67], v[32:47]
    ds_read_b128 v[88:91], v14 offset:34816
    ds_read_b64_tr_b16 v[92:93], v17 offset:40960
    ds_read_b64_tr_b16 v[94:95], v17 offset:43008
    ds_read_b64_tr_b16 v[96:97], v20 offset:40960
    ds_read_b64_tr_b16 v[98:99], v20 offset:43008
    s_waitcnt lgkmcnt(10)
    v_mfma_f32_32x32x16_bf16 v[48:63], v[72:75], v[64:67], v[48:63]
    s_waitcnt lgkmcnt(7)
    v_mfma_f32_32x32x16_bf16 v[32:47], v[80:83], v[76:79], v[32:47]
    ds_read_b128 v[100:103], v14 offset:35840
    ds_read_b64_tr_b16 v[104:105], v17 offset:45056
    ds_read_b64_tr_b16 v[106:107], v17 offset:47104
    ds_read_b64_tr_b16 v[108:109], v20 offset:45056
    ds_read_b64_tr_b16 v[110:111], v20 offset:47104
    s_waitcnt lgkmcnt(10)
    v_mfma_f32_32x32x16_bf16 v[48:63], v[84:87], v[76:79], v[48:63]
    s_waitcnt vmcnt(4)
    s_barrier
    s_waitcnt lgkmcnt(7)
    v_mfma_f32_32x32x16_bf16 v[32:47], v[92:95], v[88:91], v[32:47]
    ds_read_b128 v[64:67], v15 offset:0
    ds_read_b64_tr_b16 v[68:69], v18 offset:0
    ds_read_b64_tr_b16 v[70:71], v18 offset:2048
    ds_read_b64_tr_b16 v[72:73], v21 offset:0
    ds_read_b64_tr_b16 v[74:75], v21 offset:2048
    s_waitcnt lgkmcnt(10)
    v_mfma_f32_32x32x16_bf16 v[48:63], v[96:99], v[88:91], v[48:63]
    s_waitcnt lgkmcnt(7)
    v_mfma_f32_32x32x16_bf16 v[32:47], v[104:107], v[100:103], v[32:47]
    ds_read_b128 v[76:79], v15 offset:1024
    ds_read_b64_tr_b16 v[80:81], v18 offset:4096
    ds_read_b64_tr_b16 v[82:83], v18 offset:6144
    ds_read_b64_tr_b16 v[84:85], v21 offset:4096
    ds_read_b64_tr_b16 v[86:87], v21 offset:6144
    s_waitcnt lgkmcnt(10)
    v_mfma_f32_32x32x16_bf16 v[48:63], v[108:111], v[100:103], v[48:63]
    s_waitcnt lgkmcnt(7)
    v_mfma_f32_32x32x16_bf16 v[32:47], v[68:71], v[64:67], v[32:47]
    ds_read_b128 v[88:91], v15 offset:2048
    ds_read_b64_tr_b16 v[92:93], v18 offset:8192
    ds_read_b64_tr_b16 v[94:95], v18 offset:10240
    ds_read_b64_tr_b16 v[96:97], v21 offset:8192
    ds_read_b64_tr_b16 v[98:99], v21 offset:10240
    s_waitcnt lgkmcnt(10)
    v_mfma_f32_32x32x16_bf16 v[48:63], v[72:75], v[64:67], v[48:63]
    s_waitcnt lgkmcnt(7)
    v_mfma_f32_32x32x16_bf16 v[32:47], v[80:83], v[76:79], v[32:47]
    ds_read_b128 v[100:103], v15 offset:3072
    ds_read_b64_tr_b16 v[104:105], v18 offset:12288
    ds_read_b64_tr_b16 v[106:107], v18 offset:14336
    ds_read_b64_tr_b16 v[108:109], v21 offset:12288
    ds_read_b64_tr_b16 v[110:111], v21 offset:14336
    s_waitcnt lgkmcnt(10)
    v_mfma_f32_32x32x16_bf16 v[48:63], v[84:87], v[76:79], v[48:63]
    s_waitcnt vmcnt(0)
    s_cmp_lg_u32 s3, 0
    s_cbranch_scc1 L3C_AOK22
    s_waitcnt vmcnt(0)
    v_cmp_eq_u32 vcc, s77, v25
    s_cmp_lg_u32 vcc_lo, -1
    s_cbranch_scc1 L3C_ASLOW22
L3C_AOK22:
    s_barrier
    s_waitcnt lgkmcnt(7)
    v_mfma_f32_32x32x16_bf16 v[32:47], v[92:95], v[88:91], v[32:47]
    ds_read_b128 v[64:67], v15 offset:32768
    ds_read_b64_tr_b16 v[68:69], v18 offset:32768
    ds_read_b64_tr_b16 v[70:71], v18 offset:34816
    ds_read_b64_tr_b16 v[72:73], v21 offset:32768
    ds_read_b64_tr_b16 v[74:75], v21 offset:34816
    s_waitcnt lgkmcnt(10)
    v_mfma_f32_32x32x16_bf16 v[48:63], v[96:99], v[88:91], v[48:63]
    s_waitcnt lgkmcnt(7)
    v_mfma_f32_32x32x16_bf16 v[32:47], v[104:107], v[100:103], v[32:47]
    ds_read_b128 v[76:79], v15 offset:33792
    ds_read_b64_tr_b16 v[80:81], v18 offset:36864
    ds_read_b64_tr_b16 v[82:83], v18 offset:38912
    ds_read_b64_tr_b16 v[84:85], v21 offset:36864
    ds_read_b64_tr_b16 v[86:87], v21 offset:38912
    s_waitcnt lgkmcnt(10)
    v_mfma_f32_32x32x16_bf16 v[48:63], v[108:111], v[100:103], v[48:63]
    s_waitcnt lgkmcnt(7)
    v_mfma_f32_32x32x16_bf16 v[32:47], v[68:71], v[64:67], v[32:47]
    ds_read_b128 v[88:91], v15 offset:34816
    ds_read_b64_tr_b16 v[92:93], v18 offset:40960
    ds_read_b64_tr_b16 v[94:95], v18 offset:43008
    ds_read_b64_tr_b16 v[96:97], v21 offset:40960
    ds_read_b64_tr_b16 v[98:99], v21 offset:43008
    s_waitcnt lgkmcnt(10)
    v_mfma_f32_32x32x16_bf16 v[48:63], v[72:75], v[64:67], v[48:63]
    s_waitcnt lgkmcnt(7)
    v_mfma_f32_32x32x16_bf16 v[32:47], v[80:83], v[76:79], v[32:47]
    ds_read_b128 v[100:103], v15 offset:35840
    ds_read_b64_tr_b16 v[104:105], v18 offset:45056
    ds_read_b64_tr_b16 v[106:107], v18 offset:47104
    ds_read_b64_tr_b16 v[108:109], v21 offset:45056
    ds_read_b64_tr_b16 v[110:111], v21 offset:47104
    s_waitcnt lgkmcnt(10)
    v_mfma_f32_32x32x16_bf16 v[48:63], v[84:87], v[76:79], v[48:63]
    s_waitcnt lgkmcnt(7)
    v_mfma_f32_32x32x16_bf16 v[32:47], v[92:95], v[88:91], v[32:47]
    s_waitcnt lgkmcnt(5)
    v_mfma_f32_32x32x16_bf16 v[48:63], v[96:99], v[88:91], v[48:63]
    s_waitcnt lgkmcnt(2)
    v_mfma_f32_32x32x16_bf16 v[32:47], v[104:107], v[100:103], v[32:47]
    s_waitcnt lgkmcnt(0)
    v_mfma_f32_32x32x16_bf16 v[48:63], v[108:111], v[100:103], v[48:63]
L3C_XE:
    s_and_b32 s44, s3, 3
    s_cmp_eq_u32 s44, s53
    s_cbranch_scc1 L3C_OWN
    s_nop 6
    v_cvt_pk_bf16_f32 v88, v32, v33
    v_cvt_pk_bf16_f32 v89, v34, v35
    v_cvt_pk_bf16_f32 v90, v36, v37
    v_cvt_pk_bf16_f32 v91, v38, v39
    buffer_store_dwordx4 v[88:91], v10, s[24:27], s55 offen offset:0 sc1
    v_cvt_pk_bf16_f32 v92, v40, v41
    v_cvt_pk_bf16_f32 v93, v42, v43
    v_cvt_pk_bf16_f32 v94, v44, v45
    v_cvt_pk_bf16_f32 v95, v46, v47
    buffer_store_dwordx4 v[92:95], v10, s[24:27], s55 offen offset:1024 sc1
    v_cvt_pk_bf16_f32 v96, v48, v49
    v_cvt_pk_bf16_f32 v97, v50, v51
    v_cvt_pk_bf16_f32 v98, v52, v53
    v_cvt_pk_bf16_f32 v99, v54, v55
    buffer_store_dwordx4 v[96:99], v10, s[24:27], s55 offen offset:2048 sc1
    v_cvt_pk_bf16_f32 v100, v56, v57
    v_cvt_pk_bf16_f32 v101, v58, v59
    v_cvt_pk_bf16_f32 v102, v60, v61
    v_cvt_pk_bf16_f32 v103, v62, v63
    buffer_store_dwordx4 v[100:103], v10, s[24:27], s55 offen offset:3072 sc1
    s_branch L3C_PUB
L3C_OWN:
    s_nop 11
    s_lshr_b32 s45, s3, 2
    s_lshl_b32 s45, s45, 13
    s_add_u32 s45, s45, 131072
    v_add_u32 v2, s45, v10
    ds_write_b128 v2, v[32:35] offset:0
    ds_write_b128 v2, v[36:39] offset:1024
    ds_write_b128 v2, v[40:43] offset:2048
    ds_write_b128 v2, v[44:47] offset:3072
    ds_write_b128 v2, v[48:51] offset:4096
    ds_write_b128 v2, v[52:55] offset:5120
    ds_write_b128 v2, v[56:59] offset:6144
    ds_write_b128 v2, v[60:63] offset:7168
L3C_PUB:
    s_waitcnt lgkmcnt(0)
    s_barrier
    s_lshl_b32 s45, s3, 11
    s_add_u32 s45, s45, 131072
    v_add_u32 v2, s45, v10
    ds_read_b128 v[152:155], v2
    ds_read_b128 v[156:159], v2 offset:1024
    s_mov_b32 s45, 100000
    v_lshlrev_b32 v64, 16, v112
    v_and_b32 v65, 0xffff0000, v112
    v_lshlrev_b32 v66, 16, v113
    v_and_b32 v67, 0xffff0000, v113
    v_lshlrev_b32 v68, 16, v114
    v_and_b32 v69, 0xffff0000, v114
    v_lshlrev_b32 v70, 16, v115
    v_and_b32 v71, 0xffff0000, v115
    v_lshlrev_b32 v72, 16, v116
    v_and_b32 v73, 0xffff0000, v116
    v_lshlrev_b32 v74, 16, v117
    v_and_b32 v75, 0xffff0000, v117
    v_lshlrev_b32 v76, 16, v118
    v_and_b32 v77, 0xffff0000, v118
    v_lshlrev_b32 v78, 16, v119
    v_and_b32 v79, 0xffff0000, v119
L3C_POLL:
    buffer_load_dwordx4 v[88:91], v10, s[24:27], s58 offen sc1
    buffer_load_dwordx4 v[92:95], v10, s[24:27], s59 offen sc1
    buffer_load_dwordx4 v[96:99], v10, s[24:27], s60 offen sc1
    s_waitcnt vmcnt(0)
    v_max3_u32 v2, v88, v89, v90
    v_max3_u32 v2, v2, v91, v92
    v_max3_u32 v2, v2, v93, v94
    v_max3_u32 v2, v2, v95, v96
    v_max3_u32 v2, v2, v97, v98
    v_max_u32 v2, v2, v99
    v_cmp_eq_u32 vcc, -1, v2
    s_cbranch_vccz L3C_GOT
    s_sleep 2
    s_sub_u32 s45, s45, 1
    s_cmp_lg_u32 s45, 0
    s_cbranch_scc1 L3C_POLL
L3C_GOT:
    v_lshlrev_b32 v128, 16, v88
    v_and_b32 v129, 0xffff0000, v88
    v_lshlrev_b32 v130, 16, v89
    v_and_b32 v131, 0xffff0000, v89
    v_lshlrev_b32 v132, 16, v90
    v_and_b32 v133, 0xffff0000, v90
    v_lshlrev_b32 v134, 16, v91
    v_and_b32 v135, 0xffff0000, v91
    v_lshlrev_b32 v136, 16, v92
    v_and_b32 v137, 0xffff0000, v92
    v_lshlrev_b32 v138, 16, v93
    v_and_b32 v139, 0xffff0000, v93
    v_lshlrev_b32 v140, 16, v94
    v_and_b32 v141, 0xffff0000, v94
    v_lshlrev_b32 v142, 16, v95
    v_and_b32 v143, 0xffff0000, v95
    v_lshlrev_b32 v144, 16, v96
    v_and_b32 v145, 0xffff0000, v96
    v_lshlrev_b32 v146, 16, v97
    v_and_b32 v147, 0xffff0000, v97
    v_lshlrev_b32 v148, 16, v98
    v_and_b32 v149, 0xffff0000, v98
    v_lshlrev_b32 v150, 16, v99
    v_and_b32 v151, 0xffff0000, v99
L3C_UNP:
    s_waitcnt lgkmcnt(0)
    s_cmp_eq_u32 s53, 3
    s_cbranch_scc1 L3C_SUM
    v_swap_b32 v144, v152
    v_swap_b32 v145, v153
    v_swap_b32 v146, v154
    v_swap_b32 v147, v155
    v_swap_b32 v148, v156
    v_swap_b32 v149, v157
    v_swap_b32 v150, v158
    v_swap_b32 v151, v159
L3C_SUM:
    v_add_f32 v128, v128, v136
    v_add_f32 v129, v129, v137
    v_add_f32 v130, v130, v138
    v_add_f32 v131, v131, v139
    v_add_f32 v132, v132, v140
    v_add_f32 v133, v133, v141
    v_add_f32 v134, v134, v142
    v_add_f32 v135, v135, v143
    v_add_f32 v128, v128, v144
    v_add_f32 v129, v129, v145
    v_add_f32 v130, v130, v146
    v_add_f32 v131, v131, v147
    v_add_f32 v132, v132, v148
    v_add_f32 v133, v133, v149
    v_add_f32 v134, v134, v150
    v_add_f32 v135, v135, v151
    v_cvt_pk_bf16_f32 v80, v128, v129
    v_cvt_pk_bf16_f32 v81, v130, v131
    v_cvt_pk_bf16_f32 v82, v132, v133
    v_cvt_pk_bf16_f32 v83, v134, v135
    v_lshlrev_b32 v128, 16, v80
    v_and_b32 v129, 0xffff0000, v80
    v_lshlrev_b32 v130, 16, v81
    v_and_b32 v131, 0xffff0000, v81
    v_lshlrev_b32 v132, 16, v82
    v_and_b32 v133, 0xffff0000, v82
    v_lshlrev_b32 v134, 16, v83
    v_and_b32 v135, 0xffff0000, v83
    v_cvt_pk_bf16_f32 v80, v152, v153
    v_cvt_pk_bf16_f32 v81, v154, v155
    v_cvt_pk_bf16_f32 v82, v156, v157
    v_cvt_pk_bf16_f32 v83, v158, v159
    v_lshlrev_b32 v152, 16, v80
    v_and_b32 v153, 0xffff0000, v80
    v_lshlrev_b32 v154, 16, v81
    v_and_b32 v155, 0xffff0000, v81
    v_lshlrev_b32 v156, 16, v82
    v_and_b32 v157, 0xffff0000, v82
    v_lshlrev_b32 v158, 16, v83
    v_and_b32 v159, 0xffff0000, v83
    v_add_f32 v152, v152, v72
    v_add_f32 v153, v153, v73
    v_add_f32 v154, v154, v74
    v_add_f32 v155, v155, v75
    v_add_f32 v156, v156, v76
    v_add_f32 v157, v157, v77
    v_add_f32 v158, v158, v78
    v_add_f32 v159, v159, v79
    v_cvt_pk_bf16_f32 v80, v152, v153
    v_cvt_pk_bf16_f32 v81, v154, v155
    v_cvt_pk_bf16_f32 v82, v156, v157
    v_cvt_pk_bf16_f32 v83, v158, v159
    v_lshlrev_b32 v152, 16, v80
    v_and_b32 v153, 0xffff0000, v80
    v_lshlrev_b32 v154, 16, v81
    v_and_b32 v155, 0xffff0000, v81
    v_lshlrev_b32 v156, 16, v82
    v_and_b32 v157, 0xffff0000, v82
    v_lshlrev_b32 v158, 16, v83
    v_and_b32 v159, 0xffff0000, v83
    s_mov_b32 s44, 0xbfb8aa3b
    v_mul_f32 v72, s44, v152
    v_mul_f32 v73, s44, v153
    v_mul_f32 v74, s44, v154
    v_mul_f32 v75, s44, v155
    v_mul_f32 v76, s44, v156
    v_mul_f32 v77, s44, v157
    v_mul_f32 v78, s44, v158
    v_mul_f32 v79, s44, v159
    v_exp_f32 v72, v72
    v_exp_f32 v73, v73
    v_exp_f32 v74, v74
    v_exp_f32 v75, v75
    v_exp_f32 v76, v76
    v_exp_f32 v77, v77
    v_exp_f32 v78, v78
    v_exp_f32 v79, v79
    v_add_f32 v72, 1.0, v72
    v_add_f32 v73, 1.0, v73
    v_add_f32 v74, 1.0, v74
    v_add_f32 v75, 1.0, v75
    v_add_f32 v76, 1.0, v76
    v_add_f32 v77, 1.0, v77
    v_add_f32 v78, 1.0, v78
    v_add_f32 v79, 1.0, v79
    v_rcp_f32 v72, v72
    v_rcp_f32 v73, v73
    v_rcp_f32 v74, v74
    v_rcp_f32 v75, v75
    v_rcp_f32 v76, v76
    v_rcp_f32 v77, v77
    v_rcp_f32 v78, v78
    v_rcp_f32 v79, v79
    v_mul_f32 v152, v152, v72
    v_mul_f32 v153, v153, v73
    v_mul_f32 v154, v154, v74
    v_mul_f32 v155, v155, v75
    v_mul_f32 v156, v156, v76
    v_mul_f32 v157, v157, v77
    v_mul_f32 v158, v158, v78
    v_mul_f32 v159, v159, v79
    v_cvt_pk_bf16_f32 v80, v152, v153
    v_cvt_pk_bf16_f32 v81, v154, v155
    v_cvt_pk_bf16_f32 v82, v156, v157
    v_cvt_pk_bf16_f32 v83, v158, v159
    v_lshlrev_b32 v152, 16, v80
    v_and_b32 v153, 0xffff0000, v80
    v_lshlrev_b32 v154, 16, v81
    v_and_b32 v155, 0xffff0000, v81
    v_lshlrev_b32 v156, 16, v82
    v_and_b32 v157, 0xffff0000, v82
    v_lshlrev_b32 v158, 16, v83
    v_and_b32 v159, 0xffff0000, v83
    v_mul_f32 v128, v128, v152
    v_mul_f32 v129, v129, v153
    v_mul_f32 v130, v130, v154
    v_mul_f32 v131, v131, v155
    v_mul_f32 v132, v132, v156
    v_mul_f32 v133, v133, v157
    v_mul_f32 v134, v134, v158
    v_mul_f32 v135, v135, v159
    v_cvt_pk_bf16_f32 v80, v128, v129
    v_cvt_pk_bf16_f32 v81, v130, v131
    v_cvt_pk_bf16_f32 v82, v132, v133
    v_cvt_pk_bf16_f32 v83, v134, v135
    v_lshlrev_b32 v128, 16, v80
    v_and_b32 v129, 0xffff0000, v80
    v_lshlrev_b32 v130, 16, v81
    v_and_b32 v131, 0xffff0000, v81
    v_lshlrev_b32 v132, 16, v82
    v_and_b32 v133, 0xffff0000, v82
    v_lshlrev_b32 v134, 16, v83
    v_and_b32 v135, 0xffff0000, v83
    v_add_f32 v128, v128, v64
    v_add_f32 v129, v129, v65
    v_add_f32 v130, v130, v66
    v_add_f32 v131, v131, v67
    v_add_f32 v132, v132, v68
    v_add_f32 v133, v133, v69
    v_add_f32 v134, v134, v70
    v_add_f32 v135, v135, v71
    v_cvt_pk_bf16_f32 v80, v128, v129
    v_cvt_pk_bf16_f32 v81, v130, v131
    v_cvt_pk_bf16_f32 v82, v132, v133
    v_cvt_pk_bf16_f32 v83, v134, v135
    buffer_store_dwordx2 v[80:81], v120, s[36:39], 0 offen
    buffer_store_dwordx2 v[82:83], v120, s[36:39], 0 offen offset:16
L3C_EXIT:
    s_endpgm
L3C_S2:
    s_mov_b32 s45, 100000
L3C_L2:
    global_load_dword v25, v24, s[100:101] sc1
    s_waitcnt vmcnt(0)
    v_cmp_eq_u32 vcc, s77, v25
    s_lshr_b32 s68, vcc_lo, s64
    s_and_b32 s68, s68, s65
    s_or_b32 s68, s68, s66
    s_bitcmp1_b32 s68, s44
    s_cbranch_scc1 L3C_K2
    s_sub_u32 s45, s45, 1
    s_cmp_lg_u32 s45, 0
    s_cbranch_scc1 L3C_L2
    s_branch L3C_K2
L3C_S3:
    s_mov_b32 s45, 100000
L3C_L3:
    global_load_dword v25, v24, s[100:101] sc1
    s_waitcnt vmcnt(0)
    v_cmp_eq_u32 vcc, s77, v25
    s_lshr_b32 s68, vcc_lo, s64
    s_and_b32 s68, s68, s65
    s_or_b32 s68, s68, s66
    s_bitcmp1_b32 s68, s44
    s_cbranch_scc1 L3C_K3
    s_sub_u32 s45, s45, 1
    s_cmp_lg_u32 s45, 0
    s_cbranch_scc1 L3C_L3
    s_branch L3C_K3
L3C_S4:
    s_mov_b32 s45, 100000
L3C_L4:
    global_load_dword v25, v24, s[100:101] sc1
    s_waitcnt vmcnt(0)
    v_cmp_eq_u32 vcc, s77, v25
    s_lshr_b32 s68, vcc_lo, s64
    s_and_b32 s68, s68, s65
    s_or_b32 s68, s68, s66
    s_bitcmp1_b32 s68, s44
    s_cbranch_scc1 L3C_K4
    s_sub_u32 s45, s45, 1
    s_cmp_lg_u32 s45, 0
    s_cbranch_scc1 L3C_L4
    s_branch L3C_K4
L3C_S5:
    s_mov_b32 s45, 100000
L3C_L5:
    global_load_dword v25, v24, s[100:101] sc1
    s_waitcnt vmcnt(0)
    v_cmp_eq_u32 vcc, s77, v25
    s_lshr_b32 s68, vcc_lo, s64
    s_and_b32 s68, s68, s65
    s_or_b32 s68, s68, s66
    s_bitcmp1_b32 s68, s44
    s_cbranch_scc1 L3C_K5
    s_sub_u32 s45, s45, 1
    s_cmp_lg_u32 s45, 0
    s_cbranch_scc1 L3C_L5
    s_branch L3C_K5
L3C_S6:
    s_mov_b32 s45, 100000
L3C_L6:
    global_load_dword v25, v24, s[100:101] sc1
    s_waitcnt vmcnt(0)
    v_cmp_eq_u32 vcc, s77, v25
    s_lshr_b32 s68, vcc_lo, s64
    s_and_b32 s68, s68, s65
    s_or_b32 s68, s68, s66
    s_bitcmp1_b32 s68, s44
    s_cbranch_scc1 L3C_K6
    s_sub_u32 s45, s45, 1
    s_cmp_lg_u32 s45, 0
    s_cbranch_scc1 L3C_L6
    s_branch L3C_K6
L3C_S7:
    s_mov_b32 s45, 100000
L3C_L7:
    global_load_dword v25, v24, s[100:101] sc1
    s_waitcnt vmcnt(0)
    v_cmp_eq_u32 vcc, s77, v25
    s_lshr_b32 s68, vcc_lo, s64
    s_and_b32 s68, s68, s65
    s_or_b32 s68, s68, s66
    s_bitcmp1_b32 s68, s44
    s_cbranch_scc1 L3C_K7
    s_sub_u32 s45, s45, 1
    s_cmp_lg_u32 s45, 0
    s_cbranch_scc1 L3C_L7
    s_branch L3C_K7
L3C_S8:
    s_mov_b32 s45, 100000
L3C_L8:
    global_load_dword v25, v24, s[100:101] sc1
    s_waitcnt vmcnt(0)
    v_cmp_eq_u32 vcc, s77, v25
    s_lshr_b32 s68, vcc_lo, s64
    s_and_b32 s68, s68, s65
    s_or_b32 s68, s68, s66
    s_bitcmp1_b32 s68, s44
    s_cbranch_scc1 L3C_K8
    s_sub_u32 s45, s45, 1
    s_cmp_lg_u32 s45, 0
    s_cbranch_scc1 L3C_L8
    s_branch L3C_K8
L3C_S9:
    s_mov_b32 s45, 100000
L3C_L9:
    global_load_dword v25, v24, s[100:101] sc1
    s_waitcnt vmcnt(0)
    v_cmp_eq_u32 vcc, s77, v25
    s_lshr_b32 s68, vcc_lo, s64
    s_and_b32 s68, s68, s65
    s_or_b32 s68, s68, s66
    s_bitcmp1_b32 s68, s44
    s_cbranch_scc1 L3C_K9
    s_sub_u32 s45, s45, 1
    s_cmp_lg_u32 s45, 0
    s_cbranch_scc1 L3C_L9
    s_branch L3C_K9
L3C_S10:
    s_mov_b32 s45, 100000
L3C_L10:
    global_load_dword v25, v24, s[100:101] sc1
    s_waitcnt vmcnt(0)
    v_cmp_eq_u32 vcc, s77, v25
    s_lshr_b32 s68, vcc_lo, s64
    s_and_b32 s68, s68, s65
    s_or_b32 s68, s68, s66
    s_bitcmp1_b32 s68, s44
    s_cbranch_scc1 L3C_K10
    s_sub_u32 s45, s45, 1
    s_cmp_lg_u32 s45, 0
    s_cbranch_scc1 L3C_L10
    s_branch L3C_K10
L3C_S11:
    s_mov_b32 s45, 100000
L3C_L11:
    global_load_dword v25, v24, s[100:101] sc1
    s_waitcnt vmcnt(0)
    v_cmp_eq_u32 vcc, s77, v25
    s_lshr_b32 s68, vcc_lo, s64
    s_and_b32 s68, s68, s65
    s_or_b32 s68, s68, s66
    s_bitcmp1_b32 s68, s44
    s_cbranch_scc1 L3C_K11
    s_sub_u32 s45, s45, 1
    s_cmp_lg_u32 s45, 0
    s_cbranch_scc1 L3C_L11
    s_branch L3C_K11
L3C_ASLOW18:
    s_mov_b32 s45, 100000
L3C_AL18:
    global_load_dword v25, v24, s[100:101] sc1
    s_waitcnt vmcnt(0)
    v_cmp_eq_u32 vcc, s77, v25
    s_cmp_eq_u32 vcc_lo, -1
    s_cbranch_scc1 L3C_AOK18
    s_sub_u32 s45, s45, 1
    s_cmp_lg_u32 s45, 0
    s_cbranch_scc1 L3C_AL18
    s_branch L3C_AOK18
L3C_XS:
    s_waitcnt vmcnt(0) lgkmcnt(0)
    s_barrier
    s_nop 15
    s_branch L3C_XE
L3C_ASLOW22:
    s_mov_b32 s45, 100000
L3C_AL22:
    global_load_dword v25, v24, s[100:101] sc1
    s_waitcnt vmcnt(0)
    v_cmp_eq_u32 vcc, s77, v25
    s_cmp_eq_u32 vcc_lo, -1
    s_cbranch_scc1 L3C_AOK22
    s_sub_u32 s45, s45, 1
    s_cmp_lg_u32 s45, 0
    s_cbranch_scc1 L3C_AL22
    s_branch L3C_AOK22
F_EXIT:
    s_endpgm
.section .rodata,"a"
.p2align 6
.amdhsa_kernel kvattn_kernel
  .amdhsa_next_free_vgpr 256
  .amdhsa_next_free_sgpr 102
  .amdhsa_accum_offset 256
  .amdhsa_group_segment_fixed_size 0
  .amdhsa_kernarg_size 112
  .amdhsa_user_sgpr_count 2
  .amdhsa_user_sgpr_kernarg_segment_ptr 1
  .amdhsa_system_sgpr_workgroup_id_x 1
.end_amdhsa_kernel
```
